```python
import torch

def _softmax(x, axis=-1):
    return torch.softmax(x, dim=axis)
def _gelu(x):
    return torch.nn.functional.gelu(x, approximate="tanh")
def _silu(x):
    return torch.nn.functional.silu(x)
def _sigmoid(x):
    return torch.sigmoid(x)
def _layernorm(x, axis=-1, eps=1e-5):
    m = x.mean(dim=axis, keepdim=True)
    v = x.var(dim=axis, keepdim=True, unbiased=False)
    return (x - m) / torch.sqrt(v + eps)
def _scatter_add(tgt, idx, src, axis=0):
    return tgt.clone().index_add_(axis, idx, src)
def _segment_sum(src, seg, n):
    out = torch.zeros((n,) + src.shape[1:], dtype=src.dtype)
    return out.index_add_(0, seg, src)
def _pad(x, pw):
    flat = tuple(v for pair in reversed(pw) for v in pair)
    return torch.nn.functional.pad(x, flat)

kernel_name = 'standalone__depthwise_separable__vision'

def setup_inputs():

    _w = (lambda a: (lambda t: t.to(torch.bfloat16) if t.is_floating_point() else t)(torch.as_tensor(a)))
    H = W = 384
    C = 384
    k = 1
    return {
        "x": _w((lambda *s: torch.randn(*s, dtype=torch.bfloat16) * 0.05)(1, H, W, C)),
        "dw": _w((lambda *s: torch.randn(*s, dtype=torch.bfloat16) * 0.05)(k, k, C)),
        "pw": _w((lambda *s: torch.randn(*s, dtype=torch.bfloat16) * 0.05)(C, C)),
    }

def reference(x, dw, pw):
    B, H, W, C = x.shape
    k = dw.shape[0]
    pad = k // 2
    xp = _pad(x, ((0,0),(pad,pad),(pad,pad),(0,0)))
    out = torch.zeros_like(x)
    for i in range(k):
        for j in range(k):
            out = out + xp[:, i:i+H, j:j+W, :] * dw[i, j][None, None, None, :]
    return torch.einsum('bhwc,cd->bhwd', out, pw)
```

```asm
; @launch grid=(256,1,1) block=(256,1,1) lds=151552
.amdgcn_target "amdgcn-amd-amdhsa--gfx950"
.text
.globl standalone__depthwise_separable__vision_kernel
.p2align 8
.type standalone__depthwise_separable__vision_kernel,@function
standalone__depthwise_separable__vision_kernel:
  s_cmp_ge_u32 s2, 256
  s_cbranch_scc1 L_done
  s_load_dwordx4 s[28:31], s[0:1], 16
  s_load_dwordx4 s[24:27], s[0:1], 0
  s_getpc_b64 s[40:41]
L_pc:
  v_lshlrev_b32 v72, 7, v0
  v_min_u32 v72, L_done-L_pc, v72
  v_mov_b32 v73, s41
  v_add_co_u32 v72, vcc, s40, v72
  v_lshrrev_b32 v77, 6, v0
  v_and_b32 v74, 63, v0
  v_addc_co_u32 v73, vcc, 0, v73, vcc
  global_load_dword v23, v[72:73], off
  v_readfirstlane_b32 s20, v77
  v_and_b32 v75, 15, v74
  v_lshlrev_b32 v78, 4, v74
  v_lshlrev_b32 v79, 4, v75
  s_lshr_b32 s47, s2, 3
  s_mul_i32 s39, s47, 9216
  s_mul_i32 s38, s20, 2304
  s_add_u32 s39, s39, s38
  s_mul_i32 s38, s20, 192
  v_mul_u32_u24 v81, 0xaaab, v74
  v_lshrrev_b32 v81, 19, v81
  v_mul_u32_u24 v81, 576, v81
  v_add3_u32 v14, v81, v78, s38
  v_add_u32 v80, 64, v74
  v_mul_u32_u24 v81, 0xaaab, v80
  v_lshrrev_b32 v81, 19, v81
  v_mul_u32_u24 v81, 576, v81
  v_add3_u32 v15, v81, v78, s38
  v_add_u32 v80, 128, v74
  v_mul_u32_u24 v81, 0xaaab, v80
  v_lshrrev_b32 v81, 19, v81
  v_mul_u32_u24 v81, 576, v81
  v_add3_u32 v16, v81, v78, s38
  s_lshl_b32 s33, s20, 10
  s_mul_i32 s34, s20, 6144
  s_mov_b32 s36, 0
  s_mov_b32 s14, 294912
  s_mov_b32 s15, 0x00020000
  s_mov_b32 s18, 768
  s_mov_b32 s19, 0x00020000
  s_add_u32 m0, s33, 147456
  s_waitcnt lgkmcnt(0)
  s_mov_b32 s12, s28
  s_and_b32 s13, s29, 0xffff
  buffer_load_dwordx4 a[216:219], v78, s[12:15], s39 offen
  buffer_load_dwordx4 a[220:223], v78, s[12:15], s39 offen offset:1024
  buffer_load_dwordx4 a[224:227], v79, s[12:15], s39 offen offset:2048
  s_mov_b32 s16, s26
  s_and_b32 s17, s27, 0xffff
  buffer_load_dwordx4 v78, s[16:19], 0 offen lds
  s_and_b32 s38, s2, 7
  s_lshl_b32 s38, s38, 5
  s_add_u32 s38, s38, s47
  s_mul_i32 s21, s38, 24576
  s_mov_b32 s4, s24
  s_and_b32 s5, s25, 0xffff
  s_mov_b32 s6, 113246208
  s_mov_b32 s7, 0x00020000
  v_mul_u32_u24 v81, 0xaaab, v0
  v_lshrrev_b32 v81, 21, v81
  v_xor_b32 v80, v0, v81
  v_lshlrev_b32 v1, 4, v80
  v_add_u32 v80, 256, v0
  v_mul_u32_u24 v81, 0xaaab, v80
  v_lshrrev_b32 v81, 21, v81
  v_xor_b32 v80, v80, v81
  v_lshlrev_b32 v2, 4, v80
  v_add_u32 v80, 512, v0
  v_mul_u32_u24 v81, 0xaaab, v80
  v_lshrrev_b32 v81, 21, v81
  v_xor_b32 v80, v80, v81
  v_lshlrev_b32 v3, 4, v80
  s_add_u32 s37, s21, 12288
  s_mov_b32 s22, s21
  s_add_u32 m0, s33, 98304
  s_nop 0
  buffer_load_dwordx4 v1, s[4:7], s21 offen nt lds
  s_add_u32 m0, s33, 102400
  s_nop 0
  buffer_load_dwordx4 v2, s[4:7], s21 offen nt lds
  s_add_u32 m0, s33, 106496
  s_nop 0
  buffer_load_dwordx4 v3, s[4:7], s21 offen nt lds
  s_add_u32 m0, s33, 110592
  s_add_u32 s21, s21, 6291456
  buffer_load_dwordx4 v1, s[4:7], s37 offen nt lds
  s_add_u32 m0, s33, 114688
  s_nop 0
  buffer_load_dwordx4 v2, s[4:7], s37 offen nt lds
  s_add_u32 m0, s33, 118784
  s_nop 0
  buffer_load_dwordx4 v3, s[4:7], s37 offen nt lds
  s_add_u32 s37, s37, 6291456
  v_lshrrev_b32 v76, 4, v74
  v_lshlrev_b32 v18, 4, v76
  v_add_u32 v18, s33, v18
  v_add_u32 v18, 147456, v18
  v_bfe_u32 v81, v74, 2, 2
  v_and_b32 v82, 3, v74
  v_lshl_add_u32 v83, v76, 3, v81
  v_mul_u32_u24 v83, 192, v83
  v_mul_u32_u24 v84, 48, v82
  v_add3_u32 v17, v83, v84, s34
  v_add_u32 v104, 49152, v17
  v_lshlrev_b32 v83, 4, v82
  v_mov_b32 v84, 0xffff
  v_cmp_lt_u32 vcc, 1, v82
  v_lshlrev_b32 v84, v83, v84
  v_mul_u32_u24 v80, 0x300, v75
  v_cndmask_b32 v20, 0, v84, vcc
  v_sub_u32 v19, v84, v20
  s_add_u32 m0, s34, 49152
  s_nop 0
  buffer_load_dwordx4 v14, s[12:15], s36 offen offset:0 lds
  buffer_load_dwordx4 v15, s[12:15], s36 offen offset:1024 lds
  buffer_load_dwordx4 v16, s[12:15], s36 offen offset:2048 lds
  s_add_u32 m0, s34, 52224
  s_add_u32 s36, s36, 12288
  buffer_load_dwordx4 v14, s[12:15], s36 offen offset:0 lds
  buffer_load_dwordx4 v15, s[12:15], s36 offen offset:1024 lds
  buffer_load_dwordx4 v16, s[12:15], s36 offen offset:2048 lds
  s_mov_b32 s8, s30
  s_and_b32 s9, s31, 0xffff
  s_mov_b32 s10, 113246208
  s_mov_b32 s11, 0x00020000
  v_lshlrev_b32 v4, 4, v0
  v_add_u32 v5, 4096, v4
  v_add_u32 v6, 8192, v4
  v_xor_b32 v81, v76, v75
  v_lshl_add_u32 v7, v81, 4, v80
  v_add_u32 v7, 98304, v7
  v_xor_b32 v8, 64, v7
  v_xor_b32 v9, 128, v7
  v_xor_b32 v10, 192, v7
  s_mul_i32 s38, s20, 12
  v_mul_u32_u24 v81, 3, v76
  v_add_u32 v81, s38, v81
  v_add_u32 v82, 0, v81
  v_xor_b32 v82, v82, v75
  v_lshl_add_u32 v11, v82, 4, v80
  v_add_u32 v82, 1, v81
  v_xor_b32 v82, v82, v75
  v_lshl_add_u32 v12, v82, 4, v80
  v_add_u32 v82, 2, v81
  v_xor_b32 v82, v82, v75
  v_lshl_add_u32 v13, v82, 4, v80
  s_mov_b32 s23, 113246208
  s_mov_b32 s44, 6291456
  s_add_u32 s42, s33, 49152
  s_mov_b32 s51, 1
  s_bitcmp1_b32 s2, 0
  s_cselect_b32 s32, 16, 18
  s_cselect_b32 s45, s44, 786432
  s_add_u32 m0, s34, 73728
  s_add_u32 s36, s36, 12288
  buffer_load_dwordx4 v14, s[12:15], s36 offen offset:0 lds
  buffer_load_dwordx4 v15, s[12:15], s36 offen offset:1024 lds
  buffer_load_dwordx4 v16, s[12:15], s36 offen offset:2048 lds
  s_add_u32 m0, s34, 76800
  s_add_u32 s36, s36, 12288
  buffer_load_dwordx4 v14, s[12:15], s36 offen offset:0 lds
  buffer_load_dwordx4 v15, s[12:15], s36 offen offset:1024 lds
  buffer_load_dwordx4 v16, s[12:15], s36 offen offset:2048 lds
  s_waitcnt vmcnt(6)
  ds_read_b128 v[96:99], v18 offset:0
  ds_read_b64_tr_b16 a[144:145], v104 offset:0
  ds_read_b64_tr_b16 a[146:147], v104 offset:768
  ds_read_b64_tr_b16 a[148:149], v104 offset:8
  ds_read_b64_tr_b16 a[150:151], v104 offset:776
  ds_read_b64_tr_b16 a[152:153], v104 offset:16
  ds_read_b64_tr_b16 a[154:155], v104 offset:784
  ds_read_b64_tr_b16 a[156:157], v104 offset:24
  ds_read_b64_tr_b16 a[158:159], v104 offset:792
  ds_read_b64_tr_b16 a[160:161], v104 offset:32
  ds_read_b64_tr_b16 a[162:163], v104 offset:800
  ds_read_b64_tr_b16 a[164:165], v104 offset:40
  ds_read_b64_tr_b16 a[166:167], v104 offset:808
  s_add_u32 m0, s34, 0
  s_add_u32 s36, s36, 12288
  buffer_load_dwordx4 v14, s[12:15], s36 offen offset:0 lds
  buffer_load_dwordx4 v15, s[12:15], s36 offen offset:1024 lds
  buffer_load_dwordx4 v16, s[12:15], s36 offen offset:2048 lds
  s_add_u32 m0, s34, 3072
  s_add_u32 s36, s36, 12288
  buffer_load_dwordx4 v14, s[12:15], s36 offen offset:0 lds
  buffer_load_dwordx4 v15, s[12:15], s36 offen offset:1024 lds
  buffer_load_dwordx4 v16, s[12:15], s36 offen offset:2048 lds
  s_waitcnt lgkmcnt(12)
  v_and_b32 v96, v19, v96
  v_and_b32 v97, v20, v97
  v_and_b32 v98, v19, v98
  v_and_b32 v99, v20, v99
  s_waitcnt lgkmcnt(0)
  s_nop 0
  v_mfma_f32_4x4x4_16b_bf16 v[72:75], v[96:97], a[144:145], 0
  s_waitcnt vmcnt(6)
  ds_read_b128 v[100:103], v18 offset:64
  s_add_u32 m0, s34, 24576
  s_add_u32 s36, s36, 12288
  buffer_load_dwordx4 v14, s[12:15], s36 offen offset:0 lds
  v_mfma_f32_4x4x4_16b_bf16 v[76:79], v[98:99], a[146:147], 0
  ds_read_b64_tr_b16 a[168:169], v104 offset:24576
  ds_read_b64_tr_b16 a[170:171], v104 offset:25344
  buffer_load_dwordx4 v15, s[12:15], s36 offen offset:1024 lds
  v_mfma_f32_4x4x4_16b_bf16 v[80:83], v[96:97], a[148:149], 0
  ds_read_b64_tr_b16 a[172:173], v104 offset:24584
  buffer_load_dwordx4 v16, s[12:15], s36 offen offset:2048 lds
  v_mfma_f32_4x4x4_16b_bf16 v[84:87], v[98:99], a[150:151], 0
  ds_read_b64_tr_b16 a[174:175], v104 offset:25352
  ds_read_b64_tr_b16 a[176:177], v104 offset:24592
  s_add_u32 m0, s34, 27648
  s_add_u32 s36, s36, 12288
  buffer_load_dwordx4 v14, s[12:15], s36 offen offset:0 lds
  v_mfma_f32_4x4x4_16b_bf16 v[88:91], v[96:97], a[152:153], 0
  v_cvt_pk_bf16_f32 v72, v72, v73
  v_cvt_pk_bf16_f32 v74, v74, v75
  v_cvt_pk_bf16_f32 v76, v76, v77
  v_cvt_pk_bf16_f32 v78, v78, v79
  ds_read_b64_tr_b16 a[178:179], v104 offset:25360
  buffer_load_dwordx4 v15, s[12:15], s36 offen offset:1024 lds
  v_mfma_f32_4x4x4_16b_bf16 v[92:95], v[98:99], a[154:155], 0
  v_accvgpr_write_b32 a0, v72
  v_accvgpr_write_b32 a1, v74
  v_accvgpr_write_b32 a2, v76
  v_accvgpr_write_b32 a3, v78
  ds_read_b64_tr_b16 a[180:181], v104 offset:24600
  ds_read_b64_tr_b16 a[182:183], v104 offset:25368
  buffer_load_dwordx4 v16, s[12:15], s36 offen offset:2048 lds
  v_mfma_f32_4x4x4_16b_bf16 v[72:75], v[96:97], a[156:157], 0
  v_cvt_pk_bf16_f32 v80, v80, v81
  v_cvt_pk_bf16_f32 v82, v82, v83
  v_cvt_pk_bf16_f32 v84, v84, v85
  v_cvt_pk_bf16_f32 v86, v86, v87
  ds_read_b64_tr_b16 a[184:185], v104 offset:24608
  ds_read_b64_tr_b16 a[186:187], v104 offset:25376
  s_add_u32 m0, s34, 49152
  s_add_u32 s36, s36, 12288
  buffer_load_dwordx4 v14, s[12:15], s36 offen offset:0 lds
  v_mfma_f32_4x4x4_16b_bf16 v[76:79], v[98:99], a[158:159], 0
  v_accvgpr_write_b32 a4, v80
  v_accvgpr_write_b32 a5, v82
  v_accvgpr_write_b32 a6, v84
  v_accvgpr_write_b32 a7, v86
  ds_read_b64_tr_b16 a[188:189], v104 offset:24616
  buffer_load_dwordx4 v15, s[12:15], s36 offen offset:1024 lds
  v_mfma_f32_4x4x4_16b_bf16 v[80:83], v[96:97], a[160:161], 0
  v_cvt_pk_bf16_f32 v88, v88, v89
  v_cvt_pk_bf16_f32 v90, v90, v91
  v_cvt_pk_bf16_f32 v92, v92, v93
  v_cvt_pk_bf16_f32 v94, v94, v95
  ds_read_b64_tr_b16 a[190:191], v104 offset:25384
  s_waitcnt lgkmcnt(12)
  buffer_load_dwordx4 v16, s[12:15], s36 offen offset:2048 lds
  v_mfma_f32_4x4x4_16b_bf16 v[84:87], v[98:99], a[162:163], 0
  v_accvgpr_write_b32 a8, v88
  v_accvgpr_write_b32 a9, v90
  v_accvgpr_write_b32 a10, v92
  v_accvgpr_write_b32 a11, v94
  v_and_b32 v100, v19, v100
  s_add_u32 m0, s34, 52224
  s_add_u32 s36, s36, 12288
  buffer_load_dwordx4 v14, s[12:15], s36 offen offset:0 lds
  v_mfma_f32_4x4x4_16b_bf16 v[88:91], v[96:97], a[164:165], 0
  v_cvt_pk_bf16_f32 v72, v72, v73
  v_cvt_pk_bf16_f32 v74, v74, v75
  v_cvt_pk_bf16_f32 v76, v76, v77
  v_cvt_pk_bf16_f32 v78, v78, v79
  v_and_b32 v101, v20, v101
  v_and_b32 v102, v19, v102
  buffer_load_dwordx4 v15, s[12:15], s36 offen offset:1024 lds
  v_mfma_f32_4x4x4_16b_bf16 v[92:95], v[98:99], a[166:167], 0
  v_accvgpr_write_b32 a12, v72
  v_accvgpr_write_b32 a13, v74
  v_accvgpr_write_b32 a14, v76
  v_accvgpr_write_b32 a15, v78
  v_and_b32 v103, v20, v103
  buffer_load_dwordx4 v16, s[12:15], s36 offen offset:2048 lds
  s_waitcnt lgkmcnt(0)
  s_barrier
  ds_read_b128 a[192:195], v7 offset:0
  ds_read_b128 a[196:199], v7 offset:12288
  ds_read_b128 a[200:203], v8 offset:0
  ds_read_b128 a[204:207], v8 offset:12288
  s_nop 0
  v_mfma_f32_4x4x4_16b_bf16 v[72:75], v[100:101], a[168:169], 0
  v_cvt_pk_bf16_f32 v80, v80, v81
  v_cvt_pk_bf16_f32 v82, v82, v83
  v_cvt_pk_bf16_f32 v84, v84, v85
  v_cvt_pk_bf16_f32 v86, v86, v87
  s_waitcnt vmcnt(12)
  s_add_u32 m0, s34, 73728
  s_add_u32 s36, s36, 12288
  buffer_load_dwordx4 v14, s[12:15], s36 offen offset:0 lds
  v_mfma_f32_4x4x4_16b_bf16 v[76:79], v[102:103], a[170:171], 0
  v_accvgpr_write_b32 a16, v80
  v_accvgpr_write_b32 a17, v82
  v_accvgpr_write_b32 a18, v84
  v_accvgpr_write_b32 a19, v86
  ds_read_b128 v[96:99], v18 offset:128
  v_mfma_f32_4x4x4_16b_bf16 v[80:83], v[100:101], a[172:173], 0
  v_cvt_pk_bf16_f32 v88, v88, v89
  ds_read_b64_tr_b16 a[144:145], v17 offset:0
  buffer_load_dwordx4 v15, s[12:15], s36 offen offset:1024 lds
  v_mfma_f32_4x4x4_16b_bf16 v[84:87], v[102:103], a[174:175], 0
  v_cvt_pk_bf16_f32 v90, v90, v91
  v_cvt_pk_bf16_f32 v92, v92, v93
  ds_read_b64_tr_b16 a[146:147], v17 offset:768
  s_waitcnt lgkmcnt(5)
  v_mfma_f32_16x16x32_bf16 v[24:27], a[0:3], a[192:195], 0
  ds_read_b128 a[208:211], v9 offset:0
  ds_read_b128 a[212:215], v9 offset:12288
  v_cvt_pk_bf16_f32 v94, v94, v95
  buffer_load_dwordx4 v16, s[12:15], s36 offen offset:2048 lds
  v_mfma_f32_16x16x32_bf16 v[48:51], a[0:3], a[196:199], 0
  v_accvgpr_write_b32 a20, v88
  v_accvgpr_write_b32 a21, v90
  ds_read_b64_tr_b16 a[148:149], v17 offset:8
  v_mfma_f32_16x16x32_bf16 v[28:31], a[4:7], a[192:195], 0
  v_accvgpr_write_b32 a22, v92
  ds_read_b64_tr_b16 a[150:151], v17 offset:776
  s_add_u32 m0, s34, 76800
  s_add_u32 s36, s36, 12288
  buffer_load_dwordx4 v14, s[12:15], s36 offen offset:0 lds
  v_mfma_f32_16x16x32_bf16 v[52:55], a[4:7], a[196:199], 0
  v_accvgpr_write_b32 a23, v94
  ds_read_b64_tr_b16 a[152:153], v17 offset:16
  v_mfma_f32_4x4x4_16b_bf16 v[88:91], v[100:101], a[176:177], 0
  v_cvt_pk_bf16_f32 v72, v72, v73
  v_cvt_pk_bf16_f32 v74, v74, v75
  ds_read_b64_tr_b16 a[154:155], v17 offset:784
  buffer_load_dwordx4 v15, s[12:15], s36 offen offset:1024 lds
  v_mfma_f32_4x4x4_16b_bf16 v[92:95], v[102:103], a[178:179], 0
  v_cvt_pk_bf16_f32 v76, v76, v77
  v_cvt_pk_bf16_f32 v78, v78, v79
  v_mfma_f32_16x16x32_bf16 v[32:35], a[8:11], a[192:195], 0
  v_accvgpr_write_b32 a24, v72
  v_accvgpr_write_b32 a25, v74
  ds_read_b64_tr_b16 a[156:157], v17 offset:24
  buffer_load_dwordx4 v16, s[12:15], s36 offen offset:2048 lds
  v_mfma_f32_16x16x32_bf16 v[56:59], a[8:11], a[196:199], 0
  v_accvgpr_write_b32 a26, v76
  v_accvgpr_write_b32 a27, v78
  ds_read_b64_tr_b16 a[158:159], v17 offset:792
  v_mfma_f32_4x4x4_16b_bf16 v[72:75], v[100:101], a[180:181], 0
  v_cvt_pk_bf16_f32 v80, v80, v81
  v_cvt_pk_bf16_f32 v82, v82, v83
  ds_read_b64_tr_b16 a[160:161], v17 offset:32
  s_add_u32 m0, s33, 122880
  s_nop 0
  buffer_load_dwordx4 v1, s[4:7], s21 offen nt lds
  v_mfma_f32_4x4x4_16b_bf16 v[76:79], v[102:103], a[182:183], 0
  v_cvt_pk_bf16_f32 v84, v84, v85
  v_cvt_pk_bf16_f32 v86, v86, v87
  ds_read_b64_tr_b16 a[162:163], v17 offset:800
  v_mfma_f32_16x16x32_bf16 v[36:39], a[12:15], a[192:195], 0
  v_accvgpr_write_b32 a28, v80
  v_accvgpr_write_b32 a29, v82
  s_add_u32 m0, s33, 126976
  s_nop 0
  buffer_load_dwordx4 v2, s[4:7], s21 offen nt lds
  v_mfma_f32_16x16x32_bf16 v[60:63], a[12:15], a[196:199], 0
  v_accvgpr_write_b32 a30, v84
  v_accvgpr_write_b32 a31, v86
  ds_read_b64_tr_b16 a[164:165], v17 offset:40
  v_mfma_f32_4x4x4_16b_bf16 v[80:83], v[100:101], a[184:185], 0
  v_cvt_pk_bf16_f32 v88, v88, v89
  v_cvt_pk_bf16_f32 v90, v90, v91
  ds_read_b64_tr_b16 a[166:167], v17 offset:808
  s_add_u32 m0, s33, 131072
  s_nop 0
  buffer_load_dwordx4 v3, s[4:7], s21 offen nt lds
  v_mfma_f32_4x4x4_16b_bf16 v[84:87], v[102:103], a[186:187], 0
  v_cvt_pk_bf16_f32 v92, v92, v93
  v_cvt_pk_bf16_f32 v94, v94, v95
  s_waitcnt lgkmcnt(14)
  v_mfma_f32_16x16x32_bf16 v[40:43], a[16:19], a[192:195], 0
  v_accvgpr_write_b32 a32, v88
  v_accvgpr_write_b32 a33, v90
  v_and_b32 v96, v19, v96
  s_add_u32 m0, s33, 135168
  s_add_u32 s21, s21, 6291456
  buffer_load_dwordx4 v1, s[4:7], s37 offen nt lds
  v_mfma_f32_16x16x32_bf16 v[64:67], a[16:19], a[196:199], 0
  v_accvgpr_write_b32 a34, v92
  v_accvgpr_write_b32 a35, v94
  v_mfma_f32_4x4x4_16b_bf16 v[88:91], v[100:101], a[188:189], 0
  v_cvt_pk_bf16_f32 v72, v72, v73
  v_cvt_pk_bf16_f32 v74, v74, v75
  v_and_b32 v97, v20, v97
  s_add_u32 m0, s33, 139264
  s_nop 0
  buffer_load_dwordx4 v2, s[4:7], s37 offen nt lds
  v_mfma_f32_4x4x4_16b_bf16 v[92:95], v[102:103], a[190:191], 0
  v_cvt_pk_bf16_f32 v76, v76, v77
  v_cvt_pk_bf16_f32 v78, v78, v79
  v_and_b32 v98, v19, v98
  v_mfma_f32_16x16x32_bf16 v[44:47], a[20:23], a[192:195], 0
  v_accvgpr_write_b32 a36, v72
  v_accvgpr_write_b32 a37, v74
  v_and_b32 v99, v20, v99
  s_add_u32 m0, s33, 143360
  s_nop 0
  buffer_load_dwordx4 v3, s[4:7], s37 offen nt lds
  s_add_u32 s37, s37, 6291456
  v_mfma_f32_16x16x32_bf16 v[68:71], a[20:23], a[196:199], 0
  v_accvgpr_write_b32 a38, v76
  v_accvgpr_write_b32 a39, v78
  s_waitcnt lgkmcnt(0)
  s_nop 0
  v_mfma_f32_4x4x4_16b_bf16 v[72:75], v[96:97], a[144:145], 0
  v_cvt_pk_bf16_f32 v80, v80, v81
  v_cvt_pk_bf16_f32 v82, v82, v83
  s_waitcnt vmcnt(18)
  v_mfma_f32_4x4x4_16b_bf16 v[76:79], v[98:99], a[146:147], 0
  v_cvt_pk_bf16_f32 v84, v84, v85
  v_cvt_pk_bf16_f32 v86, v86, v87
  ds_read_b128 v[100:103], v18 offset:192
  v_mfma_f32_16x16x32_bf16 v[24:27], a[24:27], a[200:203], v[24:27]
  ds_read_b128 a[192:195], v10 offset:0
  ds_read_b128 a[196:199], v10 offset:12288
  v_accvgpr_write_b32 a40, v80
  v_accvgpr_write_b32 a41, v82
  ds_read_b64_tr_b16 a[168:169], v17 offset:24576
  v_mfma_f32_16x16x32_bf16 v[48:51], a[24:27], a[204:207], v[48:51]
  v_accvgpr_write_b32 a42, v84
  v_accvgpr_write_b32 a43, v86
  ds_read_b64_tr_b16 a[170:171], v17 offset:25344
  v_mfma_f32_4x4x4_16b_bf16 v[80:83], v[96:97], a[148:149], 0
  v_cvt_pk_bf16_f32 v88, v88, v89
  v_cvt_pk_bf16_f32 v90, v90, v91
  v_mfma_f32_4x4x4_16b_bf16 v[84:87], v[98:99], a[150:151], 0
  v_cvt_pk_bf16_f32 v92, v92, v93
  v_cvt_pk_bf16_f32 v94, v94, v95
  ds_read_b64_tr_b16 a[172:173], v17 offset:24584
  v_mfma_f32_16x16x32_bf16 v[28:31], a[28:31], a[200:203], v[28:31]
  v_accvgpr_write_b32 a44, v88
  v_accvgpr_write_b32 a45, v90
  ds_read_b64_tr_b16 a[174:175], v17 offset:25352
  v_mfma_f32_16x16x32_bf16 v[52:55], a[28:31], a[204:207], v[52:55]
  v_accvgpr_write_b32 a46, v92
  v_accvgpr_write_b32 a47, v94
  ds_read_b64_tr_b16 a[176:177], v17 offset:24592
  v_mfma_f32_4x4x4_16b_bf16 v[88:91], v[96:97], a[152:153], 0
  v_cvt_pk_bf16_f32 v72, v72, v73
  v_cvt_pk_bf16_f32 v74, v74, v75
  ds_read_b64_tr_b16 a[178:179], v17 offset:25360
  v_mfma_f32_4x4x4_16b_bf16 v[92:95], v[98:99], a[154:155], 0
  v_cvt_pk_bf16_f32 v76, v76, v77
  v_cvt_pk_bf16_f32 v78, v78, v79
  v_mfma_f32_16x16x32_bf16 v[32:35], a[32:35], a[200:203], v[32:35]
  v_accvgpr_write_b32 a48, v72
  v_accvgpr_write_b32 a49, v74
  ds_read_b64_tr_b16 a[180:181], v17 offset:24600
  v_mfma_f32_16x16x32_bf16 v[56:59], a[32:35], a[204:207], v[56:59]
  v_accvgpr_write_b32 a50, v76
  v_accvgpr_write_b32 a51, v78
  ds_read_b64_tr_b16 a[182:183], v17 offset:25368
  v_mfma_f32_4x4x4_16b_bf16 v[72:75], v[96:97], a[156:157], 0
  v_cvt_pk_bf16_f32 v80, v80, v81
  v_cvt_pk_bf16_f32 v82, v82, v83
  ds_read_b64_tr_b16 a[184:185], v17 offset:24608
  v_mfma_f32_4x4x4_16b_bf16 v[76:79], v[98:99], a[158:159], 0
  v_cvt_pk_bf16_f32 v84, v84, v85
  v_cvt_pk_bf16_f32 v86, v86, v87
  ds_read_b64_tr_b16 a[186:187], v17 offset:25376
  v_mfma_f32_16x16x32_bf16 v[36:39], a[36:39], a[200:203], v[36:39]
  v_accvgpr_write_b32 a52, v80
  v_accvgpr_write_b32 a53, v82
  v_mfma_f32_16x16x32_bf16 v[60:63], a[36:39], a[204:207], v[60:63]
  v_accvgpr_write_b32 a54, v84
  v_accvgpr_write_b32 a55, v86
  ds_read_b64_tr_b16 a[188:189], v17 offset:24616
  v_mfma_f32_4x4x4_16b_bf16 v[80:83], v[96:97], a[160:161], 0
  v_cvt_pk_bf16_f32 v88, v88, v89
  v_cvt_pk_bf16_f32 v90, v90, v91
  ds_read_b64_tr_b16 a[190:191], v17 offset:25384
  v_mfma_f32_4x4x4_16b_bf16 v[84:87], v[98:99], a[162:163], 0
  v_cvt_pk_bf16_f32 v92, v92, v93
  v_cvt_pk_bf16_f32 v94, v94, v95
  s_waitcnt lgkmcnt(14)
  v_mfma_f32_16x16x32_bf16 v[40:43], a[40:43], a[200:203], v[40:43]
  v_accvgpr_write_b32 a56, v88
  v_accvgpr_write_b32 a57, v90
  v_and_b32 v100, v19, v100
  v_mfma_f32_16x16x32_bf16 v[64:67], a[40:43], a[204:207], v[64:67]
  v_accvgpr_write_b32 a58, v92
  v_accvgpr_write_b32 a59, v94
  v_mfma_f32_4x4x4_16b_bf16 v[88:91], v[96:97], a[164:165], 0
  v_cvt_pk_bf16_f32 v72, v72, v73
  v_cvt_pk_bf16_f32 v74, v74, v75
  v_and_b32 v101, v20, v101
  v_mfma_f32_4x4x4_16b_bf16 v[92:95], v[98:99], a[166:167], 0
  v_cvt_pk_bf16_f32 v76, v76, v77
  v_cvt_pk_bf16_f32 v78, v78, v79
  v_and_b32 v102, v19, v102
  v_mfma_f32_16x16x32_bf16 v[44:47], a[44:47], a[200:203], v[44:47]
  v_accvgpr_write_b32 a60, v72
  v_accvgpr_write_b32 a61, v74
  v_and_b32 v103, v20, v103
  v_mfma_f32_16x16x32_bf16 v[68:71], a[44:47], a[204:207], v[68:71]
  v_accvgpr_write_b32 a62, v76
  v_accvgpr_write_b32 a63, v78
  s_waitcnt lgkmcnt(0)
  s_nop 0
  v_mfma_f32_4x4x4_16b_bf16 v[72:75], v[100:101], a[168:169], 0
  v_cvt_pk_bf16_f32 v80, v80, v81
  v_cvt_pk_bf16_f32 v82, v82, v83
  s_waitcnt vmcnt(12)
  v_mfma_f32_4x4x4_16b_bf16 v[76:79], v[102:103], a[170:171], 0
  v_cvt_pk_bf16_f32 v84, v84, v85
  v_cvt_pk_bf16_f32 v86, v86, v87
  ds_read_b128 v[96:99], v18 offset:256
  v_mfma_f32_16x16x32_bf16 v[24:27], a[48:51], a[208:211], v[24:27]
  ds_read_b128 a[200:203], v7 offset:256
  ds_read_b128 a[204:207], v7 offset:12544
  v_accvgpr_write_b32 a64, v80
  v_accvgpr_write_b32 a65, v82
  ds_read_b64_tr_b16 a[144:145], v104 offset:0
  v_mfma_f32_16x16x32_bf16 v[48:51], a[48:51], a[212:215], v[48:51]
  v_accvgpr_write_b32 a66, v84
  v_accvgpr_write_b32 a67, v86
  ds_read_b64_tr_b16 a[146:147], v104 offset:768
  v_mfma_f32_4x4x4_16b_bf16 v[80:83], v[100:101], a[172:173], 0
  v_cvt_pk_bf16_f32 v88, v88, v89
  v_cvt_pk_bf16_f32 v90, v90, v91
  v_mfma_f32_4x4x4_16b_bf16 v[84:87], v[102:103], a[174:175], 0
  v_cvt_pk_bf16_f32 v92, v92, v93
  v_cvt_pk_bf16_f32 v94, v94, v95
  ds_read_b64_tr_b16 a[148:149], v104 offset:8
  v_mfma_f32_16x16x32_bf16 v[28:31], a[52:55], a[208:211], v[28:31]
  v_accvgpr_write_b32 a68, v88
  v_accvgpr_write_b32 a69, v90
  ds_read_b64_tr_b16 a[150:151], v104 offset:776
  v_mfma_f32_16x16x32_bf16 v[52:55], a[52:55], a[212:215], v[52:55]
  v_accvgpr_write_b32 a70, v92
  v_accvgpr_write_b32 a71, v94
  ds_read_b64_tr_b16 a[152:153], v104 offset:16
  v_mfma_f32_4x4x4_16b_bf16 v[88:91], v[100:101], a[176:177], 0
  v_cvt_pk_bf16_f32 v72, v72, v73
  v_cvt_pk_bf16_f32 v74, v74, v75
  ds_read_b64_tr_b16 a[154:155], v104 offset:784
  v_mfma_f32_4x4x4_16b_bf16 v[92:95], v[102:103], a[178:179], 0
  v_cvt_pk_bf16_f32 v76, v76, v77
  v_cvt_pk_bf16_f32 v78, v78, v79
  v_mfma_f32_16x16x32_bf16 v[32:35], a[56:59], a[208:211], v[32:35]
  v_accvgpr_write_b32 a72, v72
  v_accvgpr_write_b32 a73, v74
  ds_read_b64_tr_b16 a[156:157], v104 offset:24
  v_mfma_f32_16x16x32_bf16 v[56:59], a[56:59], a[212:215], v[56:59]
  v_accvgpr_write_b32 a74, v76
  v_accvgpr_write_b32 a75, v78
  ds_read_b64_tr_b16 a[158:159], v104 offset:792
  v_mfma_f32_4x4x4_16b_bf16 v[72:75], v[100:101], a[180:181], 0
  v_cvt_pk_bf16_f32 v80, v80, v81
  v_cvt_pk_bf16_f32 v82, v82, v83
  ds_read_b64_tr_b16 a[160:161], v104 offset:32
  v_mfma_f32_4x4x4_16b_bf16 v[76:79], v[102:103], a[182:183], 0
  v_cvt_pk_bf16_f32 v84, v84, v85
  v_cvt_pk_bf16_f32 v86, v86, v87
  ds_read_b64_tr_b16 a[162:163], v104 offset:800
  v_mfma_f32_16x16x32_bf16 v[36:39], a[60:63], a[208:211], v[36:39]
  v_accvgpr_write_b32 a76, v80
  v_accvgpr_write_b32 a77, v82
  v_mfma_f32_16x16x32_bf16 v[60:63], a[60:63], a[212:215], v[60:63]
  v_accvgpr_write_b32 a78, v84
  v_accvgpr_write_b32 a79, v86
  ds_read_b64_tr_b16 a[164:165], v104 offset:40
  v_mfma_f32_4x4x4_16b_bf16 v[80:83], v[100:101], a[184:185], 0
  v_cvt_pk_bf16_f32 v88, v88, v89
  v_cvt_pk_bf16_f32 v90, v90, v91
  ds_read_b64_tr_b16 a[166:167], v104 offset:808
  v_mfma_f32_4x4x4_16b_bf16 v[84:87], v[102:103], a[186:187], 0
  v_cvt_pk_bf16_f32 v92, v92, v93
  v_cvt_pk_bf16_f32 v94, v94, v95
  s_waitcnt lgkmcnt(14)
  v_mfma_f32_16x16x32_bf16 v[40:43], a[64:67], a[208:211], v[40:43]
  v_accvgpr_write_b32 a80, v88
  v_accvgpr_write_b32 a81, v90
  v_and_b32 v96, v19, v96
  v_mfma_f32_16x16x32_bf16 v[64:67], a[64:67], a[212:215], v[64:67]
  v_accvgpr_write_b32 a82, v92
  v_accvgpr_write_b32 a83, v94
  v_mfma_f32_4x4x4_16b_bf16 v[88:91], v[100:101], a[188:189], 0
  v_cvt_pk_bf16_f32 v72, v72, v73
  v_cvt_pk_bf16_f32 v74, v74, v75
  v_and_b32 v97, v20, v97
  v_mfma_f32_4x4x4_16b_bf16 v[92:95], v[102:103], a[190:191], 0
  v_cvt_pk_bf16_f32 v76, v76, v77
  v_cvt_pk_bf16_f32 v78, v78, v79
  v_and_b32 v98, v19, v98
  v_mfma_f32_16x16x32_bf16 v[44:47], a[68:71], a[208:211], v[44:47]
  v_accvgpr_write_b32 a84, v72
  v_accvgpr_write_b32 a85, v74
  v_and_b32 v99, v20, v99
  v_mfma_f32_16x16x32_bf16 v[68:71], a[68:71], a[212:215], v[68:71]
  v_accvgpr_write_b32 a86, v76
  v_accvgpr_write_b32 a87, v78
  s_waitcnt lgkmcnt(0)
  s_nop 0
  v_mfma_f32_4x4x4_16b_bf16 v[72:75], v[96:97], a[144:145], 0
  v_cvt_pk_bf16_f32 v80, v80, v81
  v_cvt_pk_bf16_f32 v82, v82, v83
  s_waitcnt vmcnt(6)
  s_add_u32 m0, s34, 0
  s_add_u32 s36, s36, 12288
  buffer_load_dwordx4 v14, s[12:15], s36 offen offset:0 lds
  v_mfma_f32_4x4x4_16b_bf16 v[76:79], v[98:99], a[146:147], 0
  v_cvt_pk_bf16_f32 v84, v84, v85
  v_cvt_pk_bf16_f32 v86, v86, v87
  ds_read_b128 v[100:103], v18 offset:320
  v_mfma_f32_16x16x32_bf16 v[24:27], a[72:75], a[192:195], v[24:27]
  ds_read_b128 a[208:211], v8 offset:256
  ds_read_b128 a[212:215], v8 offset:12544
  v_accvgpr_write_b32 a88, v80
  v_accvgpr_write_b32 a89, v82
  ds_read_b64_tr_b16 a[168:169], v104 offset:24576
  buffer_load_dwordx4 v15, s[12:15], s36 offen offset:1024 lds
  v_mfma_f32_16x16x32_bf16 v[48:51], a[72:75], a[196:199], v[48:51]
  v_accvgpr_write_b32 a90, v84
  v_accvgpr_write_b32 a91, v86
  ds_read_b64_tr_b16 a[170:171], v104 offset:25344
  v_mfma_f32_4x4x4_16b_bf16 v[80:83], v[96:97], a[148:149], 0
  v_cvt_pk_bf16_f32 v88, v88, v89
  v_cvt_pk_bf16_f32 v90, v90, v91
  buffer_load_dwordx4 v16, s[12:15], s36 offen offset:2048 lds
  v_mfma_f32_4x4x4_16b_bf16 v[84:87], v[98:99], a[150:151], 0
  v_cvt_pk_bf16_f32 v92, v92, v93
  v_cvt_pk_bf16_f32 v94, v94, v95
  ds_read_b64_tr_b16 a[172:173], v104 offset:24584
  v_mfma_f32_16x16x32_bf16 v[28:31], a[76:79], a[192:195], v[28:31]
  v_accvgpr_write_b32 a92, v88
  v_accvgpr_write_b32 a93, v90
  ds_read_b64_tr_b16 a[174:175], v104 offset:25352
  s_add_u32 m0, s34, 3072
  s_add_u32 s36, s36, 12288
  buffer_load_dwordx4 v14, s[12:15], s36 offen offset:0 lds
  v_mfma_f32_16x16x32_bf16 v[52:55], a[76:79], a[196:199], v[52:55]
  v_accvgpr_write_b32 a94, v92
  v_accvgpr_write_b32 a95, v94
  ds_read_b64_tr_b16 a[176:177], v104 offset:24592
  v_mfma_f32_4x4x4_16b_bf16 v[88:91], v[96:97], a[152:153], 0
  v_cvt_pk_bf16_f32 v72, v72, v73
  v_cvt_pk_bf16_f32 v74, v74, v75
  ds_read_b64_tr_b16 a[178:179], v104 offset:25360
  buffer_load_dwordx4 v15, s[12:15], s36 offen offset:1024 lds
  v_mfma_f32_4x4x4_16b_bf16 v[92:95], v[98:99], a[154:155], 0
  v_cvt_pk_bf16_f32 v76, v76, v77
  v_cvt_pk_bf16_f32 v78, v78, v79
  v_mfma_f32_16x16x32_bf16 v[32:35], a[80:83], a[192:195], v[32:35]
  v_accvgpr_write_b32 a96, v72
  v_accvgpr_write_b32 a97, v74
  ds_read_b64_tr_b16 a[180:181], v104 offset:24600
  buffer_load_dwordx4 v16, s[12:15], s36 offen offset:2048 lds
  v_mfma_f32_16x16x32_bf16 v[56:59], a[80:83], a[196:199], v[56:59]
  v_accvgpr_write_b32 a98, v76
  v_accvgpr_write_b32 a99, v78
  ds_read_b64_tr_b16 a[182:183], v104 offset:25368
  v_mfma_f32_4x4x4_16b_bf16 v[72:75], v[96:97], a[156:157], 0
  v_cvt_pk_bf16_f32 v80, v80, v81
  v_cvt_pk_bf16_f32 v82, v82, v83
  ds_read_b64_tr_b16 a[184:185], v104 offset:24608
  s_add_u32 m0, s34, 24576
  s_add_u32 s36, s36, 12288
  buffer_load_dwordx4 v14, s[12:15], s36 offen offset:0 lds
  v_mfma_f32_4x4x4_16b_bf16 v[76:79], v[98:99], a[158:159], 0
  v_cvt_pk_bf16_f32 v84, v84, v85
  v_cvt_pk_bf16_f32 v86, v86, v87
  ds_read_b64_tr_b16 a[186:187], v104 offset:25376
  v_mfma_f32_16x16x32_bf16 v[36:39], a[84:87], a[192:195], v[36:39]
  v_accvgpr_write_b32 a100, v80
  v_accvgpr_write_b32 a101, v82
  buffer_load_dwordx4 v15, s[12:15], s36 offen offset:1024 lds
  v_mfma_f32_16x16x32_bf16 v[60:63], a[84:87], a[196:199], v[60:63]
  v_accvgpr_write_b32 a102, v84
  v_accvgpr_write_b32 a103, v86
  ds_read_b64_tr_b16 a[188:189], v104 offset:24616
  v_mfma_f32_4x4x4_16b_bf16 v[80:83], v[96:97], a[160:161], 0
  v_cvt_pk_bf16_f32 v88, v88, v89
  v_cvt_pk_bf16_f32 v90, v90, v91
  ds_read_b64_tr_b16 a[190:191], v104 offset:25384
  buffer_load_dwordx4 v16, s[12:15], s36 offen offset:2048 lds
  v_mfma_f32_4x4x4_16b_bf16 v[84:87], v[98:99], a[162:163], 0
  v_cvt_pk_bf16_f32 v92, v92, v93
  v_cvt_pk_bf16_f32 v94, v94, v95
  s_waitcnt lgkmcnt(14)
  v_mfma_f32_16x16x32_bf16 v[40:43], a[88:91], a[192:195], v[40:43]
  v_accvgpr_write_b32 a104, v88
  v_accvgpr_write_b32 a105, v90
  v_and_b32 v100, v19, v100
  s_add_u32 m0, s34, 27648
  s_add_u32 s36, s36, 12288
  buffer_load_dwordx4 v14, s[12:15], s36 offen offset:0 lds
  v_mfma_f32_16x16x32_bf16 v[64:67], a[88:91], a[196:199], v[64:67]
  v_accvgpr_write_b32 a106, v92
  v_accvgpr_write_b32 a107, v94
  v_mfma_f32_4x4x4_16b_bf16 v[88:91], v[96:97], a[164:165], 0
  v_cvt_pk_bf16_f32 v72, v72, v73
  v_cvt_pk_bf16_f32 v74, v74, v75
  v_and_b32 v101, v20, v101
  buffer_load_dwordx4 v15, s[12:15], s36 offen offset:1024 lds
  v_mfma_f32_4x4x4_16b_bf16 v[92:95], v[98:99], a[166:167], 0
  v_cvt_pk_bf16_f32 v76, v76, v77
  v_cvt_pk_bf16_f32 v78, v78, v79
  v_and_b32 v102, v19, v102
  v_mfma_f32_16x16x32_bf16 v[44:47], a[92:95], a[192:195], v[44:47]
  v_accvgpr_write_b32 a108, v72
  v_accvgpr_write_b32 a109, v74
  v_and_b32 v103, v20, v103
  buffer_load_dwordx4 v16, s[12:15], s36 offen offset:2048 lds
  v_mfma_f32_16x16x32_bf16 v[68:71], a[92:95], a[196:199], v[68:71]
  v_accvgpr_write_b32 a110, v76
  v_accvgpr_write_b32 a111, v78
  s_waitcnt lgkmcnt(0)
  s_nop 0
  v_mfma_f32_4x4x4_16b_bf16 v[72:75], v[100:101], a[168:169], 0
  v_cvt_pk_bf16_f32 v80, v80, v81
  v_cvt_pk_bf16_f32 v82, v82, v83
  s_waitcnt vmcnt(6)
  s_add_u32 m0, s34, 49152
  s_add_u32 s36, s36, 12288
  buffer_load_dwordx4 v14, s[12:15], s36 offen offset:0 lds
  v_mfma_f32_4x4x4_16b_bf16 v[76:79], v[102:103], a[170:171], 0
  v_cvt_pk_bf16_f32 v84, v84, v85
  v_cvt_pk_bf16_f32 v86, v86, v87
  ds_read_b128 v[96:99], v18 offset:384
  v_mfma_f32_16x16x32_bf16 v[24:27], a[96:99], a[200:203], v[24:27]
  ds_read_b128 a[192:195], v9 offset:256
  ds_read_b128 a[196:199], v9 offset:12544
  v_accvgpr_write_b32 a112, v80
  v_accvgpr_write_b32 a113, v82
  ds_read_b64_tr_b16 a[144:145], v17 offset:0
  buffer_load_dwordx4 v15, s[12:15], s36 offen offset:1024 lds
  v_mfma_f32_16x16x32_bf16 v[48:51], a[96:99], a[204:207], v[48:51]
  v_accvgpr_write_b32 a114, v84
  v_accvgpr_write_b32 a115, v86
  ds_read_b64_tr_b16 a[146:147], v17 offset:768
  v_mfma_f32_4x4x4_16b_bf16 v[80:83], v[100:101], a[172:173], 0
  v_cvt_pk_bf16_f32 v88, v88, v89
  v_cvt_pk_bf16_f32 v90, v90, v91
  buffer_load_dwordx4 v16, s[12:15], s36 offen offset:2048 lds
  v_mfma_f32_4x4x4_16b_bf16 v[84:87], v[102:103], a[174:175], 0
  v_cvt_pk_bf16_f32 v92, v92, v93
  v_cvt_pk_bf16_f32 v94, v94, v95
  ds_read_b64_tr_b16 a[148:149], v17 offset:8
  v_mfma_f32_16x16x32_bf16 v[28:31], a[100:103], a[200:203], v[28:31]
  v_accvgpr_write_b32 a116, v88
  v_accvgpr_write_b32 a117, v90
  ds_read_b64_tr_b16 a[150:151], v17 offset:776
  s_add_u32 m0, s34, 52224
  s_add_u32 s36, s36, 12288
  buffer_load_dwordx4 v14, s[12:15], s36 offen offset:0 lds
  v_mfma_f32_16x16x32_bf16 v[52:55], a[100:103], a[204:207], v[52:55]
  v_accvgpr_write_b32 a118, v92
  v_accvgpr_write_b32 a119, v94
  ds_read_b64_tr_b16 a[152:153], v17 offset:16
  v_mfma_f32_4x4x4_16b_bf16 v[88:91], v[100:101], a[176:177], 0
  v_cvt_pk_bf16_f32 v72, v72, v73
  v_cvt_pk_bf16_f32 v74, v74, v75
  ds_read_b64_tr_b16 a[154:155], v17 offset:784
  buffer_load_dwordx4 v15, s[12:15], s36 offen offset:1024 lds
  v_mfma_f32_4x4x4_16b_bf16 v[92:95], v[102:103], a[178:179], 0
  v_cvt_pk_bf16_f32 v76, v76, v77
  v_cvt_pk_bf16_f32 v78, v78, v79
  v_mfma_f32_16x16x32_bf16 v[32:35], a[104:107], a[200:203], v[32:35]
  v_accvgpr_write_b32 a120, v72
  v_accvgpr_write_b32 a121, v74
  ds_read_b64_tr_b16 a[156:157], v17 offset:24
  buffer_load_dwordx4 v16, s[12:15], s36 offen offset:2048 lds
  v_mfma_f32_16x16x32_bf16 v[56:59], a[104:107], a[204:207], v[56:59]
  v_accvgpr_write_b32 a122, v76
  v_accvgpr_write_b32 a123, v78
  ds_read_b64_tr_b16 a[158:159], v17 offset:792
  v_mfma_f32_4x4x4_16b_bf16 v[72:75], v[100:101], a[180:181], 0
  v_cvt_pk_bf16_f32 v80, v80, v81
  v_cvt_pk_bf16_f32 v82, v82, v83
  ds_read_b64_tr_b16 a[160:161], v17 offset:32
  s_add_u32 m0, s34, 73728
  s_add_u32 s36, s36, 12288
  buffer_load_dwordx4 v14, s[12:15], s36 offen offset:0 lds
  v_mfma_f32_4x4x4_16b_bf16 v[76:79], v[102:103], a[182:183], 0
  v_cvt_pk_bf16_f32 v84, v84, v85
  v_cvt_pk_bf16_f32 v86, v86, v87
  ds_read_b64_tr_b16 a[162:163], v17 offset:800
  v_mfma_f32_16x16x32_bf16 v[36:39], a[108:111], a[200:203], v[36:39]
  v_accvgpr_write_b32 a124, v80
  v_accvgpr_write_b32 a125, v82
  buffer_load_dwordx4 v15, s[12:15], s36 offen offset:1024 lds
  v_mfma_f32_16x16x32_bf16 v[60:63], a[108:111], a[204:207], v[60:63]
  v_accvgpr_write_b32 a126, v84
  v_accvgpr_write_b32 a127, v86
  ds_read_b64_tr_b16 a[164:165], v17 offset:40
  v_mfma_f32_4x4x4_16b_bf16 v[80:83], v[100:101], a[184:185], 0
  v_cvt_pk_bf16_f32 v88, v88, v89
  v_cvt_pk_bf16_f32 v90, v90, v91
  ds_read_b64_tr_b16 a[166:167], v17 offset:808
  buffer_load_dwordx4 v16, s[12:15], s36 offen offset:2048 lds
  v_mfma_f32_4x4x4_16b_bf16 v[84:87], v[102:103], a[186:187], 0
  v_cvt_pk_bf16_f32 v92, v92, v93
  v_cvt_pk_bf16_f32 v94, v94, v95
  s_waitcnt lgkmcnt(14)
  v_mfma_f32_16x16x32_bf16 v[40:43], a[112:115], a[200:203], v[40:43]
  v_accvgpr_write_b32 a128, v88
  v_accvgpr_write_b32 a129, v90
  v_and_b32 v96, v19, v96
  s_add_u32 m0, s34, 76800
  s_add_u32 s36, s36, 12288
  buffer_load_dwordx4 v14, s[12:15], s36 offen offset:0 lds
  v_mfma_f32_16x16x32_bf16 v[64:67], a[112:115], a[204:207], v[64:67]
  v_accvgpr_write_b32 a130, v92
  v_accvgpr_write_b32 a131, v94
  v_mfma_f32_4x4x4_16b_bf16 v[88:91], v[100:101], a[188:189], 0
  v_cvt_pk_bf16_f32 v72, v72, v73
  v_cvt_pk_bf16_f32 v74, v74, v75
  v_and_b32 v97, v20, v97
  buffer_load_dwordx4 v15, s[12:15], s36 offen offset:1024 lds
  v_mfma_f32_4x4x4_16b_bf16 v[92:95], v[102:103], a[190:191], 0
  v_cvt_pk_bf16_f32 v76, v76, v77
  v_cvt_pk_bf16_f32 v78, v78, v79
  v_and_b32 v98, v19, v98
  v_mfma_f32_16x16x32_bf16 v[44:47], a[116:119], a[200:203], v[44:47]
  v_accvgpr_write_b32 a132, v72
  v_accvgpr_write_b32 a133, v74
  v_and_b32 v99, v20, v99
  buffer_load_dwordx4 v16, s[12:15], s36 offen offset:2048 lds
  v_mfma_f32_16x16x32_bf16 v[68:71], a[116:119], a[204:207], v[68:71]
  v_accvgpr_write_b32 a134, v76
  v_accvgpr_write_b32 a135, v78
  s_waitcnt lgkmcnt(0)
  s_nop 0
  v_mfma_f32_4x4x4_16b_bf16 v[72:75], v[96:97], a[144:145], 0
  v_cvt_pk_bf16_f32 v80, v80, v81
  v_cvt_pk_bf16_f32 v82, v82, v83
  s_waitcnt vmcnt(12)
  s_add_u32 m0, s34, 0
  s_add_u32 s36, s36, 12288
  buffer_load_dwordx4 v14, s[12:15], s36 offen offset:0 lds
  v_mfma_f32_4x4x4_16b_bf16 v[76:79], v[98:99], a[146:147], 0
  v_cvt_pk_bf16_f32 v84, v84, v85
  v_cvt_pk_bf16_f32 v86, v86, v87
  ds_read_b128 v[100:103], v18 offset:448
  v_mfma_f32_16x16x32_bf16 v[24:27], a[120:123], a[208:211], v[24:27]
  ds_read_b128 a[200:203], v10 offset:256
  ds_read_b128 a[204:207], v10 offset:12544
  v_accvgpr_write_b32 a136, v80
  v_accvgpr_write_b32 a137, v82
  ds_read_b64_tr_b16 a[168:169], v17 offset:24576
  v_mfma_f32_16x16x32_bf16 v[48:51], a[120:123], a[212:215], v[48:51]
  v_accvgpr_write_b32 a138, v84
  v_accvgpr_write_b32 a139, v86
  ds_read_b64_tr_b16 a[170:171], v17 offset:25344
  v_mfma_f32_4x4x4_16b_bf16 v[80:83], v[96:97], a[148:149], 0
  v_cvt_pk_bf16_f32 v88, v88, v89
  v_cvt_pk_bf16_f32 v90, v90, v91
  buffer_load_dwordx4 v15, s[12:15], s36 offen offset:1024 lds
  v_mfma_f32_4x4x4_16b_bf16 v[84:87], v[98:99], a[150:151], 0
  v_cvt_pk_bf16_f32 v92, v92, v93
  v_cvt_pk_bf16_f32 v94, v94, v95
  ds_read_b64_tr_b16 a[172:173], v17 offset:24584
  v_mfma_f32_16x16x32_bf16 v[28:31], a[124:127], a[208:211], v[28:31]
  v_accvgpr_write_b32 a140, v88
  v_accvgpr_write_b32 a141, v90
  ds_read_b64_tr_b16 a[174:175], v17 offset:25352
  v_mfma_f32_16x16x32_bf16 v[52:55], a[124:127], a[212:215], v[52:55]
  v_accvgpr_write_b32 a142, v92
  v_accvgpr_write_b32 a143, v94
  ds_read_b64_tr_b16 a[176:177], v17 offset:24592
  v_mfma_f32_4x4x4_16b_bf16 v[88:91], v[96:97], a[152:153], 0
  v_cvt_pk_bf16_f32 v112, v72, v73
  ds_read_b64_tr_b16 a[178:179], v17 offset:25360
  buffer_load_dwordx4 v16, s[12:15], s36 offen offset:2048 lds
  v_mfma_f32_4x4x4_16b_bf16 v[92:95], v[98:99], a[154:155], 0
  v_cvt_pk_bf16_f32 v113, v74, v75
  v_mfma_f32_16x16x32_bf16 v[32:35], a[128:131], a[208:211], v[32:35]
  v_cvt_pk_bf16_f32 v114, v76, v77
  ds_read_b64_tr_b16 a[180:181], v17 offset:24600
  v_mfma_f32_16x16x32_bf16 v[56:59], a[128:131], a[212:215], v[56:59]
  v_cvt_pk_bf16_f32 v115, v78, v79
  ds_read_b64_tr_b16 a[182:183], v17 offset:25368
  v_mfma_f32_4x4x4_16b_bf16 v[72:75], v[96:97], a[156:157], 0
  v_cvt_pk_bf16_f32 v116, v80, v81
  ds_read_b64_tr_b16 a[184:185], v17 offset:24608
  s_add_u32 m0, s34, 3072
  s_add_u32 s36, s36, 12288
  buffer_load_dwordx4 v14, s[12:15], s36 offen offset:0 lds
  v_mfma_f32_4x4x4_16b_bf16 v[76:79], v[98:99], a[158:159], 0
  v_cvt_pk_bf16_f32 v117, v82, v83
  ds_read_b64_tr_b16 a[186:187], v17 offset:25376
  v_mfma_f32_16x16x32_bf16 v[36:39], a[132:135], a[208:211], v[36:39]
  v_cvt_pk_bf16_f32 v118, v84, v85
  v_mfma_f32_16x16x32_bf16 v[60:63], a[132:135], a[212:215], v[60:63]
  v_cvt_pk_bf16_f32 v119, v86, v87
  ds_read_b64_tr_b16 a[188:189], v17 offset:24616
  v_mfma_f32_4x4x4_16b_bf16 v[80:83], v[96:97], a[160:161], 0
  v_cvt_pk_bf16_f32 v120, v88, v89
  ds_read_b64_tr_b16 a[190:191], v17 offset:25384
  buffer_load_dwordx4 v15, s[12:15], s36 offen offset:1024 lds
  v_mfma_f32_4x4x4_16b_bf16 v[84:87], v[98:99], a[162:163], 0
  v_cvt_pk_bf16_f32 v121, v90, v91
  s_waitcnt lgkmcnt(14)
  v_mfma_f32_16x16x32_bf16 v[40:43], a[136:139], a[208:211], v[40:43]
  v_cvt_pk_bf16_f32 v122, v92, v93
  v_and_b32 v100, v19, v100
  v_mfma_f32_16x16x32_bf16 v[64:67], a[136:139], a[212:215], v[64:67]
  v_cvt_pk_bf16_f32 v123, v94, v95
  v_mfma_f32_4x4x4_16b_bf16 v[88:91], v[96:97], a[164:165], 0
  v_cvt_pk_bf16_f32 v124, v72, v73
  v_and_b32 v101, v20, v101
  buffer_load_dwordx4 v16, s[12:15], s36 offen offset:2048 lds
  v_mfma_f32_4x4x4_16b_bf16 v[92:95], v[98:99], a[166:167], 0
  v_cvt_pk_bf16_f32 v125, v74, v75
  v_and_b32 v102, v19, v102
  v_mfma_f32_16x16x32_bf16 v[44:47], a[140:143], a[208:211], v[44:47]
  v_cvt_pk_bf16_f32 v126, v76, v77
  v_and_b32 v103, v20, v103
  v_mfma_f32_16x16x32_bf16 v[68:71], a[140:143], a[212:215], v[68:71]
  v_cvt_pk_bf16_f32 v127, v78, v79
  s_waitcnt lgkmcnt(0)
  s_nop 0
  v_mfma_f32_4x4x4_16b_bf16 v[72:75], v[100:101], a[168:169], 0
  v_cvt_pk_bf16_f32 v128, v80, v81
  s_waitcnt vmcnt(12)
  s_add_u32 m0, s34, 24576
  s_add_u32 s36, s36, 12288
  buffer_load_dwordx4 v14, s[12:15], s36 offen offset:0 lds
  v_mfma_f32_4x4x4_16b_bf16 v[76:79], v[102:103], a[170:171], 0
  v_cvt_pk_bf16_f32 v129, v82, v83
  ds_read_b128 v[96:99], v18 offset:512
  v_mfma_f32_16x16x32_bf16 v[24:27], v[112:115], a[192:195], v[24:27]
  ds_read_b128 a[208:211], v7 offset:512
  ds_read_b128 a[212:215], v7 offset:12800
  v_cvt_pk_bf16_f32 v130, v84, v85
  ds_read_b64_tr_b16 a[144:145], v104 offset:0
  v_mfma_f32_16x16x32_bf16 v[48:51], v[112:115], a[196:199], v[48:51]
  v_cvt_pk_bf16_f32 v131, v86, v87
  ds_read_b64_tr_b16 a[146:147], v104 offset:768
  v_mfma_f32_4x4x4_16b_bf16 v[80:83], v[100:101], a[172:173], 0
  v_cvt_pk_bf16_f32 v132, v88, v89
  buffer_load_dwordx4 v15, s[12:15], s36 offen offset:1024 lds
  v_mfma_f32_4x4x4_16b_bf16 v[84:87], v[102:103], a[174:175], 0
  v_cvt_pk_bf16_f32 v133, v90, v91
  ds_read_b64_tr_b16 a[148:149], v104 offset:8
  v_mfma_f32_16x16x32_bf16 v[28:31], v[116:119], a[192:195], v[28:31]
  v_cvt_pk_bf16_f32 v134, v92, v93
  ds_read_b64_tr_b16 a[150:151], v104 offset:776
  v_mfma_f32_16x16x32_bf16 v[52:55], v[116:119], a[196:199], v[52:55]
  v_cvt_pk_bf16_f32 v135, v94, v95
  ds_read_b64_tr_b16 a[152:153], v104 offset:16
  v_mfma_f32_4x4x4_16b_bf16 v[88:91], v[100:101], a[176:177], 0
  v_cvt_pk_bf16_f32 v136, v72, v73
  ds_read_b64_tr_b16 a[154:155], v104 offset:784
  buffer_load_dwordx4 v16, s[12:15], s36 offen offset:2048 lds
  v_mfma_f32_4x4x4_16b_bf16 v[92:95], v[102:103], a[178:179], 0
  v_cvt_pk_bf16_f32 v137, v74, v75
  v_mfma_f32_16x16x32_bf16 v[32:35], v[120:123], a[192:195], v[32:35]
  v_cvt_pk_bf16_f32 v138, v76, v77
  ds_read_b64_tr_b16 a[156:157], v104 offset:24
  v_mfma_f32_16x16x32_bf16 v[56:59], v[120:123], a[196:199], v[56:59]
  v_cvt_pk_bf16_f32 v139, v78, v79
  ds_read_b64_tr_b16 a[158:159], v104 offset:792
  v_mfma_f32_4x4x4_16b_bf16 v[72:75], v[100:101], a[180:181], 0
  v_cvt_pk_bf16_f32 v140, v80, v81
  ds_read_b64_tr_b16 a[160:161], v104 offset:32
  s_add_u32 m0, s34, 27648
  s_add_u32 s36, s36, 12288
  buffer_load_dwordx4 v14, s[12:15], s36 offen offset:0 lds
  v_mfma_f32_4x4x4_16b_bf16 v[76:79], v[102:103], a[182:183], 0
  v_cvt_pk_bf16_f32 v141, v82, v83
  ds_read_b64_tr_b16 a[162:163], v104 offset:800
  v_mfma_f32_16x16x32_bf16 v[36:39], v[124:127], a[192:195], v[36:39]
  v_cvt_pk_bf16_f32 v142, v84, v85
  v_mfma_f32_16x16x32_bf16 v[60:63], v[124:127], a[196:199], v[60:63]
  v_cvt_pk_bf16_f32 v143, v86, v87
  ds_read_b64_tr_b16 a[164:165], v104 offset:40
  v_mfma_f32_4x4x4_16b_bf16 v[80:83], v[100:101], a[184:185], 0
  v_cvt_pk_bf16_f32 v144, v88, v89
  ds_read_b64_tr_b16 a[166:167], v104 offset:808
  buffer_load_dwordx4 v15, s[12:15], s36 offen offset:1024 lds
  v_mfma_f32_4x4x4_16b_bf16 v[84:87], v[102:103], a[186:187], 0
  v_cvt_pk_bf16_f32 v145, v90, v91
  s_waitcnt lgkmcnt(14)
  v_mfma_f32_16x16x32_bf16 v[40:43], v[128:131], a[192:195], v[40:43]
  v_cvt_pk_bf16_f32 v146, v92, v93
  v_and_b32 v96, v19, v96
  v_mfma_f32_16x16x32_bf16 v[64:67], v[128:131], a[196:199], v[64:67]
  v_cvt_pk_bf16_f32 v147, v94, v95
  v_mfma_f32_4x4x4_16b_bf16 v[88:91], v[100:101], a[188:189], 0
  v_cvt_pk_bf16_f32 v148, v72, v73
  v_and_b32 v97, v20, v97
  buffer_load_dwordx4 v16, s[12:15], s36 offen offset:2048 lds
  v_mfma_f32_4x4x4_16b_bf16 v[92:95], v[102:103], a[190:191], 0
  v_cvt_pk_bf16_f32 v149, v74, v75
  v_and_b32 v98, v19, v98
  v_mfma_f32_16x16x32_bf16 v[44:47], v[132:135], a[192:195], v[44:47]
  v_cvt_pk_bf16_f32 v150, v76, v77
  v_and_b32 v99, v20, v99
  v_mfma_f32_16x16x32_bf16 v[68:71], v[132:135], a[196:199], v[68:71]
  v_cvt_pk_bf16_f32 v151, v78, v79
  s_waitcnt lgkmcnt(0)
  s_barrier
  s_nop 0
  v_mfma_f32_4x4x4_16b_bf16 v[72:75], v[96:97], a[144:145], 0
  v_cvt_pk_bf16_f32 v152, v80, v81
  s_waitcnt vmcnt(12)
  s_add_u32 m0, s33, 49152
  s_nop 0
  buffer_load_dwordx4 v1, s[4:7], s21 offen nt lds
  v_mfma_f32_4x4x4_16b_bf16 v[76:79], v[98:99], a[146:147], 0
  v_cvt_pk_bf16_f32 v153, v82, v83
  ds_read_b128 v[100:103], v18 offset:576
  v_mfma_f32_16x16x32_bf16 v[24:27], v[136:139], a[200:203], v[24:27]
  ds_read_b128 a[192:195], v8 offset:512
  ds_read_b128 a[196:199], v8 offset:12800
  v_cvt_pk_bf16_f32 v154, v84, v85
  ds_read_b64_tr_b16 a[168:169], v104 offset:24576
  v_mfma_f32_16x16x32_bf16 v[48:51], v[136:139], a[204:207], v[48:51]
  v_cvt_pk_bf16_f32 v155, v86, v87
  ds_read_b64_tr_b16 a[170:171], v104 offset:25344
  v_mfma_f32_4x4x4_16b_bf16 v[80:83], v[96:97], a[148:149], 0
  v_cvt_pk_bf16_f32 v156, v88, v89
  s_add_u32 m0, s33, 53248
  s_nop 0
  buffer_load_dwordx4 v2, s[4:7], s21 offen nt lds
  v_mfma_f32_4x4x4_16b_bf16 v[84:87], v[98:99], a[150:151], 0
  v_cvt_pk_bf16_f32 v157, v90, v91
  ds_read_b64_tr_b16 a[172:173], v104 offset:24584
  v_mfma_f32_16x16x32_bf16 v[28:31], v[140:143], a[200:203], v[28:31]
  v_cvt_pk_bf16_f32 v158, v92, v93
  ds_read_b64_tr_b16 a[174:175], v104 offset:25352
  v_mfma_f32_16x16x32_bf16 v[52:55], v[140:143], a[204:207], v[52:55]
  v_cvt_pk_bf16_f32 v159, v94, v95
  ds_read_b64_tr_b16 a[176:177], v104 offset:24592
  v_mfma_f32_4x4x4_16b_bf16 v[88:91], v[96:97], a[152:153], 0
  v_cvt_pk_bf16_f32 v160, v72, v73
  ds_read_b64_tr_b16 a[178:179], v104 offset:25360
  s_add_u32 m0, s33, 57344
  s_nop 0
  buffer_load_dwordx4 v3, s[4:7], s21 offen nt lds
  v_mfma_f32_4x4x4_16b_bf16 v[92:95], v[98:99], a[154:155], 0
  v_cvt_pk_bf16_f32 v161, v74, v75
  v_mfma_f32_16x16x32_bf16 v[32:35], v[144:147], a[200:203], v[32:35]
  v_cvt_pk_bf16_f32 v162, v76, v77
  ds_read_b64_tr_b16 a[180:181], v104 offset:24600
  v_mfma_f32_16x16x32_bf16 v[56:59], v[144:147], a[204:207], v[56:59]
  v_cvt_pk_bf16_f32 v163, v78, v79
  ds_read_b64_tr_b16 a[182:183], v104 offset:25368
  v_mfma_f32_4x4x4_16b_bf16 v[72:75], v[96:97], a[156:157], 0
  v_cvt_pk_bf16_f32 v164, v80, v81
  ds_read_b64_tr_b16 a[184:185], v104 offset:24608
  s_add_u32 m0, s33, 61440
  s_add_u32 s21, s21, 6291456
  buffer_load_dwordx4 v1, s[4:7], s37 offen nt lds
  v_mfma_f32_4x4x4_16b_bf16 v[76:79], v[98:99], a[158:159], 0
  v_cvt_pk_bf16_f32 v165, v82, v83
  ds_read_b64_tr_b16 a[186:187], v104 offset:25376
  v_mfma_f32_16x16x32_bf16 v[36:39], v[148:151], a[200:203], v[36:39]
  v_cvt_pk_bf16_f32 v166, v84, v85
  v_mfma_f32_16x16x32_bf16 v[60:63], v[148:151], a[204:207], v[60:63]
  v_cvt_pk_bf16_f32 v167, v86, v87
  ds_read_b64_tr_b16 a[188:189], v104 offset:24616
  v_mfma_f32_4x4x4_16b_bf16 v[80:83], v[96:97], a[160:161], 0
  v_cvt_pk_bf16_f32 v168, v88, v89
  ds_read_b64_tr_b16 a[190:191], v104 offset:25384
  s_add_u32 m0, s33, 65536
  s_nop 0
  buffer_load_dwordx4 v2, s[4:7], s37 offen nt lds
  v_mfma_f32_4x4x4_16b_bf16 v[84:87], v[98:99], a[162:163], 0
  v_cvt_pk_bf16_f32 v169, v90, v91
  s_waitcnt lgkmcnt(14)
  v_mfma_f32_16x16x32_bf16 v[40:43], v[152:155], a[200:203], v[40:43]
  v_cvt_pk_bf16_f32 v170, v92, v93
  v_and_b32 v100, v19, v100
  v_mfma_f32_16x16x32_bf16 v[64:67], v[152:155], a[204:207], v[64:67]
  v_cvt_pk_bf16_f32 v171, v94, v95
  v_mfma_f32_4x4x4_16b_bf16 v[88:91], v[96:97], a[164:165], 0
  v_cvt_pk_bf16_f32 v172, v72, v73
  v_and_b32 v101, v20, v101
  s_add_u32 m0, s33, 69632
  s_nop 0
  buffer_load_dwordx4 v3, s[4:7], s37 offen nt lds
  s_add_u32 s37, s37, 6291456
  v_mfma_f32_4x4x4_16b_bf16 v[92:95], v[98:99], a[166:167], 0
  v_cvt_pk_bf16_f32 v173, v74, v75
  v_and_b32 v102, v19, v102
  v_mfma_f32_16x16x32_bf16 v[44:47], v[156:159], a[200:203], v[44:47]
  v_cvt_pk_bf16_f32 v174, v76, v77
  v_and_b32 v103, v20, v103
  v_mfma_f32_16x16x32_bf16 v[68:71], v[156:159], a[204:207], v[68:71]
  v_cvt_pk_bf16_f32 v175, v78, v79
  s_waitcnt lgkmcnt(0)
  s_barrier
  s_nop 0
  v_mfma_f32_4x4x4_16b_bf16 v[72:75], v[100:101], a[168:169], 0
  v_cvt_pk_bf16_f32 v176, v80, v81
  s_waitcnt vmcnt(12)
  s_add_u32 m0, s33, 73728
  s_nop 0
  buffer_load_dwordx4 v1, s[4:7], s21 offen nt lds
  v_mfma_f32_4x4x4_16b_bf16 v[76:79], v[102:103], a[170:171], 0
  v_cvt_pk_bf16_f32 v177, v82, v83
  ds_read_b128 v[96:99], v18 offset:640
  v_mfma_f32_16x16x32_bf16 v[24:27], v[160:163], a[208:211], v[24:27]
  ds_read_b128 a[200:203], v9 offset:512
  ds_read_b128 a[204:207], v9 offset:12800
  v_cvt_pk_bf16_f32 v178, v84, v85
  ds_read_b64_tr_b16 a[144:145], v17 offset:0
  v_mfma_f32_16x16x32_bf16 v[48:51], v[160:163], a[212:215], v[48:51]
  v_cvt_pk_bf16_f32 v179, v86, v87
  ds_read_b64_tr_b16 a[146:147], v17 offset:768
  v_mfma_f32_4x4x4_16b_bf16 v[80:83], v[100:101], a[172:173], 0
  v_cvt_pk_bf16_f32 v180, v88, v89
  s_add_u32 m0, s33, 77824
  s_nop 0
  buffer_load_dwordx4 v2, s[4:7], s21 offen nt lds
  v_mfma_f32_4x4x4_16b_bf16 v[84:87], v[102:103], a[174:175], 0
  v_cvt_pk_bf16_f32 v181, v90, v91
  ds_read_b64_tr_b16 a[148:149], v17 offset:8
  v_mfma_f32_16x16x32_bf16 v[28:31], v[164:167], a[208:211], v[28:31]
  v_cvt_pk_bf16_f32 v182, v92, v93
  ds_read_b64_tr_b16 a[150:151], v17 offset:776
  v_mfma_f32_16x16x32_bf16 v[52:55], v[164:167], a[212:215], v[52:55]
  v_cvt_pk_bf16_f32 v183, v94, v95
  ds_read_b64_tr_b16 a[152:153], v17 offset:16
  v_mfma_f32_4x4x4_16b_bf16 v[88:91], v[100:101], a[176:177], 0
  v_cvt_pk_bf16_f32 v184, v72, v73
  ds_read_b64_tr_b16 a[154:155], v17 offset:784
  s_add_u32 m0, s33, 81920
  s_nop 0
  buffer_load_dwordx4 v3, s[4:7], s21 offen nt lds
  v_mfma_f32_4x4x4_16b_bf16 v[92:95], v[102:103], a[178:179], 0
  v_cvt_pk_bf16_f32 v185, v74, v75
  v_mfma_f32_16x16x32_bf16 v[32:35], v[168:171], a[208:211], v[32:35]
  v_cvt_pk_bf16_f32 v186, v76, v77
  ds_read_b64_tr_b16 a[156:157], v17 offset:24
  v_mfma_f32_16x16x32_bf16 v[56:59], v[168:171], a[212:215], v[56:59]
  v_cvt_pk_bf16_f32 v187, v78, v79
  ds_read_b64_tr_b16 a[158:159], v17 offset:792
  v_mfma_f32_4x4x4_16b_bf16 v[72:75], v[100:101], a[180:181], 0
  v_cvt_pk_bf16_f32 v188, v80, v81
  ds_read_b64_tr_b16 a[160:161], v17 offset:32
  s_add_u32 m0, s33, 86016
  s_add_u32 s21, s21, 6291456
  buffer_load_dwordx4 v1, s[4:7], s37 offen nt lds
  v_mfma_f32_4x4x4_16b_bf16 v[76:79], v[102:103], a[182:183], 0
  v_cvt_pk_bf16_f32 v189, v82, v83
  ds_read_b64_tr_b16 a[162:163], v17 offset:800
  v_mfma_f32_16x16x32_bf16 v[36:39], v[172:175], a[208:211], v[36:39]
  v_cvt_pk_bf16_f32 v190, v84, v85
  v_mfma_f32_16x16x32_bf16 v[60:63], v[172:175], a[212:215], v[60:63]
  v_cvt_pk_bf16_f32 v191, v86, v87
  ds_read_b64_tr_b16 a[164:165], v17 offset:40
  v_mfma_f32_4x4x4_16b_bf16 v[80:83], v[100:101], a[184:185], 0
  v_cvt_pk_bf16_f32 v192, v88, v89
  ds_read_b64_tr_b16 a[166:167], v17 offset:808
  s_add_u32 m0, s33, 90112
  s_nop 0
  buffer_load_dwordx4 v2, s[4:7], s37 offen nt lds
  v_mfma_f32_4x4x4_16b_bf16 v[84:87], v[102:103], a[186:187], 0
  v_cvt_pk_bf16_f32 v193, v90, v91
  s_waitcnt lgkmcnt(14)
  v_mfma_f32_16x16x32_bf16 v[40:43], v[176:179], a[208:211], v[40:43]
  v_cvt_pk_bf16_f32 v194, v92, v93
  v_and_b32 v96, v19, v96
  v_mfma_f32_16x16x32_bf16 v[64:67], v[176:179], a[212:215], v[64:67]
  v_cvt_pk_bf16_f32 v195, v94, v95
  v_mfma_f32_4x4x4_16b_bf16 v[88:91], v[100:101], a[188:189], 0
  v_cvt_pk_bf16_f32 v196, v72, v73
  v_and_b32 v97, v20, v97
  s_add_u32 m0, s33, 94208
  s_nop 0
  buffer_load_dwordx4 v3, s[4:7], s37 offen nt lds
  s_add_u32 s37, s37, 6291456
  v_mfma_f32_4x4x4_16b_bf16 v[92:95], v[102:103], a[190:191], 0
  v_cvt_pk_bf16_f32 v197, v74, v75
  v_and_b32 v98, v19, v98
  v_mfma_f32_16x16x32_bf16 v[44:47], v[180:183], a[208:211], v[44:47]
  v_cvt_pk_bf16_f32 v198, v76, v77
  v_and_b32 v99, v20, v99
  v_mfma_f32_16x16x32_bf16 v[68:71], v[180:183], a[212:215], v[68:71]
  v_cvt_pk_bf16_f32 v199, v78, v79
  s_waitcnt lgkmcnt(0)
  s_nop 0
  v_mfma_f32_4x4x4_16b_bf16 v[72:75], v[96:97], a[144:145], 0
  v_cvt_pk_bf16_f32 v200, v80, v81
  s_waitcnt vmcnt(12)
  v_mfma_f32_4x4x4_16b_bf16 v[76:79], v[98:99], a[146:147], 0
  v_cvt_pk_bf16_f32 v201, v82, v83
  ds_read_b128 v[100:103], v18 offset:704
  v_mfma_f32_16x16x32_bf16 v[24:27], v[184:187], a[192:195], v[24:27]
  ds_read_b128 a[208:211], v10 offset:512
  ds_read_b128 a[212:215], v10 offset:12800
  v_cvt_pk_bf16_f32 v202, v84, v85
  ds_read_b64_tr_b16 a[168:169], v17 offset:24576
  v_mfma_f32_16x16x32_bf16 v[48:51], v[184:187], a[196:199], v[48:51]
  v_cvt_pk_bf16_f32 v203, v86, v87
  ds_read_b64_tr_b16 a[170:171], v17 offset:25344
  v_mfma_f32_4x4x4_16b_bf16 v[80:83], v[96:97], a[148:149], 0
  v_cvt_pk_bf16_f32 v204, v88, v89
  v_mfma_f32_4x4x4_16b_bf16 v[84:87], v[98:99], a[150:151], 0
  v_cvt_pk_bf16_f32 v205, v90, v91
  ds_read_b64_tr_b16 a[172:173], v17 offset:24584
  v_mfma_f32_16x16x32_bf16 v[28:31], v[188:191], a[192:195], v[28:31]
  v_cvt_pk_bf16_f32 v206, v92, v93
  ds_read_b64_tr_b16 a[174:175], v17 offset:25352
  v_mfma_f32_16x16x32_bf16 v[52:55], v[188:191], a[196:199], v[52:55]
  v_cvt_pk_bf16_f32 v207, v94, v95
  ds_read_b64_tr_b16 a[176:177], v17 offset:24592
  v_mfma_f32_4x4x4_16b_bf16 v[88:91], v[96:97], a[152:153], 0
  v_cvt_pk_bf16_f32 v208, v72, v73
  ds_read_b64_tr_b16 a[178:179], v17 offset:25360
  v_mfma_f32_4x4x4_16b_bf16 v[92:95], v[98:99], a[154:155], 0
  v_cvt_pk_bf16_f32 v209, v74, v75
  v_mfma_f32_16x16x32_bf16 v[32:35], v[192:195], a[192:195], v[32:35]
  v_cvt_pk_bf16_f32 v210, v76, v77
  ds_read_b64_tr_b16 a[180:181], v17 offset:24600
  v_mfma_f32_16x16x32_bf16 v[56:59], v[192:195], a[196:199], v[56:59]
  v_cvt_pk_bf16_f32 v211, v78, v79
  ds_read_b64_tr_b16 a[182:183], v17 offset:25368
  v_mfma_f32_4x4x4_16b_bf16 v[72:75], v[96:97], a[156:157], 0
  v_cvt_pk_bf16_f32 v212, v80, v81
  ds_read_b64_tr_b16 a[184:185], v17 offset:24608
  v_mfma_f32_4x4x4_16b_bf16 v[76:79], v[98:99], a[158:159], 0
  v_cvt_pk_bf16_f32 v213, v82, v83
  ds_read_b64_tr_b16 a[186:187], v17 offset:25376
  v_mfma_f32_16x16x32_bf16 v[36:39], v[196:199], a[192:195], v[36:39]
  v_cvt_pk_bf16_f32 v214, v84, v85
  v_mfma_f32_16x16x32_bf16 v[60:63], v[196:199], a[196:199], v[60:63]
  v_cvt_pk_bf16_f32 v215, v86, v87
  ds_read_b64_tr_b16 a[188:189], v17 offset:24616
  v_mfma_f32_4x4x4_16b_bf16 v[80:83], v[96:97], a[160:161], 0
  v_cvt_pk_bf16_f32 v216, v88, v89
  ds_read_b64_tr_b16 a[190:191], v17 offset:25384
  v_mfma_f32_4x4x4_16b_bf16 v[84:87], v[98:99], a[162:163], 0
  v_cvt_pk_bf16_f32 v217, v90, v91
  s_waitcnt lgkmcnt(14)
  v_mfma_f32_16x16x32_bf16 v[40:43], v[200:203], a[192:195], v[40:43]
  v_cvt_pk_bf16_f32 v218, v92, v93
  v_and_b32 v100, v19, v100
  v_mfma_f32_16x16x32_bf16 v[64:67], v[200:203], a[196:199], v[64:67]
  v_cvt_pk_bf16_f32 v219, v94, v95
  v_mfma_f32_4x4x4_16b_bf16 v[88:91], v[96:97], a[164:165], 0
  v_cvt_pk_bf16_f32 v220, v72, v73
  v_and_b32 v101, v20, v101
  v_mfma_f32_4x4x4_16b_bf16 v[92:95], v[98:99], a[166:167], 0
  v_cvt_pk_bf16_f32 v221, v74, v75
  v_and_b32 v102, v19, v102
  v_mfma_f32_16x16x32_bf16 v[44:47], v[204:207], a[192:195], v[44:47]
  v_cvt_pk_bf16_f32 v222, v76, v77
  v_and_b32 v103, v20, v103
  v_mfma_f32_16x16x32_bf16 v[68:71], v[204:207], a[196:199], v[68:71]
  v_cvt_pk_bf16_f32 v223, v78, v79
  s_waitcnt lgkmcnt(0)
  s_nop 0
  v_mfma_f32_4x4x4_16b_bf16 v[72:75], v[100:101], a[168:169], 0
  v_cvt_pk_bf16_f32 v224, v80, v81
  v_mfma_f32_4x4x4_16b_bf16 v[76:79], v[102:103], a[170:171], 0
  v_cvt_pk_bf16_f32 v225, v82, v83
  v_mfma_f32_16x16x32_bf16 v[24:27], v[208:211], a[200:203], v[24:27]
  v_cvt_pk_bf16_f32 v226, v84, v85
  v_mfma_f32_16x16x32_bf16 v[48:51], v[208:211], a[204:207], v[48:51]
  v_cvt_pk_bf16_f32 v227, v86, v87
  v_mfma_f32_4x4x4_16b_bf16 v[80:83], v[100:101], a[172:173], 0
  v_cvt_pk_bf16_f32 v228, v88, v89
  v_mfma_f32_4x4x4_16b_bf16 v[84:87], v[102:103], a[174:175], 0
  v_cvt_pk_bf16_f32 v229, v90, v91
  v_mfma_f32_16x16x32_bf16 v[28:31], v[212:215], a[200:203], v[28:31]
  v_cvt_pk_bf16_f32 v230, v92, v93
  v_mfma_f32_16x16x32_bf16 v[52:55], v[212:215], a[204:207], v[52:55]
  v_cvt_pk_bf16_f32 v231, v94, v95
  v_mfma_f32_4x4x4_16b_bf16 v[88:91], v[100:101], a[176:177], 0
  v_cvt_pk_bf16_f32 v232, v72, v73
  v_mfma_f32_4x4x4_16b_bf16 v[92:95], v[102:103], a[178:179], 0
  v_cvt_pk_bf16_f32 v233, v74, v75
  v_mfma_f32_16x16x32_bf16 v[32:35], v[216:219], a[200:203], v[32:35]
  v_cvt_pk_bf16_f32 v234, v76, v77
  v_mfma_f32_16x16x32_bf16 v[56:59], v[216:219], a[204:207], v[56:59]
  v_cvt_pk_bf16_f32 v235, v78, v79
  v_mfma_f32_4x4x4_16b_bf16 v[72:75], v[100:101], a[180:181], 0
  v_cvt_pk_bf16_f32 v236, v80, v81
  v_mfma_f32_4x4x4_16b_bf16 v[76:79], v[102:103], a[182:183], 0
  v_cvt_pk_bf16_f32 v237, v82, v83
  v_mfma_f32_16x16x32_bf16 v[36:39], v[220:223], a[200:203], v[36:39]
  v_cvt_pk_bf16_f32 v238, v84, v85
  v_mfma_f32_16x16x32_bf16 v[60:63], v[220:223], a[204:207], v[60:63]
  v_cvt_pk_bf16_f32 v239, v86, v87
  v_mfma_f32_4x4x4_16b_bf16 v[80:83], v[100:101], a[184:185], 0
  v_cvt_pk_bf16_f32 v240, v88, v89
  v_mfma_f32_4x4x4_16b_bf16 v[84:87], v[102:103], a[186:187], 0
  v_cvt_pk_bf16_f32 v241, v90, v91
  v_mfma_f32_16x16x32_bf16 v[40:43], v[224:227], a[200:203], v[40:43]
  v_cvt_pk_bf16_f32 v242, v92, v93
  v_mfma_f32_16x16x32_bf16 v[64:67], v[224:227], a[204:207], v[64:67]
  v_cvt_pk_bf16_f32 v243, v94, v95
  v_mfma_f32_4x4x4_16b_bf16 v[88:91], v[100:101], a[188:189], 0
  v_cvt_pk_bf16_f32 v244, v72, v73
  v_mfma_f32_4x4x4_16b_bf16 v[92:95], v[102:103], a[190:191], 0
  v_cvt_pk_bf16_f32 v245, v74, v75
  v_mfma_f32_16x16x32_bf16 v[44:47], v[228:231], a[200:203], v[44:47]
  v_cvt_pk_bf16_f32 v246, v76, v77
  v_mfma_f32_16x16x32_bf16 v[68:71], v[228:231], a[204:207], v[68:71]
  v_cvt_pk_bf16_f32 v247, v78, v79
  s_nop 0
  v_mfma_f32_16x16x32_bf16 v[24:27], v[232:235], a[208:211], v[24:27]
  v_cvt_pk_bf16_f32 v248, v80, v81
  v_cvt_pk_bf16_f32 v249, v82, v83
  v_mfma_f32_16x16x32_bf16 v[48:51], v[232:235], a[212:215], v[48:51]
  v_cvt_pk_bf16_f32 v250, v84, v85
  v_cvt_pk_bf16_f32 v251, v86, v87
  v_mfma_f32_16x16x32_bf16 v[28:31], v[236:239], a[208:211], v[28:31]
  v_cvt_pk_bf16_f32 v252, v88, v89
  v_cvt_pk_bf16_f32 v253, v90, v91
  v_mfma_f32_16x16x32_bf16 v[52:55], v[236:239], a[212:215], v[52:55]
  v_cvt_pk_bf16_f32 v254, v92, v93
  v_cvt_pk_bf16_f32 v255, v94, v95
  v_mfma_f32_16x16x32_bf16 v[32:35], v[240:243], a[208:211], v[32:35]
  v_mfma_f32_16x16x32_bf16 v[56:59], v[240:243], a[212:215], v[56:59]
  v_mfma_f32_16x16x32_bf16 v[36:39], v[244:247], a[208:211], v[36:39]
  v_mfma_f32_16x16x32_bf16 v[60:63], v[244:247], a[212:215], v[60:63]
  v_mfma_f32_16x16x32_bf16 v[40:43], v[248:251], a[208:211], v[40:43]
  v_mfma_f32_16x16x32_bf16 v[64:67], v[248:251], a[212:215], v[64:67]
  v_mfma_f32_16x16x32_bf16 v[44:47], v[252:255], a[208:211], v[44:47]
  v_mfma_f32_16x16x32_bf16 v[68:71], v[252:255], a[212:215], v[68:71]
  s_barrier
  s_mov_b64 vcc, -1
  s_nop 4
  v_cvt_pk_bf16_f32 v24, v24, v25
  v_cvt_pk_bf16_f32 v25, v26, v27
  v_cvt_pk_bf16_f32 v26, v28, v29
  v_cvt_pk_bf16_f32 v27, v30, v31
  ds_write_b128 v11, v[24:27] offset:0
  v_cvt_pk_bf16_f32 v28, v32, v33
  v_cvt_pk_bf16_f32 v29, v34, v35
  v_cvt_pk_bf16_f32 v30, v36, v37
  v_cvt_pk_bf16_f32 v31, v38, v39
  ds_write_b128 v12, v[28:31] offset:0
  v_cvt_pk_bf16_f32 v32, v40, v41
  v_cvt_pk_bf16_f32 v33, v42, v43
  v_cvt_pk_bf16_f32 v34, v44, v45
  v_cvt_pk_bf16_f32 v35, v46, v47
  ds_write_b128 v13, v[32:35] offset:0
  s_waitcnt lgkmcnt(0)
  s_barrier
  ds_read_b128 a[192:195], v7 offset:24576
  ds_read_b128 a[196:199], v8 offset:24576
  ds_read_b128 a[216:219], v1 offset:0
  ds_read_b128 a[220:223], v2 offset:0
  ds_read_b128 a[224:227], v3 offset:0
  s_xor_b32 s42, s42, 0x14000
  s_add_u32 m0, s42, 0
  s_cbranch_vccz L_sk1
  buffer_load_dwordx4 v1, s[4:7], s21 offen nt lds
L_sk1:
  ds_read_b128 a[200:203], v9 offset:24576
  ds_read_b128 a[204:207], v10 offset:24576
  ds_read_b128 a[228:231], v1 offset:12288
  ds_read_b128 a[232:235], v2 offset:12288
  ds_read_b128 a[236:239], v3 offset:12288
  s_waitcnt lgkmcnt(7)
  buffer_store_dwordx4 a[216:219], v4, s[8:11], s22 offen sc1
.p2align 6
L_loop0:
  v_mfma_f32_16x16x32_bf16 v[24:27], a[0:3], a[192:195], 0
  ds_read_b128 a[208:211], v7 offset:24832
  v_mfma_f32_16x16x32_bf16 v[24:27], a[24:27], a[196:199], v[24:27]
  ds_read_b128 a[212:215], v8 offset:24832
  v_mfma_f32_16x16x32_bf16 v[28:31], a[4:7], a[192:195], 0
  v_mfma_f32_16x16x32_bf16 v[28:31], a[28:31], a[196:199], v[28:31]
  v_mfma_f32_16x16x32_bf16 v[32:35], a[8:11], a[192:195], 0
  v_mfma_f32_16x16x32_bf16 v[32:35], a[32:35], a[196:199], v[32:35]
  v_mfma_f32_16x16x32_bf16 v[36:39], a[12:15], a[192:195], 0
  v_mfma_f32_16x16x32_bf16 v[36:39], a[36:39], a[196:199], v[36:39]
  s_add_u32 m0, s42, 4096
  v_mfma_f32_16x16x32_bf16 v[40:43], a[16:19], a[192:195], 0
  s_cbranch_vccz L_sk2
  buffer_load_dwordx4 v2, s[4:7], s21 offen nt lds
L_sk2:
  v_mfma_f32_16x16x32_bf16 v[40:43], a[40:43], a[196:199], v[40:43]
  v_mfma_f32_16x16x32_bf16 v[44:47], a[20:23], a[192:195], 0
  v_mfma_f32_16x16x32_bf16 v[44:47], a[44:47], a[196:199], v[44:47]
  s_waitcnt lgkmcnt(5)
  v_mfma_f32_16x16x32_bf16 v[24:27], a[48:51], a[200:203], v[24:27]
  ds_read_b128 a[192:195], v9 offset:24832
  v_mfma_f32_16x16x32_bf16 v[24:27], a[72:75], a[204:207], v[24:27]
  ds_read_b128 a[196:199], v10 offset:24832
  v_mfma_f32_16x16x32_bf16 v[28:31], a[52:55], a[200:203], v[28:31]
  v_cvt_pk_bf16_f32 v48, v48, v49
  v_mfma_f32_16x16x32_bf16 v[28:31], a[76:79], a[204:207], v[28:31]
  v_cvt_pk_bf16_f32 v49, v50, v51
  v_mfma_f32_16x16x32_bf16 v[32:35], a[56:59], a[200:203], v[32:35]
  v_cvt_pk_bf16_f32 v50, v52, v53
  v_mfma_f32_16x16x32_bf16 v[32:35], a[80:83], a[204:207], v[32:35]
  v_cvt_pk_bf16_f32 v51, v54, v55
  v_mfma_f32_16x16x32_bf16 v[36:39], a[60:63], a[200:203], v[36:39]
  ds_write_b128 v11, v[48:51] offset:36864
  v_mfma_f32_16x16x32_bf16 v[36:39], a[84:87], a[204:207], v[36:39]
  v_mfma_f32_16x16x32_bf16 v[40:43], a[64:67], a[200:203], v[40:43]
  buffer_store_dwordx4 a[220:223], v5, s[8:11], s22 offen sc1
  v_mfma_f32_16x16x32_bf16 v[40:43], a[88:91], a[204:207], v[40:43]
  v_mfma_f32_16x16x32_bf16 v[44:47], a[68:71], a[200:203], v[44:47]
  v_mfma_f32_16x16x32_bf16 v[44:47], a[92:95], a[204:207], v[44:47]
  s_waitcnt lgkmcnt(3)
  v_mfma_f32_16x16x32_bf16 v[24:27], a[96:99], a[208:211], v[24:27]
  ds_read_b128 a[200:203], v7 offset:25088
  v_mfma_f32_16x16x32_bf16 v[24:27], a[120:123], a[212:215], v[24:27]
  ds_read_b128 a[204:207], v8 offset:25088
  v_mfma_f32_16x16x32_bf16 v[28:31], a[100:103], a[208:211], v[28:31]
  v_cvt_pk_bf16_f32 v52, v56, v57
  v_mfma_f32_16x16x32_bf16 v[28:31], a[124:127], a[212:215], v[28:31]
  v_cvt_pk_bf16_f32 v53, v58, v59
  v_mfma_f32_16x16x32_bf16 v[32:35], a[104:107], a[208:211], v[32:35]
  v_cvt_pk_bf16_f32 v54, v60, v61
  v_mfma_f32_16x16x32_bf16 v[32:35], a[128:131], a[212:215], v[32:35]
  v_cvt_pk_bf16_f32 v55, v62, v63
  v_mfma_f32_16x16x32_bf16 v[36:39], a[108:111], a[208:211], v[36:39]
  v_mfma_f32_16x16x32_bf16 v[36:39], a[132:135], a[212:215], v[36:39]
  s_add_u32 m0, s42, 8192
  v_mfma_f32_16x16x32_bf16 v[40:43], a[112:115], a[208:211], v[40:43]
  s_cbranch_vccz L_sk3
  buffer_load_dwordx4 v3, s[4:7], s21 offen nt lds
L_sk3:
  v_mfma_f32_16x16x32_bf16 v[40:43], a[136:139], a[212:215], v[40:43]
  v_mfma_f32_16x16x32_bf16 v[44:47], a[116:119], a[208:211], v[44:47]
  ds_write_b128 v12, v[52:55] offset:36864
  v_mfma_f32_16x16x32_bf16 v[44:47], a[140:143], a[212:215], v[44:47]
  s_waitcnt lgkmcnt(4)
  v_mfma_f32_16x16x32_bf16 v[24:27], v[112:115], a[192:195], v[24:27]
  ds_read_b128 a[208:211], v9 offset:25088
  v_mfma_f32_16x16x32_bf16 v[24:27], v[136:139], a[196:199], v[24:27]
  ds_read_b128 a[212:215], v10 offset:25088
  v_mfma_f32_16x16x32_bf16 v[28:31], v[116:119], a[192:195], v[28:31]
  v_cvt_pk_bf16_f32 v56, v64, v65
  v_mfma_f32_16x16x32_bf16 v[28:31], v[140:143], a[196:199], v[28:31]
  v_cvt_pk_bf16_f32 v57, v66, v67
  v_mfma_f32_16x16x32_bf16 v[32:35], v[120:123], a[192:195], v[32:35]
  v_cvt_pk_bf16_f32 v58, v68, v69
  v_mfma_f32_16x16x32_bf16 v[32:35], v[144:147], a[196:199], v[32:35]
  v_cvt_pk_bf16_f32 v59, v70, v71
  v_mfma_f32_16x16x32_bf16 v[36:39], v[124:127], a[192:195], v[36:39]
  ds_write_b128 v13, v[56:59] offset:36864
  v_mfma_f32_16x16x32_bf16 v[36:39], v[148:151], a[196:199], v[36:39]
  v_mfma_f32_16x16x32_bf16 v[40:43], v[128:131], a[192:195], v[40:43]
  buffer_store_dwordx4 a[224:227], v6, s[8:11], s22 offen sc1
  v_mfma_f32_16x16x32_bf16 v[40:43], v[152:155], a[196:199], v[40:43]
  v_mfma_f32_16x16x32_bf16 v[44:47], v[132:135], a[192:195], v[44:47]
  v_mfma_f32_16x16x32_bf16 v[44:47], v[156:159], a[196:199], v[44:47]
  s_waitcnt lgkmcnt(4)
  v_mfma_f32_16x16x32_bf16 v[24:27], v[160:163], a[200:203], v[24:27]
  ds_read_b128 a[192:195], v7 offset:36864
  v_mfma_f32_16x16x32_bf16 v[24:27], v[184:187], a[204:207], v[24:27]
  ds_read_b128 a[196:199], v8 offset:36864
  v_mfma_f32_16x16x32_bf16 v[28:31], v[164:167], a[200:203], v[28:31]
  v_mfma_f32_16x16x32_bf16 v[28:31], v[188:191], a[204:207], v[28:31]
  s_cmp_eq_u32 s32, 5
  s_cselect_b32 s43, s45, s44
  s_add_u32 s21, s21, s43
  v_mfma_f32_16x16x32_bf16 v[32:35], v[168:171], a[200:203], v[32:35]
  v_mfma_f32_16x16x32_bf16 v[32:35], v[192:195], a[204:207], v[32:35]
  v_mfma_f32_16x16x32_bf16 v[36:39], v[172:175], a[200:203], v[36:39]
  v_mfma_f32_16x16x32_bf16 v[36:39], v[196:199], a[204:207], v[36:39]
  s_add_u32 m0, s42, 12288
  v_mfma_f32_16x16x32_bf16 v[40:43], v[176:179], a[200:203], v[40:43]
  s_cbranch_vccz L_sk4
  buffer_load_dwordx4 v1, s[4:7], s37 offen nt lds
L_sk4:
  v_mfma_f32_16x16x32_bf16 v[40:43], v[200:203], a[204:207], v[40:43]
  v_mfma_f32_16x16x32_bf16 v[44:47], v[180:183], a[200:203], v[44:47]
  v_mfma_f32_16x16x32_bf16 v[44:47], v[204:207], a[204:207], v[44:47]
  s_waitcnt lgkmcnt(3)
  v_mfma_f32_16x16x32_bf16 v[24:27], v[208:211], a[208:211], v[24:27]
  ds_read_b128 a[200:203], v9 offset:36864
  v_mfma_f32_16x16x32_bf16 v[24:27], v[232:235], a[212:215], v[24:27]
  ds_read_b128 a[204:207], v10 offset:36864
  v_mfma_f32_16x16x32_bf16 v[28:31], v[212:215], a[208:211], v[28:31]
  v_mfma_f32_16x16x32_bf16 v[28:31], v[236:239], a[212:215], v[28:31]
  v_mfma_f32_16x16x32_bf16 v[32:35], v[216:219], a[208:211], v[32:35]
  v_mfma_f32_16x16x32_bf16 v[32:35], v[240:243], a[212:215], v[32:35]
  v_mfma_f32_16x16x32_bf16 v[36:39], v[220:223], a[208:211], v[36:39]
  v_mfma_f32_16x16x32_bf16 v[36:39], v[244:247], a[212:215], v[36:39]
  v_mfma_f32_16x16x32_bf16 v[40:43], v[224:227], a[208:211], v[40:43]
  buffer_store_dwordx4 a[228:231], v4, s[8:11], s23 offen sc1
  v_mfma_f32_16x16x32_bf16 v[40:43], v[248:251], a[212:215], v[40:43]
  v_mfma_f32_16x16x32_bf16 v[44:47], v[228:231], a[208:211], v[44:47]
  v_mfma_f32_16x16x32_bf16 v[44:47], v[252:255], a[212:215], v[44:47]
  s_waitcnt lgkmcnt(2)
  v_mfma_f32_16x16x32_bf16 v[48:51], a[0:3], a[192:195], 0
  ds_read_b128 a[208:211], v7 offset:37120
  v_mfma_f32_16x16x32_bf16 v[48:51], a[24:27], a[196:199], v[48:51]
  ds_read_b128 a[212:215], v8 offset:37120
  v_mfma_f32_16x16x32_bf16 v[52:55], a[4:7], a[192:195], 0
  v_cvt_pk_bf16_f32 v24, v24, v25
  v_mfma_f32_16x16x32_bf16 v[52:55], a[28:31], a[196:199], v[52:55]
  v_cvt_pk_bf16_f32 v25, v26, v27
  v_mfma_f32_16x16x32_bf16 v[56:59], a[8:11], a[192:195], 0
  v_cvt_pk_bf16_f32 v26, v28, v29
  v_mfma_f32_16x16x32_bf16 v[56:59], a[32:35], a[196:199], v[56:59]
  v_cvt_pk_bf16_f32 v27, v30, v31
  v_mfma_f32_16x16x32_bf16 v[60:63], a[12:15], a[192:195], 0
  v_mfma_f32_16x16x32_bf16 v[60:63], a[36:39], a[196:199], v[60:63]
  s_add_u32 m0, s42, 16384
  v_mfma_f32_16x16x32_bf16 v[64:67], a[16:19], a[192:195], 0
  s_cbranch_vccz L_sk5
  buffer_load_dwordx4 v2, s[4:7], s37 offen nt lds
L_sk5:
  v_mfma_f32_16x16x32_bf16 v[64:67], a[40:43], a[196:199], v[64:67]
  v_mfma_f32_16x16x32_bf16 v[68:71], a[20:23], a[192:195], 0
  ds_write_b128 v11, v[24:27] offset:24576
  v_mfma_f32_16x16x32_bf16 v[68:71], a[44:47], a[196:199], v[68:71]
  s_waitcnt lgkmcnt(3)
  v_mfma_f32_16x16x32_bf16 v[48:51], a[48:51], a[200:203], v[48:51]
  ds_read_b128 a[192:195], v9 offset:37120
  v_mfma_f32_16x16x32_bf16 v[48:51], a[72:75], a[204:207], v[48:51]
  ds_read_b128 a[196:199], v10 offset:37120
  v_mfma_f32_16x16x32_bf16 v[52:55], a[52:55], a[200:203], v[52:55]
  v_cvt_pk_bf16_f32 v28, v32, v33
  v_mfma_f32_16x16x32_bf16 v[52:55], a[76:79], a[204:207], v[52:55]
  v_cvt_pk_bf16_f32 v29, v34, v35
  v_mfma_f32_16x16x32_bf16 v[56:59], a[56:59], a[200:203], v[56:59]
  v_cvt_pk_bf16_f32 v30, v36, v37
  v_mfma_f32_16x16x32_bf16 v[56:59], a[80:83], a[204:207], v[56:59]
  v_cvt_pk_bf16_f32 v31, v38, v39
  v_mfma_f32_16x16x32_bf16 v[60:63], a[60:63], a[200:203], v[60:63]
  ds_write_b128 v12, v[28:31] offset:24576
  v_mfma_f32_16x16x32_bf16 v[60:63], a[84:87], a[204:207], v[60:63]
  v_mfma_f32_16x16x32_bf16 v[64:67], a[64:67], a[200:203], v[64:67]
  buffer_store_dwordx4 a[232:235], v5, s[8:11], s23 offen sc1
  v_mfma_f32_16x16x32_bf16 v[64:67], a[88:91], a[204:207], v[64:67]
  v_mfma_f32_16x16x32_bf16 v[68:71], a[68:71], a[200:203], v[68:71]
  v_mfma_f32_16x16x32_bf16 v[68:71], a[92:95], a[204:207], v[68:71]
  s_waitcnt lgkmcnt(4)
  v_mfma_f32_16x16x32_bf16 v[48:51], a[96:99], a[208:211], v[48:51]
  ds_read_b128 a[200:203], v7 offset:37376
  v_mfma_f32_16x16x32_bf16 v[48:51], a[120:123], a[212:215], v[48:51]
  ds_read_b128 a[204:207], v8 offset:37376
  v_mfma_f32_16x16x32_bf16 v[52:55], a[100:103], a[208:211], v[52:55]
  v_cvt_pk_bf16_f32 v32, v40, v41
  v_mfma_f32_16x16x32_bf16 v[52:55], a[124:127], a[212:215], v[52:55]
  v_cvt_pk_bf16_f32 v33, v42, v43
  v_mfma_f32_16x16x32_bf16 v[56:59], a[104:107], a[208:211], v[56:59]
  v_cvt_pk_bf16_f32 v34, v44, v45
  v_mfma_f32_16x16x32_bf16 v[56:59], a[128:131], a[212:215], v[56:59]
  v_cvt_pk_bf16_f32 v35, v46, v47
  v_mfma_f32_16x16x32_bf16 v[60:63], a[108:111], a[208:211], v[60:63]
  v_mfma_f32_16x16x32_bf16 v[60:63], a[132:135], a[212:215], v[60:63]
  s_add_u32 m0, s42, 20480
  v_mfma_f32_16x16x32_bf16 v[64:67], a[112:115], a[208:211], v[64:67]
  s_cbranch_vccz L_sk6
  buffer_load_dwordx4 v3, s[4:7], s37 offen nt lds
L_sk6:
  v_mfma_f32_16x16x32_bf16 v[64:67], a[136:139], a[212:215], v[64:67]
  v_mfma_f32_16x16x32_bf16 v[68:71], a[116:119], a[208:211], v[68:71]
  ds_write_b128 v13, v[32:35] offset:24576
  v_mfma_f32_16x16x32_bf16 v[68:71], a[140:143], a[212:215], v[68:71]
  s_waitcnt lgkmcnt(4)
  v_mfma_f32_16x16x32_bf16 v[48:51], v[112:115], a[192:195], v[48:51]
  ds_read_b128 a[208:211], v9 offset:37376
  v_mfma_f32_16x16x32_bf16 v[48:51], v[136:139], a[196:199], v[48:51]
  ds_read_b128 a[212:215], v10 offset:37376
  v_mfma_f32_16x16x32_bf16 v[52:55], v[116:119], a[192:195], v[52:55]
  s_add_u32 s37, s37, s43
  v_mfma_f32_16x16x32_bf16 v[52:55], v[140:143], a[196:199], v[52:55]
  v_xor_b32 v7, 0x14000, v7
  v_mfma_f32_16x16x32_bf16 v[56:59], v[120:123], a[192:195], v[56:59]
  v_xor_b32 v8, 0x14000, v8
  v_mfma_f32_16x16x32_bf16 v[56:59], v[144:147], a[196:199], v[56:59]
  v_xor_b32 v9, 0x14000, v9
  v_mfma_f32_16x16x32_bf16 v[60:63], v[124:127], a[192:195], v[60:63]
  v_xor_b32 v10, 0x14000, v10
  v_mfma_f32_16x16x32_bf16 v[60:63], v[148:151], a[196:199], v[60:63]
  buffer_store_dwordx4 a[236:239], v6, s[8:11], s23 offen sc1
  v_mfma_f32_16x16x32_bf16 v[64:67], v[128:131], a[192:195], v[64:67]
  s_add_u32 s23, s22, 12288
  v_mfma_f32_16x16x32_bf16 v[64:67], v[152:155], a[196:199], v[64:67]
  s_cmp_eq_u32 s32, 1
  s_cselect_b32 s43, s45, s44
  s_add_u32 s22, s22, s43
  v_mfma_f32_16x16x32_bf16 v[68:71], v[132:135], a[192:195], v[68:71]
  s_cmp_eq_u32 s51, 1
  v_mfma_f32_16x16x32_bf16 v[68:71], v[156:159], a[196:199], v[68:71]
  s_waitcnt vmcnt(25) lgkmcnt(0)
  s_cbranch_scc1 L_o1
  s_cbranch_vccz L_ow7
L_ob7:
  s_barrier
  v_mfma_f32_16x16x32_bf16 v[48:51], v[160:163], a[200:203], v[48:51]
  ds_read_b128 a[192:195], v7 offset:0
  v_mfma_f32_16x16x32_bf16 v[48:51], v[184:187], a[204:207], v[48:51]
  ds_read_b128 a[196:199], v8 offset:0
  v_mfma_f32_16x16x32_bf16 v[52:55], v[164:167], a[200:203], v[52:55]
  s_cmp_ge_u32 s32, 5
  s_cselect_b64 vcc, -1, 0
  v_mfma_f32_16x16x32_bf16 v[52:55], v[188:191], a[204:207], v[52:55]
  ds_read_b128 a[216:219], v1 offset:24576
  v_mfma_f32_16x16x32_bf16 v[56:59], v[168:171], a[200:203], v[56:59]
  ds_read_b128 a[220:223], v2 offset:24576
  v_mfma_f32_16x16x32_bf16 v[56:59], v[192:195], a[204:207], v[56:59]
  ds_read_b128 a[224:227], v3 offset:24576
  v_mfma_f32_16x16x32_bf16 v[60:63], v[172:175], a[200:203], v[60:63]
  v_mfma_f32_16x16x32_bf16 v[60:63], v[196:199], a[204:207], v[60:63]
  s_add_u32 m0, s42, 24576
  v_mfma_f32_16x16x32_bf16 v[64:67], v[176:179], a[200:203], v[64:67]
  s_cbranch_vccz L_sk8
  buffer_load_dwordx4 v1, s[4:7], s21 offen nt lds
L_sk8:
  v_mfma_f32_16x16x32_bf16 v[64:67], v[200:203], a[204:207], v[64:67]
  v_mfma_f32_16x16x32_bf16 v[68:71], v[180:183], a[200:203], v[68:71]
  v_mfma_f32_16x16x32_bf16 v[68:71], v[204:207], a[204:207], v[68:71]
  v_mfma_f32_16x16x32_bf16 v[48:51], v[208:211], a[208:211], v[48:51]
  ds_read_b128 a[200:203], v9 offset:0
  v_mfma_f32_16x16x32_bf16 v[48:51], v[232:235], a[212:215], v[48:51]
  ds_read_b128 a[204:207], v10 offset:0
  v_mfma_f32_16x16x32_bf16 v[52:55], v[212:215], a[208:211], v[52:55]
  v_mfma_f32_16x16x32_bf16 v[52:55], v[236:239], a[212:215], v[52:55]
  ds_read_b128 a[228:231], v1 offset:36864
  v_mfma_f32_16x16x32_bf16 v[56:59], v[216:219], a[208:211], v[56:59]
  ds_read_b128 a[232:235], v2 offset:36864
  v_mfma_f32_16x16x32_bf16 v[56:59], v[240:243], a[212:215], v[56:59]
  ds_read_b128 a[236:239], v3 offset:36864
  v_mfma_f32_16x16x32_bf16 v[60:63], v[220:223], a[208:211], v[60:63]
  v_mfma_f32_16x16x32_bf16 v[60:63], v[244:247], a[212:215], v[60:63]
  s_waitcnt lgkmcnt(7)
  buffer_store_dwordx4 a[216:219], v4, s[8:11], s22 offen sc1
  v_mfma_f32_16x16x32_bf16 v[64:67], v[224:227], a[208:211], v[64:67]
  v_mfma_f32_16x16x32_bf16 v[64:67], v[248:251], a[212:215], v[64:67]
  v_mfma_f32_16x16x32_bf16 v[68:71], v[228:231], a[208:211], v[68:71]
  s_sub_u32 s32, s32, 1
  s_cmp_eq_u32 s32, 0
  v_mfma_f32_16x16x32_bf16 v[68:71], v[252:255], a[212:215], v[68:71]
L_mid0:
  v_mfma_f32_16x16x32_bf16 v[24:27], a[0:3], a[192:195], 0
  ds_read_b128 a[208:211], v7 offset:256
  v_mfma_f32_16x16x32_bf16 v[24:27], a[24:27], a[196:199], v[24:27]
  ds_read_b128 a[212:215], v8 offset:256
  v_mfma_f32_16x16x32_bf16 v[28:31], a[4:7], a[192:195], 0
  v_mfma_f32_16x16x32_bf16 v[28:31], a[28:31], a[196:199], v[28:31]
  v_mfma_f32_16x16x32_bf16 v[32:35], a[8:11], a[192:195], 0
  v_mfma_f32_16x16x32_bf16 v[32:35], a[32:35], a[196:199], v[32:35]
  v_mfma_f32_16x16x32_bf16 v[36:39], a[12:15], a[192:195], 0
  v_mfma_f32_16x16x32_bf16 v[36:39], a[36:39], a[196:199], v[36:39]
  s_add_u32 m0, s42, 28672
  v_mfma_f32_16x16x32_bf16 v[40:43], a[16:19], a[192:195], 0
  s_cbranch_vccz L_sk9
  buffer_load_dwordx4 v2, s[4:7], s21 offen nt lds
L_sk9:
  v_mfma_f32_16x16x32_bf16 v[40:43], a[40:43], a[196:199], v[40:43]
  v_mfma_f32_16x16x32_bf16 v[44:47], a[20:23], a[192:195], 0
  v_mfma_f32_16x16x32_bf16 v[44:47], a[44:47], a[196:199], v[44:47]
  s_waitcnt lgkmcnt(5)
  v_mfma_f32_16x16x32_bf16 v[24:27], a[48:51], a[200:203], v[24:27]
  ds_read_b128 a[192:195], v9 offset:256
  v_mfma_f32_16x16x32_bf16 v[24:27], a[72:75], a[204:207], v[24:27]
  ds_read_b128 a[196:199], v10 offset:256
  v_mfma_f32_16x16x32_bf16 v[28:31], a[52:55], a[200:203], v[28:31]
  v_cvt_pk_bf16_f32 v48, v48, v49
  v_mfma_f32_16x16x32_bf16 v[28:31], a[76:79], a[204:207], v[28:31]
  v_cvt_pk_bf16_f32 v49, v50, v51
  v_mfma_f32_16x16x32_bf16 v[32:35], a[56:59], a[200:203], v[32:35]
  v_cvt_pk_bf16_f32 v50, v52, v53
  v_mfma_f32_16x16x32_bf16 v[32:35], a[80:83], a[204:207], v[32:35]
  v_cvt_pk_bf16_f32 v51, v54, v55
  v_mfma_f32_16x16x32_bf16 v[36:39], a[60:63], a[200:203], v[36:39]
  ds_write_b128 v11, v[48:51] offset:12288
  v_mfma_f32_16x16x32_bf16 v[36:39], a[84:87], a[204:207], v[36:39]
  v_mfma_f32_16x16x32_bf16 v[40:43], a[64:67], a[200:203], v[40:43]
  buffer_store_dwordx4 a[220:223], v5, s[8:11], s22 offen sc1
  v_mfma_f32_16x16x32_bf16 v[40:43], a[88:91], a[204:207], v[40:43]
  v_mfma_f32_16x16x32_bf16 v[44:47], a[68:71], a[200:203], v[44:47]
  v_mfma_f32_16x16x32_bf16 v[44:47], a[92:95], a[204:207], v[44:47]
  s_waitcnt lgkmcnt(3)
  v_mfma_f32_16x16x32_bf16 v[24:27], a[96:99], a[208:211], v[24:27]
  ds_read_b128 a[200:203], v7 offset:512
  v_mfma_f32_16x16x32_bf16 v[24:27], a[120:123], a[212:215], v[24:27]
  ds_read_b128 a[204:207], v8 offset:512
  v_mfma_f32_16x16x32_bf16 v[28:31], a[100:103], a[208:211], v[28:31]
  v_cvt_pk_bf16_f32 v52, v56, v57
  v_mfma_f32_16x16x32_bf16 v[28:31], a[124:127], a[212:215], v[28:31]
  v_cvt_pk_bf16_f32 v53, v58, v59
  v_mfma_f32_16x16x32_bf16 v[32:35], a[104:107], a[208:211], v[32:35]
  v_cvt_pk_bf16_f32 v54, v60, v61
  v_mfma_f32_16x16x32_bf16 v[32:35], a[128:131], a[212:215], v[32:35]
  v_cvt_pk_bf16_f32 v55, v62, v63
  v_mfma_f32_16x16x32_bf16 v[36:39], a[108:111], a[208:211], v[36:39]
  v_mfma_f32_16x16x32_bf16 v[36:39], a[132:135], a[212:215], v[36:39]
  s_add_u32 m0, s42, 32768
  v_mfma_f32_16x16x32_bf16 v[40:43], a[112:115], a[208:211], v[40:43]
  s_cbranch_vccz L_sk10
  buffer_load_dwordx4 v3, s[4:7], s21 offen nt lds
L_sk10:
  v_mfma_f32_16x16x32_bf16 v[40:43], a[136:139], a[212:215], v[40:43]
  v_mfma_f32_16x16x32_bf16 v[44:47], a[116:119], a[208:211], v[44:47]
  ds_write_b128 v12, v[52:55] offset:12288
  v_mfma_f32_16x16x32_bf16 v[44:47], a[140:143], a[212:215], v[44:47]
  s_waitcnt lgkmcnt(4)
  v_mfma_f32_16x16x32_bf16 v[24:27], v[112:115], a[192:195], v[24:27]
  ds_read_b128 a[208:211], v9 offset:512
  v_mfma_f32_16x16x32_bf16 v[24:27], v[136:139], a[196:199], v[24:27]
  ds_read_b128 a[212:215], v10 offset:512
  v_mfma_f32_16x16x32_bf16 v[28:31], v[116:119], a[192:195], v[28:31]
  v_cvt_pk_bf16_f32 v56, v64, v65
  v_mfma_f32_16x16x32_bf16 v[28:31], v[140:143], a[196:199], v[28:31]
  v_cvt_pk_bf16_f32 v57, v66, v67
  v_mfma_f32_16x16x32_bf16 v[32:35], v[120:123], a[192:195], v[32:35]
  v_cvt_pk_bf16_f32 v58, v68, v69
  v_mfma_f32_16x16x32_bf16 v[32:35], v[144:147], a[196:199], v[32:35]
  v_cvt_pk_bf16_f32 v59, v70, v71
  v_mfma_f32_16x16x32_bf16 v[36:39], v[124:127], a[192:195], v[36:39]
  ds_write_b128 v13, v[56:59] offset:12288
  v_mfma_f32_16x16x32_bf16 v[36:39], v[148:151], a[196:199], v[36:39]
  v_mfma_f32_16x16x32_bf16 v[40:43], v[128:131], a[192:195], v[40:43]
  buffer_store_dwordx4 a[224:227], v6, s[8:11], s22 offen sc1
  v_mfma_f32_16x16x32_bf16 v[40:43], v[152:155], a[196:199], v[40:43]
  v_mfma_f32_16x16x32_bf16 v[44:47], v[132:135], a[192:195], v[44:47]
  v_mfma_f32_16x16x32_bf16 v[44:47], v[156:159], a[196:199], v[44:47]
  s_waitcnt lgkmcnt(4)
  v_mfma_f32_16x16x32_bf16 v[24:27], v[160:163], a[200:203], v[24:27]
  ds_read_b128 a[192:195], v7 offset:12288
  v_mfma_f32_16x16x32_bf16 v[24:27], v[184:187], a[204:207], v[24:27]
  ds_read_b128 a[196:199], v8 offset:12288
  v_mfma_f32_16x16x32_bf16 v[28:31], v[164:167], a[200:203], v[28:31]
  v_mfma_f32_16x16x32_bf16 v[28:31], v[188:191], a[204:207], v[28:31]
  s_cmp_eq_u32 s32, 5
  s_cselect_b32 s43, s45, s44
  s_add_u32 s21, s21, s43
  v_mfma_f32_16x16x32_bf16 v[32:35], v[168:171], a[200:203], v[32:35]
  v_mfma_f32_16x16x32_bf16 v[32:35], v[192:195], a[204:207], v[32:35]
  v_mfma_f32_16x16x32_bf16 v[36:39], v[172:175], a[200:203], v[36:39]
  v_mfma_f32_16x16x32_bf16 v[36:39], v[196:199], a[204:207], v[36:39]
  s_add_u32 m0, s42, 36864
  v_mfma_f32_16x16x32_bf16 v[40:43], v[176:179], a[200:203], v[40:43]
  s_cbranch_vccz L_sk11
  buffer_load_dwordx4 v1, s[4:7], s37 offen nt lds
L_sk11:
  v_mfma_f32_16x16x32_bf16 v[40:43], v[200:203], a[204:207], v[40:43]
  v_mfma_f32_16x16x32_bf16 v[44:47], v[180:183], a[200:203], v[44:47]
  v_mfma_f32_16x16x32_bf16 v[44:47], v[204:207], a[204:207], v[44:47]
  s_waitcnt lgkmcnt(3)
  v_mfma_f32_16x16x32_bf16 v[24:27], v[208:211], a[208:211], v[24:27]
  ds_read_b128 a[200:203], v9 offset:12288
  v_mfma_f32_16x16x32_bf16 v[24:27], v[232:235], a[212:215], v[24:27]
  ds_read_b128 a[204:207], v10 offset:12288
  v_mfma_f32_16x16x32_bf16 v[28:31], v[212:215], a[208:211], v[28:31]
  v_mfma_f32_16x16x32_bf16 v[28:31], v[236:239], a[212:215], v[28:31]
  v_mfma_f32_16x16x32_bf16 v[32:35], v[216:219], a[208:211], v[32:35]
  v_mfma_f32_16x16x32_bf16 v[32:35], v[240:243], a[212:215], v[32:35]
  v_mfma_f32_16x16x32_bf16 v[36:39], v[220:223], a[208:211], v[36:39]
  v_mfma_f32_16x16x32_bf16 v[36:39], v[244:247], a[212:215], v[36:39]
  v_mfma_f32_16x16x32_bf16 v[40:43], v[224:227], a[208:211], v[40:43]
  buffer_store_dwordx4 a[228:231], v4, s[8:11], s23 offen sc1
  v_mfma_f32_16x16x32_bf16 v[40:43], v[248:251], a[212:215], v[40:43]
  v_mfma_f32_16x16x32_bf16 v[44:47], v[228:231], a[208:211], v[44:47]
  v_mfma_f32_16x16x32_bf16 v[44:47], v[252:255], a[212:215], v[44:47]
  s_waitcnt lgkmcnt(2)
  v_mfma_f32_16x16x32_bf16 v[48:51], a[0:3], a[192:195], 0
  ds_read_b128 a[208:211], v7 offset:12544
  v_mfma_f32_16x16x32_bf16 v[48:51], a[24:27], a[196:199], v[48:51]
  ds_read_b128 a[212:215], v8 offset:12544
  v_mfma_f32_16x16x32_bf16 v[52:55], a[4:7], a[192:195], 0
  v_cvt_pk_bf16_f32 v24, v24, v25
  v_mfma_f32_16x16x32_bf16 v[52:55], a[28:31], a[196:199], v[52:55]
  v_cvt_pk_bf16_f32 v25, v26, v27
  v_mfma_f32_16x16x32_bf16 v[56:59], a[8:11], a[192:195], 0
  v_cvt_pk_bf16_f32 v26, v28, v29
  v_mfma_f32_16x16x32_bf16 v[56:59], a[32:35], a[196:199], v[56:59]
  v_cvt_pk_bf16_f32 v27, v30, v31
  v_mfma_f32_16x16x32_bf16 v[60:63], a[12:15], a[192:195], 0
  v_mfma_f32_16x16x32_bf16 v[60:63], a[36:39], a[196:199], v[60:63]
  s_add_u32 m0, s42, 40960
  v_mfma_f32_16x16x32_bf16 v[64:67], a[16:19], a[192:195], 0
  s_cbranch_vccz L_sk12
  buffer_load_dwordx4 v2, s[4:7], s37 offen nt lds
L_sk12:
  v_mfma_f32_16x16x32_bf16 v[64:67], a[40:43], a[196:199], v[64:67]
  v_mfma_f32_16x16x32_bf16 v[68:71], a[20:23], a[192:195], 0
  ds_write_b128 v11, v[24:27] offset:0
  v_mfma_f32_16x16x32_bf16 v[68:71], a[44:47], a[196:199], v[68:71]
  s_waitcnt lgkmcnt(3)
  v_mfma_f32_16x16x32_bf16 v[48:51], a[48:51], a[200:203], v[48:51]
  ds_read_b128 a[192:195], v9 offset:12544
  v_mfma_f32_16x16x32_bf16 v[48:51], a[72:75], a[204:207], v[48:51]
  ds_read_b128 a[196:199], v10 offset:12544
  v_mfma_f32_16x16x32_bf16 v[52:55], a[52:55], a[200:203], v[52:55]
  v_cvt_pk_bf16_f32 v28, v32, v33
  v_mfma_f32_16x16x32_bf16 v[52:55], a[76:79], a[204:207], v[52:55]
  v_cvt_pk_bf16_f32 v29, v34, v35
  v_mfma_f32_16x16x32_bf16 v[56:59], a[56:59], a[200:203], v[56:59]
  v_cvt_pk_bf16_f32 v30, v36, v37
  v_mfma_f32_16x16x32_bf16 v[56:59], a[80:83], a[204:207], v[56:59]
  v_cvt_pk_bf16_f32 v31, v38, v39
  v_mfma_f32_16x16x32_bf16 v[60:63], a[60:63], a[200:203], v[60:63]
  ds_write_b128 v12, v[28:31] offset:0
  v_mfma_f32_16x16x32_bf16 v[60:63], a[84:87], a[204:207], v[60:63]
  v_mfma_f32_16x16x32_bf16 v[64:67], a[64:67], a[200:203], v[64:67]
  buffer_store_dwordx4 a[232:235], v5, s[8:11], s23 offen sc1
  v_mfma_f32_16x16x32_bf16 v[64:67], a[88:91], a[204:207], v[64:67]
  v_mfma_f32_16x16x32_bf16 v[68:71], a[68:71], a[200:203], v[68:71]
  v_mfma_f32_16x16x32_bf16 v[68:71], a[92:95], a[204:207], v[68:71]
  s_waitcnt lgkmcnt(4)
  v_mfma_f32_16x16x32_bf16 v[48:51], a[96:99], a[208:211], v[48:51]
  ds_read_b128 a[200:203], v7 offset:12800
  v_mfma_f32_16x16x32_bf16 v[48:51], a[120:123], a[212:215], v[48:51]
  ds_read_b128 a[204:207], v8 offset:12800
  v_mfma_f32_16x16x32_bf16 v[52:55], a[100:103], a[208:211], v[52:55]
  v_cvt_pk_bf16_f32 v32, v40, v41
  v_mfma_f32_16x16x32_bf16 v[52:55], a[124:127], a[212:215], v[52:55]
  v_cvt_pk_bf16_f32 v33, v42, v43
  v_mfma_f32_16x16x32_bf16 v[56:59], a[104:107], a[208:211], v[56:59]
  v_cvt_pk_bf16_f32 v34, v44, v45
  v_mfma_f32_16x16x32_bf16 v[56:59], a[128:131], a[212:215], v[56:59]
  v_cvt_pk_bf16_f32 v35, v46, v47
  v_mfma_f32_16x16x32_bf16 v[60:63], a[108:111], a[208:211], v[60:63]
  v_mfma_f32_16x16x32_bf16 v[60:63], a[132:135], a[212:215], v[60:63]
  s_add_u32 m0, s42, 45056
  v_mfma_f32_16x16x32_bf16 v[64:67], a[112:115], a[208:211], v[64:67]
  s_cbranch_vccz L_sk13
  buffer_load_dwordx4 v3, s[4:7], s37 offen nt lds
L_sk13:
  v_mfma_f32_16x16x32_bf16 v[64:67], a[136:139], a[212:215], v[64:67]
  v_mfma_f32_16x16x32_bf16 v[68:71], a[116:119], a[208:211], v[68:71]
  ds_write_b128 v13, v[32:35] offset:0
  v_mfma_f32_16x16x32_bf16 v[68:71], a[140:143], a[212:215], v[68:71]
  s_waitcnt lgkmcnt(4)
  v_mfma_f32_16x16x32_bf16 v[48:51], v[112:115], a[192:195], v[48:51]
  ds_read_b128 a[208:211], v9 offset:12800
  v_mfma_f32_16x16x32_bf16 v[48:51], v[136:139], a[196:199], v[48:51]
  ds_read_b128 a[212:215], v10 offset:12800
  v_mfma_f32_16x16x32_bf16 v[52:55], v[116:119], a[192:195], v[52:55]
  s_add_u32 s37, s37, s43
  v_mfma_f32_16x16x32_bf16 v[52:55], v[140:143], a[196:199], v[52:55]
  v_mfma_f32_16x16x32_bf16 v[56:59], v[120:123], a[192:195], v[56:59]
  v_mfma_f32_16x16x32_bf16 v[56:59], v[144:147], a[196:199], v[56:59]
  v_mfma_f32_16x16x32_bf16 v[60:63], v[124:127], a[192:195], v[60:63]
  v_mfma_f32_16x16x32_bf16 v[60:63], v[148:151], a[196:199], v[60:63]
  buffer_store_dwordx4 a[236:239], v6, s[8:11], s23 offen sc1
  v_mfma_f32_16x16x32_bf16 v[64:67], v[128:131], a[192:195], v[64:67]
  s_add_u32 s23, s22, 12288
  v_mfma_f32_16x16x32_bf16 v[64:67], v[152:155], a[196:199], v[64:67]
  s_cmp_eq_u32 s32, 1
  s_cselect_b32 s43, s45, s44
  s_add_u32 s22, s22, s43
  v_mfma_f32_16x16x32_bf16 v[68:71], v[132:135], a[192:195], v[68:71]
  v_mfma_f32_16x16x32_bf16 v[68:71], v[156:159], a[196:199], v[68:71]
  s_waitcnt vmcnt(24) lgkmcnt(0)
  s_cbranch_vccz L_ow14
L_ob14:
  s_barrier
  v_mfma_f32_16x16x32_bf16 v[48:51], v[160:163], a[200:203], v[48:51]
  ds_read_b128 a[192:195], v7 offset:24576
  v_mfma_f32_16x16x32_bf16 v[48:51], v[184:187], a[204:207], v[48:51]
  ds_read_b128 a[196:199], v8 offset:24576
  v_mfma_f32_16x16x32_bf16 v[52:55], v[164:167], a[200:203], v[52:55]
  s_cmp_ge_u32 s32, 5
  s_cselect_b64 vcc, -1, 0
  v_mfma_f32_16x16x32_bf16 v[52:55], v[188:191], a[204:207], v[52:55]
  ds_read_b128 a[216:219], v1 offset:0
  v_mfma_f32_16x16x32_bf16 v[56:59], v[168:171], a[200:203], v[56:59]
  ds_read_b128 a[220:223], v2 offset:0
  v_mfma_f32_16x16x32_bf16 v[56:59], v[192:195], a[204:207], v[56:59]
  ds_read_b128 a[224:227], v3 offset:0
  v_mfma_f32_16x16x32_bf16 v[60:63], v[172:175], a[200:203], v[60:63]
  s_xor_b32 s42, s42, 0x14000
  v_mfma_f32_16x16x32_bf16 v[60:63], v[196:199], a[204:207], v[60:63]
  s_add_u32 m0, s42, 0
  v_mfma_f32_16x16x32_bf16 v[64:67], v[176:179], a[200:203], v[64:67]
  s_cbranch_vccz L_sk15
  buffer_load_dwordx4 v1, s[4:7], s21 offen nt lds
L_sk15:
  v_mfma_f32_16x16x32_bf16 v[64:67], v[200:203], a[204:207], v[64:67]
  v_mfma_f32_16x16x32_bf16 v[68:71], v[180:183], a[200:203], v[68:71]
  v_mfma_f32_16x16x32_bf16 v[68:71], v[204:207], a[204:207], v[68:71]
  v_mfma_f32_16x16x32_bf16 v[48:51], v[208:211], a[208:211], v[48:51]
  ds_read_b128 a[200:203], v9 offset:24576
  v_mfma_f32_16x16x32_bf16 v[48:51], v[232:235], a[212:215], v[48:51]
  ds_read_b128 a[204:207], v10 offset:24576
  v_mfma_f32_16x16x32_bf16 v[52:55], v[212:215], a[208:211], v[52:55]
  v_mfma_f32_16x16x32_bf16 v[52:55], v[236:239], a[212:215], v[52:55]
  ds_read_b128 a[228:231], v1 offset:12288
  v_mfma_f32_16x16x32_bf16 v[56:59], v[216:219], a[208:211], v[56:59]
  ds_read_b128 a[232:235], v2 offset:12288
  v_mfma_f32_16x16x32_bf16 v[56:59], v[240:243], a[212:215], v[56:59]
  ds_read_b128 a[236:239], v3 offset:12288
  v_mfma_f32_16x16x32_bf16 v[60:63], v[220:223], a[208:211], v[60:63]
  v_mfma_f32_16x16x32_bf16 v[60:63], v[244:247], a[212:215], v[60:63]
  s_waitcnt lgkmcnt(7)
  buffer_store_dwordx4 a[216:219], v4, s[8:11], s22 offen sc1
  v_mfma_f32_16x16x32_bf16 v[64:67], v[224:227], a[208:211], v[64:67]
  v_mfma_f32_16x16x32_bf16 v[64:67], v[248:251], a[212:215], v[64:67]
  v_mfma_f32_16x16x32_bf16 v[68:71], v[228:231], a[208:211], v[68:71]
  s_sub_u32 s32, s32, 1
  s_cmp_eq_u32 s32, 0
  v_mfma_f32_16x16x32_bf16 v[68:71], v[252:255], a[212:215], v[68:71]
  s_cbranch_scc0 L_loop0
L_tail1:
  s_nop 1
  v_cvt_pk_bf16_f32 v48, v48, v49
  v_cvt_pk_bf16_f32 v49, v50, v51
  v_cvt_pk_bf16_f32 v50, v52, v53
  v_cvt_pk_bf16_f32 v51, v54, v55
  ds_write_b128 v11, v[48:51] offset:36864
  v_cvt_pk_bf16_f32 v52, v56, v57
  v_cvt_pk_bf16_f32 v53, v58, v59
  v_cvt_pk_bf16_f32 v54, v60, v61
  v_cvt_pk_bf16_f32 v55, v62, v63
  ds_write_b128 v12, v[52:55] offset:36864
  v_cvt_pk_bf16_f32 v56, v64, v65
  v_cvt_pk_bf16_f32 v57, v66, v67
  v_cvt_pk_bf16_f32 v58, v68, v69
  v_cvt_pk_bf16_f32 v59, v70, v71
  ds_write_b128 v13, v[56:59] offset:36864
  s_waitcnt lgkmcnt(9)
  buffer_store_dwordx4 a[220:223], v5, s[8:11], s22 offen sc1
  s_waitcnt lgkmcnt(8)
  buffer_store_dwordx4 a[224:227], v6, s[8:11], s22 offen sc1
  s_waitcnt lgkmcnt(0)
  s_barrier
  ds_read_b128 a[192:195], v1 offset:36864
  ds_read_b128 a[196:199], v2 offset:36864
  ds_read_b128 a[200:203], v3 offset:36864
  buffer_store_dwordx4 a[228:231], v4, s[8:11], s23 offen sc1
  buffer_store_dwordx4 a[232:235], v5, s[8:11], s23 offen sc1
  buffer_store_dwordx4 a[236:239], v6, s[8:11], s23 offen sc1
  s_add_u32 s23, s22, 12288
  s_waitcnt lgkmcnt(2)
  buffer_store_dwordx4 a[192:195], v4, s[8:11], s23 offen sc1
  s_waitcnt lgkmcnt(1)
  buffer_store_dwordx4 a[196:199], v5, s[8:11], s23 offen sc1
  s_waitcnt lgkmcnt(0)
  buffer_store_dwordx4 a[200:203], v6, s[8:11], s23 offen sc1
  s_endpgm
L_o1:
  s_waitcnt vmcnt(18)
  s_mov_b32 s51, 0
  s_branch L_ob7
L_ow7:
  s_cmp_eq_u32 s32, 1
  s_cbranch_scc1 L_ob7
  s_waitcnt vmcnt(19)
  s_cmp_eq_u32 s32, 3
  s_cbranch_scc1 L_ob7
  s_waitcnt vmcnt(13)
  s_branch L_ob7
L_ow14:
  s_cmp_eq_u32 s32, 1
  s_cbranch_scc1 L_ob14
  s_waitcnt vmcnt(19)
  s_cmp_eq_u32 s32, 3
  s_cbranch_scc1 L_ob14
  s_waitcnt vmcnt(13)
  s_branch L_ob14
L_done:
  s_endpgm
.section .rodata,"a"
.p2align 6
.amdhsa_kernel standalone__depthwise_separable__vision_kernel
  .amdhsa_next_free_vgpr 512
  .amdhsa_next_free_sgpr 100
  .amdhsa_accum_offset 256
  .amdhsa_group_segment_fixed_size 0
  .amdhsa_kernarg_size 48
  .amdhsa_user_sgpr_count 2
  .amdhsa_user_sgpr_kernarg_segment_ptr 1
  .amdhsa_system_sgpr_workgroup_id_x 1
  .amdhsa_float_denorm_mode_32 3
.end_amdhsa_kernel
```

```asm
; @launch grid=(256,1,1) block=(256,1,1) lds=151552
.amdgcn_target "amdgcn-amd-amdhsa--gfx950"
.text
.globl standalone__depthwise_separable__vision_kernel
.p2align 8
.type standalone__depthwise_separable__vision_kernel,@function
standalone__depthwise_separable__vision_kernel:
  s_cmp_ge_u32 s2, 256
  s_cbranch_scc1 L_done
  s_load_dwordx4 s[28:31], s[0:1], 16
  s_load_dwordx4 s[24:27], s[0:1], 0
  s_load_dwordx2 s[52:53], s[0:1], 32
  s_getpc_b64 s[40:41]
L_pc:
  v_lshlrev_b32 v72, 7, v0
  v_min_u32 v72, L_done-L_pc, v72
  v_mov_b32 v73, s41
  v_add_co_u32 v72, vcc, s40, v72
  v_lshrrev_b32 v77, 6, v0
  v_and_b32 v74, 63, v0
  v_addc_co_u32 v73, vcc, 0, v73, vcc
  global_load_dword v23, v[72:73], off
  v_readfirstlane_b32 s20, v77
  v_and_b32 v75, 15, v74
  v_lshlrev_b32 v78, 4, v74
  v_lshlrev_b32 v79, 4, v75
  s_lshr_b32 s47, s2, 3
  s_mul_i32 s39, s47, 9216
  s_mul_i32 s38, s20, 2304
  s_add_u32 s39, s39, s38
  s_mul_i32 s38, s20, 192
  v_mul_u32_u24 v81, 0xaaab, v74
  v_lshrrev_b32 v81, 19, v81
  v_mul_u32_u24 v81, 576, v81
  v_add3_u32 v14, v81, v78, s38
  v_add_u32 v80, 64, v74
  v_mul_u32_u24 v81, 0xaaab, v80
  v_lshrrev_b32 v81, 19, v81
  v_mul_u32_u24 v81, 576, v81
  v_add3_u32 v15, v81, v78, s38
  v_add_u32 v80, 128, v74
  v_mul_u32_u24 v81, 0xaaab, v80
  v_lshrrev_b32 v81, 19, v81
  v_mul_u32_u24 v81, 576, v81
  v_add3_u32 v16, v81, v78, s38
  s_lshl_b32 s33, s20, 10
  s_mul_i32 s34, s20, 6144
  s_mov_b32 s36, 0
  s_mov_b32 s14, 294912
  s_mov_b32 s15, 0x00020000
  s_mov_b32 s18, 768
  s_mov_b32 s19, 0x00020000
  s_add_u32 m0, s33, 147456
  s_waitcnt lgkmcnt(0)
  s_mov_b32 s12, s28
  s_and_b32 s13, s29, 0xffff
  buffer_load_dwordx4 a[216:219], v78, s[12:15], s39 offen
  buffer_load_dwordx4 a[220:223], v78, s[12:15], s39 offen offset:1024
  buffer_load_dwordx4 a[224:227], v79, s[12:15], s39 offen offset:2048
  s_mov_b32 s16, s26
  s_and_b32 s17, s27, 0xffff
  buffer_load_dwordx4 v78, s[16:19], 0 offen lds
  s_and_b32 s38, s2, 7
  s_lshl_b32 s38, s38, 5
  s_add_u32 s38, s38, s47
  s_mul_i32 s21, s38, 24576
  s_mov_b32 s4, s24
  s_and_b32 s5, s25, 0xffff
  s_mov_b32 s6, 113246208
  s_mov_b32 s7, 0x00020000
  v_mul_u32_u24 v81, 0xaaab, v0
  v_lshrrev_b32 v81, 21, v81
  v_xor_b32 v80, v0, v81
  v_lshlrev_b32 v1, 4, v80
  v_add_u32 v80, 256, v0
  v_mul_u32_u24 v81, 0xaaab, v80
  v_lshrrev_b32 v81, 21, v81
  v_xor_b32 v80, v80, v81
  v_lshlrev_b32 v2, 4, v80
  v_add_u32 v80, 512, v0
  v_mul_u32_u24 v81, 0xaaab, v80
  v_lshrrev_b32 v81, 21, v81
  v_xor_b32 v80, v80, v81
  v_lshlrev_b32 v3, 4, v80
  s_add_u32 s37, s21, 12288
  s_mov_b32 s22, s21
  s_add_u32 m0, s33, 98304
  s_nop 0
  buffer_load_dwordx4 v1, s[4:7], s21 offen nt lds
  s_add_u32 m0, s33, 102400
  s_nop 0
  buffer_load_dwordx4 v2, s[4:7], s21 offen nt lds
  s_add_u32 m0, s33, 106496
  s_nop 0
  buffer_load_dwordx4 v3, s[4:7], s21 offen nt lds
  s_add_u32 m0, s33, 110592
  s_add_u32 s21, s21, 6291456
  buffer_load_dwordx4 v1, s[4:7], s37 offen nt lds
  s_add_u32 m0, s33, 114688
  s_nop 0
  buffer_load_dwordx4 v2, s[4:7], s37 offen nt lds
  s_add_u32 m0, s33, 118784
  s_nop 0
  buffer_load_dwordx4 v3, s[4:7], s37 offen nt lds
  s_add_u32 s37, s37, 6291456
  v_lshrrev_b32 v76, 4, v74
  v_lshlrev_b32 v18, 4, v76
  v_add_u32 v18, s33, v18
  v_add_u32 v18, 147456, v18
  v_bfe_u32 v81, v74, 2, 2
  v_and_b32 v82, 3, v74
  v_lshl_add_u32 v83, v76, 3, v81
  v_mul_u32_u24 v83, 192, v83
  v_mul_u32_u24 v84, 48, v82
  v_add3_u32 v17, v83, v84, s34
  v_add_u32 v104, 49152, v17
  v_lshlrev_b32 v83, 4, v82
  v_mov_b32 v84, 0xffff
  v_cmp_lt_u32 vcc, 1, v82
  v_lshlrev_b32 v84, v83, v84
  v_mul_u32_u24 v80, 0x300, v75
  v_cndmask_b32 v20, 0, v84, vcc
  v_sub_u32 v19, v84, v20
  s_add_u32 m0, s34, 49152
  s_nop 0
  buffer_load_dwordx4 v14, s[12:15], s36 offen offset:0 lds
  buffer_load_dwordx4 v15, s[12:15], s36 offen offset:1024 lds
  buffer_load_dwordx4 v16, s[12:15], s36 offen offset:2048 lds
  s_add_u32 m0, s34, 52224
  s_add_u32 s36, s36, 12288
  buffer_load_dwordx4 v14, s[12:15], s36 offen offset:0 lds
  buffer_load_dwordx4 v15, s[12:15], s36 offen offset:1024 lds
  buffer_load_dwordx4 v16, s[12:15], s36 offen offset:2048 lds
  s_mov_b32 s8, s30
  s_and_b32 s9, s31, 0xffff
  s_mov_b32 s10, 113246208
  s_mov_b32 s11, 0x00020000
  v_lshlrev_b32 v4, 4, v0
  v_add_u32 v5, 4096, v4
  v_add_u32 v6, 8192, v4
  v_xor_b32 v81, v76, v75
  v_lshl_add_u32 v7, v81, 4, v80
  v_add_u32 v7, 98304, v7
  v_xor_b32 v8, 64, v7
  v_xor_b32 v9, 128, v7
  v_xor_b32 v10, 192, v7
  s_mul_i32 s38, s20, 12
  v_mul_u32_u24 v81, 3, v76
  v_add_u32 v81, s38, v81
  v_add_u32 v82, 0, v81
  v_xor_b32 v82, v82, v75
  v_lshl_add_u32 v11, v82, 4, v80
  v_add_u32 v82, 1, v81
  v_xor_b32 v82, v82, v75
  v_lshl_add_u32 v12, v82, 4, v80
  v_add_u32 v82, 2, v81
  v_xor_b32 v82, v82, v75
  v_lshl_add_u32 v13, v82, 4, v80
  s_mov_b32 s23, 113246208
  s_mov_b32 s44, 6291456
  s_add_u32 s42, s33, 49152
  s_mov_b32 s51, 1
  s_and_b32 s38, s47, 3
  s_mul_i32 s57, s38, 24576
  s_add_u32 s57, s57, 100663296
  s_lshl_b32 s38, s38, 6
  s_add_u32 s52, s52, s38
  s_addc_u32 s53, s53, 0
  s_bitcmp1_b32 s2, 0
  s_mov_b32 s55, 128
  s_cselect_b32 s55, 64, s55
  s_cmp_eq_u32 s20, 0
  s_cselect_b32 s66, s55, 0
  s_mov_b32 s55, 0
  s_mov_b32 s65, 0
  s_mov_b32 s61, 11
  s_add_u32 s62, s22, 25165824
  s_mov_b32 s54, 0
  s_add_u32 s58, s22, 6291456
  s_add_u32 s59, s22, 12582912
  s_add_u32 s60, s22, 18874368
  s_mov_b32 s32, 4
  v_mov_b32 v105, 147456
  v_add_u32 v106, s33, v105
  s_add_u32 m0, s34, 73728
  s_add_u32 s36, s36, 12288
  buffer_load_dwordx4 v14, s[12:15], s36 offen offset:0 lds
  buffer_load_dwordx4 v15, s[12:15], s36 offen offset:1024 lds
  buffer_load_dwordx4 v16, s[12:15], s36 offen offset:2048 lds
  s_add_u32 m0, s34, 76800
  s_add_u32 s36, s36, 12288
  buffer_load_dwordx4 v14, s[12:15], s36 offen offset:0 lds
  buffer_load_dwordx4 v15, s[12:15], s36 offen offset:1024 lds
  buffer_load_dwordx4 v16, s[12:15], s36 offen offset:2048 lds
  s_waitcnt vmcnt(6)
  ds_read_b128 v[96:99], v18 offset:0
  ds_read_b64_tr_b16 a[144:145], v104 offset:0
  ds_read_b64_tr_b16 a[146:147], v104 offset:768
  ds_read_b64_tr_b16 a[148:149], v104 offset:8
  ds_read_b64_tr_b16 a[150:151], v104 offset:776
  ds_read_b64_tr_b16 a[152:153], v104 offset:16
  ds_read_b64_tr_b16 a[154:155], v104 offset:784
  ds_read_b64_tr_b16 a[156:157], v104 offset:24
  ds_read_b64_tr_b16 a[158:159], v104 offset:792
  ds_read_b64_tr_b16 a[160:161], v104 offset:32
  ds_read_b64_tr_b16 a[162:163], v104 offset:800
  ds_read_b64_tr_b16 a[164:165], v104 offset:40
  ds_read_b64_tr_b16 a[166:167], v104 offset:808
  s_add_u32 m0, s34, 0
  s_add_u32 s36, s36, 12288
  buffer_load_dwordx4 v14, s[12:15], s36 offen offset:0 lds
  buffer_load_dwordx4 v15, s[12:15], s36 offen offset:1024 lds
  buffer_load_dwordx4 v16, s[12:15], s36 offen offset:2048 lds
  s_add_u32 m0, s34, 3072
  s_add_u32 s36, s36, 12288
  buffer_load_dwordx4 v14, s[12:15], s36 offen offset:0 lds
  buffer_load_dwordx4 v15, s[12:15], s36 offen offset:1024 lds
  buffer_load_dwordx4 v16, s[12:15], s36 offen offset:2048 lds
  s_waitcnt lgkmcnt(12)
  v_and_b32 v96, v19, v96
  v_and_b32 v97, v20, v97
  v_and_b32 v98, v19, v98
  v_and_b32 v99, v20, v99
  s_waitcnt lgkmcnt(0)
  s_nop 0
  v_mfma_f32_4x4x4_16b_bf16 v[72:75], v[96:97], a[144:145], 0
  s_waitcnt vmcnt(6)
  ds_read_b128 v[100:103], v18 offset:64
  s_add_u32 m0, s34, 24576
  s_add_u32 s36, s36, 12288
  buffer_load_dwordx4 v14, s[12:15], s36 offen offset:0 lds
  v_mfma_f32_4x4x4_16b_bf16 v[76:79], v[98:99], a[146:147], 0
  ds_read_b64_tr_b16 a[168:169], v104 offset:24576
  ds_read_b64_tr_b16 a[170:171], v104 offset:25344
  buffer_load_dwordx4 v15, s[12:15], s36 offen offset:1024 lds
  v_mfma_f32_4x4x4_16b_bf16 v[80:83], v[96:97], a[148:149], 0
  ds_read_b64_tr_b16 a[172:173], v104 offset:24584
  buffer_load_dwordx4 v16, s[12:15], s36 offen offset:2048 lds
  v_mfma_f32_4x4x4_16b_bf16 v[84:87], v[98:99], a[150:151], 0
  ds_read_b64_tr_b16 a[174:175], v104 offset:25352
  ds_read_b64_tr_b16 a[176:177], v104 offset:24592
  s_add_u32 m0, s34, 27648
  s_add_u32 s36, s36, 12288
  buffer_load_dwordx4 v14, s[12:15], s36 offen offset:0 lds
  v_mfma_f32_4x4x4_16b_bf16 v[88:91], v[96:97], a[152:153], 0
  v_cvt_pk_bf16_f32 v72, v72, v73
  v_cvt_pk_bf16_f32 v74, v74, v75
  v_cvt_pk_bf16_f32 v76, v76, v77
  v_cvt_pk_bf16_f32 v78, v78, v79
  ds_read_b64_tr_b16 a[178:179], v104 offset:25360
  buffer_load_dwordx4 v15, s[12:15], s36 offen offset:1024 lds
  v_mfma_f32_4x4x4_16b_bf16 v[92:95], v[98:99], a[154:155], 0
  v_accvgpr_write_b32 a0, v72
  v_accvgpr_write_b32 a1, v74
  v_accvgpr_write_b32 a2, v76
  v_accvgpr_write_b32 a3, v78
  ds_read_b64_tr_b16 a[180:181], v104 offset:24600
  ds_read_b64_tr_b16 a[182:183], v104 offset:25368
  buffer_load_dwordx4 v16, s[12:15], s36 offen offset:2048 lds
  v_mfma_f32_4x4x4_16b_bf16 v[72:75], v[96:97], a[156:157], 0
  v_cvt_pk_bf16_f32 v80, v80, v81
  v_cvt_pk_bf16_f32 v82, v82, v83
  v_cvt_pk_bf16_f32 v84, v84, v85
  v_cvt_pk_bf16_f32 v86, v86, v87
  ds_read_b64_tr_b16 a[184:185], v104 offset:24608
  ds_read_b64_tr_b16 a[186:187], v104 offset:25376
  s_add_u32 m0, s34, 49152
  s_add_u32 s36, s36, 12288
  buffer_load_dwordx4 v14, s[12:15], s36 offen offset:0 lds
  v_mfma_f32_4x4x4_16b_bf16 v[76:79], v[98:99], a[158:159], 0
  v_accvgpr_write_b32 a4, v80
  v_accvgpr_write_b32 a5, v82
  v_accvgpr_write_b32 a6, v84
  v_accvgpr_write_b32 a7, v86
  ds_read_b64_tr_b16 a[188:189], v104 offset:24616
  buffer_load_dwordx4 v15, s[12:15], s36 offen offset:1024 lds
  v_mfma_f32_4x4x4_16b_bf16 v[80:83], v[96:97], a[160:161], 0
  v_cvt_pk_bf16_f32 v88, v88, v89
  v_cvt_pk_bf16_f32 v90, v90, v91
  v_cvt_pk_bf16_f32 v92, v92, v93
  v_cvt_pk_bf16_f32 v94, v94, v95
  ds_read_b64_tr_b16 a[190:191], v104 offset:25384
  s_waitcnt lgkmcnt(12)
  buffer_load_dwordx4 v16, s[12:15], s36 offen offset:2048 lds
  v_mfma_f32_4x4x4_16b_bf16 v[84:87], v[98:99], a[162:163], 0
  v_accvgpr_write_b32 a8, v88
  v_accvgpr_write_b32 a9, v90
  v_accvgpr_write_b32 a10, v92
  v_accvgpr_write_b32 a11, v94
  v_and_b32 v100, v19, v100
  s_add_u32 m0, s34, 52224
  s_add_u32 s36, s36, 12288
  buffer_load_dwordx4 v14, s[12:15], s36 offen offset:0 lds
  v_mfma_f32_4x4x4_16b_bf16 v[88:91], v[96:97], a[164:165], 0
  v_cvt_pk_bf16_f32 v72, v72, v73
  v_cvt_pk_bf16_f32 v74, v74, v75
  v_cvt_pk_bf16_f32 v76, v76, v77
  v_cvt_pk_bf16_f32 v78, v78, v79
  v_and_b32 v101, v20, v101
  v_and_b32 v102, v19, v102
  buffer_load_dwordx4 v15, s[12:15], s36 offen offset:1024 lds
  v_mfma_f32_4x4x4_16b_bf16 v[92:95], v[98:99], a[166:167], 0
  v_accvgpr_write_b32 a12, v72
  v_accvgpr_write_b32 a13, v74
  v_accvgpr_write_b32 a14, v76
  v_accvgpr_write_b32 a15, v78
  v_and_b32 v103, v20, v103
  buffer_load_dwordx4 v16, s[12:15], s36 offen offset:2048 lds
  s_waitcnt lgkmcnt(0)
  s_barrier
  ds_read_b128 a[192:195], v7 offset:0
  ds_read_b128 a[196:199], v7 offset:12288
  ds_read_b128 a[200:203], v8 offset:0
  ds_read_b128 a[204:207], v8 offset:12288
  s_nop 0
  v_mfma_f32_4x4x4_16b_bf16 v[72:75], v[100:101], a[168:169], 0
  v_cvt_pk_bf16_f32 v80, v80, v81
  v_cvt_pk_bf16_f32 v82, v82, v83
  v_cvt_pk_bf16_f32 v84, v84, v85
  v_cvt_pk_bf16_f32 v86, v86, v87
  s_waitcnt vmcnt(12)
  s_add_u32 m0, s34, 73728
  s_add_u32 s36, s36, 12288
  buffer_load_dwordx4 v14, s[12:15], s36 offen offset:0 lds
  v_mfma_f32_4x4x4_16b_bf16 v[76:79], v[102:103], a[170:171], 0
  v_accvgpr_write_b32 a16, v80
  v_accvgpr_write_b32 a17, v82
  v_accvgpr_write_b32 a18, v84
  v_accvgpr_write_b32 a19, v86
  ds_read_b128 v[96:99], v18 offset:128
  v_mfma_f32_4x4x4_16b_bf16 v[80:83], v[100:101], a[172:173], 0
  v_cvt_pk_bf16_f32 v88, v88, v89
  ds_read_b64_tr_b16 a[144:145], v17 offset:0
  buffer_load_dwordx4 v15, s[12:15], s36 offen offset:1024 lds
  v_mfma_f32_4x4x4_16b_bf16 v[84:87], v[102:103], a[174:175], 0
  v_cvt_pk_bf16_f32 v90, v90, v91
  v_cvt_pk_bf16_f32 v92, v92, v93
  ds_read_b64_tr_b16 a[146:147], v17 offset:768
  s_waitcnt lgkmcnt(5)
  v_mfma_f32_16x16x32_bf16 v[24:27], a[0:3], a[192:195], 0
  ds_read_b128 a[208:211], v9 offset:0
  ds_read_b128 a[212:215], v9 offset:12288
  v_cvt_pk_bf16_f32 v94, v94, v95
  buffer_load_dwordx4 v16, s[12:15], s36 offen offset:2048 lds
  v_mfma_f32_16x16x32_bf16 v[48:51], a[0:3], a[196:199], 0
  v_accvgpr_write_b32 a20, v88
  v_accvgpr_write_b32 a21, v90
  ds_read_b64_tr_b16 a[148:149], v17 offset:8
  v_mfma_f32_16x16x32_bf16 v[28:31], a[4:7], a[192:195], 0
  v_accvgpr_write_b32 a22, v92
  ds_read_b64_tr_b16 a[150:151], v17 offset:776
  s_add_u32 m0, s34, 76800
  s_add_u32 s36, s36, 12288
  buffer_load_dwordx4 v14, s[12:15], s36 offen offset:0 lds
  v_mfma_f32_16x16x32_bf16 v[52:55], a[4:7], a[196:199], 0
  v_accvgpr_write_b32 a23, v94
  ds_read_b64_tr_b16 a[152:153], v17 offset:16
  v_mfma_f32_4x4x4_16b_bf16 v[88:91], v[100:101], a[176:177], 0
  v_cvt_pk_bf16_f32 v72, v72, v73
  v_cvt_pk_bf16_f32 v74, v74, v75
  ds_read_b64_tr_b16 a[154:155], v17 offset:784
  buffer_load_dwordx4 v15, s[12:15], s36 offen offset:1024 lds
  v_mfma_f32_4x4x4_16b_bf16 v[92:95], v[102:103], a[178:179], 0
  v_cvt_pk_bf16_f32 v76, v76, v77
  v_cvt_pk_bf16_f32 v78, v78, v79
  v_mfma_f32_16x16x32_bf16 v[32:35], a[8:11], a[192:195], 0
  v_accvgpr_write_b32 a24, v72
  v_accvgpr_write_b32 a25, v74
  ds_read_b64_tr_b16 a[156:157], v17 offset:24
  buffer_load_dwordx4 v16, s[12:15], s36 offen offset:2048 lds
  v_mfma_f32_16x16x32_bf16 v[56:59], a[8:11], a[196:199], 0
  v_accvgpr_write_b32 a26, v76
  v_accvgpr_write_b32 a27, v78
  ds_read_b64_tr_b16 a[158:159], v17 offset:792
  v_mfma_f32_4x4x4_16b_bf16 v[72:75], v[100:101], a[180:181], 0
  v_cvt_pk_bf16_f32 v80, v80, v81
  v_cvt_pk_bf16_f32 v82, v82, v83
  ds_read_b64_tr_b16 a[160:161], v17 offset:32
  s_add_u32 m0, s33, 122880
  s_nop 0
  buffer_load_dwordx4 v1, s[4:7], s21 offen nt lds
  v_mfma_f32_4x4x4_16b_bf16 v[76:79], v[102:103], a[182:183], 0
  v_cvt_pk_bf16_f32 v84, v84, v85
  v_cvt_pk_bf16_f32 v86, v86, v87
  ds_read_b64_tr_b16 a[162:163], v17 offset:800
  v_mfma_f32_16x16x32_bf16 v[36:39], a[12:15], a[192:195], 0
  v_accvgpr_write_b32 a28, v80
  v_accvgpr_write_b32 a29, v82
  s_add_u32 m0, s33, 126976
  s_nop 0
  buffer_load_dwordx4 v2, s[4:7], s21 offen nt lds
  v_mfma_f32_16x16x32_bf16 v[60:63], a[12:15], a[196:199], 0
  v_accvgpr_write_b32 a30, v84
  v_accvgpr_write_b32 a31, v86
  ds_read_b64_tr_b16 a[164:165], v17 offset:40
  v_mfma_f32_4x4x4_16b_bf16 v[80:83], v[100:101], a[184:185], 0
  v_cvt_pk_bf16_f32 v88, v88, v89
  v_cvt_pk_bf16_f32 v90, v90, v91
  ds_read_b64_tr_b16 a[166:167], v17 offset:808
  s_add_u32 m0, s33, 131072
  s_nop 0
  buffer_load_dwordx4 v3, s[4:7], s21 offen nt lds
  v_mfma_f32_4x4x4_16b_bf16 v[84:87], v[102:103], a[186:187], 0
  v_cvt_pk_bf16_f32 v92, v92, v93
  v_cvt_pk_bf16_f32 v94, v94, v95
  s_waitcnt lgkmcnt(14)
  v_mfma_f32_16x16x32_bf16 v[40:43], a[16:19], a[192:195], 0
  v_accvgpr_write_b32 a32, v88
  v_accvgpr_write_b32 a33, v90
  v_and_b32 v96, v19, v96
  s_add_u32 m0, s33, 135168
  s_add_u32 s21, s21, 6291456
  buffer_load_dwordx4 v1, s[4:7], s37 offen nt lds
  v_mfma_f32_16x16x32_bf16 v[64:67], a[16:19], a[196:199], 0
  v_accvgpr_write_b32 a34, v92
  v_accvgpr_write_b32 a35, v94
  v_mfma_f32_4x4x4_16b_bf16 v[88:91], v[100:101], a[188:189], 0
  v_cvt_pk_bf16_f32 v72, v72, v73
  v_cvt_pk_bf16_f32 v74, v74, v75
  v_and_b32 v97, v20, v97
  s_add_u32 m0, s33, 139264
  s_nop 0
  buffer_load_dwordx4 v2, s[4:7], s37 offen nt lds
  v_mfma_f32_4x4x4_16b_bf16 v[92:95], v[102:103], a[190:191], 0
  v_cvt_pk_bf16_f32 v76, v76, v77
  v_cvt_pk_bf16_f32 v78, v78, v79
  v_and_b32 v98, v19, v98
  v_mfma_f32_16x16x32_bf16 v[44:47], a[20:23], a[192:195], 0
  v_accvgpr_write_b32 a36, v72
  v_accvgpr_write_b32 a37, v74
  v_and_b32 v99, v20, v99
  s_add_u32 m0, s33, 143360
  s_nop 0
  buffer_load_dwordx4 v3, s[4:7], s37 offen nt lds
  s_add_u32 s37, s37, 6291456
  v_mfma_f32_16x16x32_bf16 v[68:71], a[20:23], a[196:199], 0
  v_accvgpr_write_b32 a38, v76
  v_accvgpr_write_b32 a39, v78
  s_waitcnt lgkmcnt(0)
  s_nop 0
  v_mfma_f32_4x4x4_16b_bf16 v[72:75], v[96:97], a[144:145], 0
  v_cvt_pk_bf16_f32 v80, v80, v81
  v_cvt_pk_bf16_f32 v82, v82, v83
  s_waitcnt vmcnt(18)
  v_mfma_f32_4x4x4_16b_bf16 v[76:79], v[98:99], a[146:147], 0
  v_cvt_pk_bf16_f32 v84, v84, v85
  v_cvt_pk_bf16_f32 v86, v86, v87
  ds_read_b128 v[100:103], v18 offset:192
  v_mfma_f32_16x16x32_bf16 v[24:27], a[24:27], a[200:203], v[24:27]
  ds_read_b128 a[192:195], v10 offset:0
  ds_read_b128 a[196:199], v10 offset:12288
  v_accvgpr_write_b32 a40, v80
  v_accvgpr_write_b32 a41, v82
  ds_read_b64_tr_b16 a[168:169], v17 offset:24576
  v_mfma_f32_16x16x32_bf16 v[48:51], a[24:27], a[204:207], v[48:51]
  v_accvgpr_write_b32 a42, v84
  v_accvgpr_write_b32 a43, v86
  ds_read_b64_tr_b16 a[170:171], v17 offset:25344
  v_mfma_f32_4x4x4_16b_bf16 v[80:83], v[96:97], a[148:149], 0
  v_cvt_pk_bf16_f32 v88, v88, v89
  v_cvt_pk_bf16_f32 v90, v90, v91
  v_mfma_f32_4x4x4_16b_bf16 v[84:87], v[98:99], a[150:151], 0
  v_cvt_pk_bf16_f32 v92, v92, v93
  v_cvt_pk_bf16_f32 v94, v94, v95
  ds_read_b64_tr_b16 a[172:173], v17 offset:24584
  v_mfma_f32_16x16x32_bf16 v[28:31], a[28:31], a[200:203], v[28:31]
  v_accvgpr_write_b32 a44, v88
  v_accvgpr_write_b32 a45, v90
  ds_read_b64_tr_b16 a[174:175], v17 offset:25352
  v_mfma_f32_16x16x32_bf16 v[52:55], a[28:31], a[204:207], v[52:55]
  v_accvgpr_write_b32 a46, v92
  v_accvgpr_write_b32 a47, v94
  ds_read_b64_tr_b16 a[176:177], v17 offset:24592
  v_mfma_f32_4x4x4_16b_bf16 v[88:91], v[96:97], a[152:153], 0
  v_cvt_pk_bf16_f32 v72, v72, v73
  v_cvt_pk_bf16_f32 v74, v74, v75
  ds_read_b64_tr_b16 a[178:179], v17 offset:25360
  v_mfma_f32_4x4x4_16b_bf16 v[92:95], v[98:99], a[154:155], 0
  v_cvt_pk_bf16_f32 v76, v76, v77
  v_cvt_pk_bf16_f32 v78, v78, v79
  v_mfma_f32_16x16x32_bf16 v[32:35], a[32:35], a[200:203], v[32:35]
  v_accvgpr_write_b32 a48, v72
  v_accvgpr_write_b32 a49, v74
  ds_read_b64_tr_b16 a[180:181], v17 offset:24600
  v_mfma_f32_16x16x32_bf16 v[56:59], a[32:35], a[204:207], v[56:59]
  v_accvgpr_write_b32 a50, v76
  v_accvgpr_write_b32 a51, v78
  ds_read_b64_tr_b16 a[182:183], v17 offset:25368
  v_mfma_f32_4x4x4_16b_bf16 v[72:75], v[96:97], a[156:157], 0
  v_cvt_pk_bf16_f32 v80, v80, v81
  v_cvt_pk_bf16_f32 v82, v82, v83
  ds_read_b64_tr_b16 a[184:185], v17 offset:24608
  v_mfma_f32_4x4x4_16b_bf16 v[76:79], v[98:99], a[158:159], 0
  v_cvt_pk_bf16_f32 v84, v84, v85
  v_cvt_pk_bf16_f32 v86, v86, v87
  ds_read_b64_tr_b16 a[186:187], v17 offset:25376
  v_mfma_f32_16x16x32_bf16 v[36:39], a[36:39], a[200:203], v[36:39]
  v_accvgpr_write_b32 a52, v80
  v_accvgpr_write_b32 a53, v82
  v_mfma_f32_16x16x32_bf16 v[60:63], a[36:39], a[204:207], v[60:63]
  v_accvgpr_write_b32 a54, v84
  v_accvgpr_write_b32 a55, v86
  ds_read_b64_tr_b16 a[188:189], v17 offset:24616
  v_mfma_f32_4x4x4_16b_bf16 v[80:83], v[96:97], a[160:161], 0
  v_cvt_pk_bf16_f32 v88, v88, v89
  v_cvt_pk_bf16_f32 v90, v90, v91
  ds_read_b64_tr_b16 a[190:191], v17 offset:25384
  v_mfma_f32_4x4x4_16b_bf16 v[84:87], v[98:99], a[162:163], 0
  v_cvt_pk_bf16_f32 v92, v92, v93
  v_cvt_pk_bf16_f32 v94, v94, v95
  s_waitcnt lgkmcnt(14)
  v_mfma_f32_16x16x32_bf16 v[40:43], a[40:43], a[200:203], v[40:43]
  v_accvgpr_write_b32 a56, v88
  v_accvgpr_write_b32 a57, v90
  v_and_b32 v100, v19, v100
  v_mfma_f32_16x16x32_bf16 v[64:67], a[40:43], a[204:207], v[64:67]
  v_accvgpr_write_b32 a58, v92
  v_accvgpr_write_b32 a59, v94
  v_mfma_f32_4x4x4_16b_bf16 v[88:91], v[96:97], a[164:165], 0
  v_cvt_pk_bf16_f32 v72, v72, v73
  v_cvt_pk_bf16_f32 v74, v74, v75
  v_and_b32 v101, v20, v101
  v_mfma_f32_4x4x4_16b_bf16 v[92:95], v[98:99], a[166:167], 0
  v_cvt_pk_bf16_f32 v76, v76, v77
  v_cvt_pk_bf16_f32 v78, v78, v79
  v_and_b32 v102, v19, v102
  v_mfma_f32_16x16x32_bf16 v[44:47], a[44:47], a[200:203], v[44:47]
  v_accvgpr_write_b32 a60, v72
  v_accvgpr_write_b32 a61, v74
  v_and_b32 v103, v20, v103
  v_mfma_f32_16x16x32_bf16 v[68:71], a[44:47], a[204:207], v[68:71]
  v_accvgpr_write_b32 a62, v76
  v_accvgpr_write_b32 a63, v78
  s_waitcnt lgkmcnt(0)
  s_nop 0
  v_mfma_f32_4x4x4_16b_bf16 v[72:75], v[100:101], a[168:169], 0
  v_cvt_pk_bf16_f32 v80, v80, v81
  v_cvt_pk_bf16_f32 v82, v82, v83
  s_waitcnt vmcnt(12)
  v_mfma_f32_4x4x4_16b_bf16 v[76:79], v[102:103], a[170:171], 0
  v_cvt_pk_bf16_f32 v84, v84, v85
  v_cvt_pk_bf16_f32 v86, v86, v87
  ds_read_b128 v[96:99], v18 offset:256
  v_mfma_f32_16x16x32_bf16 v[24:27], a[48:51], a[208:211], v[24:27]
  ds_read_b128 a[200:203], v7 offset:256
  ds_read_b128 a[204:207], v7 offset:12544
  v_accvgpr_write_b32 a64, v80
  v_accvgpr_write_b32 a65, v82
  ds_read_b64_tr_b16 a[144:145], v104 offset:0
  v_mfma_f32_16x16x32_bf16 v[48:51], a[48:51], a[212:215], v[48:51]
  v_accvgpr_write_b32 a66, v84
  v_accvgpr_write_b32 a67, v86
  ds_read_b64_tr_b16 a[146:147], v104 offset:768
  v_mfma_f32_4x4x4_16b_bf16 v[80:83], v[100:101], a[172:173], 0
  v_cvt_pk_bf16_f32 v88, v88, v89
  v_cvt_pk_bf16_f32 v90, v90, v91
  v_mfma_f32_4x4x4_16b_bf16 v[84:87], v[102:103], a[174:175], 0
  v_cvt_pk_bf16_f32 v92, v92, v93
  v_cvt_pk_bf16_f32 v94, v94, v95
  ds_read_b64_tr_b16 a[148:149], v104 offset:8
  v_mfma_f32_16x16x32_bf16 v[28:31], a[52:55], a[208:211], v[28:31]
  v_accvgpr_write_b32 a68, v88
  v_accvgpr_write_b32 a69, v90
  ds_read_b64_tr_b16 a[150:151], v104 offset:776
  v_mfma_f32_16x16x32_bf16 v[52:55], a[52:55], a[212:215], v[52:55]
  v_accvgpr_write_b32 a70, v92
  v_accvgpr_write_b32 a71, v94
  ds_read_b64_tr_b16 a[152:153], v104 offset:16
  v_mfma_f32_4x4x4_16b_bf16 v[88:91], v[100:101], a[176:177], 0
  v_cvt_pk_bf16_f32 v72, v72, v73
  v_cvt_pk_bf16_f32 v74, v74, v75
  ds_read_b64_tr_b16 a[154:155], v104 offset:784
  v_mfma_f32_4x4x4_16b_bf16 v[92:95], v[102:103], a[178:179], 0
  v_cvt_pk_bf16_f32 v76, v76, v77
  v_cvt_pk_bf16_f32 v78, v78, v79
  v_mfma_f32_16x16x32_bf16 v[32:35], a[56:59], a[208:211], v[32:35]
  v_accvgpr_write_b32 a72, v72
  v_accvgpr_write_b32 a73, v74
  ds_read_b64_tr_b16 a[156:157], v104 offset:24
  v_mfma_f32_16x16x32_bf16 v[56:59], a[56:59], a[212:215], v[56:59]
  v_accvgpr_write_b32 a74, v76
  v_accvgpr_write_b32 a75, v78
  ds_read_b64_tr_b16 a[158:159], v104 offset:792
  v_mfma_f32_4x4x4_16b_bf16 v[72:75], v[100:101], a[180:181], 0
  v_cvt_pk_bf16_f32 v80, v80, v81
  v_cvt_pk_bf16_f32 v82, v82, v83
  ds_read_b64_tr_b16 a[160:161], v104 offset:32
  v_mfma_f32_4x4x4_16b_bf16 v[76:79], v[102:103], a[182:183], 0
  v_cvt_pk_bf16_f32 v84, v84, v85
  v_cvt_pk_bf16_f32 v86, v86, v87
  ds_read_b64_tr_b16 a[162:163], v104 offset:800
  v_mfma_f32_16x16x32_bf16 v[36:39], a[60:63], a[208:211], v[36:39]
  v_accvgpr_write_b32 a76, v80
  v_accvgpr_write_b32 a77, v82
  v_mfma_f32_16x16x32_bf16 v[60:63], a[60:63], a[212:215], v[60:63]
  v_accvgpr_write_b32 a78, v84
  v_accvgpr_write_b32 a79, v86
  ds_read_b64_tr_b16 a[164:165], v104 offset:40
  v_mfma_f32_4x4x4_16b_bf16 v[80:83], v[100:101], a[184:185], 0
  v_cvt_pk_bf16_f32 v88, v88, v89
  v_cvt_pk_bf16_f32 v90, v90, v91
  ds_read_b64_tr_b16 a[166:167], v104 offset:808
  v_mfma_f32_4x4x4_16b_bf16 v[84:87], v[102:103], a[186:187], 0
  v_cvt_pk_bf16_f32 v92, v92, v93
  v_cvt_pk_bf16_f32 v94, v94, v95
  s_waitcnt lgkmcnt(14)
  v_mfma_f32_16x16x32_bf16 v[40:43], a[64:67], a[208:211], v[40:43]
  v_accvgpr_write_b32 a80, v88
  v_accvgpr_write_b32 a81, v90
  v_and_b32 v96, v19, v96
  v_mfma_f32_16x16x32_bf16 v[64:67], a[64:67], a[212:215], v[64:67]
  v_accvgpr_write_b32 a82, v92
  v_accvgpr_write_b32 a83, v94
  v_mfma_f32_4x4x4_16b_bf16 v[88:91], v[100:101], a[188:189], 0
  v_cvt_pk_bf16_f32 v72, v72, v73
  v_cvt_pk_bf16_f32 v74, v74, v75
  v_and_b32 v97, v20, v97
  v_mfma_f32_4x4x4_16b_bf16 v[92:95], v[102:103], a[190:191], 0
  v_cvt_pk_bf16_f32 v76, v76, v77
  v_cvt_pk_bf16_f32 v78, v78, v79
  v_and_b32 v98, v19, v98
  v_mfma_f32_16x16x32_bf16 v[44:47], a[68:71], a[208:211], v[44:47]
  v_accvgpr_write_b32 a84, v72
  v_accvgpr_write_b32 a85, v74
  v_and_b32 v99, v20, v99
  v_mfma_f32_16x16x32_bf16 v[68:71], a[68:71], a[212:215], v[68:71]
  v_accvgpr_write_b32 a86, v76
  v_accvgpr_write_b32 a87, v78
  s_waitcnt lgkmcnt(0)
  s_nop 0
  v_mfma_f32_4x4x4_16b_bf16 v[72:75], v[96:97], a[144:145], 0
  v_cvt_pk_bf16_f32 v80, v80, v81
  v_cvt_pk_bf16_f32 v82, v82, v83
  s_waitcnt vmcnt(6)
  s_add_u32 m0, s34, 0
  s_add_u32 s36, s36, 12288
  buffer_load_dwordx4 v14, s[12:15], s36 offen offset:0 lds
  v_mfma_f32_4x4x4_16b_bf16 v[76:79], v[98:99], a[146:147], 0
  v_cvt_pk_bf16_f32 v84, v84, v85
  v_cvt_pk_bf16_f32 v86, v86, v87
  ds_read_b128 v[100:103], v18 offset:320
  v_mfma_f32_16x16x32_bf16 v[24:27], a[72:75], a[192:195], v[24:27]
  ds_read_b128 a[208:211], v8 offset:256
  ds_read_b128 a[212:215], v8 offset:12544
  v_accvgpr_write_b32 a88, v80
  v_accvgpr_write_b32 a89, v82
  ds_read_b64_tr_b16 a[168:169], v104 offset:24576
  buffer_load_dwordx4 v15, s[12:15], s36 offen offset:1024 lds
  v_mfma_f32_16x16x32_bf16 v[48:51], a[72:75], a[196:199], v[48:51]
  v_accvgpr_write_b32 a90, v84
  v_accvgpr_write_b32 a91, v86
  ds_read_b64_tr_b16 a[170:171], v104 offset:25344
  v_mfma_f32_4x4x4_16b_bf16 v[80:83], v[96:97], a[148:149], 0
  v_cvt_pk_bf16_f32 v88, v88, v89
  v_cvt_pk_bf16_f32 v90, v90, v91
  buffer_load_dwordx4 v16, s[12:15], s36 offen offset:2048 lds
  v_mfma_f32_4x4x4_16b_bf16 v[84:87], v[98:99], a[150:151], 0
  v_cvt_pk_bf16_f32 v92, v92, v93
  v_cvt_pk_bf16_f32 v94, v94, v95
  ds_read_b64_tr_b16 a[172:173], v104 offset:24584
  v_mfma_f32_16x16x32_bf16 v[28:31], a[76:79], a[192:195], v[28:31]
  v_accvgpr_write_b32 a92, v88
  v_accvgpr_write_b32 a93, v90
  ds_read_b64_tr_b16 a[174:175], v104 offset:25352
  s_add_u32 m0, s34, 3072
  s_add_u32 s36, s36, 12288
  buffer_load_dwordx4 v14, s[12:15], s36 offen offset:0 lds
  v_mfma_f32_16x16x32_bf16 v[52:55], a[76:79], a[196:199], v[52:55]
  v_accvgpr_write_b32 a94, v92
  v_accvgpr_write_b32 a95, v94
  ds_read_b64_tr_b16 a[176:177], v104 offset:24592
  v_mfma_f32_4x4x4_16b_bf16 v[88:91], v[96:97], a[152:153], 0
  v_cvt_pk_bf16_f32 v72, v72, v73
  v_cvt_pk_bf16_f32 v74, v74, v75
  ds_read_b64_tr_b16 a[178:179], v104 offset:25360
  buffer_load_dwordx4 v15, s[12:15], s36 offen offset:1024 lds
  v_mfma_f32_4x4x4_16b_bf16 v[92:95], v[98:99], a[154:155], 0
  v_cvt_pk_bf16_f32 v76, v76, v77
  v_cvt_pk_bf16_f32 v78, v78, v79
  v_mfma_f32_16x16x32_bf16 v[32:35], a[80:83], a[192:195], v[32:35]
  v_accvgpr_write_b32 a96, v72
  v_accvgpr_write_b32 a97, v74
  ds_read_b64_tr_b16 a[180:181], v104 offset:24600
  buffer_load_dwordx4 v16, s[12:15], s36 offen offset:2048 lds
  v_mfma_f32_16x16x32_bf16 v[56:59], a[80:83], a[196:199], v[56:59]
  v_accvgpr_write_b32 a98, v76
  v_accvgpr_write_b32 a99, v78
  ds_read_b64_tr_b16 a[182:183], v104 offset:25368
  v_mfma_f32_4x4x4_16b_bf16 v[72:75], v[96:97], a[156:157], 0
  v_cvt_pk_bf16_f32 v80, v80, v81
  v_cvt_pk_bf16_f32 v82, v82, v83
  ds_read_b64_tr_b16 a[184:185], v104 offset:24608
  s_add_u32 m0, s34, 24576
  s_add_u32 s36, s36, 12288
  buffer_load_dwordx4 v14, s[12:15], s36 offen offset:0 lds
  v_mfma_f32_4x4x4_16b_bf16 v[76:79], v[98:99], a[158:159], 0
  v_cvt_pk_bf16_f32 v84, v84, v85
  v_cvt_pk_bf16_f32 v86, v86, v87
  ds_read_b64_tr_b16 a[186:187], v104 offset:25376
  v_mfma_f32_16x16x32_bf16 v[36:39], a[84:87], a[192:195], v[36:39]
  v_accvgpr_write_b32 a100, v80
  v_accvgpr_write_b32 a101, v82
  buffer_load_dwordx4 v15, s[12:15], s36 offen offset:1024 lds
  v_mfma_f32_16x16x32_bf16 v[60:63], a[84:87], a[196:199], v[60:63]
  v_accvgpr_write_b32 a102, v84
  v_accvgpr_write_b32 a103, v86
  ds_read_b64_tr_b16 a[188:189], v104 offset:24616
  v_mfma_f32_4x4x4_16b_bf16 v[80:83], v[96:97], a[160:161], 0
  v_cvt_pk_bf16_f32 v88, v88, v89
  v_cvt_pk_bf16_f32 v90, v90, v91
  ds_read_b64_tr_b16 a[190:191], v104 offset:25384
  buffer_load_dwordx4 v16, s[12:15], s36 offen offset:2048 lds
  v_mfma_f32_4x4x4_16b_bf16 v[84:87], v[98:99], a[162:163], 0
  v_cvt_pk_bf16_f32 v92, v92, v93
  v_cvt_pk_bf16_f32 v94, v94, v95
  s_waitcnt lgkmcnt(14)
  v_mfma_f32_16x16x32_bf16 v[40:43], a[88:91], a[192:195], v[40:43]
  v_accvgpr_write_b32 a104, v88
  v_accvgpr_write_b32 a105, v90
  v_and_b32 v100, v19, v100
  s_add_u32 m0, s34, 27648
  s_add_u32 s36, s36, 12288
  buffer_load_dwordx4 v14, s[12:15], s36 offen offset:0 lds
  v_mfma_f32_16x16x32_bf16 v[64:67], a[88:91], a[196:199], v[64:67]
  v_accvgpr_write_b32 a106, v92
  v_accvgpr_write_b32 a107, v94
  v_mfma_f32_4x4x4_16b_bf16 v[88:91], v[96:97], a[164:165], 0
  v_cvt_pk_bf16_f32 v72, v72, v73
  v_cvt_pk_bf16_f32 v74, v74, v75
  v_and_b32 v101, v20, v101
  buffer_load_dwordx4 v15, s[12:15], s36 offen offset:1024 lds
  v_mfma_f32_4x4x4_16b_bf16 v[92:95], v[98:99], a[166:167], 0
  v_cvt_pk_bf16_f32 v76, v76, v77
  v_cvt_pk_bf16_f32 v78, v78, v79
  v_and_b32 v102, v19, v102
  v_mfma_f32_16x16x32_bf16 v[44:47], a[92:95], a[192:195], v[44:47]
  v_accvgpr_write_b32 a108, v72
  v_accvgpr_write_b32 a109, v74
  v_and_b32 v103, v20, v103
  buffer_load_dwordx4 v16, s[12:15], s36 offen offset:2048 lds
  v_mfma_f32_16x16x32_bf16 v[68:71], a[92:95], a[196:199], v[68:71]
  v_accvgpr_write_b32 a110, v76
  v_accvgpr_write_b32 a111, v78
  s_waitcnt lgkmcnt(0)
  s_nop 0
  v_mfma_f32_4x4x4_16b_bf16 v[72:75], v[100:101], a[168:169], 0
  v_cvt_pk_bf16_f32 v80, v80, v81
  v_cvt_pk_bf16_f32 v82, v82, v83
  s_waitcnt vmcnt(6)
  s_add_u32 m0, s34, 49152
  s_add_u32 s36, s36, 12288
  buffer_load_dwordx4 v14, s[12:15], s36 offen offset:0 lds
  v_mfma_f32_4x4x4_16b_bf16 v[76:79], v[102:103], a[170:171], 0
  v_cvt_pk_bf16_f32 v84, v84, v85
  v_cvt_pk_bf16_f32 v86, v86, v87
  ds_read_b128 v[96:99], v18 offset:384
  v_mfma_f32_16x16x32_bf16 v[24:27], a[96:99], a[200:203], v[24:27]
  ds_read_b128 a[192:195], v9 offset:256
  ds_read_b128 a[196:199], v9 offset:12544
  v_accvgpr_write_b32 a112, v80
  v_accvgpr_write_b32 a113, v82
  ds_read_b64_tr_b16 a[144:145], v17 offset:0
  buffer_load_dwordx4 v15, s[12:15], s36 offen offset:1024 lds
  v_mfma_f32_16x16x32_bf16 v[48:51], a[96:99], a[204:207], v[48:51]
  v_accvgpr_write_b32 a114, v84
  v_accvgpr_write_b32 a115, v86
  ds_read_b64_tr_b16 a[146:147], v17 offset:768
  v_mfma_f32_4x4x4_16b_bf16 v[80:83], v[100:101], a[172:173], 0
  v_cvt_pk_bf16_f32 v88, v88, v89
  v_cvt_pk_bf16_f32 v90, v90, v91
  buffer_load_dwordx4 v16, s[12:15], s36 offen offset:2048 lds
  v_mfma_f32_4x4x4_16b_bf16 v[84:87], v[102:103], a[174:175], 0
  v_cvt_pk_bf16_f32 v92, v92, v93
  v_cvt_pk_bf16_f32 v94, v94, v95
  ds_read_b64_tr_b16 a[148:149], v17 offset:8
  v_mfma_f32_16x16x32_bf16 v[28:31], a[100:103], a[200:203], v[28:31]
  v_accvgpr_write_b32 a116, v88
  v_accvgpr_write_b32 a117, v90
  ds_read_b64_tr_b16 a[150:151], v17 offset:776
  s_add_u32 m0, s34, 52224
  s_add_u32 s36, s36, 12288
  buffer_load_dwordx4 v14, s[12:15], s36 offen offset:0 lds
  v_mfma_f32_16x16x32_bf16 v[52:55], a[100:103], a[204:207], v[52:55]
  v_accvgpr_write_b32 a118, v92
  v_accvgpr_write_b32 a119, v94
  ds_read_b64_tr_b16 a[152:153], v17 offset:16
  v_mfma_f32_4x4x4_16b_bf16 v[88:91], v[100:101], a[176:177], 0
  v_cvt_pk_bf16_f32 v72, v72, v73
  v_cvt_pk_bf16_f32 v74, v74, v75
  ds_read_b64_tr_b16 a[154:155], v17 offset:784
  buffer_load_dwordx4 v15, s[12:15], s36 offen offset:1024 lds
  v_mfma_f32_4x4x4_16b_bf16 v[92:95], v[102:103], a[178:179], 0
  v_cvt_pk_bf16_f32 v76, v76, v77
  v_cvt_pk_bf16_f32 v78, v78, v79
  v_mfma_f32_16x16x32_bf16 v[32:35], a[104:107], a[200:203], v[32:35]
  v_accvgpr_write_b32 a120, v72
  v_accvgpr_write_b32 a121, v74
  ds_read_b64_tr_b16 a[156:157], v17 offset:24
  buffer_load_dwordx4 v16, s[12:15], s36 offen offset:2048 lds
  v_mfma_f32_16x16x32_bf16 v[56:59], a[104:107], a[204:207], v[56:59]
  v_accvgpr_write_b32 a122, v76
  v_accvgpr_write_b32 a123, v78
  ds_read_b64_tr_b16 a[158:159], v17 offset:792
  v_mfma_f32_4x4x4_16b_bf16 v[72:75], v[100:101], a[180:181], 0
  v_cvt_pk_bf16_f32 v80, v80, v81
  v_cvt_pk_bf16_f32 v82, v82, v83
  ds_read_b64_tr_b16 a[160:161], v17 offset:32
  s_add_u32 m0, s34, 73728
  s_add_u32 s36, s36, 12288
  buffer_load_dwordx4 v14, s[12:15], s36 offen offset:0 lds
  v_mfma_f32_4x4x4_16b_bf16 v[76:79], v[102:103], a[182:183], 0
  v_cvt_pk_bf16_f32 v84, v84, v85
  v_cvt_pk_bf16_f32 v86, v86, v87
  ds_read_b64_tr_b16 a[162:163], v17 offset:800
  v_mfma_f32_16x16x32_bf16 v[36:39], a[108:111], a[200:203], v[36:39]
  v_accvgpr_write_b32 a124, v80
  v_accvgpr_write_b32 a125, v82
  buffer_load_dwordx4 v15, s[12:15], s36 offen offset:1024 lds
  v_mfma_f32_16x16x32_bf16 v[60:63], a[108:111], a[204:207], v[60:63]
  v_accvgpr_write_b32 a126, v84
  v_accvgpr_write_b32 a127, v86
  ds_read_b64_tr_b16 a[164:165], v17 offset:40
  v_mfma_f32_4x4x4_16b_bf16 v[80:83], v[100:101], a[184:185], 0
  v_cvt_pk_bf16_f32 v88, v88, v89
  v_cvt_pk_bf16_f32 v90, v90, v91
  ds_read_b64_tr_b16 a[166:167], v17 offset:808
  buffer_load_dwordx4 v16, s[12:15], s36 offen offset:2048 lds
  v_mfma_f32_4x4x4_16b_bf16 v[84:87], v[102:103], a[186:187], 0
  v_cvt_pk_bf16_f32 v92, v92, v93
  v_cvt_pk_bf16_f32 v94, v94, v95
  s_waitcnt lgkmcnt(14)
  v_mfma_f32_16x16x32_bf16 v[40:43], a[112:115], a[200:203], v[40:43]
  v_accvgpr_write_b32 a128, v88
  v_accvgpr_write_b32 a129, v90
  v_and_b32 v96, v19, v96
  s_add_u32 m0, s34, 76800
  s_add_u32 s36, s36, 12288
  buffer_load_dwordx4 v14, s[12:15], s36 offen offset:0 lds
  v_mfma_f32_16x16x32_bf16 v[64:67], a[112:115], a[204:207], v[64:67]
  v_accvgpr_write_b32 a130, v92
  v_accvgpr_write_b32 a131, v94
  v_mfma_f32_4x4x4_16b_bf16 v[88:91], v[100:101], a[188:189], 0
  v_cvt_pk_bf16_f32 v72, v72, v73
  v_cvt_pk_bf16_f32 v74, v74, v75
  v_and_b32 v97, v20, v97
  buffer_load_dwordx4 v15, s[12:15], s36 offen offset:1024 lds
  v_mfma_f32_4x4x4_16b_bf16 v[92:95], v[102:103], a[190:191], 0
  v_cvt_pk_bf16_f32 v76, v76, v77
  v_cvt_pk_bf16_f32 v78, v78, v79
  v_and_b32 v98, v19, v98
  v_mfma_f32_16x16x32_bf16 v[44:47], a[116:119], a[200:203], v[44:47]
  v_accvgpr_write_b32 a132, v72
  v_accvgpr_write_b32 a133, v74
  v_and_b32 v99, v20, v99
  buffer_load_dwordx4 v16, s[12:15], s36 offen offset:2048 lds
  v_mfma_f32_16x16x32_bf16 v[68:71], a[116:119], a[204:207], v[68:71]
  v_accvgpr_write_b32 a134, v76
  v_accvgpr_write_b32 a135, v78
  s_waitcnt lgkmcnt(0)
  s_nop 0
  v_mfma_f32_4x4x4_16b_bf16 v[72:75], v[96:97], a[144:145], 0
  v_cvt_pk_bf16_f32 v80, v80, v81
  v_cvt_pk_bf16_f32 v82, v82, v83
  s_waitcnt vmcnt(12)
  s_add_u32 m0, s34, 0
  s_add_u32 s36, s36, 12288
  buffer_load_dwordx4 v14, s[12:15], s36 offen offset:0 lds
  v_mfma_f32_4x4x4_16b_bf16 v[76:79], v[98:99], a[146:147], 0
  v_cvt_pk_bf16_f32 v84, v84, v85
  v_cvt_pk_bf16_f32 v86, v86, v87
  ds_read_b128 v[100:103], v18 offset:448
  v_mfma_f32_16x16x32_bf16 v[24:27], a[120:123], a[208:211], v[24:27]
  ds_read_b128 a[200:203], v10 offset:256
  ds_read_b128 a[204:207], v10 offset:12544
  v_accvgpr_write_b32 a136, v80
  v_accvgpr_write_b32 a137, v82
  ds_read_b64_tr_b16 a[168:169], v17 offset:24576
  v_mfma_f32_16x16x32_bf16 v[48:51], a[120:123], a[212:215], v[48:51]
  v_accvgpr_write_b32 a138, v84
  v_accvgpr_write_b32 a139, v86
  ds_read_b64_tr_b16 a[170:171], v17 offset:25344
  v_mfma_f32_4x4x4_16b_bf16 v[80:83], v[96:97], a[148:149], 0
  v_cvt_pk_bf16_f32 v88, v88, v89
  v_cvt_pk_bf16_f32 v90, v90, v91
  buffer_load_dwordx4 v15, s[12:15], s36 offen offset:1024 lds
  v_mfma_f32_4x4x4_16b_bf16 v[84:87], v[98:99], a[150:151], 0
  v_cvt_pk_bf16_f32 v92, v92, v93
  v_cvt_pk_bf16_f32 v94, v94, v95
  ds_read_b64_tr_b16 a[172:173], v17 offset:24584
  v_mfma_f32_16x16x32_bf16 v[28:31], a[124:127], a[208:211], v[28:31]
  v_accvgpr_write_b32 a140, v88
  v_accvgpr_write_b32 a141, v90
  ds_read_b64_tr_b16 a[174:175], v17 offset:25352
  v_mfma_f32_16x16x32_bf16 v[52:55], a[124:127], a[212:215], v[52:55]
  v_accvgpr_write_b32 a142, v92
  v_accvgpr_write_b32 a143, v94
  ds_read_b64_tr_b16 a[176:177], v17 offset:24592
  v_mfma_f32_4x4x4_16b_bf16 v[88:91], v[96:97], a[152:153], 0
  v_cvt_pk_bf16_f32 v112, v72, v73
  ds_read_b64_tr_b16 a[178:179], v17 offset:25360
  buffer_load_dwordx4 v16, s[12:15], s36 offen offset:2048 lds
  v_mfma_f32_4x4x4_16b_bf16 v[92:95], v[98:99], a[154:155], 0
  v_cvt_pk_bf16_f32 v113, v74, v75
  v_mfma_f32_16x16x32_bf16 v[32:35], a[128:131], a[208:211], v[32:35]
  v_cvt_pk_bf16_f32 v114, v76, v77
  ds_read_b64_tr_b16 a[180:181], v17 offset:24600
  v_mfma_f32_16x16x32_bf16 v[56:59], a[128:131], a[212:215], v[56:59]
  v_cvt_pk_bf16_f32 v115, v78, v79
  ds_read_b64_tr_b16 a[182:183], v17 offset:25368
  v_mfma_f32_4x4x4_16b_bf16 v[72:75], v[96:97], a[156:157], 0
  v_cvt_pk_bf16_f32 v116, v80, v81
  ds_read_b64_tr_b16 a[184:185], v17 offset:24608
  s_add_u32 m0, s34, 3072
  s_add_u32 s36, s36, 12288
  buffer_load_dwordx4 v14, s[12:15], s36 offen offset:0 lds
  v_mfma_f32_4x4x4_16b_bf16 v[76:79], v[98:99], a[158:159], 0
  v_cvt_pk_bf16_f32 v117, v82, v83
  ds_read_b64_tr_b16 a[186:187], v17 offset:25376
  v_mfma_f32_16x16x32_bf16 v[36:39], a[132:135], a[208:211], v[36:39]
  v_cvt_pk_bf16_f32 v118, v84, v85
  v_mfma_f32_16x16x32_bf16 v[60:63], a[132:135], a[212:215], v[60:63]
  v_cvt_pk_bf16_f32 v119, v86, v87
  ds_read_b64_tr_b16 a[188:189], v17 offset:24616
  v_mfma_f32_4x4x4_16b_bf16 v[80:83], v[96:97], a[160:161], 0
  v_cvt_pk_bf16_f32 v120, v88, v89
  ds_read_b64_tr_b16 a[190:191], v17 offset:25384
  buffer_load_dwordx4 v15, s[12:15], s36 offen offset:1024 lds
  v_mfma_f32_4x4x4_16b_bf16 v[84:87], v[98:99], a[162:163], 0
  v_cvt_pk_bf16_f32 v121, v90, v91
  s_waitcnt lgkmcnt(14)
  v_mfma_f32_16x16x32_bf16 v[40:43], a[136:139], a[208:211], v[40:43]
  v_cvt_pk_bf16_f32 v122, v92, v93
  v_and_b32 v100, v19, v100
  v_mfma_f32_16x16x32_bf16 v[64:67], a[136:139], a[212:215], v[64:67]
  v_cvt_pk_bf16_f32 v123, v94, v95
  v_mfma_f32_4x4x4_16b_bf16 v[88:91], v[96:97], a[164:165], 0
  v_cvt_pk_bf16_f32 v124, v72, v73
  v_and_b32 v101, v20, v101
  buffer_load_dwordx4 v16, s[12:15], s36 offen offset:2048 lds
  v_mfma_f32_4x4x4_16b_bf16 v[92:95], v[98:99], a[166:167], 0
  v_cvt_pk_bf16_f32 v125, v74, v75
  v_and_b32 v102, v19, v102
  v_mfma_f32_16x16x32_bf16 v[44:47], a[140:143], a[208:211], v[44:47]
  v_cvt_pk_bf16_f32 v126, v76, v77
  v_and_b32 v103, v20, v103
  v_mfma_f32_16x16x32_bf16 v[68:71], a[140:143], a[212:215], v[68:71]
  v_cvt_pk_bf16_f32 v127, v78, v79
  s_waitcnt lgkmcnt(0)
  s_nop 0
  v_mfma_f32_4x4x4_16b_bf16 v[72:75], v[100:101], a[168:169], 0
  v_cvt_pk_bf16_f32 v128, v80, v81
  s_waitcnt vmcnt(12)
  s_add_u32 m0, s34, 24576
  s_add_u32 s36, s36, 12288
  buffer_load_dwordx4 v14, s[12:15], s36 offen offset:0 lds
  v_mfma_f32_4x4x4_16b_bf16 v[76:79], v[102:103], a[170:171], 0
  v_cvt_pk_bf16_f32 v129, v82, v83
  ds_read_b128 v[96:99], v18 offset:512
  v_mfma_f32_16x16x32_bf16 v[24:27], v[112:115], a[192:195], v[24:27]
  ds_read_b128 a[208:211], v7 offset:512
  ds_read_b128 a[212:215], v7 offset:12800
  v_cvt_pk_bf16_f32 v130, v84, v85
  ds_read_b64_tr_b16 a[144:145], v104 offset:0
  v_mfma_f32_16x16x32_bf16 v[48:51], v[112:115], a[196:199], v[48:51]
  v_cvt_pk_bf16_f32 v131, v86, v87
  ds_read_b64_tr_b16 a[146:147], v104 offset:768
  v_mfma_f32_4x4x4_16b_bf16 v[80:83], v[100:101], a[172:173], 0
  v_cvt_pk_bf16_f32 v132, v88, v89
  buffer_load_dwordx4 v15, s[12:15], s36 offen offset:1024 lds
  v_mfma_f32_4x4x4_16b_bf16 v[84:87], v[102:103], a[174:175], 0
  v_cvt_pk_bf16_f32 v133, v90, v91
  ds_read_b64_tr_b16 a[148:149], v104 offset:8
  v_mfma_f32_16x16x32_bf16 v[28:31], v[116:119], a[192:195], v[28:31]
  v_cvt_pk_bf16_f32 v134, v92, v93
  ds_read_b64_tr_b16 a[150:151], v104 offset:776
  v_mfma_f32_16x16x32_bf16 v[52:55], v[116:119], a[196:199], v[52:55]
  v_cvt_pk_bf16_f32 v135, v94, v95
  ds_read_b64_tr_b16 a[152:153], v104 offset:16
  v_mfma_f32_4x4x4_16b_bf16 v[88:91], v[100:101], a[176:177], 0
  v_cvt_pk_bf16_f32 v136, v72, v73
  ds_read_b64_tr_b16 a[154:155], v104 offset:784
  buffer_load_dwordx4 v16, s[12:15], s36 offen offset:2048 lds
  v_mfma_f32_4x4x4_16b_bf16 v[92:95], v[102:103], a[178:179], 0
  v_cvt_pk_bf16_f32 v137, v74, v75
  v_mfma_f32_16x16x32_bf16 v[32:35], v[120:123], a[192:195], v[32:35]
  v_cvt_pk_bf16_f32 v138, v76, v77
  ds_read_b64_tr_b16 a[156:157], v104 offset:24
  v_mfma_f32_16x16x32_bf16 v[56:59], v[120:123], a[196:199], v[56:59]
  v_cvt_pk_bf16_f32 v139, v78, v79
  ds_read_b64_tr_b16 a[158:159], v104 offset:792
  v_mfma_f32_4x4x4_16b_bf16 v[72:75], v[100:101], a[180:181], 0
  v_cvt_pk_bf16_f32 v140, v80, v81
  ds_read_b64_tr_b16 a[160:161], v104 offset:32
  s_add_u32 m0, s34, 27648
  s_add_u32 s36, s36, 12288
  buffer_load_dwordx4 v14, s[12:15], s36 offen offset:0 lds
  v_mfma_f32_4x4x4_16b_bf16 v[76:79], v[102:103], a[182:183], 0
  v_cvt_pk_bf16_f32 v141, v82, v83
  ds_read_b64_tr_b16 a[162:163], v104 offset:800
  v_mfma_f32_16x16x32_bf16 v[36:39], v[124:127], a[192:195], v[36:39]
  v_cvt_pk_bf16_f32 v142, v84, v85
  v_mfma_f32_16x16x32_bf16 v[60:63], v[124:127], a[196:199], v[60:63]
  v_cvt_pk_bf16_f32 v143, v86, v87
  ds_read_b64_tr_b16 a[164:165], v104 offset:40
  v_mfma_f32_4x4x4_16b_bf16 v[80:83], v[100:101], a[184:185], 0
  v_cvt_pk_bf16_f32 v144, v88, v89
  ds_read_b64_tr_b16 a[166:167], v104 offset:808
  buffer_load_dwordx4 v15, s[12:15], s36 offen offset:1024 lds
  v_mfma_f32_4x4x4_16b_bf16 v[84:87], v[102:103], a[186:187], 0
  v_cvt_pk_bf16_f32 v145, v90, v91
  s_waitcnt lgkmcnt(14)
  v_mfma_f32_16x16x32_bf16 v[40:43], v[128:131], a[192:195], v[40:43]
  v_cvt_pk_bf16_f32 v146, v92, v93
  v_and_b32 v96, v19, v96
  v_mfma_f32_16x16x32_bf16 v[64:67], v[128:131], a[196:199], v[64:67]
  v_cvt_pk_bf16_f32 v147, v94, v95
  v_mfma_f32_4x4x4_16b_bf16 v[88:91], v[100:101], a[188:189], 0
  v_cvt_pk_bf16_f32 v148, v72, v73
  v_and_b32 v97, v20, v97
  buffer_load_dwordx4 v16, s[12:15], s36 offen offset:2048 lds
  v_mfma_f32_4x4x4_16b_bf16 v[92:95], v[102:103], a[190:191], 0
  v_cvt_pk_bf16_f32 v149, v74, v75
  v_and_b32 v98, v19, v98
  v_mfma_f32_16x16x32_bf16 v[44:47], v[132:135], a[192:195], v[44:47]
  v_cvt_pk_bf16_f32 v150, v76, v77
  v_and_b32 v99, v20, v99
  v_mfma_f32_16x16x32_bf16 v[68:71], v[132:135], a[196:199], v[68:71]
  v_cvt_pk_bf16_f32 v151, v78, v79
  s_waitcnt lgkmcnt(0)
  s_barrier
  s_nop 0
  v_mfma_f32_4x4x4_16b_bf16 v[72:75], v[96:97], a[144:145], 0
  v_cvt_pk_bf16_f32 v152, v80, v81
  s_waitcnt vmcnt(12)
  s_add_u32 m0, s33, 49152
  s_nop 0
  buffer_load_dwordx4 v1, s[4:7], s21 offen nt lds
  v_mfma_f32_4x4x4_16b_bf16 v[76:79], v[98:99], a[146:147], 0
  v_cvt_pk_bf16_f32 v153, v82, v83
  ds_read_b128 v[100:103], v18 offset:576
  v_mfma_f32_16x16x32_bf16 v[24:27], v[136:139], a[200:203], v[24:27]
  ds_read_b128 a[192:195], v8 offset:512
  ds_read_b128 a[196:199], v8 offset:12800
  v_cvt_pk_bf16_f32 v154, v84, v85
  ds_read_b64_tr_b16 a[168:169], v104 offset:24576
  v_mfma_f32_16x16x32_bf16 v[48:51], v[136:139], a[204:207], v[48:51]
  v_cvt_pk_bf16_f32 v155, v86, v87
  ds_read_b64_tr_b16 a[170:171], v104 offset:25344
  v_mfma_f32_4x4x4_16b_bf16 v[80:83], v[96:97], a[148:149], 0
  v_cvt_pk_bf16_f32 v156, v88, v89
  s_add_u32 m0, s33, 53248
  s_nop 0
  buffer_load_dwordx4 v2, s[4:7], s21 offen nt lds
  v_mfma_f32_4x4x4_16b_bf16 v[84:87], v[98:99], a[150:151], 0
  v_cvt_pk_bf16_f32 v157, v90, v91
  ds_read_b64_tr_b16 a[172:173], v104 offset:24584
  v_mfma_f32_16x16x32_bf16 v[28:31], v[140:143], a[200:203], v[28:31]
  v_cvt_pk_bf16_f32 v158, v92, v93
  ds_read_b64_tr_b16 a[174:175], v104 offset:25352
  v_mfma_f32_16x16x32_bf16 v[52:55], v[140:143], a[204:207], v[52:55]
  v_cvt_pk_bf16_f32 v159, v94, v95
  ds_read_b64_tr_b16 a[176:177], v104 offset:24592
  v_mfma_f32_4x4x4_16b_bf16 v[88:91], v[96:97], a[152:153], 0
  v_cvt_pk_bf16_f32 v160, v72, v73
  ds_read_b64_tr_b16 a[178:179], v104 offset:25360
  s_add_u32 m0, s33, 57344
  s_nop 0
  buffer_load_dwordx4 v3, s[4:7], s21 offen nt lds
  v_mfma_f32_4x4x4_16b_bf16 v[92:95], v[98:99], a[154:155], 0
  v_cvt_pk_bf16_f32 v161, v74, v75
  v_mfma_f32_16x16x32_bf16 v[32:35], v[144:147], a[200:203], v[32:35]
  v_cvt_pk_bf16_f32 v162, v76, v77
  ds_read_b64_tr_b16 a[180:181], v104 offset:24600
  v_mfma_f32_16x16x32_bf16 v[56:59], v[144:147], a[204:207], v[56:59]
  v_cvt_pk_bf16_f32 v163, v78, v79
  ds_read_b64_tr_b16 a[182:183], v104 offset:25368
  v_mfma_f32_4x4x4_16b_bf16 v[72:75], v[96:97], a[156:157], 0
  v_cvt_pk_bf16_f32 v164, v80, v81
  ds_read_b64_tr_b16 a[184:185], v104 offset:24608
  s_add_u32 m0, s33, 61440
  s_add_u32 s21, s21, 6291456
  buffer_load_dwordx4 v1, s[4:7], s37 offen nt lds
  v_mfma_f32_4x4x4_16b_bf16 v[76:79], v[98:99], a[158:159], 0
  v_cvt_pk_bf16_f32 v165, v82, v83
  ds_read_b64_tr_b16 a[186:187], v104 offset:25376
  v_mfma_f32_16x16x32_bf16 v[36:39], v[148:151], a[200:203], v[36:39]
  v_cvt_pk_bf16_f32 v166, v84, v85
  v_mfma_f32_16x16x32_bf16 v[60:63], v[148:151], a[204:207], v[60:63]
  v_cvt_pk_bf16_f32 v167, v86, v87
  ds_read_b64_tr_b16 a[188:189], v104 offset:24616
  v_mfma_f32_4x4x4_16b_bf16 v[80:83], v[96:97], a[160:161], 0
  v_cvt_pk_bf16_f32 v168, v88, v89
  ds_read_b64_tr_b16 a[190:191], v104 offset:25384
  s_add_u32 m0, s33, 65536
  s_nop 0
  buffer_load_dwordx4 v2, s[4:7], s37 offen nt lds
  v_mfma_f32_4x4x4_16b_bf16 v[84:87], v[98:99], a[162:163], 0
  v_cvt_pk_bf16_f32 v169, v90, v91
  s_waitcnt lgkmcnt(14)
  v_mfma_f32_16x16x32_bf16 v[40:43], v[152:155], a[200:203], v[40:43]
  v_cvt_pk_bf16_f32 v170, v92, v93
  v_and_b32 v100, v19, v100
  v_mfma_f32_16x16x32_bf16 v[64:67], v[152:155], a[204:207], v[64:67]
  v_cvt_pk_bf16_f32 v171, v94, v95
  v_mfma_f32_4x4x4_16b_bf16 v[88:91], v[96:97], a[164:165], 0
  v_cvt_pk_bf16_f32 v172, v72, v73
  v_and_b32 v101, v20, v101
  s_add_u32 m0, s33, 69632
  s_nop 0
  buffer_load_dwordx4 v3, s[4:7], s37 offen nt lds
  s_add_u32 s37, s37, 6291456
  v_mfma_f32_4x4x4_16b_bf16 v[92:95], v[98:99], a[166:167], 0
  v_cvt_pk_bf16_f32 v173, v74, v75
  v_and_b32 v102, v19, v102
  v_mfma_f32_16x16x32_bf16 v[44:47], v[156:159], a[200:203], v[44:47]
  v_cvt_pk_bf16_f32 v174, v76, v77
  v_and_b32 v103, v20, v103
  v_mfma_f32_16x16x32_bf16 v[68:71], v[156:159], a[204:207], v[68:71]
  v_cvt_pk_bf16_f32 v175, v78, v79
  s_waitcnt lgkmcnt(0)
  s_barrier
  s_nop 0
  v_mfma_f32_4x4x4_16b_bf16 v[72:75], v[100:101], a[168:169], 0
  v_cvt_pk_bf16_f32 v176, v80, v81
  s_waitcnt vmcnt(12)
  s_add_u32 m0, s33, 73728
  s_nop 0
  buffer_load_dwordx4 v1, s[4:7], s21 offen nt lds
  v_mfma_f32_4x4x4_16b_bf16 v[76:79], v[102:103], a[170:171], 0
  v_cvt_pk_bf16_f32 v177, v82, v83
  ds_read_b128 v[96:99], v18 offset:640
  v_mfma_f32_16x16x32_bf16 v[24:27], v[160:163], a[208:211], v[24:27]
  ds_read_b128 a[200:203], v9 offset:512
  ds_read_b128 a[204:207], v9 offset:12800
  v_cvt_pk_bf16_f32 v178, v84, v85
  ds_read_b64_tr_b16 a[144:145], v17 offset:0
  v_mfma_f32_16x16x32_bf16 v[48:51], v[160:163], a[212:215], v[48:51]
  v_cvt_pk_bf16_f32 v179, v86, v87
  ds_read_b64_tr_b16 a[146:147], v17 offset:768
  v_mfma_f32_4x4x4_16b_bf16 v[80:83], v[100:101], a[172:173], 0
  v_cvt_pk_bf16_f32 v180, v88, v89
  s_add_u32 m0, s33, 77824
  s_nop 0
  buffer_load_dwordx4 v2, s[4:7], s21 offen nt lds
  v_mfma_f32_4x4x4_16b_bf16 v[84:87], v[102:103], a[174:175], 0
  v_cvt_pk_bf16_f32 v181, v90, v91
  ds_read_b64_tr_b16 a[148:149], v17 offset:8
  v_mfma_f32_16x16x32_bf16 v[28:31], v[164:167], a[208:211], v[28:31]
  v_cvt_pk_bf16_f32 v182, v92, v93
  ds_read_b64_tr_b16 a[150:151], v17 offset:776
  v_mfma_f32_16x16x32_bf16 v[52:55], v[164:167], a[212:215], v[52:55]
  v_cvt_pk_bf16_f32 v183, v94, v95
  ds_read_b64_tr_b16 a[152:153], v17 offset:16
  v_mfma_f32_4x4x4_16b_bf16 v[88:91], v[100:101], a[176:177], 0
  v_cvt_pk_bf16_f32 v184, v72, v73
  ds_read_b64_tr_b16 a[154:155], v17 offset:784
  s_add_u32 m0, s33, 81920
  s_nop 0
  buffer_load_dwordx4 v3, s[4:7], s21 offen nt lds
  v_mfma_f32_4x4x4_16b_bf16 v[92:95], v[102:103], a[178:179], 0
  v_cvt_pk_bf16_f32 v185, v74, v75
  v_mfma_f32_16x16x32_bf16 v[32:35], v[168:171], a[208:211], v[32:35]
  v_cvt_pk_bf16_f32 v186, v76, v77
  ds_read_b64_tr_b16 a[156:157], v17 offset:24
  v_mfma_f32_16x16x32_bf16 v[56:59], v[168:171], a[212:215], v[56:59]
  v_cvt_pk_bf16_f32 v187, v78, v79
  ds_read_b64_tr_b16 a[158:159], v17 offset:792
  v_mfma_f32_4x4x4_16b_bf16 v[72:75], v[100:101], a[180:181], 0
  v_cvt_pk_bf16_f32 v188, v80, v81
  ds_read_b64_tr_b16 a[160:161], v17 offset:32
  s_add_u32 m0, s33, 86016
  s_add_u32 s21, s21, 6291456
  buffer_load_dwordx4 v1, s[4:7], s37 offen nt lds
  v_mfma_f32_4x4x4_16b_bf16 v[76:79], v[102:103], a[182:183], 0
  v_cvt_pk_bf16_f32 v189, v82, v83
  ds_read_b64_tr_b16 a[162:163], v17 offset:800
  v_mfma_f32_16x16x32_bf16 v[36:39], v[172:175], a[208:211], v[36:39]
  v_cvt_pk_bf16_f32 v190, v84, v85
  v_mfma_f32_16x16x32_bf16 v[60:63], v[172:175], a[212:215], v[60:63]
  v_cvt_pk_bf16_f32 v191, v86, v87
  ds_read_b64_tr_b16 a[164:165], v17 offset:40
  v_mfma_f32_4x4x4_16b_bf16 v[80:83], v[100:101], a[184:185], 0
  v_cvt_pk_bf16_f32 v192, v88, v89
  ds_read_b64_tr_b16 a[166:167], v17 offset:808
  s_add_u32 m0, s33, 90112
  s_nop 0
  buffer_load_dwordx4 v2, s[4:7], s37 offen nt lds
  v_mfma_f32_4x4x4_16b_bf16 v[84:87], v[102:103], a[186:187], 0
  v_cvt_pk_bf16_f32 v193, v90, v91
  s_waitcnt lgkmcnt(14)
  v_mfma_f32_16x16x32_bf16 v[40:43], v[176:179], a[208:211], v[40:43]
  v_cvt_pk_bf16_f32 v194, v92, v93
  v_and_b32 v96, v19, v96
  v_mfma_f32_16x16x32_bf16 v[64:67], v[176:179], a[212:215], v[64:67]
  v_cvt_pk_bf16_f32 v195, v94, v95
  v_mfma_f32_4x4x4_16b_bf16 v[88:91], v[100:101], a[188:189], 0
  v_cvt_pk_bf16_f32 v196, v72, v73
  v_and_b32 v97, v20, v97
  s_add_u32 m0, s33, 94208
  s_nop 0
  buffer_load_dwordx4 v3, s[4:7], s37 offen nt lds
  s_add_u32 s37, s37, 6291456
  v_mfma_f32_4x4x4_16b_bf16 v[92:95], v[102:103], a[190:191], 0
  v_cvt_pk_bf16_f32 v197, v74, v75
  v_and_b32 v98, v19, v98
  v_mfma_f32_16x16x32_bf16 v[44:47], v[180:183], a[208:211], v[44:47]
  v_cvt_pk_bf16_f32 v198, v76, v77
  v_and_b32 v99, v20, v99
  v_mfma_f32_16x16x32_bf16 v[68:71], v[180:183], a[212:215], v[68:71]
  v_cvt_pk_bf16_f32 v199, v78, v79
  s_waitcnt lgkmcnt(0)
  s_nop 0
  v_mfma_f32_4x4x4_16b_bf16 v[72:75], v[96:97], a[144:145], 0
  v_cvt_pk_bf16_f32 v200, v80, v81
  s_waitcnt vmcnt(12)
  v_mfma_f32_4x4x4_16b_bf16 v[76:79], v[98:99], a[146:147], 0
  v_cvt_pk_bf16_f32 v201, v82, v83
  ds_read_b128 v[100:103], v18 offset:704
  v_mfma_f32_16x16x32_bf16 v[24:27], v[184:187], a[192:195], v[24:27]
  ds_read_b128 a[208:211], v10 offset:512
  ds_read_b128 a[212:215], v10 offset:12800
  v_cvt_pk_bf16_f32 v202, v84, v85
  ds_read_b64_tr_b16 a[168:169], v17 offset:24576
  v_mfma_f32_16x16x32_bf16 v[48:51], v[184:187], a[196:199], v[48:51]
  v_cvt_pk_bf16_f32 v203, v86, v87
  ds_read_b64_tr_b16 a[170:171], v17 offset:25344
  v_mfma_f32_4x4x4_16b_bf16 v[80:83], v[96:97], a[148:149], 0
  v_cvt_pk_bf16_f32 v204, v88, v89
  v_mfma_f32_4x4x4_16b_bf16 v[84:87], v[98:99], a[150:151], 0
  v_cvt_pk_bf16_f32 v205, v90, v91
  ds_read_b64_tr_b16 a[172:173], v17 offset:24584
  v_mfma_f32_16x16x32_bf16 v[28:31], v[188:191], a[192:195], v[28:31]
  v_cvt_pk_bf16_f32 v206, v92, v93
  ds_read_b64_tr_b16 a[174:175], v17 offset:25352
  v_mfma_f32_16x16x32_bf16 v[52:55], v[188:191], a[196:199], v[52:55]
  v_cvt_pk_bf16_f32 v207, v94, v95
  ds_read_b64_tr_b16 a[176:177], v17 offset:24592
  v_mfma_f32_4x4x4_16b_bf16 v[88:91], v[96:97], a[152:153], 0
  v_cvt_pk_bf16_f32 v208, v72, v73
  ds_read_b64_tr_b16 a[178:179], v17 offset:25360
  v_mfma_f32_4x4x4_16b_bf16 v[92:95], v[98:99], a[154:155], 0
  v_cvt_pk_bf16_f32 v209, v74, v75
  v_mfma_f32_16x16x32_bf16 v[32:35], v[192:195], a[192:195], v[32:35]
  v_cvt_pk_bf16_f32 v210, v76, v77
  ds_read_b64_tr_b16 a[180:181], v17 offset:24600
  v_mfma_f32_16x16x32_bf16 v[56:59], v[192:195], a[196:199], v[56:59]
  v_cvt_pk_bf16_f32 v211, v78, v79
  ds_read_b64_tr_b16 a[182:183], v17 offset:25368
  v_mfma_f32_4x4x4_16b_bf16 v[72:75], v[96:97], a[156:157], 0
  v_cvt_pk_bf16_f32 v212, v80, v81
  ds_read_b64_tr_b16 a[184:185], v17 offset:24608
  v_mfma_f32_4x4x4_16b_bf16 v[76:79], v[98:99], a[158:159], 0
  v_cvt_pk_bf16_f32 v213, v82, v83
  ds_read_b64_tr_b16 a[186:187], v17 offset:25376
  v_mfma_f32_16x16x32_bf16 v[36:39], v[196:199], a[192:195], v[36:39]
  v_cvt_pk_bf16_f32 v214, v84, v85
  v_mfma_f32_16x16x32_bf16 v[60:63], v[196:199], a[196:199], v[60:63]
  v_cvt_pk_bf16_f32 v215, v86, v87
  ds_read_b64_tr_b16 a[188:189], v17 offset:24616
  v_mfma_f32_4x4x4_16b_bf16 v[80:83], v[96:97], a[160:161], 0
  v_cvt_pk_bf16_f32 v216, v88, v89
  ds_read_b64_tr_b16 a[190:191], v17 offset:25384
  v_mfma_f32_4x4x4_16b_bf16 v[84:87], v[98:99], a[162:163], 0
  v_cvt_pk_bf16_f32 v217, v90, v91
  s_waitcnt lgkmcnt(14)
  v_mfma_f32_16x16x32_bf16 v[40:43], v[200:203], a[192:195], v[40:43]
  v_cvt_pk_bf16_f32 v218, v92, v93
  v_and_b32 v100, v19, v100
  v_mfma_f32_16x16x32_bf16 v[64:67], v[200:203], a[196:199], v[64:67]
  v_cvt_pk_bf16_f32 v219, v94, v95
  v_mfma_f32_4x4x4_16b_bf16 v[88:91], v[96:97], a[164:165], 0
  v_cvt_pk_bf16_f32 v220, v72, v73
  v_and_b32 v101, v20, v101
  v_mfma_f32_4x4x4_16b_bf16 v[92:95], v[98:99], a[166:167], 0
  v_cvt_pk_bf16_f32 v221, v74, v75
  v_and_b32 v102, v19, v102
  v_mfma_f32_16x16x32_bf16 v[44:47], v[204:207], a[192:195], v[44:47]
  v_cvt_pk_bf16_f32 v222, v76, v77
  v_and_b32 v103, v20, v103
  v_mfma_f32_16x16x32_bf16 v[68:71], v[204:207], a[196:199], v[68:71]
  v_cvt_pk_bf16_f32 v223, v78, v79
  s_waitcnt lgkmcnt(0)
  s_nop 0
  v_mfma_f32_4x4x4_16b_bf16 v[72:75], v[100:101], a[168:169], 0
  v_cvt_pk_bf16_f32 v224, v80, v81
  v_mfma_f32_4x4x4_16b_bf16 v[76:79], v[102:103], a[170:171], 0
  v_cvt_pk_bf16_f32 v225, v82, v83
  v_mfma_f32_16x16x32_bf16 v[24:27], v[208:211], a[200:203], v[24:27]
  v_cvt_pk_bf16_f32 v226, v84, v85
  v_mfma_f32_16x16x32_bf16 v[48:51], v[208:211], a[204:207], v[48:51]
  v_cvt_pk_bf16_f32 v227, v86, v87
  v_mfma_f32_4x4x4_16b_bf16 v[80:83], v[100:101], a[172:173], 0
  v_cvt_pk_bf16_f32 v228, v88, v89
  v_mfma_f32_4x4x4_16b_bf16 v[84:87], v[102:103], a[174:175], 0
  v_cvt_pk_bf16_f32 v229, v90, v91
  v_mfma_f32_16x16x32_bf16 v[28:31], v[212:215], a[200:203], v[28:31]
  v_cvt_pk_bf16_f32 v230, v92, v93
  v_mfma_f32_16x16x32_bf16 v[52:55], v[212:215], a[204:207], v[52:55]
  v_cvt_pk_bf16_f32 v231, v94, v95
  v_mfma_f32_4x4x4_16b_bf16 v[88:91], v[100:101], a[176:177], 0
  v_cvt_pk_bf16_f32 v232, v72, v73
  v_mfma_f32_4x4x4_16b_bf16 v[92:95], v[102:103], a[178:179], 0
  v_cvt_pk_bf16_f32 v233, v74, v75
  v_mfma_f32_16x16x32_bf16 v[32:35], v[216:219], a[200:203], v[32:35]
  v_cvt_pk_bf16_f32 v234, v76, v77
  v_mfma_f32_16x16x32_bf16 v[56:59], v[216:219], a[204:207], v[56:59]
  v_cvt_pk_bf16_f32 v235, v78, v79
  v_mfma_f32_4x4x4_16b_bf16 v[72:75], v[100:101], a[180:181], 0
  v_cvt_pk_bf16_f32 v236, v80, v81
  v_mfma_f32_4x4x4_16b_bf16 v[76:79], v[102:103], a[182:183], 0
  v_cvt_pk_bf16_f32 v237, v82, v83
  v_mfma_f32_16x16x32_bf16 v[36:39], v[220:223], a[200:203], v[36:39]
  v_cvt_pk_bf16_f32 v238, v84, v85
  v_mfma_f32_16x16x32_bf16 v[60:63], v[220:223], a[204:207], v[60:63]
  v_cvt_pk_bf16_f32 v239, v86, v87
  v_mfma_f32_4x4x4_16b_bf16 v[80:83], v[100:101], a[184:185], 0
  v_cvt_pk_bf16_f32 v240, v88, v89
  v_mfma_f32_4x4x4_16b_bf16 v[84:87], v[102:103], a[186:187], 0
  v_cvt_pk_bf16_f32 v241, v90, v91
  v_mfma_f32_16x16x32_bf16 v[40:43], v[224:227], a[200:203], v[40:43]
  v_cvt_pk_bf16_f32 v242, v92, v93
  v_mfma_f32_16x16x32_bf16 v[64:67], v[224:227], a[204:207], v[64:67]
  v_cvt_pk_bf16_f32 v243, v94, v95
  v_mfma_f32_4x4x4_16b_bf16 v[88:91], v[100:101], a[188:189], 0
  v_cvt_pk_bf16_f32 v244, v72, v73
  v_mfma_f32_4x4x4_16b_bf16 v[92:95], v[102:103], a[190:191], 0
  v_cvt_pk_bf16_f32 v245, v74, v75
  v_mfma_f32_16x16x32_bf16 v[44:47], v[228:231], a[200:203], v[44:47]
  v_cvt_pk_bf16_f32 v246, v76, v77
  v_mfma_f32_16x16x32_bf16 v[68:71], v[228:231], a[204:207], v[68:71]
  v_cvt_pk_bf16_f32 v247, v78, v79
  s_nop 0
  v_mfma_f32_16x16x32_bf16 v[24:27], v[232:235], a[208:211], v[24:27]
  v_cvt_pk_bf16_f32 v248, v80, v81
  v_cvt_pk_bf16_f32 v249, v82, v83
  v_mfma_f32_16x16x32_bf16 v[48:51], v[232:235], a[212:215], v[48:51]
  v_cvt_pk_bf16_f32 v250, v84, v85
  v_cvt_pk_bf16_f32 v251, v86, v87
  v_mfma_f32_16x16x32_bf16 v[28:31], v[236:239], a[208:211], v[28:31]
  v_cvt_pk_bf16_f32 v252, v88, v89
  v_cvt_pk_bf16_f32 v253, v90, v91
  v_mfma_f32_16x16x32_bf16 v[52:55], v[236:239], a[212:215], v[52:55]
  v_cvt_pk_bf16_f32 v254, v92, v93
  v_cvt_pk_bf16_f32 v255, v94, v95
  v_mfma_f32_16x16x32_bf16 v[32:35], v[240:243], a[208:211], v[32:35]
  v_mfma_f32_16x16x32_bf16 v[56:59], v[240:243], a[212:215], v[56:59]
  v_mfma_f32_16x16x32_bf16 v[36:39], v[244:247], a[208:211], v[36:39]
  v_mfma_f32_16x16x32_bf16 v[60:63], v[244:247], a[212:215], v[60:63]
  v_mfma_f32_16x16x32_bf16 v[40:43], v[248:251], a[208:211], v[40:43]
  v_mfma_f32_16x16x32_bf16 v[64:67], v[248:251], a[212:215], v[64:67]
  v_mfma_f32_16x16x32_bf16 v[44:47], v[252:255], a[208:211], v[44:47]
  v_mfma_f32_16x16x32_bf16 v[68:71], v[252:255], a[212:215], v[68:71]
  s_barrier
  s_mov_b64 vcc, -1
  s_nop 4
  v_cvt_pk_bf16_f32 v24, v24, v25
  v_cvt_pk_bf16_f32 v25, v26, v27
  v_cvt_pk_bf16_f32 v26, v28, v29
  v_cvt_pk_bf16_f32 v27, v30, v31
  ds_write_b128 v11, v[24:27] offset:0
  v_cvt_pk_bf16_f32 v28, v32, v33
  v_cvt_pk_bf16_f32 v29, v34, v35
  v_cvt_pk_bf16_f32 v30, v36, v37
  v_cvt_pk_bf16_f32 v31, v38, v39
  ds_write_b128 v12, v[28:31] offset:0
  v_cvt_pk_bf16_f32 v32, v40, v41
  v_cvt_pk_bf16_f32 v33, v42, v43
  v_cvt_pk_bf16_f32 v34, v44, v45
  v_cvt_pk_bf16_f32 v35, v46, v47
  ds_write_b128 v13, v[32:35] offset:0
  s_waitcnt lgkmcnt(0)
  s_barrier
  ds_read_b128 a[192:195], v7 offset:24576
  ds_read_b128 a[196:199], v8 offset:24576
  ds_read_b128 a[216:219], v1 offset:0
  ds_read_b128 a[220:223], v2 offset:0
  ds_read_b128 a[224:227], v3 offset:0
  ds_read_b128 a[200:203], v9 offset:24576
  ds_read_b128 a[204:207], v10 offset:24576
  ds_read_b128 a[228:231], v1 offset:12288
  ds_read_b128 a[232:235], v2 offset:12288
  ds_read_b128 a[236:239], v3 offset:12288
  s_xor_b32 s42, s42, 0x14000
  s_add_u32 m0, s42, 0
  s_nop 0
  buffer_load_dwordx4 v1, s[4:7], s21 offen nt lds
  s_waitcnt lgkmcnt(8)
.p2align 6
L_loop0:
  v_mfma_f32_16x16x32_bf16 v[24:27], a[0:3], a[192:195], 0
  ds_read_b128 a[208:211], v7 offset:24832
  v_mfma_f32_16x16x32_bf16 v[24:27], a[24:27], a[196:199], v[24:27]
  ds_read_b128 a[212:215], v8 offset:24832
  v_mfma_f32_16x16x32_bf16 v[28:31], a[4:7], a[192:195], 0
  v_mfma_f32_16x16x32_bf16 v[28:31], a[28:31], a[196:199], v[28:31]
  v_mfma_f32_16x16x32_bf16 v[32:35], a[8:11], a[192:195], 0
  v_mfma_f32_16x16x32_bf16 v[32:35], a[32:35], a[196:199], v[32:35]
  v_mfma_f32_16x16x32_bf16 v[36:39], a[12:15], a[192:195], 0
  v_mfma_f32_16x16x32_bf16 v[36:39], a[36:39], a[196:199], v[36:39]
  v_mfma_f32_16x16x32_bf16 v[40:43], a[16:19], a[192:195], 0
  s_waitcnt lgkmcnt(9)
  buffer_store_dwordx4 a[216:219], v4, s[8:11], s22 offen sc1
  v_mfma_f32_16x16x32_bf16 v[40:43], a[40:43], a[196:199], v[40:43]
  s_waitcnt lgkmcnt(8)
  buffer_store_dwordx4 a[220:223], v5, s[8:11], s22 offen sc1
  s_waitcnt lgkmcnt(7)
  buffer_store_dwordx4 a[224:227], v6, s[8:11], s22 offen sc1
  v_mfma_f32_16x16x32_bf16 v[44:47], a[20:23], a[192:195], 0
  v_mfma_f32_16x16x32_bf16 v[44:47], a[44:47], a[196:199], v[44:47]
  s_waitcnt lgkmcnt(5)
  v_mfma_f32_16x16x32_bf16 v[24:27], a[48:51], a[200:203], v[24:27]
  ds_read_b128 a[192:195], v9 offset:24832
  v_mfma_f32_16x16x32_bf16 v[24:27], a[72:75], a[204:207], v[24:27]
  ds_read_b128 a[196:199], v10 offset:24832
  v_mfma_f32_16x16x32_bf16 v[28:31], a[52:55], a[200:203], v[28:31]
  v_cvt_pk_bf16_f32 v48, v48, v49
  v_mfma_f32_16x16x32_bf16 v[28:31], a[76:79], a[204:207], v[28:31]
  v_cvt_pk_bf16_f32 v49, v50, v51
  v_mfma_f32_16x16x32_bf16 v[32:35], a[56:59], a[200:203], v[32:35]
  v_cvt_pk_bf16_f32 v50, v52, v53
  v_mfma_f32_16x16x32_bf16 v[32:35], a[80:83], a[204:207], v[32:35]
  v_cvt_pk_bf16_f32 v51, v54, v55
  v_mfma_f32_16x16x32_bf16 v[36:39], a[60:63], a[200:203], v[36:39]
  v_mfma_f32_16x16x32_bf16 v[36:39], a[84:87], a[204:207], v[36:39]
  s_add_u32 m0, s42, 4096
  v_mfma_f32_16x16x32_bf16 v[40:43], a[64:67], a[200:203], v[40:43]
  s_cbranch_vccz L_sk1
  buffer_load_dwordx4 v2, s[4:7], s21 offen nt lds
L_sk1:
  v_mfma_f32_16x16x32_bf16 v[40:43], a[88:91], a[204:207], v[40:43]
  v_mfma_f32_16x16x32_bf16 v[44:47], a[68:71], a[200:203], v[44:47]
  ds_write_b128 v11, v[48:51] offset:36864
  v_mfma_f32_16x16x32_bf16 v[44:47], a[92:95], a[204:207], v[44:47]
  s_waitcnt lgkmcnt(3)
  v_mfma_f32_16x16x32_bf16 v[24:27], a[96:99], a[208:211], v[24:27]
  ds_read_b128 a[200:203], v7 offset:25088
  v_mfma_f32_16x16x32_bf16 v[24:27], a[120:123], a[212:215], v[24:27]
  ds_read_b128 a[204:207], v8 offset:25088
  v_mfma_f32_16x16x32_bf16 v[28:31], a[100:103], a[208:211], v[28:31]
  v_cvt_pk_bf16_f32 v52, v56, v57
  v_mfma_f32_16x16x32_bf16 v[28:31], a[124:127], a[212:215], v[28:31]
  v_cvt_pk_bf16_f32 v53, v58, v59
  v_mfma_f32_16x16x32_bf16 v[32:35], a[104:107], a[208:211], v[32:35]
  v_cvt_pk_bf16_f32 v54, v60, v61
  v_mfma_f32_16x16x32_bf16 v[32:35], a[128:131], a[212:215], v[32:35]
  v_cvt_pk_bf16_f32 v55, v62, v63
  v_mfma_f32_16x16x32_bf16 v[36:39], a[108:111], a[208:211], v[36:39]
  ds_write_b128 v12, v[52:55] offset:36864
  v_mfma_f32_16x16x32_bf16 v[36:39], a[132:135], a[212:215], v[36:39]
  v_mfma_f32_16x16x32_bf16 v[40:43], a[112:115], a[208:211], v[40:43]
  v_mfma_f32_16x16x32_bf16 v[40:43], a[136:139], a[212:215], v[40:43]
  v_mfma_f32_16x16x32_bf16 v[44:47], a[116:119], a[208:211], v[44:47]
  v_mfma_f32_16x16x32_bf16 v[44:47], a[140:143], a[212:215], v[44:47]
  s_waitcnt lgkmcnt(4)
  v_mfma_f32_16x16x32_bf16 v[24:27], v[112:115], a[192:195], v[24:27]
  ds_read_b128 a[208:211], v9 offset:25088
  v_mfma_f32_16x16x32_bf16 v[24:27], v[136:139], a[196:199], v[24:27]
  ds_read_b128 a[212:215], v10 offset:25088
  v_mfma_f32_16x16x32_bf16 v[28:31], v[116:119], a[192:195], v[28:31]
  v_cvt_pk_bf16_f32 v56, v64, v65
  v_mfma_f32_16x16x32_bf16 v[28:31], v[140:143], a[196:199], v[28:31]
  v_cvt_pk_bf16_f32 v57, v66, v67
  v_mfma_f32_16x16x32_bf16 v[32:35], v[120:123], a[192:195], v[32:35]
  v_cvt_pk_bf16_f32 v58, v68, v69
  v_mfma_f32_16x16x32_bf16 v[32:35], v[144:147], a[196:199], v[32:35]
  v_cvt_pk_bf16_f32 v59, v70, v71
  v_mfma_f32_16x16x32_bf16 v[36:39], v[124:127], a[192:195], v[36:39]
  v_mfma_f32_16x16x32_bf16 v[36:39], v[148:151], a[196:199], v[36:39]
  s_add_u32 m0, s42, 8192
  v_mfma_f32_16x16x32_bf16 v[40:43], v[128:131], a[192:195], v[40:43]
  s_cbranch_vccz L_sk2
  buffer_load_dwordx4 v3, s[4:7], s21 offen nt lds
L_sk2:
  v_mfma_f32_16x16x32_bf16 v[40:43], v[152:155], a[196:199], v[40:43]
  v_mfma_f32_16x16x32_bf16 v[44:47], v[132:135], a[192:195], v[44:47]
  ds_write_b128 v13, v[56:59] offset:36864
  v_mfma_f32_16x16x32_bf16 v[44:47], v[156:159], a[196:199], v[44:47]
  s_waitcnt lgkmcnt(4)
  v_mfma_f32_16x16x32_bf16 v[24:27], v[160:163], a[200:203], v[24:27]
  ds_read_b128 a[192:195], v7 offset:36864
  v_mfma_f32_16x16x32_bf16 v[24:27], v[184:187], a[204:207], v[24:27]
  ds_read_b128 a[196:199], v8 offset:36864
  v_mfma_f32_16x16x32_bf16 v[28:31], v[164:167], a[200:203], v[28:31]
  v_mfma_f32_16x16x32_bf16 v[28:31], v[188:191], a[204:207], v[28:31]
  s_add_u32 s62, s62, s44
  s_sub_u32 s61, s61, 1
  v_mfma_f32_16x16x32_bf16 v[32:35], v[168:171], a[200:203], v[32:35]
  s_cmp_eq_u32 s61, 0
  s_cselect_b32 s55, s66, s55
  s_cselect_b32 s65, 128, s65
  v_mfma_f32_16x16x32_bf16 v[32:35], v[192:195], a[204:207], v[32:35]
  v_mfma_f32_16x16x32_bf16 v[36:39], v[172:175], a[200:203], v[36:39]
  v_mfma_f32_16x16x32_bf16 v[36:39], v[196:199], a[204:207], v[36:39]
  v_mfma_f32_16x16x32_bf16 v[40:43], v[176:179], a[200:203], v[40:43]
  v_mfma_f32_16x16x32_bf16 v[40:43], v[200:203], a[204:207], v[40:43]
  v_mfma_f32_16x16x32_bf16 v[44:47], v[180:183], a[200:203], v[44:47]
  v_mfma_f32_16x16x32_bf16 v[44:47], v[204:207], a[204:207], v[44:47]
  s_waitcnt lgkmcnt(3)
  v_mfma_f32_16x16x32_bf16 v[24:27], v[208:211], a[208:211], v[24:27]
  ds_read_b128 a[200:203], v9 offset:36864
  v_mfma_f32_16x16x32_bf16 v[24:27], v[232:235], a[212:215], v[24:27]
  ds_read_b128 a[204:207], v10 offset:36864
  v_mfma_f32_16x16x32_bf16 v[28:31], v[212:215], a[208:211], v[28:31]
  v_mfma_f32_16x16x32_bf16 v[28:31], v[236:239], a[212:215], v[28:31]
  v_mfma_f32_16x16x32_bf16 v[32:35], v[216:219], a[208:211], v[32:35]
  v_mfma_f32_16x16x32_bf16 v[32:35], v[240:243], a[212:215], v[32:35]
  v_mfma_f32_16x16x32_bf16 v[36:39], v[220:223], a[208:211], v[36:39]
  v_mfma_f32_16x16x32_bf16 v[36:39], v[244:247], a[212:215], v[36:39]
  s_add_u32 m0, s42, 12288
  v_mfma_f32_16x16x32_bf16 v[40:43], v[224:227], a[208:211], v[40:43]
  s_cbranch_vccz L_sk3
  buffer_load_dwordx4 v1, s[4:7], s37 offen nt lds
L_sk3:
  v_mfma_f32_16x16x32_bf16 v[40:43], v[248:251], a[212:215], v[40:43]
  v_mfma_f32_16x16x32_bf16 v[44:47], v[228:231], a[208:211], v[44:47]
  v_mfma_f32_16x16x32_bf16 v[44:47], v[252:255], a[212:215], v[44:47]
  s_waitcnt lgkmcnt(2)
  v_mfma_f32_16x16x32_bf16 v[48:51], a[0:3], a[192:195], 0
  ds_read_b128 a[208:211], v7 offset:37120
  v_mfma_f32_16x16x32_bf16 v[48:51], a[24:27], a[196:199], v[48:51]
  ds_read_b128 a[212:215], v8 offset:37120
  v_mfma_f32_16x16x32_bf16 v[52:55], a[4:7], a[192:195], 0
  v_cvt_pk_bf16_f32 v24, v24, v25
  v_mfma_f32_16x16x32_bf16 v[52:55], a[28:31], a[196:199], v[52:55]
  v_cvt_pk_bf16_f32 v25, v26, v27
  v_mfma_f32_16x16x32_bf16 v[56:59], a[8:11], a[192:195], 0
  v_cvt_pk_bf16_f32 v26, v28, v29
  v_mfma_f32_16x16x32_bf16 v[56:59], a[32:35], a[196:199], v[56:59]
  v_cvt_pk_bf16_f32 v27, v30, v31
  v_mfma_f32_16x16x32_bf16 v[60:63], a[12:15], a[192:195], 0
  ds_write_b128 v11, v[24:27] offset:24576
  v_mfma_f32_16x16x32_bf16 v[60:63], a[36:39], a[196:199], v[60:63]
  v_mfma_f32_16x16x32_bf16 v[64:67], a[16:19], a[192:195], 0
  buffer_store_dwordx4 a[228:231], v4, s[8:11], s23 offen sc1
  v_mfma_f32_16x16x32_bf16 v[64:67], a[40:43], a[196:199], v[64:67]
  buffer_store_dwordx4 a[232:235], v5, s[8:11], s23 offen sc1
  buffer_store_dwordx4 a[236:239], v6, s[8:11], s23 offen sc1
  v_mfma_f32_16x16x32_bf16 v[68:71], a[20:23], a[192:195], 0
  v_mfma_f32_16x16x32_bf16 v[68:71], a[44:47], a[196:199], v[68:71]
  s_waitcnt lgkmcnt(3)
  v_mfma_f32_16x16x32_bf16 v[48:51], a[48:51], a[200:203], v[48:51]
  ds_read_b128 a[192:195], v9 offset:37120
  v_mfma_f32_16x16x32_bf16 v[48:51], a[72:75], a[204:207], v[48:51]
  ds_read_b128 a[196:199], v10 offset:37120
  v_mfma_f32_16x16x32_bf16 v[52:55], a[52:55], a[200:203], v[52:55]
  v_cvt_pk_bf16_f32 v28, v32, v33
  v_mfma_f32_16x16x32_bf16 v[52:55], a[76:79], a[204:207], v[52:55]
  v_cvt_pk_bf16_f32 v29, v34, v35
  v_mfma_f32_16x16x32_bf16 v[56:59], a[56:59], a[200:203], v[56:59]
  v_cvt_pk_bf16_f32 v30, v36, v37
  v_mfma_f32_16x16x32_bf16 v[56:59], a[80:83], a[204:207], v[56:59]
  v_cvt_pk_bf16_f32 v31, v38, v39
  v_mfma_f32_16x16x32_bf16 v[60:63], a[60:63], a[200:203], v[60:63]
  v_mfma_f32_16x16x32_bf16 v[60:63], a[84:87], a[204:207], v[60:63]
  s_add_u32 m0, s42, 16384
  v_mfma_f32_16x16x32_bf16 v[64:67], a[64:67], a[200:203], v[64:67]
  s_cbranch_vccz L_sk4
  buffer_load_dwordx4 v2, s[4:7], s37 offen nt lds
L_sk4:
  v_mfma_f32_16x16x32_bf16 v[64:67], a[88:91], a[204:207], v[64:67]
  v_mfma_f32_16x16x32_bf16 v[68:71], a[68:71], a[200:203], v[68:71]
  ds_write_b128 v12, v[28:31] offset:24576
  v_mfma_f32_16x16x32_bf16 v[68:71], a[92:95], a[204:207], v[68:71]
  s_waitcnt lgkmcnt(4)
  v_mfma_f32_16x16x32_bf16 v[48:51], a[96:99], a[208:211], v[48:51]
  ds_read_b128 a[200:203], v7 offset:37376
  v_mfma_f32_16x16x32_bf16 v[48:51], a[120:123], a[212:215], v[48:51]
  ds_read_b128 a[204:207], v8 offset:37376
  v_mfma_f32_16x16x32_bf16 v[52:55], a[100:103], a[208:211], v[52:55]
  v_cvt_pk_bf16_f32 v32, v40, v41
  v_mfma_f32_16x16x32_bf16 v[52:55], a[124:127], a[212:215], v[52:55]
  v_cvt_pk_bf16_f32 v33, v42, v43
  v_mfma_f32_16x16x32_bf16 v[56:59], a[104:107], a[208:211], v[56:59]
  v_cvt_pk_bf16_f32 v34, v44, v45
  v_mfma_f32_16x16x32_bf16 v[56:59], a[128:131], a[212:215], v[56:59]
  v_cvt_pk_bf16_f32 v35, v46, v47
  v_mfma_f32_16x16x32_bf16 v[60:63], a[108:111], a[208:211], v[60:63]
  ds_write_b128 v13, v[32:35] offset:24576
  v_mfma_f32_16x16x32_bf16 v[60:63], a[132:135], a[212:215], v[60:63]
  v_mfma_f32_16x16x32_bf16 v[64:67], a[112:115], a[208:211], v[64:67]
  v_mfma_f32_16x16x32_bf16 v[64:67], a[136:139], a[212:215], v[64:67]
  v_mfma_f32_16x16x32_bf16 v[68:71], a[116:119], a[208:211], v[68:71]
  v_mfma_f32_16x16x32_bf16 v[68:71], a[140:143], a[212:215], v[68:71]
  s_waitcnt lgkmcnt(0)
  v_mfma_f32_16x16x32_bf16 v[48:51], v[112:115], a[192:195], v[48:51]
  ds_read_b128 a[208:211], v9 offset:37376
  v_mfma_f32_16x16x32_bf16 v[48:51], v[136:139], a[196:199], v[48:51]
  ds_read_b128 a[212:215], v10 offset:37376
  v_mfma_f32_16x16x32_bf16 v[52:55], v[116:119], a[192:195], v[52:55]
  s_mul_i32 s56, s54, 98304
  s_add_u32 s56, s56, s57
  v_mfma_f32_16x16x32_bf16 v[52:55], v[140:143], a[196:199], v[52:55]
  v_xor_b32 v7, 0x14000, v7
  s_cmp_lt_u32 s54, 128
  s_cselect_b32 s56, s56, s6
  v_mfma_f32_16x16x32_bf16 v[56:59], v[120:123], a[192:195], v[56:59]
  v_xor_b32 v8, 0x14000, v8
  s_cmp_ge_i32 s61, 0
  s_cselect_b32 s56, s62, s56
  v_mfma_f32_16x16x32_bf16 v[56:59], v[144:147], a[196:199], v[56:59]
  v_xor_b32 v9, 0x14000, v9
  v_mov_b32 v23, s56
  v_mfma_f32_16x16x32_bf16 v[60:63], v[124:127], a[192:195], v[60:63]
  v_xor_b32 v10, 0x14000, v10
  ds_write_b32 v106, v23 offset:4
  v_mfma_f32_16x16x32_bf16 v[60:63], v[148:151], a[196:199], v[60:63]
  s_add_u32 m0, s42, 20480
  v_mfma_f32_16x16x32_bf16 v[64:67], v[128:131], a[192:195], v[64:67]
  s_cbranch_vccz L_sk5
  buffer_load_dwordx4 v3, s[4:7], s37 offen nt lds
L_sk5:
  v_mfma_f32_16x16x32_bf16 v[64:67], v[152:155], a[196:199], v[64:67]
  s_add_u32 s23, s22, 12288
  s_mov_b32 s22, s58
  v_mfma_f32_16x16x32_bf16 v[68:71], v[132:135], a[192:195], v[68:71]
  s_mov_b32 s58, s59
  s_mov_b32 s59, s60
  v_mfma_f32_16x16x32_bf16 v[68:71], v[156:159], a[196:199], v[68:71]
  s_waitcnt vmcnt(18) lgkmcnt(0)
  s_cbranch_vccz L_ow6
L_ob6:
  s_barrier
  v_mfma_f32_16x16x32_bf16 v[48:51], v[160:163], a[200:203], v[48:51]
  ds_read_b128 a[192:195], v7 offset:0
  v_mfma_f32_16x16x32_bf16 v[48:51], v[184:187], a[204:207], v[48:51]
  ds_read_b128 a[196:199], v8 offset:0
  v_mfma_f32_16x16x32_bf16 v[52:55], v[164:167], a[200:203], v[52:55]
  ds_read_b128 a[216:219], v1 offset:24576
  v_mfma_f32_16x16x32_bf16 v[52:55], v[188:191], a[204:207], v[52:55]
  ds_read_b32 v107, v105 offset:4
  v_mfma_f32_16x16x32_bf16 v[56:59], v[168:171], a[200:203], v[56:59]
  ds_read_b128 a[220:223], v2 offset:24576
  v_mfma_f32_16x16x32_bf16 v[56:59], v[192:195], a[204:207], v[56:59]
  ds_read_b128 a[224:227], v3 offset:24576
  v_mfma_f32_16x16x32_bf16 v[60:63], v[172:175], a[200:203], v[60:63]
  s_mov_b32 s60, s21
  v_mfma_f32_16x16x32_bf16 v[60:63], v[196:199], a[204:207], v[60:63]
  s_cmp_lt_u32 s54, s55
  s_cselect_b32 s54, 1, s65
  s_cbranch_scc0 L_cl7
  s_atomic_add s54, s[52:53], 0 glc
L_cl7:
  v_mfma_f32_16x16x32_bf16 v[64:67], v[176:179], a[200:203], v[64:67]
  v_mfma_f32_16x16x32_bf16 v[64:67], v[200:203], a[204:207], v[64:67]
  s_waitcnt lgkmcnt(2)
  v_readfirstlane_b32 s21, v107
  v_mfma_f32_16x16x32_bf16 v[68:71], v[180:183], a[200:203], v[68:71]
  v_mfma_f32_16x16x32_bf16 v[68:71], v[204:207], a[204:207], v[68:71]
  v_mfma_f32_16x16x32_bf16 v[48:51], v[208:211], a[208:211], v[48:51]
  ds_read_b128 a[200:203], v9 offset:0
  s_cmp_lt_u32 s21, s6
  s_cselect_b64 vcc, -1, 0
  v_mfma_f32_16x16x32_bf16 v[48:51], v[232:235], a[212:215], v[48:51]
  ds_read_b128 a[204:207], v10 offset:0
  s_cselect_b32 s32, 5, s32
  s_add_u32 s37, s21, 12288
  v_mfma_f32_16x16x32_bf16 v[52:55], v[212:215], a[208:211], v[52:55]
  ds_read_b128 a[228:231], v1 offset:36864
  v_mfma_f32_16x16x32_bf16 v[52:55], v[236:239], a[212:215], v[52:55]
  ds_read_b128 a[232:235], v2 offset:36864
  v_mfma_f32_16x16x32_bf16 v[56:59], v[216:219], a[208:211], v[56:59]
  ds_read_b128 a[236:239], v3 offset:36864
  v_mfma_f32_16x16x32_bf16 v[56:59], v[240:243], a[212:215], v[56:59]
  v_mfma_f32_16x16x32_bf16 v[60:63], v[220:223], a[208:211], v[60:63]
  v_mfma_f32_16x16x32_bf16 v[60:63], v[244:247], a[212:215], v[60:63]
  s_add_u32 m0, s42, 24576
  v_mfma_f32_16x16x32_bf16 v[64:67], v[224:227], a[208:211], v[64:67]
  s_cbranch_vccz L_sk8
  buffer_load_dwordx4 v1, s[4:7], s21 offen nt lds
L_sk8:
  v_mfma_f32_16x16x32_bf16 v[64:67], v[248:251], a[212:215], v[64:67]
  v_mfma_f32_16x16x32_bf16 v[68:71], v[228:231], a[208:211], v[68:71]
  s_sub_u32 s32, s32, 1
  s_cmp_eq_u32 s32, 0
  v_mfma_f32_16x16x32_bf16 v[68:71], v[252:255], a[212:215], v[68:71]
  s_cbranch_scc1 L_tail0
L_mid0:
  v_mfma_f32_16x16x32_bf16 v[24:27], a[0:3], a[192:195], 0
  ds_read_b128 a[208:211], v7 offset:256
  v_mfma_f32_16x16x32_bf16 v[24:27], a[24:27], a[196:199], v[24:27]
  ds_read_b128 a[212:215], v8 offset:256
  v_mfma_f32_16x16x32_bf16 v[28:31], a[4:7], a[192:195], 0
  v_mfma_f32_16x16x32_bf16 v[28:31], a[28:31], a[196:199], v[28:31]
  v_mfma_f32_16x16x32_bf16 v[32:35], a[8:11], a[192:195], 0
  v_mfma_f32_16x16x32_bf16 v[32:35], a[32:35], a[196:199], v[32:35]
  v_mfma_f32_16x16x32_bf16 v[36:39], a[12:15], a[192:195], 0
  v_mfma_f32_16x16x32_bf16 v[36:39], a[36:39], a[196:199], v[36:39]
  v_mfma_f32_16x16x32_bf16 v[40:43], a[16:19], a[192:195], 0
  buffer_store_dwordx4 a[216:219], v4, s[8:11], s22 offen sc1
  v_mfma_f32_16x16x32_bf16 v[40:43], a[40:43], a[196:199], v[40:43]
  s_waitcnt lgkmcnt(8)
  buffer_store_dwordx4 a[220:223], v5, s[8:11], s22 offen sc1
  s_waitcnt lgkmcnt(7)
  buffer_store_dwordx4 a[224:227], v6, s[8:11], s22 offen sc1
  v_mfma_f32_16x16x32_bf16 v[44:47], a[20:23], a[192:195], 0
  v_mfma_f32_16x16x32_bf16 v[44:47], a[44:47], a[196:199], v[44:47]
  s_waitcnt lgkmcnt(5)
  v_mfma_f32_16x16x32_bf16 v[24:27], a[48:51], a[200:203], v[24:27]
  ds_read_b128 a[192:195], v9 offset:256
  v_mfma_f32_16x16x32_bf16 v[24:27], a[72:75], a[204:207], v[24:27]
  ds_read_b128 a[196:199], v10 offset:256
  v_mfma_f32_16x16x32_bf16 v[28:31], a[52:55], a[200:203], v[28:31]
  v_cvt_pk_bf16_f32 v48, v48, v49
  v_mfma_f32_16x16x32_bf16 v[28:31], a[76:79], a[204:207], v[28:31]
  v_cvt_pk_bf16_f32 v49, v50, v51
  v_mfma_f32_16x16x32_bf16 v[32:35], a[56:59], a[200:203], v[32:35]
  v_cvt_pk_bf16_f32 v50, v52, v53
  v_mfma_f32_16x16x32_bf16 v[32:35], a[80:83], a[204:207], v[32:35]
  v_cvt_pk_bf16_f32 v51, v54, v55
  v_mfma_f32_16x16x32_bf16 v[36:39], a[60:63], a[200:203], v[36:39]
  v_mfma_f32_16x16x32_bf16 v[36:39], a[84:87], a[204:207], v[36:39]
  s_add_u32 m0, s42, 28672
  v_mfma_f32_16x16x32_bf16 v[40:43], a[64:67], a[200:203], v[40:43]
  s_cbranch_vccz L_sk9
  buffer_load_dwordx4 v2, s[4:7], s21 offen nt lds
L_sk9:
  v_mfma_f32_16x16x32_bf16 v[40:43], a[88:91], a[204:207], v[40:43]
  v_mfma_f32_16x16x32_bf16 v[44:47], a[68:71], a[200:203], v[44:47]
  ds_write_b128 v11, v[48:51] offset:12288
  v_mfma_f32_16x16x32_bf16 v[44:47], a[92:95], a[204:207], v[44:47]
  s_waitcnt lgkmcnt(3)
  v_mfma_f32_16x16x32_bf16 v[24:27], a[96:99], a[208:211], v[24:27]
  ds_read_b128 a[200:203], v7 offset:512
  v_mfma_f32_16x16x32_bf16 v[24:27], a[120:123], a[212:215], v[24:27]
  ds_read_b128 a[204:207], v8 offset:512
  v_mfma_f32_16x16x32_bf16 v[28:31], a[100:103], a[208:211], v[28:31]
  v_cvt_pk_bf16_f32 v52, v56, v57
  v_mfma_f32_16x16x32_bf16 v[28:31], a[124:127], a[212:215], v[28:31]
  v_cvt_pk_bf16_f32 v53, v58, v59
  v_mfma_f32_16x16x32_bf16 v[32:35], a[104:107], a[208:211], v[32:35]
  v_cvt_pk_bf16_f32 v54, v60, v61
  v_mfma_f32_16x16x32_bf16 v[32:35], a[128:131], a[212:215], v[32:35]
  v_cvt_pk_bf16_f32 v55, v62, v63
  v_mfma_f32_16x16x32_bf16 v[36:39], a[108:111], a[208:211], v[36:39]
  ds_write_b128 v12, v[52:55] offset:12288
  v_mfma_f32_16x16x32_bf16 v[36:39], a[132:135], a[212:215], v[36:39]
  v_mfma_f32_16x16x32_bf16 v[40:43], a[112:115], a[208:211], v[40:43]
  v_mfma_f32_16x16x32_bf16 v[40:43], a[136:139], a[212:215], v[40:43]
  v_mfma_f32_16x16x32_bf16 v[44:47], a[116:119], a[208:211], v[44:47]
  v_mfma_f32_16x16x32_bf16 v[44:47], a[140:143], a[212:215], v[44:47]
  s_waitcnt lgkmcnt(4)
  v_mfma_f32_16x16x32_bf16 v[24:27], v[112:115], a[192:195], v[24:27]
  ds_read_b128 a[208:211], v9 offset:512
  v_mfma_f32_16x16x32_bf16 v[24:27], v[136:139], a[196:199], v[24:27]
  ds_read_b128 a[212:215], v10 offset:512
  v_mfma_f32_16x16x32_bf16 v[28:31], v[116:119], a[192:195], v[28:31]
  v_cvt_pk_bf16_f32 v56, v64, v65
  v_mfma_f32_16x16x32_bf16 v[28:31], v[140:143], a[196:199], v[28:31]
  v_cvt_pk_bf16_f32 v57, v66, v67
  v_mfma_f32_16x16x32_bf16 v[32:35], v[120:123], a[192:195], v[32:35]
  v_cvt_pk_bf16_f32 v58, v68, v69
  v_mfma_f32_16x16x32_bf16 v[32:35], v[144:147], a[196:199], v[32:35]
  v_cvt_pk_bf16_f32 v59, v70, v71
  v_mfma_f32_16x16x32_bf16 v[36:39], v[124:127], a[192:195], v[36:39]
  v_mfma_f32_16x16x32_bf16 v[36:39], v[148:151], a[196:199], v[36:39]
  s_add_u32 m0, s42, 32768
  v_mfma_f32_16x16x32_bf16 v[40:43], v[128:131], a[192:195], v[40:43]
  s_cbranch_vccz L_sk10
  buffer_load_dwordx4 v3, s[4:7], s21 offen nt lds
L_sk10:
  v_mfma_f32_16x16x32_bf16 v[40:43], v[152:155], a[196:199], v[40:43]
  v_mfma_f32_16x16x32_bf16 v[44:47], v[132:135], a[192:195], v[44:47]
  ds_write_b128 v13, v[56:59] offset:12288
  v_mfma_f32_16x16x32_bf16 v[44:47], v[156:159], a[196:199], v[44:47]
  s_waitcnt lgkmcnt(4)
  v_mfma_f32_16x16x32_bf16 v[24:27], v[160:163], a[200:203], v[24:27]
  ds_read_b128 a[192:195], v7 offset:12288
  v_mfma_f32_16x16x32_bf16 v[24:27], v[184:187], a[204:207], v[24:27]
  ds_read_b128 a[196:199], v8 offset:12288
  v_mfma_f32_16x16x32_bf16 v[28:31], v[164:167], a[200:203], v[28:31]
  v_mfma_f32_16x16x32_bf16 v[28:31], v[188:191], a[204:207], v[28:31]
  s_add_u32 s62, s62, s44
  s_sub_u32 s61, s61, 1
  v_mfma_f32_16x16x32_bf16 v[32:35], v[168:171], a[200:203], v[32:35]
  s_cmp_eq_u32 s61, 0
  s_cselect_b32 s55, s66, s55
  s_cselect_b32 s65, 128, s65
  v_mfma_f32_16x16x32_bf16 v[32:35], v[192:195], a[204:207], v[32:35]
  v_mfma_f32_16x16x32_bf16 v[36:39], v[172:175], a[200:203], v[36:39]
  v_mfma_f32_16x16x32_bf16 v[36:39], v[196:199], a[204:207], v[36:39]
  v_mfma_f32_16x16x32_bf16 v[40:43], v[176:179], a[200:203], v[40:43]
  v_mfma_f32_16x16x32_bf16 v[40:43], v[200:203], a[204:207], v[40:43]
  v_mfma_f32_16x16x32_bf16 v[44:47], v[180:183], a[200:203], v[44:47]
  v_mfma_f32_16x16x32_bf16 v[44:47], v[204:207], a[204:207], v[44:47]
  s_waitcnt lgkmcnt(3)
  v_mfma_f32_16x16x32_bf16 v[24:27], v[208:211], a[208:211], v[24:27]
  ds_read_b128 a[200:203], v9 offset:12288
  v_mfma_f32_16x16x32_bf16 v[24:27], v[232:235], a[212:215], v[24:27]
  ds_read_b128 a[204:207], v10 offset:12288
  v_mfma_f32_16x16x32_bf16 v[28:31], v[212:215], a[208:211], v[28:31]
  v_mfma_f32_16x16x32_bf16 v[28:31], v[236:239], a[212:215], v[28:31]
  v_mfma_f32_16x16x32_bf16 v[32:35], v[216:219], a[208:211], v[32:35]
  v_mfma_f32_16x16x32_bf16 v[32:35], v[240:243], a[212:215], v[32:35]
  v_mfma_f32_16x16x32_bf16 v[36:39], v[220:223], a[208:211], v[36:39]
  v_mfma_f32_16x16x32_bf16 v[36:39], v[244:247], a[212:215], v[36:39]
  s_add_u32 m0, s42, 36864
  v_mfma_f32_16x16x32_bf16 v[40:43], v[224:227], a[208:211], v[40:43]
  s_cbranch_vccz L_sk11
  buffer_load_dwordx4 v1, s[4:7], s37 offen nt lds
L_sk11:
  v_mfma_f32_16x16x32_bf16 v[40:43], v[248:251], a[212:215], v[40:43]
  v_mfma_f32_16x16x32_bf16 v[44:47], v[228:231], a[208:211], v[44:47]
  v_mfma_f32_16x16x32_bf16 v[44:47], v[252:255], a[212:215], v[44:47]
  s_waitcnt lgkmcnt(2)
  v_mfma_f32_16x16x32_bf16 v[48:51], a[0:3], a[192:195], 0
  ds_read_b128 a[208:211], v7 offset:12544
  v_mfma_f32_16x16x32_bf16 v[48:51], a[24:27], a[196:199], v[48:51]
  ds_read_b128 a[212:215], v8 offset:12544
  v_mfma_f32_16x16x32_bf16 v[52:55], a[4:7], a[192:195], 0
  v_cvt_pk_bf16_f32 v24, v24, v25
  v_mfma_f32_16x16x32_bf16 v[52:55], a[28:31], a[196:199], v[52:55]
  v_cvt_pk_bf16_f32 v25, v26, v27
  v_mfma_f32_16x16x32_bf16 v[56:59], a[8:11], a[192:195], 0
  v_cvt_pk_bf16_f32 v26, v28, v29
  v_mfma_f32_16x16x32_bf16 v[56:59], a[32:35], a[196:199], v[56:59]
  v_cvt_pk_bf16_f32 v27, v30, v31
  v_mfma_f32_16x16x32_bf16 v[60:63], a[12:15], a[192:195], 0
  ds_write_b128 v11, v[24:27] offset:0
  v_mfma_f32_16x16x32_bf16 v[60:63], a[36:39], a[196:199], v[60:63]
  v_mfma_f32_16x16x32_bf16 v[64:67], a[16:19], a[192:195], 0
  buffer_store_dwordx4 a[228:231], v4, s[8:11], s23 offen sc1
  v_mfma_f32_16x16x32_bf16 v[64:67], a[40:43], a[196:199], v[64:67]
  buffer_store_dwordx4 a[232:235], v5, s[8:11], s23 offen sc1
  buffer_store_dwordx4 a[236:239], v6, s[8:11], s23 offen sc1
  v_mfma_f32_16x16x32_bf16 v[68:71], a[20:23], a[192:195], 0
  v_mfma_f32_16x16x32_bf16 v[68:71], a[44:47], a[196:199], v[68:71]
  s_waitcnt lgkmcnt(3)
  v_mfma_f32_16x16x32_bf16 v[48:51], a[48:51], a[200:203], v[48:51]
  ds_read_b128 a[192:195], v9 offset:12544
  v_mfma_f32_16x16x32_bf16 v[48:51], a[72:75], a[204:207], v[48:51]
  ds_read_b128 a[196:199], v10 offset:12544
  v_mfma_f32_16x16x32_bf16 v[52:55], a[52:55], a[200:203], v[52:55]
  v_cvt_pk_bf16_f32 v28, v32, v33
  v_mfma_f32_16x16x32_bf16 v[52:55], a[76:79], a[204:207], v[52:55]
  v_cvt_pk_bf16_f32 v29, v34, v35
  v_mfma_f32_16x16x32_bf16 v[56:59], a[56:59], a[200:203], v[56:59]
  v_cvt_pk_bf16_f32 v30, v36, v37
  v_mfma_f32_16x16x32_bf16 v[56:59], a[80:83], a[204:207], v[56:59]
  v_cvt_pk_bf16_f32 v31, v38, v39
  v_mfma_f32_16x16x32_bf16 v[60:63], a[60:63], a[200:203], v[60:63]
  v_mfma_f32_16x16x32_bf16 v[60:63], a[84:87], a[204:207], v[60:63]
  s_add_u32 m0, s42, 40960
  v_mfma_f32_16x16x32_bf16 v[64:67], a[64:67], a[200:203], v[64:67]
  s_cbranch_vccz L_sk12
  buffer_load_dwordx4 v2, s[4:7], s37 offen nt lds
L_sk12:
  v_mfma_f32_16x16x32_bf16 v[64:67], a[88:91], a[204:207], v[64:67]
  v_mfma_f32_16x16x32_bf16 v[68:71], a[68:71], a[200:203], v[68:71]
  ds_write_b128 v12, v[28:31] offset:0
  v_mfma_f32_16x16x32_bf16 v[68:71], a[92:95], a[204:207], v[68:71]
  s_waitcnt lgkmcnt(4)
  v_mfma_f32_16x16x32_bf16 v[48:51], a[96:99], a[208:211], v[48:51]
  ds_read_b128 a[200:203], v7 offset:12800
  v_mfma_f32_16x16x32_bf16 v[48:51], a[120:123], a[212:215], v[48:51]
  ds_read_b128 a[204:207], v8 offset:12800
  v_mfma_f32_16x16x32_bf16 v[52:55], a[100:103], a[208:211], v[52:55]
  v_cvt_pk_bf16_f32 v32, v40, v41
  v_mfma_f32_16x16x32_bf16 v[52:55], a[124:127], a[212:215], v[52:55]
  v_cvt_pk_bf16_f32 v33, v42, v43
  v_mfma_f32_16x16x32_bf16 v[56:59], a[104:107], a[208:211], v[56:59]
  v_cvt_pk_bf16_f32 v34, v44, v45
  v_mfma_f32_16x16x32_bf16 v[56:59], a[128:131], a[212:215], v[56:59]
  v_cvt_pk_bf16_f32 v35, v46, v47
  v_mfma_f32_16x16x32_bf16 v[60:63], a[108:111], a[208:211], v[60:63]
  ds_write_b128 v13, v[32:35] offset:0
  v_mfma_f32_16x16x32_bf16 v[60:63], a[132:135], a[212:215], v[60:63]
  v_mfma_f32_16x16x32_bf16 v[64:67], a[112:115], a[208:211], v[64:67]
  v_mfma_f32_16x16x32_bf16 v[64:67], a[136:139], a[212:215], v[64:67]
  v_mfma_f32_16x16x32_bf16 v[68:71], a[116:119], a[208:211], v[68:71]
  v_mfma_f32_16x16x32_bf16 v[68:71], a[140:143], a[212:215], v[68:71]
  s_waitcnt lgkmcnt(0)
  v_mfma_f32_16x16x32_bf16 v[48:51], v[112:115], a[192:195], v[48:51]
  ds_read_b128 a[208:211], v9 offset:12800
  v_mfma_f32_16x16x32_bf16 v[48:51], v[136:139], a[196:199], v[48:51]
  ds_read_b128 a[212:215], v10 offset:12800
  v_mfma_f32_16x16x32_bf16 v[52:55], v[116:119], a[192:195], v[52:55]
  s_mul_i32 s56, s54, 98304
  s_add_u32 s56, s56, s57
  v_mfma_f32_16x16x32_bf16 v[52:55], v[140:143], a[196:199], v[52:55]
  s_cmp_lt_u32 s54, 128
  s_cselect_b32 s56, s56, s6
  v_mfma_f32_16x16x32_bf16 v[56:59], v[120:123], a[192:195], v[56:59]
  s_cmp_ge_i32 s61, 0
  s_cselect_b32 s56, s62, s56
  v_mfma_f32_16x16x32_bf16 v[56:59], v[144:147], a[196:199], v[56:59]
  v_mov_b32 v23, s56
  v_mfma_f32_16x16x32_bf16 v[60:63], v[124:127], a[192:195], v[60:63]
  ds_write_b32 v106, v23 offset:0
  v_mfma_f32_16x16x32_bf16 v[60:63], v[148:151], a[196:199], v[60:63]
  s_add_u32 m0, s42, 45056
  v_mfma_f32_16x16x32_bf16 v[64:67], v[128:131], a[192:195], v[64:67]
  s_cbranch_vccz L_sk13
  buffer_load_dwordx4 v3, s[4:7], s37 offen nt lds
L_sk13:
  v_mfma_f32_16x16x32_bf16 v[64:67], v[152:155], a[196:199], v[64:67]
  s_add_u32 s23, s22, 12288
  s_mov_b32 s22, s58
  v_mfma_f32_16x16x32_bf16 v[68:71], v[132:135], a[192:195], v[68:71]
  s_mov_b32 s58, s59
  s_mov_b32 s59, s60
  v_mfma_f32_16x16x32_bf16 v[68:71], v[156:159], a[196:199], v[68:71]
  s_waitcnt vmcnt(24) lgkmcnt(0)
  s_cbranch_vccz L_ow14
L_ob14:
  s_barrier
  v_mfma_f32_16x16x32_bf16 v[48:51], v[160:163], a[200:203], v[48:51]
  ds_read_b128 a[192:195], v7 offset:24576
  v_mfma_f32_16x16x32_bf16 v[48:51], v[184:187], a[204:207], v[48:51]
  ds_read_b128 a[196:199], v8 offset:24576
  v_mfma_f32_16x16x32_bf16 v[52:55], v[164:167], a[200:203], v[52:55]
  ds_read_b128 a[216:219], v1 offset:0
  v_mfma_f32_16x16x32_bf16 v[52:55], v[188:191], a[204:207], v[52:55]
  ds_read_b32 v107, v105 offset:0
  v_mfma_f32_16x16x32_bf16 v[56:59], v[168:171], a[200:203], v[56:59]
  ds_read_b128 a[220:223], v2 offset:0
  v_mfma_f32_16x16x32_bf16 v[56:59], v[192:195], a[204:207], v[56:59]
  ds_read_b128 a[224:227], v3 offset:0
  v_mfma_f32_16x16x32_bf16 v[60:63], v[172:175], a[200:203], v[60:63]
  s_mov_b32 s60, s21
  v_mfma_f32_16x16x32_bf16 v[60:63], v[196:199], a[204:207], v[60:63]
  s_cmp_lt_u32 s54, s55
  s_cselect_b32 s54, 1, s65
  s_cbranch_scc0 L_cl15
  s_atomic_add s54, s[52:53], 0 glc
L_cl15:
  v_mfma_f32_16x16x32_bf16 v[64:67], v[176:179], a[200:203], v[64:67]
  v_mfma_f32_16x16x32_bf16 v[64:67], v[200:203], a[204:207], v[64:67]
  s_waitcnt lgkmcnt(2)
  v_readfirstlane_b32 s21, v107
  v_mfma_f32_16x16x32_bf16 v[68:71], v[180:183], a[200:203], v[68:71]
  v_mfma_f32_16x16x32_bf16 v[68:71], v[204:207], a[204:207], v[68:71]
  v_mfma_f32_16x16x32_bf16 v[48:51], v[208:211], a[208:211], v[48:51]
  ds_read_b128 a[200:203], v9 offset:24576
  s_cmp_lt_u32 s21, s6
  s_cselect_b64 vcc, -1, 0
  v_mfma_f32_16x16x32_bf16 v[48:51], v[232:235], a[212:215], v[48:51]
  ds_read_b128 a[204:207], v10 offset:24576
  s_cselect_b32 s32, 5, s32
  s_add_u32 s37, s21, 12288
  v_mfma_f32_16x16x32_bf16 v[52:55], v[212:215], a[208:211], v[52:55]
  ds_read_b128 a[228:231], v1 offset:12288
  v_mfma_f32_16x16x32_bf16 v[52:55], v[236:239], a[212:215], v[52:55]
  ds_read_b128 a[232:235], v2 offset:12288
  v_mfma_f32_16x16x32_bf16 v[56:59], v[216:219], a[208:211], v[56:59]
  ds_read_b128 a[236:239], v3 offset:12288
  v_mfma_f32_16x16x32_bf16 v[56:59], v[240:243], a[212:215], v[56:59]
  v_mfma_f32_16x16x32_bf16 v[60:63], v[220:223], a[208:211], v[60:63]
  s_xor_b32 s42, s42, 0x14000
  v_mfma_f32_16x16x32_bf16 v[60:63], v[244:247], a[212:215], v[60:63]
  s_add_u32 m0, s42, 0
  v_mfma_f32_16x16x32_bf16 v[64:67], v[224:227], a[208:211], v[64:67]
  s_cbranch_vccz L_sk16
  buffer_load_dwordx4 v1, s[4:7], s21 offen nt lds
L_sk16:
  v_mfma_f32_16x16x32_bf16 v[64:67], v[248:251], a[212:215], v[64:67]
  v_mfma_f32_16x16x32_bf16 v[68:71], v[228:231], a[208:211], v[68:71]
  s_sub_u32 s32, s32, 1
  s_cmp_eq_u32 s32, 0
  v_mfma_f32_16x16x32_bf16 v[68:71], v[252:255], a[212:215], v[68:71]
  s_cbranch_scc0 L_loop0
L_tail1:
  s_nop 1
  v_cvt_pk_bf16_f32 v48, v48, v49
  v_cvt_pk_bf16_f32 v49, v50, v51
  v_cvt_pk_bf16_f32 v50, v52, v53
  v_cvt_pk_bf16_f32 v51, v54, v55
  ds_write_b128 v11, v[48:51] offset:36864
  v_cvt_pk_bf16_f32 v52, v56, v57
  v_cvt_pk_bf16_f32 v53, v58, v59
  v_cvt_pk_bf16_f32 v54, v60, v61
  v_cvt_pk_bf16_f32 v55, v62, v63
  ds_write_b128 v12, v[52:55] offset:36864
  v_cvt_pk_bf16_f32 v56, v64, v65
  v_cvt_pk_bf16_f32 v57, v66, v67
  v_cvt_pk_bf16_f32 v58, v68, v69
  v_cvt_pk_bf16_f32 v59, v70, v71
  ds_write_b128 v13, v[56:59] offset:36864
  buffer_store_dwordx4 a[216:219], v4, s[8:11], s22 offen sc1
  s_waitcnt lgkmcnt(9)
  buffer_store_dwordx4 a[220:223], v5, s[8:11], s22 offen sc1
  s_waitcnt lgkmcnt(0)
  s_barrier
  ds_read_b128 a[192:195], v1 offset:36864
  ds_read_b128 a[196:199], v2 offset:36864
  ds_read_b128 a[200:203], v3 offset:36864
  buffer_store_dwordx4 a[224:227], v6, s[8:11], s22 offen sc1
  buffer_store_dwordx4 a[228:231], v4, s[8:11], s23 offen sc1
  buffer_store_dwordx4 a[232:235], v5, s[8:11], s23 offen sc1
  buffer_store_dwordx4 a[236:239], v6, s[8:11], s23 offen sc1
  s_add_u32 s23, s22, 12288
  s_waitcnt lgkmcnt(2)
  buffer_store_dwordx4 a[192:195], v4, s[8:11], s23 offen sc1
  s_waitcnt lgkmcnt(1)
  buffer_store_dwordx4 a[196:199], v5, s[8:11], s23 offen sc1
  s_waitcnt lgkmcnt(0)
  buffer_store_dwordx4 a[200:203], v6, s[8:11], s23 offen sc1
  s_endpgm
L_tail0:
  s_nop 1
  v_cvt_pk_bf16_f32 v48, v48, v49
  v_cvt_pk_bf16_f32 v49, v50, v51
  v_cvt_pk_bf16_f32 v50, v52, v53
  v_cvt_pk_bf16_f32 v51, v54, v55
  ds_write_b128 v11, v[48:51] offset:12288
  v_cvt_pk_bf16_f32 v52, v56, v57
  v_cvt_pk_bf16_f32 v53, v58, v59
  v_cvt_pk_bf16_f32 v54, v60, v61
  v_cvt_pk_bf16_f32 v55, v62, v63
  ds_write_b128 v12, v[52:55] offset:12288
  v_cvt_pk_bf16_f32 v56, v64, v65
  v_cvt_pk_bf16_f32 v57, v66, v67
  v_cvt_pk_bf16_f32 v58, v68, v69
  v_cvt_pk_bf16_f32 v59, v70, v71
  ds_write_b128 v13, v[56:59] offset:12288
  buffer_store_dwordx4 a[216:219], v4, s[8:11], s22 offen sc1
  s_waitcnt lgkmcnt(9)
  buffer_store_dwordx4 a[220:223], v5, s[8:11], s22 offen sc1
  s_waitcnt lgkmcnt(0)
  s_barrier
  ds_read_b128 a[192:195], v1 offset:12288
  ds_read_b128 a[196:199], v2 offset:12288
  ds_read_b128 a[200:203], v3 offset:12288
  buffer_store_dwordx4 a[224:227], v6, s[8:11], s22 offen sc1
  buffer_store_dwordx4 a[228:231], v4, s[8:11], s23 offen sc1
  buffer_store_dwordx4 a[232:235], v5, s[8:11], s23 offen sc1
  buffer_store_dwordx4 a[236:239], v6, s[8:11], s23 offen sc1
  s_add_u32 s23, s22, 12288
  s_waitcnt lgkmcnt(2)
  buffer_store_dwordx4 a[192:195], v4, s[8:11], s23 offen sc1
  s_waitcnt lgkmcnt(1)
  buffer_store_dwordx4 a[196:199], v5, s[8:11], s23 offen sc1
  s_waitcnt lgkmcnt(0)
  buffer_store_dwordx4 a[200:203], v6, s[8:11], s23 offen sc1
  s_endpgm
L_ow6:
  s_cmp_eq_u32 s32, 1
  s_cbranch_scc1 L_ob6
  s_waitcnt vmcnt(18)
  s_cmp_eq_u32 s32, 3
  s_cbranch_scc1 L_ob6
  s_waitcnt vmcnt(12)
  s_branch L_ob6
L_ow14:
  s_cmp_eq_u32 s32, 1
  s_cbranch_scc1 L_ob14
  s_waitcnt vmcnt(18)
  s_cmp_eq_u32 s32, 3
  s_cbranch_scc1 L_ob14
  s_waitcnt vmcnt(12)
  s_branch L_ob14
L_done:
  s_endpgm
.section .rodata,"a"
.p2align 6
.amdhsa_kernel standalone__depthwise_separable__vision_kernel
  .amdhsa_next_free_vgpr 512
  .amdhsa_next_free_sgpr 100
  .amdhsa_accum_offset 256
  .amdhsa_group_segment_fixed_size 0
  .amdhsa_kernarg_size 48
  .amdhsa_user_sgpr_count 2
  .amdhsa_user_sgpr_kernarg_segment_ptr 1
  .amdhsa_system_sgpr_workgroup_id_x 1
  .amdhsa_float_denorm_mode_32 3
.end_amdhsa_kernel
```

```asm
; @launch grid=(256,1,1) block=(256,1,1) lds=151552
.amdgcn_target "amdgcn-amd-amdhsa--gfx950"
.text
.globl standalone__depthwise_separable__vision_kernel
.p2align 8
.type standalone__depthwise_separable__vision_kernel,@function
standalone__depthwise_separable__vision_kernel:
  s_cmp_ge_u32 s2, 256
  s_cbranch_scc1 L_done
  s_load_dwordx4 s[28:31], s[0:1], 16
  s_load_dwordx4 s[24:27], s[0:1], 0
  s_load_dwordx2 s[52:53], s[0:1], 32
  s_getpc_b64 s[40:41]
L_pc:
  v_lshlrev_b32 v72, 7, v0
  v_min_u32 v72, L_done-L_pc, v72
  v_mov_b32 v73, s41
  v_add_co_u32 v72, vcc, s40, v72
  v_lshrrev_b32 v77, 6, v0
  v_and_b32 v74, 63, v0
  v_addc_co_u32 v73, vcc, 0, v73, vcc
  global_load_dword v23, v[72:73], off
  v_readfirstlane_b32 s20, v77
  v_and_b32 v75, 15, v74
  v_lshlrev_b32 v78, 4, v74
  v_lshlrev_b32 v79, 4, v75
  s_lshr_b32 s47, s2, 3
  s_mul_i32 s39, s47, 9216
  s_mul_i32 s38, s20, 2304
  s_add_u32 s39, s39, s38
  s_mul_i32 s38, s20, 192
  v_mul_u32_u24 v81, 0xaaab, v74
  v_lshrrev_b32 v81, 19, v81
  v_mul_u32_u24 v81, 576, v81
  v_add3_u32 v14, v81, v78, s38
  v_add_u32 v80, 64, v74
  v_mul_u32_u24 v81, 0xaaab, v80
  v_lshrrev_b32 v81, 19, v81
  v_mul_u32_u24 v81, 576, v81
  v_add3_u32 v15, v81, v78, s38
  v_add_u32 v80, 128, v74
  v_mul_u32_u24 v81, 0xaaab, v80
  v_lshrrev_b32 v81, 19, v81
  v_mul_u32_u24 v81, 576, v81
  v_add3_u32 v16, v81, v78, s38
  s_lshl_b32 s33, s20, 10
  s_mul_i32 s34, s20, 6144
  s_mov_b32 s36, 0
  s_mov_b32 s14, 294912
  s_mov_b32 s15, 0x00020000
  s_mov_b32 s18, 768
  s_mov_b32 s19, 0x00020000
  s_add_u32 m0, s33, 147456
  s_waitcnt lgkmcnt(0)
  s_mov_b32 s12, s28
  s_and_b32 s13, s29, 0xffff
  buffer_load_dwordx4 a[216:219], v78, s[12:15], s39 offen
  buffer_load_dwordx4 a[220:223], v78, s[12:15], s39 offen offset:1024
  buffer_load_dwordx4 a[224:227], v79, s[12:15], s39 offen offset:2048
  s_mov_b32 s16, s26
  s_and_b32 s17, s27, 0xffff
  buffer_load_dwordx4 v78, s[16:19], 0 offen lds
  s_and_b32 s38, s2, 7
  s_lshl_b32 s38, s38, 5
  s_add_u32 s38, s38, s47
  s_mul_i32 s21, s38, 24576
  s_mov_b32 s4, s24
  s_and_b32 s5, s25, 0xffff
  s_mov_b32 s6, 113246208
  s_mov_b32 s7, 0x00020000
  v_mul_u32_u24 v81, 0xaaab, v0
  v_lshrrev_b32 v81, 21, v81
  v_xor_b32 v80, v0, v81
  v_lshlrev_b32 v1, 4, v80
  v_add_u32 v80, 256, v0
  v_mul_u32_u24 v81, 0xaaab, v80
  v_lshrrev_b32 v81, 21, v81
  v_xor_b32 v80, v80, v81
  v_lshlrev_b32 v2, 4, v80
  v_add_u32 v80, 512, v0
  v_mul_u32_u24 v81, 0xaaab, v80
  v_lshrrev_b32 v81, 21, v81
  v_xor_b32 v80, v80, v81
  v_lshlrev_b32 v3, 4, v80
  s_add_u32 s37, s21, 12288
  s_mov_b32 s22, s21
  s_add_u32 m0, s33, 98304
  s_nop 0
  buffer_load_dwordx4 v1, s[4:7], s21 offen nt lds
  s_add_u32 m0, s33, 102400
  s_nop 0
  buffer_load_dwordx4 v2, s[4:7], s21 offen nt lds
  s_add_u32 m0, s33, 106496
  s_nop 0
  buffer_load_dwordx4 v3, s[4:7], s21 offen nt lds
  s_add_u32 m0, s33, 110592
  s_add_u32 s21, s21, 6291456
  buffer_load_dwordx4 v1, s[4:7], s37 offen nt lds
  s_add_u32 m0, s33, 114688
  s_nop 0
  buffer_load_dwordx4 v2, s[4:7], s37 offen nt lds
  s_add_u32 m0, s33, 118784
  s_nop 0
  buffer_load_dwordx4 v3, s[4:7], s37 offen nt lds
  s_add_u32 s37, s37, 6291456
  v_lshrrev_b32 v76, 4, v74
  v_lshlrev_b32 v18, 4, v76
  v_add_u32 v18, s33, v18
  v_add_u32 v18, 147456, v18
  v_bfe_u32 v81, v74, 2, 2
  v_and_b32 v82, 3, v74
  v_lshl_add_u32 v83, v76, 3, v81
  v_mul_u32_u24 v83, 192, v83
  v_mul_u32_u24 v84, 48, v82
  v_add3_u32 v17, v83, v84, s34
  v_add_u32 v104, 49152, v17
  v_lshlrev_b32 v83, 4, v82
  v_mov_b32 v84, 0xffff
  v_cmp_lt_u32 vcc, 1, v82
  v_lshlrev_b32 v84, v83, v84
  v_mul_u32_u24 v80, 0x300, v75
  v_cndmask_b32 v20, 0, v84, vcc
  v_sub_u32 v19, v84, v20
  s_add_u32 m0, s34, 49152
  s_nop 0
  buffer_load_dwordx4 v14, s[12:15], s36 offen offset:0 lds
  buffer_load_dwordx4 v15, s[12:15], s36 offen offset:1024 lds
  buffer_load_dwordx4 v16, s[12:15], s36 offen offset:2048 lds
  s_add_u32 m0, s34, 52224
  s_add_u32 s36, s36, 12288
  buffer_load_dwordx4 v14, s[12:15], s36 offen offset:0 lds
  buffer_load_dwordx4 v15, s[12:15], s36 offen offset:1024 lds
  buffer_load_dwordx4 v16, s[12:15], s36 offen offset:2048 lds
  s_mov_b32 s8, s30
  s_and_b32 s9, s31, 0xffff
  s_mov_b32 s10, 113246208
  s_mov_b32 s11, 0x00020000
  v_lshlrev_b32 v4, 4, v0
  v_add_u32 v5, 4096, v4
  v_add_u32 v6, 8192, v4
  v_xor_b32 v81, v76, v75
  v_lshl_add_u32 v7, v81, 4, v80
  v_add_u32 v7, 98304, v7
  v_xor_b32 v8, 64, v7
  v_xor_b32 v9, 128, v7
  v_xor_b32 v10, 192, v7
  s_mul_i32 s38, s20, 12
  v_mul_u32_u24 v81, 3, v76
  v_add_u32 v81, s38, v81
  v_add_u32 v82, 0, v81
  v_xor_b32 v82, v82, v75
  v_lshl_add_u32 v11, v82, 4, v80
  v_add_u32 v82, 1, v81
  v_xor_b32 v82, v82, v75
  v_lshl_add_u32 v12, v82, 4, v80
  v_add_u32 v82, 2, v81
  v_xor_b32 v82, v82, v75
  v_lshl_add_u32 v13, v82, 4, v80
  s_mov_b32 s23, 113246208
  s_mov_b32 s44, 6291456
  s_add_u32 s42, s33, 49152
  s_mov_b32 s51, 1
  s_and_b32 s38, s47, 3
  s_mul_i32 s57, s38, 24576
  s_add_u32 s57, s57, 100663296
  s_lshl_b32 s38, s38, 6
  s_add_u32 s52, s52, s38
  s_addc_u32 s53, s53, 0
  s_bitcmp1_b32 s2, 0
  s_mov_b32 s55, 128
  s_cselect_b32 s55, 64, s55
  s_cmp_eq_u32 s20, 0
  s_cselect_b32 s66, s55, 0
  s_mov_b32 s55, 0
  s_mov_b32 s65, 0
  s_mov_b32 s61, 11
  s_add_u32 s62, s22, 25165824
  s_mov_b32 s54, 0
  s_add_u32 s58, s22, 6291456
  s_add_u32 s59, s22, 12582912
  s_add_u32 s60, s22, 18874368
  s_mov_b32 s32, 4
  v_mov_b32 v105, 147456
  v_add_u32 v106, s33, v105
  s_add_u32 m0, s34, 73728
  s_add_u32 s36, s36, 12288
  buffer_load_dwordx4 v14, s[12:15], s36 offen offset:0 lds
  buffer_load_dwordx4 v15, s[12:15], s36 offen offset:1024 lds
  buffer_load_dwordx4 v16, s[12:15], s36 offen offset:2048 lds
  s_add_u32 m0, s34, 76800
  s_add_u32 s36, s36, 12288
  buffer_load_dwordx4 v14, s[12:15], s36 offen offset:0 lds
  buffer_load_dwordx4 v15, s[12:15], s36 offen offset:1024 lds
  buffer_load_dwordx4 v16, s[12:15], s36 offen offset:2048 lds
  s_waitcnt vmcnt(6)
  ds_read_b128 v[96:99], v18 offset:0
  ds_read_b64_tr_b16 a[144:145], v104 offset:0
  ds_read_b64_tr_b16 a[146:147], v104 offset:768
  ds_read_b64_tr_b16 a[148:149], v104 offset:8
  ds_read_b64_tr_b16 a[150:151], v104 offset:776
  ds_read_b64_tr_b16 a[152:153], v104 offset:16
  ds_read_b64_tr_b16 a[154:155], v104 offset:784
  ds_read_b64_tr_b16 a[156:157], v104 offset:24
  ds_read_b64_tr_b16 a[158:159], v104 offset:792
  ds_read_b64_tr_b16 a[160:161], v104 offset:32
  ds_read_b64_tr_b16 a[162:163], v104 offset:800
  ds_read_b64_tr_b16 a[164:165], v104 offset:40
  ds_read_b64_tr_b16 a[166:167], v104 offset:808
  s_add_u32 m0, s34, 0
  s_add_u32 s36, s36, 12288
  buffer_load_dwordx4 v14, s[12:15], s36 offen offset:0 lds
  buffer_load_dwordx4 v15, s[12:15], s36 offen offset:1024 lds
  buffer_load_dwordx4 v16, s[12:15], s36 offen offset:2048 lds
  s_add_u32 m0, s34, 3072
  s_add_u32 s36, s36, 12288
  buffer_load_dwordx4 v14, s[12:15], s36 offen offset:0 lds
  buffer_load_dwordx4 v15, s[12:15], s36 offen offset:1024 lds
  buffer_load_dwordx4 v16, s[12:15], s36 offen offset:2048 lds
  s_waitcnt lgkmcnt(12)
  v_and_b32 v96, v19, v96
  v_and_b32 v97, v20, v97
  v_and_b32 v98, v19, v98
  v_and_b32 v99, v20, v99
  s_waitcnt lgkmcnt(10)
  v_mfma_f32_4x4x4_16b_bf16 v[72:75], v[96:97], a[144:145], 0
  v_mfma_f32_4x4x4_16b_bf16 v[76:79], v[98:99], a[146:147], 0
  s_waitcnt vmcnt(6)
  s_add_u32 m0, s34, 24576
  s_add_u32 s36, s36, 12288
  s_nop 0
  ds_read_b64_tr_b16 a[168:169], v104 offset:24576
  ds_read_b64_tr_b16 a[170:171], v104 offset:25344
  buffer_load_dwordx4 v14, s[12:15], s36 offen offset:0 lds
  buffer_load_dwordx4 v15, s[12:15], s36 offen offset:1024 lds
  s_waitcnt lgkmcnt(10)
  v_mfma_f32_4x4x4_16b_bf16 v[80:83], v[96:97], a[148:149], 0
  v_mfma_f32_4x4x4_16b_bf16 v[84:87], v[98:99], a[150:151], 0
  ds_read_b64_tr_b16 a[172:173], v104 offset:24584
  ds_read_b128 v[100:103], v18 offset:64
  ds_read_b64_tr_b16 a[174:175], v104 offset:25352
  buffer_load_dwordx4 v16, s[12:15], s36 offen offset:2048 lds
  s_add_u32 m0, s34, 27648
  s_add_u32 s36, s36, 12288
  buffer_load_dwordx4 v14, s[12:15], s36 offen offset:0 lds
  s_waitcnt lgkmcnt(11)
  v_mfma_f32_4x4x4_16b_bf16 v[88:91], v[96:97], a[152:153], 0
  v_mfma_f32_4x4x4_16b_bf16 v[92:95], v[98:99], a[154:155], 0
  v_cvt_pk_bf16_f32 v72, v72, v73
  v_cvt_pk_bf16_f32 v74, v74, v75
  ds_read_b64_tr_b16 a[176:177], v104 offset:24592
  ds_read_b64_tr_b16 a[178:179], v104 offset:25360
  buffer_load_dwordx4 v15, s[12:15], s36 offen offset:1024 lds
  buffer_load_dwordx4 v16, s[12:15], s36 offen offset:2048 lds
  v_cvt_pk_bf16_f32 v76, v76, v77
  v_accvgpr_write_b32 a0, v72
  v_cvt_pk_bf16_f32 v78, v78, v79
  v_accvgpr_write_b32 a1, v74
  v_accvgpr_write_b32 a2, v76
  v_accvgpr_write_b32 a3, v78
  s_waitcnt lgkmcnt(11)
  v_mfma_f32_4x4x4_16b_bf16 v[72:75], v[96:97], a[156:157], 0
  v_mfma_f32_4x4x4_16b_bf16 v[76:79], v[98:99], a[158:159], 0
  v_cvt_pk_bf16_f32 v80, v80, v81
  v_cvt_pk_bf16_f32 v82, v82, v83
  s_add_u32 m0, s34, 49152
  s_add_u32 s36, s36, 12288
  s_waitcnt lgkmcnt(7)
  s_nop 0
  ds_read_b64_tr_b16 a[180:181], v104 offset:24600
  ds_read_b64_tr_b16 a[182:183], v104 offset:25368
  buffer_load_dwordx4 v14, s[12:15], s36 offen offset:0 lds
  buffer_load_dwordx4 v15, s[12:15], s36 offen offset:1024 lds
  v_cvt_pk_bf16_f32 v84, v84, v85
  v_accvgpr_write_b32 a4, v80
  v_cvt_pk_bf16_f32 v86, v86, v87
  v_accvgpr_write_b32 a5, v82
  v_accvgpr_write_b32 a6, v84
  v_accvgpr_write_b32 a7, v86
  v_mfma_f32_4x4x4_16b_bf16 v[80:83], v[96:97], a[160:161], 0
  v_mfma_f32_4x4x4_16b_bf16 v[84:87], v[98:99], a[162:163], 0
  v_cvt_pk_bf16_f32 v88, v88, v89
  v_cvt_pk_bf16_f32 v90, v90, v91
  ds_read_b64_tr_b16 a[184:185], v104 offset:24608
  ds_read_b64_tr_b16 a[186:187], v104 offset:25376
  buffer_load_dwordx4 v16, s[12:15], s36 offen offset:2048 lds
  s_add_u32 m0, s34, 52224
  s_add_u32 s36, s36, 12288
  buffer_load_dwordx4 v14, s[12:15], s36 offen offset:0 lds
  v_cvt_pk_bf16_f32 v92, v92, v93
  v_accvgpr_write_b32 a8, v88
  v_cvt_pk_bf16_f32 v94, v94, v95
  v_accvgpr_write_b32 a9, v90
  v_accvgpr_write_b32 a10, v92
  v_accvgpr_write_b32 a11, v94
  s_waitcnt lgkmcnt(7)
  v_and_b32 v100, v19, v100
  v_and_b32 v101, v20, v101
  v_mfma_f32_4x4x4_16b_bf16 v[88:91], v[96:97], a[164:165], 0
  v_mfma_f32_4x4x4_16b_bf16 v[92:95], v[98:99], a[166:167], 0
  v_and_b32 v102, v19, v102
  v_and_b32 v103, v20, v103
  ds_read_b64_tr_b16 a[188:189], v104 offset:24616
  ds_read_b64_tr_b16 a[190:191], v104 offset:25384
  buffer_load_dwordx4 v15, s[12:15], s36 offen offset:1024 lds
  buffer_load_dwordx4 v16, s[12:15], s36 offen offset:2048 lds
  v_cvt_pk_bf16_f32 v72, v72, v73
  v_cvt_pk_bf16_f32 v74, v74, v75
  v_cvt_pk_bf16_f32 v76, v76, v77
  v_accvgpr_write_b32 a12, v72
  v_cvt_pk_bf16_f32 v78, v78, v79
  v_accvgpr_write_b32 a13, v74
  v_accvgpr_write_b32 a14, v76
  v_accvgpr_write_b32 a15, v78
  s_waitcnt lgkmcnt(0)
  s_barrier
  ds_read_b128 a[192:195], v7 offset:0
  ds_read_b128 a[196:199], v7 offset:12288
  ds_read_b128 a[200:203], v8 offset:0
  ds_read_b128 a[204:207], v8 offset:12288
  v_mfma_f32_4x4x4_16b_bf16 v[72:75], v[100:101], a[168:169], 0
  v_mfma_f32_4x4x4_16b_bf16 v[76:79], v[102:103], a[170:171], 0
  v_cvt_pk_bf16_f32 v80, v80, v81
  v_cvt_pk_bf16_f32 v82, v82, v83
  s_waitcnt vmcnt(12)
  s_add_u32 m0, s34, 73728
  s_add_u32 s36, s36, 12288
  s_nop 0
  ds_read_b64_tr_b16 a[144:145], v17 offset:0
  ds_read_b64_tr_b16 a[146:147], v17 offset:768
  buffer_load_dwordx4 v14, s[12:15], s36 offen offset:0 lds
  buffer_load_dwordx4 v15, s[12:15], s36 offen offset:1024 lds
  v_cvt_pk_bf16_f32 v84, v84, v85
  v_accvgpr_write_b32 a16, v80
  v_cvt_pk_bf16_f32 v86, v86, v87
  v_accvgpr_write_b32 a17, v82
  v_accvgpr_write_b32 a18, v84
  v_accvgpr_write_b32 a19, v86
  v_mfma_f32_4x4x4_16b_bf16 v[80:83], v[100:101], a[172:173], 0
  v_mfma_f32_4x4x4_16b_bf16 v[84:87], v[102:103], a[174:175], 0
  v_cvt_pk_bf16_f32 v88, v88, v89
  v_cvt_pk_bf16_f32 v90, v90, v91
  s_waitcnt lgkmcnt(4)
  v_mfma_f32_16x16x32_bf16 v[24:27], a[0:3], a[192:195], 0
  ds_read_b64_tr_b16 a[148:149], v17 offset:8
  v_cvt_pk_bf16_f32 v92, v92, v93
  v_mfma_f32_16x16x32_bf16 v[48:51], a[0:3], a[196:199], 0
  ds_read_b128 v[96:99], v18 offset:128
  v_accvgpr_write_b32 a20, v88
  v_mfma_f32_16x16x32_bf16 v[28:31], a[4:7], a[192:195], 0
  ds_read_b64_tr_b16 a[150:151], v17 offset:776
  v_cvt_pk_bf16_f32 v94, v94, v95
  v_mfma_f32_16x16x32_bf16 v[52:55], a[4:7], a[196:199], 0
  buffer_load_dwordx4 v16, s[12:15], s36 offen offset:2048 lds
  s_add_u32 m0, s34, 76800
  s_add_u32 s36, s36, 12288
  buffer_load_dwordx4 v14, s[12:15], s36 offen offset:0 lds
  v_accvgpr_write_b32 a21, v90
  v_accvgpr_write_b32 a22, v92
  v_accvgpr_write_b32 a23, v94
  v_mfma_f32_4x4x4_16b_bf16 v[88:91], v[100:101], a[176:177], 0
  v_mfma_f32_4x4x4_16b_bf16 v[92:95], v[102:103], a[178:179], 0
  v_cvt_pk_bf16_f32 v72, v72, v73
  v_cvt_pk_bf16_f32 v74, v74, v75
  v_mfma_f32_16x16x32_bf16 v[32:35], a[8:11], a[192:195], 0
  ds_read_b64_tr_b16 a[152:153], v17 offset:16
  ds_read_b128 a[208:211], v9 offset:0
  v_cvt_pk_bf16_f32 v76, v76, v77
  v_mfma_f32_16x16x32_bf16 v[56:59], a[8:11], a[196:199], 0
  ds_read_b64_tr_b16 a[154:155], v17 offset:784
  buffer_load_dwordx4 v15, s[12:15], s36 offen offset:1024 lds
  buffer_load_dwordx4 v16, s[12:15], s36 offen offset:2048 lds
  v_accvgpr_write_b32 a24, v72
  v_cvt_pk_bf16_f32 v78, v78, v79
  v_accvgpr_write_b32 a25, v74
  v_accvgpr_write_b32 a26, v76
  v_accvgpr_write_b32 a27, v78
  v_mfma_f32_4x4x4_16b_bf16 v[72:75], v[100:101], a[180:181], 0
  v_mfma_f32_4x4x4_16b_bf16 v[76:79], v[102:103], a[182:183], 0
  v_cvt_pk_bf16_f32 v80, v80, v81
  v_cvt_pk_bf16_f32 v82, v82, v83
  v_mfma_f32_16x16x32_bf16 v[36:39], a[12:15], a[192:195], 0
  ds_read_b64_tr_b16 a[156:157], v17 offset:24
  ds_read_b128 a[212:215], v9 offset:12288
  v_cvt_pk_bf16_f32 v84, v84, v85
  s_add_u32 m0, s33, 122880
  v_mfma_f32_16x16x32_bf16 v[60:63], a[12:15], a[196:199], 0
  ds_read_b64_tr_b16 a[158:159], v17 offset:792
  buffer_load_dwordx4 v1, s[4:7], s21 offen nt lds
  s_add_u32 m0, s33, 126976
  s_nop 0
  buffer_load_dwordx4 v2, s[4:7], s21 offen nt lds
  v_accvgpr_write_b32 a28, v80
  v_cvt_pk_bf16_f32 v86, v86, v87
  v_accvgpr_write_b32 a29, v82
  v_accvgpr_write_b32 a30, v84
  v_accvgpr_write_b32 a31, v86
  v_mfma_f32_4x4x4_16b_bf16 v[80:83], v[100:101], a[184:185], 0
  v_mfma_f32_4x4x4_16b_bf16 v[84:87], v[102:103], a[186:187], 0
  v_cvt_pk_bf16_f32 v88, v88, v89
  v_cvt_pk_bf16_f32 v90, v90, v91
  v_mfma_f32_16x16x32_bf16 v[40:43], a[16:19], a[192:195], 0
  ds_read_b64_tr_b16 a[160:161], v17 offset:32
  ds_read_b64_tr_b16 a[162:163], v17 offset:800
  v_cvt_pk_bf16_f32 v92, v92, v93
  v_accvgpr_write_b32 a32, v88
  s_add_u32 m0, s33, 131072
  v_mfma_f32_16x16x32_bf16 v[64:67], a[16:19], a[196:199], 0
  buffer_load_dwordx4 v3, s[4:7], s21 offen nt lds
  s_add_u32 m0, s33, 135168
  s_add_u32 s21, s21, 6291456
  buffer_load_dwordx4 v1, s[4:7], s37 offen nt lds
  v_cvt_pk_bf16_f32 v94, v94, v95
  v_accvgpr_write_b32 a33, v90
  v_accvgpr_write_b32 a34, v92
  v_accvgpr_write_b32 a35, v94
  s_waitcnt lgkmcnt(9)
  v_and_b32 v96, v19, v96
  v_and_b32 v97, v20, v97
  v_mfma_f32_4x4x4_16b_bf16 v[88:91], v[100:101], a[188:189], 0
  v_mfma_f32_4x4x4_16b_bf16 v[92:95], v[102:103], a[190:191], 0
  v_and_b32 v98, v19, v98
  v_and_b32 v99, v20, v99
  v_mfma_f32_16x16x32_bf16 v[44:47], a[20:23], a[192:195], 0
  ds_read_b64_tr_b16 a[164:165], v17 offset:40
  ds_read_b64_tr_b16 a[166:167], v17 offset:808
  v_cvt_pk_bf16_f32 v72, v72, v73
  v_cvt_pk_bf16_f32 v74, v74, v75
  s_add_u32 m0, s33, 139264
  v_mfma_f32_16x16x32_bf16 v[68:71], a[20:23], a[196:199], 0
  buffer_load_dwordx4 v2, s[4:7], s37 offen nt lds
  s_add_u32 m0, s33, 143360
  s_nop 0
  buffer_load_dwordx4 v3, s[4:7], s37 offen nt lds
  s_add_u32 s37, s37, 6291456
  v_cvt_pk_bf16_f32 v76, v76, v77
  v_accvgpr_write_b32 a36, v72
  v_cvt_pk_bf16_f32 v78, v78, v79
  v_accvgpr_write_b32 a37, v74
  v_accvgpr_write_b32 a38, v76
  v_accvgpr_write_b32 a39, v78
  v_mfma_f32_4x4x4_16b_bf16 v[72:75], v[96:97], a[144:145], 0
  v_mfma_f32_4x4x4_16b_bf16 v[76:79], v[98:99], a[146:147], 0
  v_cvt_pk_bf16_f32 v80, v80, v81
  v_cvt_pk_bf16_f32 v82, v82, v83
  s_waitcnt vmcnt(18)
  v_mfma_f32_16x16x32_bf16 v[24:27], a[24:27], a[200:203], v[24:27]
  ds_read_b64_tr_b16 a[168:169], v17 offset:24576
  v_cvt_pk_bf16_f32 v84, v84, v85
  v_mfma_f32_16x16x32_bf16 v[48:51], a[24:27], a[204:207], v[48:51]
  ds_read_b64_tr_b16 a[170:171], v17 offset:25344
  v_accvgpr_write_b32 a40, v80
  v_cvt_pk_bf16_f32 v86, v86, v87
  v_accvgpr_write_b32 a41, v82
  v_accvgpr_write_b32 a42, v84
  v_accvgpr_write_b32 a43, v86
  s_waitcnt lgkmcnt(12)
  v_mfma_f32_4x4x4_16b_bf16 v[80:83], v[96:97], a[148:149], 0
  v_mfma_f32_4x4x4_16b_bf16 v[84:87], v[98:99], a[150:151], 0
  v_cvt_pk_bf16_f32 v88, v88, v89
  v_cvt_pk_bf16_f32 v90, v90, v91
  v_mfma_f32_16x16x32_bf16 v[28:31], a[28:31], a[200:203], v[28:31]
  ds_read_b64_tr_b16 a[172:173], v17 offset:24584
  v_cvt_pk_bf16_f32 v92, v92, v93
  v_mfma_f32_16x16x32_bf16 v[52:55], a[28:31], a[204:207], v[52:55]
  ds_read_b128 v[100:103], v18 offset:192
  ds_read_b64_tr_b16 a[174:175], v17 offset:25352
  v_accvgpr_write_b32 a44, v88
  v_cvt_pk_bf16_f32 v94, v94, v95
  v_accvgpr_write_b32 a45, v90
  v_accvgpr_write_b32 a46, v92
  v_accvgpr_write_b32 a47, v94
  s_waitcnt lgkmcnt(12)
  v_mfma_f32_4x4x4_16b_bf16 v[88:91], v[96:97], a[152:153], 0
  v_mfma_f32_4x4x4_16b_bf16 v[92:95], v[98:99], a[154:155], 0
  v_cvt_pk_bf16_f32 v72, v72, v73
  v_cvt_pk_bf16_f32 v74, v74, v75
  v_mfma_f32_16x16x32_bf16 v[32:35], a[32:35], a[200:203], v[32:35]
  ds_read_b64_tr_b16 a[176:177], v17 offset:24592
  v_cvt_pk_bf16_f32 v76, v76, v77
  v_mfma_f32_16x16x32_bf16 v[56:59], a[32:35], a[204:207], v[56:59]
  ds_read_b128 a[192:195], v10 offset:0
  ds_read_b64_tr_b16 a[178:179], v17 offset:25360
  v_accvgpr_write_b32 a48, v72
  v_cvt_pk_bf16_f32 v78, v78, v79
  v_accvgpr_write_b32 a49, v74
  v_accvgpr_write_b32 a50, v76
  v_accvgpr_write_b32 a51, v78
  s_waitcnt lgkmcnt(12)
  v_mfma_f32_4x4x4_16b_bf16 v[72:75], v[96:97], a[156:157], 0
  v_mfma_f32_4x4x4_16b_bf16 v[76:79], v[98:99], a[158:159], 0
  v_cvt_pk_bf16_f32 v80, v80, v81
  v_cvt_pk_bf16_f32 v82, v82, v83
  v_mfma_f32_16x16x32_bf16 v[36:39], a[36:39], a[200:203], v[36:39]
  ds_read_b64_tr_b16 a[180:181], v17 offset:24600
  v_cvt_pk_bf16_f32 v84, v84, v85
  v_mfma_f32_16x16x32_bf16 v[60:63], a[36:39], a[204:207], v[60:63]
  ds_read_b128 a[196:199], v10 offset:12288
  ds_read_b64_tr_b16 a[182:183], v17 offset:25368
  v_accvgpr_write_b32 a52, v80
  v_cvt_pk_bf16_f32 v86, v86, v87
  v_accvgpr_write_b32 a53, v82
  v_accvgpr_write_b32 a54, v84
  v_accvgpr_write_b32 a55, v86
  s_waitcnt lgkmcnt(13)
  v_mfma_f32_4x4x4_16b_bf16 v[80:83], v[96:97], a[160:161], 0
  v_mfma_f32_4x4x4_16b_bf16 v[84:87], v[98:99], a[162:163], 0
  v_cvt_pk_bf16_f32 v88, v88, v89
  v_cvt_pk_bf16_f32 v90, v90, v91
  v_mfma_f32_16x16x32_bf16 v[40:43], a[40:43], a[200:203], v[40:43]
  ds_read_b64_tr_b16 a[184:185], v17 offset:24608
  v_cvt_pk_bf16_f32 v92, v92, v93
  v_accvgpr_write_b32 a56, v88
  v_mfma_f32_16x16x32_bf16 v[64:67], a[40:43], a[204:207], v[64:67]
  ds_read_b64_tr_b16 a[186:187], v17 offset:25376
  v_cvt_pk_bf16_f32 v94, v94, v95
  v_accvgpr_write_b32 a57, v90
  v_accvgpr_write_b32 a58, v92
  v_accvgpr_write_b32 a59, v94
  s_waitcnt lgkmcnt(9)
  v_and_b32 v100, v19, v100
  v_and_b32 v101, v20, v101
  v_mfma_f32_4x4x4_16b_bf16 v[88:91], v[96:97], a[164:165], 0
  v_mfma_f32_4x4x4_16b_bf16 v[92:95], v[98:99], a[166:167], 0
  v_and_b32 v102, v19, v102
  v_and_b32 v103, v20, v103
  v_mfma_f32_16x16x32_bf16 v[44:47], a[44:47], a[200:203], v[44:47]
  ds_read_b64_tr_b16 a[188:189], v17 offset:24616
  v_cvt_pk_bf16_f32 v72, v72, v73
  v_cvt_pk_bf16_f32 v74, v74, v75
  v_mfma_f32_16x16x32_bf16 v[68:71], a[44:47], a[204:207], v[68:71]
  ds_read_b64_tr_b16 a[190:191], v17 offset:25384
  v_cvt_pk_bf16_f32 v76, v76, v77
  v_accvgpr_write_b32 a60, v72
  v_cvt_pk_bf16_f32 v78, v78, v79
  v_accvgpr_write_b32 a61, v74
  v_accvgpr_write_b32 a62, v76
  v_accvgpr_write_b32 a63, v78
  v_mfma_f32_4x4x4_16b_bf16 v[72:75], v[100:101], a[168:169], 0
  v_mfma_f32_4x4x4_16b_bf16 v[76:79], v[102:103], a[170:171], 0
  v_cvt_pk_bf16_f32 v80, v80, v81
  v_cvt_pk_bf16_f32 v82, v82, v83
  s_waitcnt vmcnt(12)
  v_mfma_f32_16x16x32_bf16 v[24:27], a[48:51], a[208:211], v[24:27]
  ds_read_b64_tr_b16 a[144:145], v104 offset:0
  v_cvt_pk_bf16_f32 v84, v84, v85
  v_mfma_f32_16x16x32_bf16 v[48:51], a[48:51], a[212:215], v[48:51]
  ds_read_b64_tr_b16 a[146:147], v104 offset:768
  v_accvgpr_write_b32 a64, v80
  v_cvt_pk_bf16_f32 v86, v86, v87
  v_accvgpr_write_b32 a65, v82
  v_accvgpr_write_b32 a66, v84
  v_accvgpr_write_b32 a67, v86
  s_waitcnt lgkmcnt(12)
  v_mfma_f32_4x4x4_16b_bf16 v[80:83], v[100:101], a[172:173], 0
  v_mfma_f32_4x4x4_16b_bf16 v[84:87], v[102:103], a[174:175], 0
  v_cvt_pk_bf16_f32 v88, v88, v89
  v_cvt_pk_bf16_f32 v90, v90, v91
  v_mfma_f32_16x16x32_bf16 v[28:31], a[52:55], a[208:211], v[28:31]
  ds_read_b64_tr_b16 a[148:149], v104 offset:8
  v_cvt_pk_bf16_f32 v92, v92, v93
  v_mfma_f32_16x16x32_bf16 v[52:55], a[52:55], a[212:215], v[52:55]
  ds_read_b128 v[96:99], v18 offset:256
  ds_read_b64_tr_b16 a[150:151], v104 offset:776
  v_accvgpr_write_b32 a68, v88
  v_cvt_pk_bf16_f32 v94, v94, v95
  v_accvgpr_write_b32 a69, v90
  v_accvgpr_write_b32 a70, v92
  v_accvgpr_write_b32 a71, v94
  s_waitcnt lgkmcnt(12)
  v_mfma_f32_4x4x4_16b_bf16 v[88:91], v[100:101], a[176:177], 0
  v_mfma_f32_4x4x4_16b_bf16 v[92:95], v[102:103], a[178:179], 0
  v_cvt_pk_bf16_f32 v72, v72, v73
  v_cvt_pk_bf16_f32 v74, v74, v75
  v_mfma_f32_16x16x32_bf16 v[32:35], a[56:59], a[208:211], v[32:35]
  ds_read_b64_tr_b16 a[152:153], v104 offset:16
  v_cvt_pk_bf16_f32 v76, v76, v77
  v_mfma_f32_16x16x32_bf16 v[56:59], a[56:59], a[212:215], v[56:59]
  ds_read_b128 a[200:203], v7 offset:256
  ds_read_b64_tr_b16 a[154:155], v104 offset:784
  v_accvgpr_write_b32 a72, v72
  v_cvt_pk_bf16_f32 v78, v78, v79
  v_accvgpr_write_b32 a73, v74
  v_accvgpr_write_b32 a74, v76
  v_accvgpr_write_b32 a75, v78
  s_waitcnt lgkmcnt(12)
  v_mfma_f32_4x4x4_16b_bf16 v[72:75], v[100:101], a[180:181], 0
  v_mfma_f32_4x4x4_16b_bf16 v[76:79], v[102:103], a[182:183], 0
  v_cvt_pk_bf16_f32 v80, v80, v81
  v_cvt_pk_bf16_f32 v82, v82, v83
  v_mfma_f32_16x16x32_bf16 v[36:39], a[60:63], a[208:211], v[36:39]
  ds_read_b64_tr_b16 a[156:157], v104 offset:24
  v_cvt_pk_bf16_f32 v84, v84, v85
  v_mfma_f32_16x16x32_bf16 v[60:63], a[60:63], a[212:215], v[60:63]
  ds_read_b128 a[204:207], v7 offset:12544
  ds_read_b64_tr_b16 a[158:159], v104 offset:792
  v_accvgpr_write_b32 a76, v80
  v_cvt_pk_bf16_f32 v86, v86, v87
  v_accvgpr_write_b32 a77, v82
  v_accvgpr_write_b32 a78, v84
  v_accvgpr_write_b32 a79, v86
  s_waitcnt lgkmcnt(13)
  v_mfma_f32_4x4x4_16b_bf16 v[80:83], v[100:101], a[184:185], 0
  v_mfma_f32_4x4x4_16b_bf16 v[84:87], v[102:103], a[186:187], 0
  v_cvt_pk_bf16_f32 v88, v88, v89
  v_cvt_pk_bf16_f32 v90, v90, v91
  v_mfma_f32_16x16x32_bf16 v[40:43], a[64:67], a[208:211], v[40:43]
  ds_read_b64_tr_b16 a[160:161], v104 offset:32
  v_cvt_pk_bf16_f32 v92, v92, v93
  v_accvgpr_write_b32 a80, v88
  v_mfma_f32_16x16x32_bf16 v[64:67], a[64:67], a[212:215], v[64:67]
  ds_read_b64_tr_b16 a[162:163], v104 offset:800
  v_cvt_pk_bf16_f32 v94, v94, v95
  v_accvgpr_write_b32 a81, v90
  v_accvgpr_write_b32 a82, v92
  v_accvgpr_write_b32 a83, v94
  s_waitcnt lgkmcnt(9)
  v_and_b32 v96, v19, v96
  v_and_b32 v97, v20, v97
  v_mfma_f32_4x4x4_16b_bf16 v[88:91], v[100:101], a[188:189], 0
  v_mfma_f32_4x4x4_16b_bf16 v[92:95], v[102:103], a[190:191], 0
  v_and_b32 v98, v19, v98
  v_and_b32 v99, v20, v99
  v_mfma_f32_16x16x32_bf16 v[44:47], a[68:71], a[208:211], v[44:47]
  ds_read_b64_tr_b16 a[164:165], v104 offset:40
  v_cvt_pk_bf16_f32 v72, v72, v73
  v_cvt_pk_bf16_f32 v74, v74, v75
  v_mfma_f32_16x16x32_bf16 v[68:71], a[68:71], a[212:215], v[68:71]
  ds_read_b64_tr_b16 a[166:167], v104 offset:808
  v_cvt_pk_bf16_f32 v76, v76, v77
  v_accvgpr_write_b32 a84, v72
  v_cvt_pk_bf16_f32 v78, v78, v79
  v_accvgpr_write_b32 a85, v74
  v_accvgpr_write_b32 a86, v76
  v_accvgpr_write_b32 a87, v78
  v_mfma_f32_4x4x4_16b_bf16 v[72:75], v[96:97], a[144:145], 0
  v_mfma_f32_4x4x4_16b_bf16 v[76:79], v[98:99], a[146:147], 0
  v_cvt_pk_bf16_f32 v80, v80, v81
  v_cvt_pk_bf16_f32 v82, v82, v83
  s_waitcnt vmcnt(6)
  v_mfma_f32_16x16x32_bf16 v[24:27], a[72:75], a[192:195], v[24:27]
  ds_read_b64_tr_b16 a[168:169], v104 offset:24576
  ds_read_b64_tr_b16 a[170:171], v104 offset:25344
  v_cvt_pk_bf16_f32 v84, v84, v85
  s_add_u32 m0, s34, 0
  s_add_u32 s36, s36, 12288
  v_mfma_f32_16x16x32_bf16 v[48:51], a[72:75], a[196:199], v[48:51]
  buffer_load_dwordx4 v14, s[12:15], s36 offen offset:0 lds
  buffer_load_dwordx4 v15, s[12:15], s36 offen offset:1024 lds
  v_accvgpr_write_b32 a88, v80
  v_cvt_pk_bf16_f32 v86, v86, v87
  v_accvgpr_write_b32 a89, v82
  v_accvgpr_write_b32 a90, v84
  v_accvgpr_write_b32 a91, v86
  s_waitcnt lgkmcnt(12)
  v_mfma_f32_4x4x4_16b_bf16 v[80:83], v[96:97], a[148:149], 0
  v_mfma_f32_4x4x4_16b_bf16 v[84:87], v[98:99], a[150:151], 0
  v_cvt_pk_bf16_f32 v88, v88, v89
  v_cvt_pk_bf16_f32 v90, v90, v91
  v_mfma_f32_16x16x32_bf16 v[28:31], a[76:79], a[192:195], v[28:31]
  ds_read_b64_tr_b16 a[172:173], v104 offset:24584
  ds_read_b128 v[100:103], v18 offset:320
  v_cvt_pk_bf16_f32 v92, v92, v93
  v_mfma_f32_16x16x32_bf16 v[52:55], a[76:79], a[196:199], v[52:55]
  ds_read_b64_tr_b16 a[174:175], v104 offset:25352
  buffer_load_dwordx4 v16, s[12:15], s36 offen offset:2048 lds
  s_add_u32 m0, s34, 3072
  s_add_u32 s36, s36, 12288
  buffer_load_dwordx4 v14, s[12:15], s36 offen offset:0 lds
  v_accvgpr_write_b32 a92, v88
  v_cvt_pk_bf16_f32 v94, v94, v95
  v_accvgpr_write_b32 a93, v90
  v_accvgpr_write_b32 a94, v92
  v_accvgpr_write_b32 a95, v94
  s_waitcnt lgkmcnt(12)
  v_mfma_f32_4x4x4_16b_bf16 v[88:91], v[96:97], a[152:153], 0
  v_mfma_f32_4x4x4_16b_bf16 v[92:95], v[98:99], a[154:155], 0
  v_cvt_pk_bf16_f32 v72, v72, v73
  v_cvt_pk_bf16_f32 v74, v74, v75
  v_mfma_f32_16x16x32_bf16 v[32:35], a[80:83], a[192:195], v[32:35]
  ds_read_b64_tr_b16 a[176:177], v104 offset:24592
  ds_read_b128 a[208:211], v8 offset:256
  v_cvt_pk_bf16_f32 v76, v76, v77
  v_mfma_f32_16x16x32_bf16 v[56:59], a[80:83], a[196:199], v[56:59]
  ds_read_b64_tr_b16 a[178:179], v104 offset:25360
  buffer_load_dwordx4 v15, s[12:15], s36 offen offset:1024 lds
  buffer_load_dwordx4 v16, s[12:15], s36 offen offset:2048 lds
  v_accvgpr_write_b32 a96, v72
  v_cvt_pk_bf16_f32 v78, v78, v79
  v_accvgpr_write_b32 a97, v74
  v_accvgpr_write_b32 a98, v76
  v_accvgpr_write_b32 a99, v78
  s_waitcnt lgkmcnt(12)
  v_mfma_f32_4x4x4_16b_bf16 v[72:75], v[96:97], a[156:157], 0
  v_mfma_f32_4x4x4_16b_bf16 v[76:79], v[98:99], a[158:159], 0
  v_cvt_pk_bf16_f32 v80, v80, v81
  v_cvt_pk_bf16_f32 v82, v82, v83
  v_mfma_f32_16x16x32_bf16 v[36:39], a[84:87], a[192:195], v[36:39]
  ds_read_b64_tr_b16 a[180:181], v104 offset:24600
  ds_read_b128 a[212:215], v8 offset:12544
  v_cvt_pk_bf16_f32 v84, v84, v85
  s_add_u32 m0, s34, 24576
  s_add_u32 s36, s36, 12288
  v_mfma_f32_16x16x32_bf16 v[60:63], a[84:87], a[196:199], v[60:63]
  ds_read_b64_tr_b16 a[182:183], v104 offset:25368
  buffer_load_dwordx4 v14, s[12:15], s36 offen offset:0 lds
  buffer_load_dwordx4 v15, s[12:15], s36 offen offset:1024 lds
  v_accvgpr_write_b32 a100, v80
  v_cvt_pk_bf16_f32 v86, v86, v87
  v_accvgpr_write_b32 a101, v82
  v_accvgpr_write_b32 a102, v84
  v_accvgpr_write_b32 a103, v86
  s_waitcnt lgkmcnt(13)
  v_mfma_f32_4x4x4_16b_bf16 v[80:83], v[96:97], a[160:161], 0
  v_mfma_f32_4x4x4_16b_bf16 v[84:87], v[98:99], a[162:163], 0
  v_cvt_pk_bf16_f32 v88, v88, v89
  v_cvt_pk_bf16_f32 v90, v90, v91
  v_mfma_f32_16x16x32_bf16 v[40:43], a[88:91], a[192:195], v[40:43]
  ds_read_b64_tr_b16 a[184:185], v104 offset:24608
  ds_read_b64_tr_b16 a[186:187], v104 offset:25376
  v_cvt_pk_bf16_f32 v92, v92, v93
  v_accvgpr_write_b32 a104, v88
  v_mfma_f32_16x16x32_bf16 v[64:67], a[88:91], a[196:199], v[64:67]
  buffer_load_dwordx4 v16, s[12:15], s36 offen offset:2048 lds
  s_add_u32 m0, s34, 27648
  s_add_u32 s36, s36, 12288
  buffer_load_dwordx4 v14, s[12:15], s36 offen offset:0 lds
  v_cvt_pk_bf16_f32 v94, v94, v95
  v_accvgpr_write_b32 a105, v90
  v_accvgpr_write_b32 a106, v92
  v_accvgpr_write_b32 a107, v94
  s_waitcnt lgkmcnt(9)
  v_and_b32 v100, v19, v100
  v_and_b32 v101, v20, v101
  v_mfma_f32_4x4x4_16b_bf16 v[88:91], v[96:97], a[164:165], 0
  v_mfma_f32_4x4x4_16b_bf16 v[92:95], v[98:99], a[166:167], 0
  v_and_b32 v102, v19, v102
  v_and_b32 v103, v20, v103
  v_mfma_f32_16x16x32_bf16 v[44:47], a[92:95], a[192:195], v[44:47]
  ds_read_b64_tr_b16 a[188:189], v104 offset:24616
  ds_read_b64_tr_b16 a[190:191], v104 offset:25384
  v_cvt_pk_bf16_f32 v72, v72, v73
  v_cvt_pk_bf16_f32 v74, v74, v75
  v_mfma_f32_16x16x32_bf16 v[68:71], a[92:95], a[196:199], v[68:71]
  buffer_load_dwordx4 v15, s[12:15], s36 offen offset:1024 lds
  buffer_load_dwordx4 v16, s[12:15], s36 offen offset:2048 lds
  v_cvt_pk_bf16_f32 v76, v76, v77
  v_accvgpr_write_b32 a108, v72
  v_cvt_pk_bf16_f32 v78, v78, v79
  v_accvgpr_write_b32 a109, v74
  v_accvgpr_write_b32 a110, v76
  v_accvgpr_write_b32 a111, v78
  v_mfma_f32_4x4x4_16b_bf16 v[72:75], v[100:101], a[168:169], 0
  v_mfma_f32_4x4x4_16b_bf16 v[76:79], v[102:103], a[170:171], 0
  v_cvt_pk_bf16_f32 v80, v80, v81
  v_cvt_pk_bf16_f32 v82, v82, v83
  s_waitcnt vmcnt(6)
  v_mfma_f32_16x16x32_bf16 v[24:27], a[96:99], a[200:203], v[24:27]
  ds_read_b64_tr_b16 a[144:145], v17 offset:0
  ds_read_b64_tr_b16 a[146:147], v17 offset:768
  v_cvt_pk_bf16_f32 v84, v84, v85
  s_add_u32 m0, s34, 49152
  s_add_u32 s36, s36, 12288
  v_mfma_f32_16x16x32_bf16 v[48:51], a[96:99], a[204:207], v[48:51]
  buffer_load_dwordx4 v14, s[12:15], s36 offen offset:0 lds
  buffer_load_dwordx4 v15, s[12:15], s36 offen offset:1024 lds
  v_accvgpr_write_b32 a112, v80
  v_cvt_pk_bf16_f32 v86, v86, v87
  v_accvgpr_write_b32 a113, v82
  v_accvgpr_write_b32 a114, v84
  v_accvgpr_write_b32 a115, v86
  s_waitcnt lgkmcnt(12)
  v_mfma_f32_4x4x4_16b_bf16 v[80:83], v[100:101], a[172:173], 0
  v_mfma_f32_4x4x4_16b_bf16 v[84:87], v[102:103], a[174:175], 0
  v_cvt_pk_bf16_f32 v88, v88, v89
  v_cvt_pk_bf16_f32 v90, v90, v91
  v_mfma_f32_16x16x32_bf16 v[28:31], a[100:103], a[200:203], v[28:31]
  ds_read_b64_tr_b16 a[148:149], v17 offset:8
  ds_read_b128 v[96:99], v18 offset:384
  v_cvt_pk_bf16_f32 v92, v92, v93
  v_mfma_f32_16x16x32_bf16 v[52:55], a[100:103], a[204:207], v[52:55]
  ds_read_b64_tr_b16 a[150:151], v17 offset:776
  buffer_load_dwordx4 v16, s[12:15], s36 offen offset:2048 lds
  s_add_u32 m0, s34, 52224
  s_add_u32 s36, s36, 12288
  buffer_load_dwordx4 v14, s[12:15], s36 offen offset:0 lds
  v_accvgpr_write_b32 a116, v88
  v_cvt_pk_bf16_f32 v94, v94, v95
  v_accvgpr_write_b32 a117, v90
  v_accvgpr_write_b32 a118, v92
  v_accvgpr_write_b32 a119, v94
  s_waitcnt lgkmcnt(12)
  v_mfma_f32_4x4x4_16b_bf16 v[88:91], v[100:101], a[176:177], 0
  v_mfma_f32_4x4x4_16b_bf16 v[92:95], v[102:103], a[178:179], 0
  v_cvt_pk_bf16_f32 v72, v72, v73
  v_cvt_pk_bf16_f32 v74, v74, v75
  v_mfma_f32_16x16x32_bf16 v[32:35], a[104:107], a[200:203], v[32:35]
  ds_read_b64_tr_b16 a[152:153], v17 offset:16
  ds_read_b128 a[192:195], v9 offset:256
  v_cvt_pk_bf16_f32 v76, v76, v77
  v_mfma_f32_16x16x32_bf16 v[56:59], a[104:107], a[204:207], v[56:59]
  ds_read_b64_tr_b16 a[154:155], v17 offset:784
  buffer_load_dwordx4 v15, s[12:15], s36 offen offset:1024 lds
  buffer_load_dwordx4 v16, s[12:15], s36 offen offset:2048 lds
  v_accvgpr_write_b32 a120, v72
  v_cvt_pk_bf16_f32 v78, v78, v79
  v_accvgpr_write_b32 a121, v74
  v_accvgpr_write_b32 a122, v76
  v_accvgpr_write_b32 a123, v78
  s_waitcnt lgkmcnt(12)
  v_mfma_f32_4x4x4_16b_bf16 v[72:75], v[100:101], a[180:181], 0
  v_mfma_f32_4x4x4_16b_bf16 v[76:79], v[102:103], a[182:183], 0
  v_cvt_pk_bf16_f32 v80, v80, v81
  v_cvt_pk_bf16_f32 v82, v82, v83
  v_mfma_f32_16x16x32_bf16 v[36:39], a[108:111], a[200:203], v[36:39]
  ds_read_b64_tr_b16 a[156:157], v17 offset:24
  ds_read_b128 a[196:199], v9 offset:12544
  v_cvt_pk_bf16_f32 v84, v84, v85
  s_add_u32 m0, s34, 73728
  s_add_u32 s36, s36, 12288
  s_waitcnt lgkmcnt(10)
  v_mfma_f32_16x16x32_bf16 v[60:63], a[108:111], a[204:207], v[60:63]
  ds_read_b64_tr_b16 a[158:159], v17 offset:792
  buffer_load_dwordx4 v14, s[12:15], s36 offen offset:0 lds
  buffer_load_dwordx4 v15, s[12:15], s36 offen offset:1024 lds
  v_accvgpr_write_b32 a124, v80
  v_cvt_pk_bf16_f32 v86, v86, v87
  v_accvgpr_write_b32 a125, v82
  v_accvgpr_write_b32 a126, v84
  v_accvgpr_write_b32 a127, v86
  v_mfma_f32_4x4x4_16b_bf16 v[80:83], v[100:101], a[184:185], 0
  v_mfma_f32_4x4x4_16b_bf16 v[84:87], v[102:103], a[186:187], 0
  v_cvt_pk_bf16_f32 v88, v88, v89
  v_cvt_pk_bf16_f32 v90, v90, v91
  v_mfma_f32_16x16x32_bf16 v[40:43], a[112:115], a[200:203], v[40:43]
  ds_read_b64_tr_b16 a[160:161], v17 offset:32
  ds_read_b64_tr_b16 a[162:163], v17 offset:800
  v_cvt_pk_bf16_f32 v92, v92, v93
  v_accvgpr_write_b32 a128, v88
  v_mfma_f32_16x16x32_bf16 v[64:67], a[112:115], a[204:207], v[64:67]
  buffer_load_dwordx4 v16, s[12:15], s36 offen offset:2048 lds
  s_add_u32 m0, s34, 76800
  s_add_u32 s36, s36, 12288
  buffer_load_dwordx4 v14, s[12:15], s36 offen offset:0 lds
  v_cvt_pk_bf16_f32 v94, v94, v95
  v_accvgpr_write_b32 a129, v90
  v_accvgpr_write_b32 a130, v92
  v_accvgpr_write_b32 a131, v94
  s_waitcnt lgkmcnt(9)
  v_and_b32 v96, v19, v96
  v_and_b32 v97, v20, v97
  v_mfma_f32_4x4x4_16b_bf16 v[88:91], v[100:101], a[188:189], 0
  v_mfma_f32_4x4x4_16b_bf16 v[92:95], v[102:103], a[190:191], 0
  v_and_b32 v98, v19, v98
  v_and_b32 v99, v20, v99
  v_mfma_f32_16x16x32_bf16 v[44:47], a[116:119], a[200:203], v[44:47]
  ds_read_b64_tr_b16 a[164:165], v17 offset:40
  ds_read_b64_tr_b16 a[166:167], v17 offset:808
  v_cvt_pk_bf16_f32 v72, v72, v73
  v_cvt_pk_bf16_f32 v74, v74, v75
  v_mfma_f32_16x16x32_bf16 v[68:71], a[116:119], a[204:207], v[68:71]
  buffer_load_dwordx4 v15, s[12:15], s36 offen offset:1024 lds
  buffer_load_dwordx4 v16, s[12:15], s36 offen offset:2048 lds
  v_cvt_pk_bf16_f32 v76, v76, v77
  v_accvgpr_write_b32 a132, v72
  v_cvt_pk_bf16_f32 v78, v78, v79
  v_accvgpr_write_b32 a133, v74
  v_accvgpr_write_b32 a134, v76
  v_accvgpr_write_b32 a135, v78
  v_mfma_f32_4x4x4_16b_bf16 v[72:75], v[96:97], a[144:145], 0
  v_mfma_f32_4x4x4_16b_bf16 v[76:79], v[98:99], a[146:147], 0
  v_cvt_pk_bf16_f32 v80, v80, v81
  v_cvt_pk_bf16_f32 v82, v82, v83
  s_waitcnt vmcnt(12)
  v_mfma_f32_16x16x32_bf16 v[24:27], a[120:123], a[208:211], v[24:27]
  ds_read_b64_tr_b16 a[168:169], v17 offset:24576
  v_cvt_pk_bf16_f32 v84, v84, v85
  s_add_u32 m0, s34, 0
  s_add_u32 s36, s36, 12288
  s_waitcnt lgkmcnt(1)
  v_mfma_f32_16x16x32_bf16 v[48:51], a[120:123], a[212:215], v[48:51]
  ds_read_b64_tr_b16 a[170:171], v17 offset:25344
  buffer_load_dwordx4 v14, s[12:15], s36 offen offset:0 lds
  v_accvgpr_write_b32 a136, v80
  v_cvt_pk_bf16_f32 v86, v86, v87
  v_accvgpr_write_b32 a137, v82
  v_accvgpr_write_b32 a138, v84
  v_accvgpr_write_b32 a139, v86
  v_mfma_f32_4x4x4_16b_bf16 v[80:83], v[96:97], a[148:149], 0
  v_mfma_f32_4x4x4_16b_bf16 v[84:87], v[98:99], a[150:151], 0
  v_cvt_pk_bf16_f32 v88, v88, v89
  v_cvt_pk_bf16_f32 v90, v90, v91
  v_mfma_f32_16x16x32_bf16 v[28:31], a[124:127], a[208:211], v[28:31]
  ds_read_b64_tr_b16 a[172:173], v17 offset:24584
  ds_read_b128 v[100:103], v18 offset:448
  v_cvt_pk_bf16_f32 v92, v92, v93
  v_mfma_f32_16x16x32_bf16 v[52:55], a[124:127], a[212:215], v[52:55]
  ds_read_b64_tr_b16 a[174:175], v17 offset:25352
  buffer_load_dwordx4 v15, s[12:15], s36 offen offset:1024 lds
  v_accvgpr_write_b32 a140, v88
  v_cvt_pk_bf16_f32 v94, v94, v95
  v_accvgpr_write_b32 a141, v90
  v_accvgpr_write_b32 a142, v92
  v_accvgpr_write_b32 a143, v94
  v_mfma_f32_4x4x4_16b_bf16 v[88:91], v[96:97], a[152:153], 0
  v_mfma_f32_4x4x4_16b_bf16 v[92:95], v[98:99], a[154:155], 0
  v_cvt_pk_bf16_f32 v112, v72, v73
  v_cvt_pk_bf16_f32 v113, v74, v75
  v_mfma_f32_16x16x32_bf16 v[32:35], a[128:131], a[208:211], v[32:35]
  ds_read_b64_tr_b16 a[176:177], v17 offset:24592
  ds_read_b128 a[200:203], v10 offset:256
  v_cvt_pk_bf16_f32 v114, v76, v77
  v_mfma_f32_16x16x32_bf16 v[56:59], a[128:131], a[212:215], v[56:59]
  ds_read_b64_tr_b16 a[178:179], v17 offset:25360
  buffer_load_dwordx4 v16, s[12:15], s36 offen offset:2048 lds
  v_cvt_pk_bf16_f32 v115, v78, v79
  v_mfma_f32_4x4x4_16b_bf16 v[72:75], v[96:97], a[156:157], 0
  v_mfma_f32_4x4x4_16b_bf16 v[76:79], v[98:99], a[158:159], 0
  v_cvt_pk_bf16_f32 v116, v80, v81
  v_cvt_pk_bf16_f32 v117, v82, v83
  v_mfma_f32_16x16x32_bf16 v[36:39], a[132:135], a[208:211], v[36:39]
  ds_read_b64_tr_b16 a[180:181], v17 offset:24600
  ds_read_b128 a[204:207], v10 offset:12544
  v_cvt_pk_bf16_f32 v118, v84, v85
  s_add_u32 m0, s34, 3072
  s_add_u32 s36, s36, 12288
  v_mfma_f32_16x16x32_bf16 v[60:63], a[132:135], a[212:215], v[60:63]
  ds_read_b64_tr_b16 a[182:183], v17 offset:25368
  buffer_load_dwordx4 v14, s[12:15], s36 offen offset:0 lds
  v_cvt_pk_bf16_f32 v119, v86, v87
  v_mfma_f32_4x4x4_16b_bf16 v[80:83], v[96:97], a[160:161], 0
  v_mfma_f32_4x4x4_16b_bf16 v[84:87], v[98:99], a[162:163], 0
  v_cvt_pk_bf16_f32 v120, v88, v89
  v_cvt_pk_bf16_f32 v121, v90, v91
  v_mfma_f32_16x16x32_bf16 v[40:43], a[136:139], a[208:211], v[40:43]
  ds_read_b64_tr_b16 a[184:185], v17 offset:24608
  v_cvt_pk_bf16_f32 v122, v92, v93
  v_mfma_f32_16x16x32_bf16 v[64:67], a[136:139], a[212:215], v[64:67]
  ds_read_b64_tr_b16 a[186:187], v17 offset:25376
  buffer_load_dwordx4 v15, s[12:15], s36 offen offset:1024 lds
  v_cvt_pk_bf16_f32 v123, v94, v95
  s_waitcnt lgkmcnt(9)
  v_and_b32 v100, v19, v100
  v_and_b32 v101, v20, v101
  v_mfma_f32_4x4x4_16b_bf16 v[88:91], v[96:97], a[164:165], 0
  v_mfma_f32_4x4x4_16b_bf16 v[92:95], v[98:99], a[166:167], 0
  v_and_b32 v102, v19, v102
  v_and_b32 v103, v20, v103
  v_mfma_f32_16x16x32_bf16 v[44:47], a[140:143], a[208:211], v[44:47]
  ds_read_b64_tr_b16 a[188:189], v17 offset:24616
  v_cvt_pk_bf16_f32 v124, v72, v73
  v_mfma_f32_16x16x32_bf16 v[68:71], a[140:143], a[212:215], v[68:71]
  ds_read_b64_tr_b16 a[190:191], v17 offset:25384
  buffer_load_dwordx4 v16, s[12:15], s36 offen offset:2048 lds
  v_cvt_pk_bf16_f32 v125, v74, v75
  v_cvt_pk_bf16_f32 v126, v76, v77
  v_cvt_pk_bf16_f32 v127, v78, v79
  v_mfma_f32_4x4x4_16b_bf16 v[72:75], v[100:101], a[168:169], 0
  v_mfma_f32_4x4x4_16b_bf16 v[76:79], v[102:103], a[170:171], 0
  v_cvt_pk_bf16_f32 v128, v80, v81
  v_cvt_pk_bf16_f32 v129, v82, v83
  s_waitcnt vmcnt(12)
  v_mfma_f32_16x16x32_bf16 v[24:27], v[112:115], a[192:195], v[24:27]
  ds_read_b64_tr_b16 a[144:145], v104 offset:0
  v_cvt_pk_bf16_f32 v130, v84, v85
  s_add_u32 m0, s34, 24576
  s_add_u32 s36, s36, 12288
  s_waitcnt lgkmcnt(1)
  v_mfma_f32_16x16x32_bf16 v[48:51], v[112:115], a[196:199], v[48:51]
  ds_read_b64_tr_b16 a[146:147], v104 offset:768
  buffer_load_dwordx4 v14, s[12:15], s36 offen offset:0 lds
  v_cvt_pk_bf16_f32 v131, v86, v87
  v_mfma_f32_4x4x4_16b_bf16 v[80:83], v[100:101], a[172:173], 0
  v_mfma_f32_4x4x4_16b_bf16 v[84:87], v[102:103], a[174:175], 0
  v_cvt_pk_bf16_f32 v132, v88, v89
  v_cvt_pk_bf16_f32 v133, v90, v91
  v_mfma_f32_16x16x32_bf16 v[28:31], v[116:119], a[192:195], v[28:31]
  ds_read_b64_tr_b16 a[148:149], v104 offset:8
  ds_read_b128 v[96:99], v18 offset:512
  v_cvt_pk_bf16_f32 v134, v92, v93
  v_mfma_f32_16x16x32_bf16 v[52:55], v[116:119], a[196:199], v[52:55]
  ds_read_b64_tr_b16 a[150:151], v104 offset:776
  buffer_load_dwordx4 v15, s[12:15], s36 offen offset:1024 lds
  v_cvt_pk_bf16_f32 v135, v94, v95
  v_mfma_f32_4x4x4_16b_bf16 v[88:91], v[100:101], a[176:177], 0
  v_mfma_f32_4x4x4_16b_bf16 v[92:95], v[102:103], a[178:179], 0
  v_cvt_pk_bf16_f32 v136, v72, v73
  v_cvt_pk_bf16_f32 v137, v74, v75
  v_mfma_f32_16x16x32_bf16 v[32:35], v[120:123], a[192:195], v[32:35]
  ds_read_b64_tr_b16 a[152:153], v104 offset:16
  ds_read_b128 a[208:211], v7 offset:512
  v_cvt_pk_bf16_f32 v138, v76, v77
  v_mfma_f32_16x16x32_bf16 v[56:59], v[120:123], a[196:199], v[56:59]
  ds_read_b64_tr_b16 a[154:155], v104 offset:784
  buffer_load_dwordx4 v16, s[12:15], s36 offen offset:2048 lds
  v_cvt_pk_bf16_f32 v139, v78, v79
  v_mfma_f32_4x4x4_16b_bf16 v[72:75], v[100:101], a[180:181], 0
  v_mfma_f32_4x4x4_16b_bf16 v[76:79], v[102:103], a[182:183], 0
  v_cvt_pk_bf16_f32 v140, v80, v81
  v_cvt_pk_bf16_f32 v141, v82, v83
  v_mfma_f32_16x16x32_bf16 v[36:39], v[124:127], a[192:195], v[36:39]
  ds_read_b64_tr_b16 a[156:157], v104 offset:24
  ds_read_b128 a[212:215], v7 offset:12800
  v_cvt_pk_bf16_f32 v142, v84, v85
  s_add_u32 m0, s34, 27648
  s_add_u32 s36, s36, 12288
  v_mfma_f32_16x16x32_bf16 v[60:63], v[124:127], a[196:199], v[60:63]
  ds_read_b64_tr_b16 a[158:159], v104 offset:792
  buffer_load_dwordx4 v14, s[12:15], s36 offen offset:0 lds
  v_cvt_pk_bf16_f32 v143, v86, v87
  v_mfma_f32_4x4x4_16b_bf16 v[80:83], v[100:101], a[184:185], 0
  v_mfma_f32_4x4x4_16b_bf16 v[84:87], v[102:103], a[186:187], 0
  v_cvt_pk_bf16_f32 v144, v88, v89
  v_cvt_pk_bf16_f32 v145, v90, v91
  v_mfma_f32_16x16x32_bf16 v[40:43], v[128:131], a[192:195], v[40:43]
  ds_read_b64_tr_b16 a[160:161], v104 offset:32
  v_cvt_pk_bf16_f32 v146, v92, v93
  v_mfma_f32_16x16x32_bf16 v[64:67], v[128:131], a[196:199], v[64:67]
  ds_read_b64_tr_b16 a[162:163], v104 offset:800
  buffer_load_dwordx4 v15, s[12:15], s36 offen offset:1024 lds
  v_cvt_pk_bf16_f32 v147, v94, v95
  s_waitcnt lgkmcnt(9)
  v_and_b32 v96, v19, v96
  v_and_b32 v97, v20, v97
  v_mfma_f32_4x4x4_16b_bf16 v[88:91], v[100:101], a[188:189], 0
  v_mfma_f32_4x4x4_16b_bf16 v[92:95], v[102:103], a[190:191], 0
  v_and_b32 v98, v19, v98
  v_and_b32 v99, v20, v99
  v_mfma_f32_16x16x32_bf16 v[44:47], v[132:135], a[192:195], v[44:47]
  ds_read_b64_tr_b16 a[164:165], v104 offset:40
  v_cvt_pk_bf16_f32 v148, v72, v73
  v_mfma_f32_16x16x32_bf16 v[68:71], v[132:135], a[196:199], v[68:71]
  ds_read_b64_tr_b16 a[166:167], v104 offset:808
  buffer_load_dwordx4 v16, s[12:15], s36 offen offset:2048 lds
  v_cvt_pk_bf16_f32 v149, v74, v75
  v_cvt_pk_bf16_f32 v150, v76, v77
  v_cvt_pk_bf16_f32 v151, v78, v79
  s_waitcnt lgkmcnt(0)
  s_barrier
  v_mfma_f32_4x4x4_16b_bf16 v[72:75], v[96:97], a[144:145], 0
  v_mfma_f32_4x4x4_16b_bf16 v[76:79], v[98:99], a[146:147], 0
  v_cvt_pk_bf16_f32 v152, v80, v81
  v_cvt_pk_bf16_f32 v153, v82, v83
  s_waitcnt vmcnt(12)
  v_mfma_f32_16x16x32_bf16 v[24:27], v[136:139], a[200:203], v[24:27]
  ds_read_b64_tr_b16 a[168:169], v104 offset:24576
  v_cvt_pk_bf16_f32 v154, v84, v85
  s_add_u32 m0, s33, 49152
  v_mfma_f32_16x16x32_bf16 v[48:51], v[136:139], a[204:207], v[48:51]
  ds_read_b64_tr_b16 a[170:171], v104 offset:25344
  buffer_load_dwordx4 v1, s[4:7], s21 offen nt lds
  v_cvt_pk_bf16_f32 v155, v86, v87
  v_mfma_f32_4x4x4_16b_bf16 v[80:83], v[96:97], a[148:149], 0
  v_mfma_f32_4x4x4_16b_bf16 v[84:87], v[98:99], a[150:151], 0
  v_cvt_pk_bf16_f32 v156, v88, v89
  v_cvt_pk_bf16_f32 v157, v90, v91
  v_mfma_f32_16x16x32_bf16 v[28:31], v[140:143], a[200:203], v[28:31]
  ds_read_b64_tr_b16 a[172:173], v104 offset:24584
  ds_read_b128 v[100:103], v18 offset:576
  v_cvt_pk_bf16_f32 v158, v92, v93
  s_add_u32 m0, s33, 53248
  v_mfma_f32_16x16x32_bf16 v[52:55], v[140:143], a[204:207], v[52:55]
  ds_read_b64_tr_b16 a[174:175], v104 offset:25352
  buffer_load_dwordx4 v2, s[4:7], s21 offen nt lds
  v_cvt_pk_bf16_f32 v159, v94, v95
  v_mfma_f32_4x4x4_16b_bf16 v[88:91], v[96:97], a[152:153], 0
  v_mfma_f32_4x4x4_16b_bf16 v[92:95], v[98:99], a[154:155], 0
  v_cvt_pk_bf16_f32 v160, v72, v73
  v_cvt_pk_bf16_f32 v161, v74, v75
  v_mfma_f32_16x16x32_bf16 v[32:35], v[144:147], a[200:203], v[32:35]
  ds_read_b64_tr_b16 a[176:177], v104 offset:24592
  ds_read_b128 a[192:195], v8 offset:512
  v_cvt_pk_bf16_f32 v162, v76, v77
  s_add_u32 m0, s33, 57344
  v_mfma_f32_16x16x32_bf16 v[56:59], v[144:147], a[204:207], v[56:59]
  ds_read_b64_tr_b16 a[178:179], v104 offset:25360
  buffer_load_dwordx4 v3, s[4:7], s21 offen nt lds
  v_cvt_pk_bf16_f32 v163, v78, v79
  v_mfma_f32_4x4x4_16b_bf16 v[72:75], v[96:97], a[156:157], 0
  v_mfma_f32_4x4x4_16b_bf16 v[76:79], v[98:99], a[158:159], 0
  v_cvt_pk_bf16_f32 v164, v80, v81
  v_cvt_pk_bf16_f32 v165, v82, v83
  v_mfma_f32_16x16x32_bf16 v[36:39], v[148:151], a[200:203], v[36:39]
  ds_read_b64_tr_b16 a[180:181], v104 offset:24600
  ds_read_b128 a[196:199], v8 offset:12800
  v_cvt_pk_bf16_f32 v166, v84, v85
  s_add_u32 m0, s33, 61440
  s_add_u32 s21, s21, 6291456
  v_mfma_f32_16x16x32_bf16 v[60:63], v[148:151], a[204:207], v[60:63]
  ds_read_b64_tr_b16 a[182:183], v104 offset:25368
  buffer_load_dwordx4 v1, s[4:7], s37 offen nt lds
  v_cvt_pk_bf16_f32 v167, v86, v87
  v_mfma_f32_4x4x4_16b_bf16 v[80:83], v[96:97], a[160:161], 0
  v_mfma_f32_4x4x4_16b_bf16 v[84:87], v[98:99], a[162:163], 0
  v_cvt_pk_bf16_f32 v168, v88, v89
  v_cvt_pk_bf16_f32 v169, v90, v91
  v_mfma_f32_16x16x32_bf16 v[40:43], v[152:155], a[200:203], v[40:43]
  ds_read_b64_tr_b16 a[184:185], v104 offset:24608
  v_cvt_pk_bf16_f32 v170, v92, v93
  s_add_u32 m0, s33, 65536
  v_mfma_f32_16x16x32_bf16 v[64:67], v[152:155], a[204:207], v[64:67]
  ds_read_b64_tr_b16 a[186:187], v104 offset:25376
  buffer_load_dwordx4 v2, s[4:7], s37 offen nt lds
  v_cvt_pk_bf16_f32 v171, v94, v95
  s_waitcnt lgkmcnt(9)
  v_and_b32 v100, v19, v100
  v_and_b32 v101, v20, v101
  v_mfma_f32_4x4x4_16b_bf16 v[88:91], v[96:97], a[164:165], 0
  v_mfma_f32_4x4x4_16b_bf16 v[92:95], v[98:99], a[166:167], 0
  v_and_b32 v102, v19, v102
  v_and_b32 v103, v20, v103
  v_mfma_f32_16x16x32_bf16 v[44:47], v[156:159], a[200:203], v[44:47]
  ds_read_b64_tr_b16 a[188:189], v104 offset:24616
  v_cvt_pk_bf16_f32 v172, v72, v73
  s_add_u32 m0, s33, 69632
  v_mfma_f32_16x16x32_bf16 v[68:71], v[156:159], a[204:207], v[68:71]
  ds_read_b64_tr_b16 a[190:191], v104 offset:25384
  buffer_load_dwordx4 v3, s[4:7], s37 offen nt lds
  s_add_u32 s37, s37, 6291456
  v_cvt_pk_bf16_f32 v173, v74, v75
  v_cvt_pk_bf16_f32 v174, v76, v77
  v_cvt_pk_bf16_f32 v175, v78, v79
  s_waitcnt lgkmcnt(0)
  s_barrier
  v_mfma_f32_4x4x4_16b_bf16 v[72:75], v[100:101], a[168:169], 0
  v_mfma_f32_4x4x4_16b_bf16 v[76:79], v[102:103], a[170:171], 0
  v_cvt_pk_bf16_f32 v176, v80, v81
  v_cvt_pk_bf16_f32 v177, v82, v83
  s_waitcnt vmcnt(12)
  v_mfma_f32_16x16x32_bf16 v[24:27], v[160:163], a[208:211], v[24:27]
  ds_read_b64_tr_b16 a[144:145], v17 offset:0
  v_cvt_pk_bf16_f32 v178, v84, v85
  s_add_u32 m0, s33, 73728
  v_mfma_f32_16x16x32_bf16 v[48:51], v[160:163], a[212:215], v[48:51]
  ds_read_b64_tr_b16 a[146:147], v17 offset:768
  buffer_load_dwordx4 v1, s[4:7], s21 offen nt lds
  v_cvt_pk_bf16_f32 v179, v86, v87
  v_mfma_f32_4x4x4_16b_bf16 v[80:83], v[100:101], a[172:173], 0
  v_mfma_f32_4x4x4_16b_bf16 v[84:87], v[102:103], a[174:175], 0
  v_cvt_pk_bf16_f32 v180, v88, v89
  v_cvt_pk_bf16_f32 v181, v90, v91
  v_mfma_f32_16x16x32_bf16 v[28:31], v[164:167], a[208:211], v[28:31]
  ds_read_b64_tr_b16 a[148:149], v17 offset:8
  ds_read_b128 v[96:99], v18 offset:640
  v_cvt_pk_bf16_f32 v182, v92, v93
  s_add_u32 m0, s33, 77824
  v_mfma_f32_16x16x32_bf16 v[52:55], v[164:167], a[212:215], v[52:55]
  ds_read_b64_tr_b16 a[150:151], v17 offset:776
  buffer_load_dwordx4 v2, s[4:7], s21 offen nt lds
  v_cvt_pk_bf16_f32 v183, v94, v95
  v_mfma_f32_4x4x4_16b_bf16 v[88:91], v[100:101], a[176:177], 0
  v_mfma_f32_4x4x4_16b_bf16 v[92:95], v[102:103], a[178:179], 0
  v_cvt_pk_bf16_f32 v184, v72, v73
  v_cvt_pk_bf16_f32 v185, v74, v75
  v_mfma_f32_16x16x32_bf16 v[32:35], v[168:171], a[208:211], v[32:35]
  ds_read_b64_tr_b16 a[152:153], v17 offset:16
  ds_read_b128 a[200:203], v9 offset:512
  v_cvt_pk_bf16_f32 v186, v76, v77
  s_add_u32 m0, s33, 81920
  v_mfma_f32_16x16x32_bf16 v[56:59], v[168:171], a[212:215], v[56:59]
  ds_read_b64_tr_b16 a[154:155], v17 offset:784
  buffer_load_dwordx4 v3, s[4:7], s21 offen nt lds
  v_cvt_pk_bf16_f32 v187, v78, v79
  v_mfma_f32_4x4x4_16b_bf16 v[72:75], v[100:101], a[180:181], 0
  v_mfma_f32_4x4x4_16b_bf16 v[76:79], v[102:103], a[182:183], 0
  v_cvt_pk_bf16_f32 v188, v80, v81
  v_cvt_pk_bf16_f32 v189, v82, v83
  v_mfma_f32_16x16x32_bf16 v[36:39], v[172:175], a[208:211], v[36:39]
  ds_read_b64_tr_b16 a[156:157], v17 offset:24
  ds_read_b128 a[204:207], v9 offset:12800
  v_cvt_pk_bf16_f32 v190, v84, v85
  s_add_u32 m0, s33, 86016
  s_add_u32 s21, s21, 6291456
  v_mfma_f32_16x16x32_bf16 v[60:63], v[172:175], a[212:215], v[60:63]
  ds_read_b64_tr_b16 a[158:159], v17 offset:792
  buffer_load_dwordx4 v1, s[4:7], s37 offen nt lds
  v_cvt_pk_bf16_f32 v191, v86, v87
  v_mfma_f32_4x4x4_16b_bf16 v[80:83], v[100:101], a[184:185], 0
  v_mfma_f32_4x4x4_16b_bf16 v[84:87], v[102:103], a[186:187], 0
  v_cvt_pk_bf16_f32 v192, v88, v89
  v_cvt_pk_bf16_f32 v193, v90, v91
  v_mfma_f32_16x16x32_bf16 v[40:43], v[176:179], a[208:211], v[40:43]
  ds_read_b64_tr_b16 a[160:161], v17 offset:32
  v_cvt_pk_bf16_f32 v194, v92, v93
  s_add_u32 m0, s33, 90112
  v_mfma_f32_16x16x32_bf16 v[64:67], v[176:179], a[212:215], v[64:67]
  ds_read_b64_tr_b16 a[162:163], v17 offset:800
  buffer_load_dwordx4 v2, s[4:7], s37 offen nt lds
  v_cvt_pk_bf16_f32 v195, v94, v95
  s_waitcnt lgkmcnt(9)
  v_and_b32 v96, v19, v96
  v_and_b32 v97, v20, v97
  v_mfma_f32_4x4x4_16b_bf16 v[88:91], v[100:101], a[188:189], 0
  v_mfma_f32_4x4x4_16b_bf16 v[92:95], v[102:103], a[190:191], 0
  v_and_b32 v98, v19, v98
  v_and_b32 v99, v20, v99
  v_mfma_f32_16x16x32_bf16 v[44:47], v[180:183], a[208:211], v[44:47]
  ds_read_b64_tr_b16 a[164:165], v17 offset:40
  v_cvt_pk_bf16_f32 v196, v72, v73
  s_add_u32 m0, s33, 94208
  v_mfma_f32_16x16x32_bf16 v[68:71], v[180:183], a[212:215], v[68:71]
  ds_read_b64_tr_b16 a[166:167], v17 offset:808
  buffer_load_dwordx4 v3, s[4:7], s37 offen nt lds
  s_add_u32 s37, s37, 6291456
  v_cvt_pk_bf16_f32 v197, v74, v75
  v_cvt_pk_bf16_f32 v198, v76, v77
  v_cvt_pk_bf16_f32 v199, v78, v79
  v_mfma_f32_4x4x4_16b_bf16 v[72:75], v[96:97], a[144:145], 0
  v_mfma_f32_4x4x4_16b_bf16 v[76:79], v[98:99], a[146:147], 0
  v_cvt_pk_bf16_f32 v200, v80, v81
  v_cvt_pk_bf16_f32 v201, v82, v83
  s_waitcnt vmcnt(12)
  v_mfma_f32_16x16x32_bf16 v[24:27], v[184:187], a[192:195], v[24:27]
  ds_read_b64_tr_b16 a[168:169], v17 offset:24576
  v_cvt_pk_bf16_f32 v202, v84, v85
  v_mfma_f32_16x16x32_bf16 v[48:51], v[184:187], a[196:199], v[48:51]
  ds_read_b64_tr_b16 a[170:171], v17 offset:25344
  v_cvt_pk_bf16_f32 v203, v86, v87
  s_waitcnt lgkmcnt(12)
  v_mfma_f32_4x4x4_16b_bf16 v[80:83], v[96:97], a[148:149], 0
  v_mfma_f32_4x4x4_16b_bf16 v[84:87], v[98:99], a[150:151], 0
  v_cvt_pk_bf16_f32 v204, v88, v89
  v_cvt_pk_bf16_f32 v205, v90, v91
  v_mfma_f32_16x16x32_bf16 v[28:31], v[188:191], a[192:195], v[28:31]
  ds_read_b64_tr_b16 a[172:173], v17 offset:24584
  v_cvt_pk_bf16_f32 v206, v92, v93
  v_mfma_f32_16x16x32_bf16 v[52:55], v[188:191], a[196:199], v[52:55]
  ds_read_b128 v[100:103], v18 offset:704
  ds_read_b64_tr_b16 a[174:175], v17 offset:25352
  v_cvt_pk_bf16_f32 v207, v94, v95
  s_waitcnt lgkmcnt(12)
  v_mfma_f32_4x4x4_16b_bf16 v[88:91], v[96:97], a[152:153], 0
  v_mfma_f32_4x4x4_16b_bf16 v[92:95], v[98:99], a[154:155], 0
  v_cvt_pk_bf16_f32 v208, v72, v73
  v_cvt_pk_bf16_f32 v209, v74, v75
  v_mfma_f32_16x16x32_bf16 v[32:35], v[192:195], a[192:195], v[32:35]
  ds_read_b64_tr_b16 a[176:177], v17 offset:24592
  v_cvt_pk_bf16_f32 v210, v76, v77
  v_mfma_f32_16x16x32_bf16 v[56:59], v[192:195], a[196:199], v[56:59]
  ds_read_b128 a[208:211], v10 offset:512
  ds_read_b64_tr_b16 a[178:179], v17 offset:25360
  v_cvt_pk_bf16_f32 v211, v78, v79
  s_waitcnt lgkmcnt(12)
  v_mfma_f32_4x4x4_16b_bf16 v[72:75], v[96:97], a[156:157], 0
  v_mfma_f32_4x4x4_16b_bf16 v[76:79], v[98:99], a[158:159], 0
  v_cvt_pk_bf16_f32 v212, v80, v81
  v_cvt_pk_bf16_f32 v213, v82, v83
  v_mfma_f32_16x16x32_bf16 v[36:39], v[196:199], a[192:195], v[36:39]
  ds_read_b64_tr_b16 a[180:181], v17 offset:24600
  v_cvt_pk_bf16_f32 v214, v84, v85
  v_mfma_f32_16x16x32_bf16 v[60:63], v[196:199], a[196:199], v[60:63]
  ds_read_b128 a[212:215], v10 offset:12800
  ds_read_b64_tr_b16 a[182:183], v17 offset:25368
  v_cvt_pk_bf16_f32 v215, v86, v87
  s_waitcnt lgkmcnt(13)
  v_mfma_f32_4x4x4_16b_bf16 v[80:83], v[96:97], a[160:161], 0
  v_mfma_f32_4x4x4_16b_bf16 v[84:87], v[98:99], a[162:163], 0
  v_cvt_pk_bf16_f32 v216, v88, v89
  v_cvt_pk_bf16_f32 v217, v90, v91
  v_mfma_f32_16x16x32_bf16 v[40:43], v[200:203], a[192:195], v[40:43]
  ds_read_b64_tr_b16 a[184:185], v17 offset:24608
  v_cvt_pk_bf16_f32 v218, v92, v93
  v_mfma_f32_16x16x32_bf16 v[64:67], v[200:203], a[196:199], v[64:67]
  ds_read_b64_tr_b16 a[186:187], v17 offset:25376
  v_cvt_pk_bf16_f32 v219, v94, v95
  s_waitcnt lgkmcnt(9)
  v_and_b32 v100, v19, v100
  v_and_b32 v101, v20, v101
  v_mfma_f32_4x4x4_16b_bf16 v[88:91], v[96:97], a[164:165], 0
  v_mfma_f32_4x4x4_16b_bf16 v[92:95], v[98:99], a[166:167], 0
  v_and_b32 v102, v19, v102
  v_and_b32 v103, v20, v103
  v_mfma_f32_16x16x32_bf16 v[44:47], v[204:207], a[192:195], v[44:47]
  ds_read_b64_tr_b16 a[188:189], v17 offset:24616
  v_cvt_pk_bf16_f32 v220, v72, v73
  v_mfma_f32_16x16x32_bf16 v[68:71], v[204:207], a[196:199], v[68:71]
  ds_read_b64_tr_b16 a[190:191], v17 offset:25384
  v_cvt_pk_bf16_f32 v221, v74, v75
  v_cvt_pk_bf16_f32 v222, v76, v77
  v_cvt_pk_bf16_f32 v223, v78, v79
  v_mfma_f32_4x4x4_16b_bf16 v[72:75], v[100:101], a[168:169], 0
  v_mfma_f32_4x4x4_16b_bf16 v[76:79], v[102:103], a[170:171], 0
  v_cvt_pk_bf16_f32 v224, v80, v81
  v_cvt_pk_bf16_f32 v225, v82, v83
  v_mfma_f32_16x16x32_bf16 v[24:27], v[208:211], a[200:203], v[24:27]
  v_cvt_pk_bf16_f32 v226, v84, v85
  v_mfma_f32_16x16x32_bf16 v[48:51], v[208:211], a[204:207], v[48:51]
  v_cvt_pk_bf16_f32 v227, v86, v87
  s_waitcnt lgkmcnt(10)
  v_mfma_f32_4x4x4_16b_bf16 v[80:83], v[100:101], a[172:173], 0
  v_mfma_f32_4x4x4_16b_bf16 v[84:87], v[102:103], a[174:175], 0
  v_cvt_pk_bf16_f32 v228, v88, v89
  v_cvt_pk_bf16_f32 v229, v90, v91
  v_mfma_f32_16x16x32_bf16 v[28:31], v[212:215], a[200:203], v[28:31]
  v_cvt_pk_bf16_f32 v230, v92, v93
  v_mfma_f32_16x16x32_bf16 v[52:55], v[212:215], a[204:207], v[52:55]
  v_cvt_pk_bf16_f32 v231, v94, v95
  s_waitcnt lgkmcnt(7)
  v_mfma_f32_4x4x4_16b_bf16 v[88:91], v[100:101], a[176:177], 0
  v_mfma_f32_4x4x4_16b_bf16 v[92:95], v[102:103], a[178:179], 0
  v_cvt_pk_bf16_f32 v232, v72, v73
  v_cvt_pk_bf16_f32 v233, v74, v75
  v_mfma_f32_16x16x32_bf16 v[32:35], v[216:219], a[200:203], v[32:35]
  v_cvt_pk_bf16_f32 v234, v76, v77
  v_mfma_f32_16x16x32_bf16 v[56:59], v[216:219], a[204:207], v[56:59]
  v_cvt_pk_bf16_f32 v235, v78, v79
  s_waitcnt lgkmcnt(4)
  v_mfma_f32_4x4x4_16b_bf16 v[72:75], v[100:101], a[180:181], 0
  v_mfma_f32_4x4x4_16b_bf16 v[76:79], v[102:103], a[182:183], 0
  v_cvt_pk_bf16_f32 v236, v80, v81
  v_cvt_pk_bf16_f32 v237, v82, v83
  v_mfma_f32_16x16x32_bf16 v[36:39], v[220:223], a[200:203], v[36:39]
  v_cvt_pk_bf16_f32 v238, v84, v85
  v_mfma_f32_16x16x32_bf16 v[60:63], v[220:223], a[204:207], v[60:63]
  v_cvt_pk_bf16_f32 v239, v86, v87
  s_waitcnt lgkmcnt(2)
  v_mfma_f32_4x4x4_16b_bf16 v[80:83], v[100:101], a[184:185], 0
  v_mfma_f32_4x4x4_16b_bf16 v[84:87], v[102:103], a[186:187], 0
  v_cvt_pk_bf16_f32 v240, v88, v89
  v_cvt_pk_bf16_f32 v241, v90, v91
  v_mfma_f32_16x16x32_bf16 v[40:43], v[224:227], a[200:203], v[40:43]
  v_cvt_pk_bf16_f32 v242, v92, v93
  v_mfma_f32_16x16x32_bf16 v[64:67], v[224:227], a[204:207], v[64:67]
  v_cvt_pk_bf16_f32 v243, v94, v95
  s_waitcnt lgkmcnt(0)
  v_mfma_f32_4x4x4_16b_bf16 v[88:91], v[100:101], a[188:189], 0
  v_mfma_f32_4x4x4_16b_bf16 v[92:95], v[102:103], a[190:191], 0
  v_cvt_pk_bf16_f32 v244, v72, v73
  v_cvt_pk_bf16_f32 v245, v74, v75
  v_mfma_f32_16x16x32_bf16 v[44:47], v[228:231], a[200:203], v[44:47]
  v_cvt_pk_bf16_f32 v246, v76, v77
  v_mfma_f32_16x16x32_bf16 v[68:71], v[228:231], a[204:207], v[68:71]
  v_cvt_pk_bf16_f32 v247, v78, v79
  v_mfma_f32_16x16x32_bf16 v[24:27], v[232:235], a[208:211], v[24:27]
  v_cvt_pk_bf16_f32 v248, v80, v81
  v_mfma_f32_16x16x32_bf16 v[48:51], v[232:235], a[212:215], v[48:51]
  v_cvt_pk_bf16_f32 v249, v82, v83
  v_cvt_pk_bf16_f32 v250, v84, v85
  v_cvt_pk_bf16_f32 v251, v86, v87
  v_mfma_f32_16x16x32_bf16 v[28:31], v[236:239], a[208:211], v[28:31]
  v_cvt_pk_bf16_f32 v252, v88, v89
  v_mfma_f32_16x16x32_bf16 v[52:55], v[236:239], a[212:215], v[52:55]
  v_cvt_pk_bf16_f32 v253, v90, v91
  v_cvt_pk_bf16_f32 v254, v92, v93
  v_cvt_pk_bf16_f32 v255, v94, v95
  v_mfma_f32_16x16x32_bf16 v[32:35], v[240:243], a[208:211], v[32:35]
  v_mfma_f32_16x16x32_bf16 v[56:59], v[240:243], a[212:215], v[56:59]
  v_mfma_f32_16x16x32_bf16 v[36:39], v[244:247], a[208:211], v[36:39]
  v_mfma_f32_16x16x32_bf16 v[60:63], v[244:247], a[212:215], v[60:63]
  v_mfma_f32_16x16x32_bf16 v[40:43], v[248:251], a[208:211], v[40:43]
  v_mfma_f32_16x16x32_bf16 v[64:67], v[248:251], a[212:215], v[64:67]
  v_mfma_f32_16x16x32_bf16 v[44:47], v[252:255], a[208:211], v[44:47]
  v_mfma_f32_16x16x32_bf16 v[68:71], v[252:255], a[212:215], v[68:71]
  s_barrier
  s_mov_b64 vcc, -1
  s_nop 4
  v_cvt_pk_bf16_f32 v24, v24, v25
  v_cvt_pk_bf16_f32 v25, v26, v27
  v_cvt_pk_bf16_f32 v26, v28, v29
  v_cvt_pk_bf16_f32 v27, v30, v31
  ds_write_b128 v11, v[24:27] offset:0
  v_cvt_pk_bf16_f32 v28, v32, v33
  v_cvt_pk_bf16_f32 v29, v34, v35
  v_cvt_pk_bf16_f32 v30, v36, v37
  v_cvt_pk_bf16_f32 v31, v38, v39
  ds_write_b128 v12, v[28:31] offset:0
  v_cvt_pk_bf16_f32 v32, v40, v41
  v_cvt_pk_bf16_f32 v33, v42, v43
  v_cvt_pk_bf16_f32 v34, v44, v45
  v_cvt_pk_bf16_f32 v35, v46, v47
  ds_write_b128 v13, v[32:35] offset:0
  s_waitcnt lgkmcnt(0)
  s_barrier
  ds_read_b128 a[192:195], v7 offset:24576
  ds_read_b128 a[196:199], v8 offset:24576
  ds_read_b128 a[216:219], v1 offset:0
  ds_read_b128 a[220:223], v2 offset:0
  ds_read_b128 a[224:227], v3 offset:0
  ds_read_b128 a[200:203], v9 offset:24576
  ds_read_b128 a[204:207], v10 offset:24576
  ds_read_b128 a[228:231], v1 offset:12288
  ds_read_b128 a[232:235], v2 offset:12288
  ds_read_b128 a[236:239], v3 offset:12288
  s_xor_b32 s42, s42, 0x14000
  s_add_u32 m0, s42, 0
  s_nop 0
  buffer_load_dwordx4 v1, s[4:7], s21 offen nt lds
  s_waitcnt lgkmcnt(8)
.p2align 6
L_loop0:
  v_mfma_f32_16x16x32_bf16 v[24:27], a[0:3], a[192:195], 0
  ds_read_b128 a[208:211], v7 offset:24832
  v_mfma_f32_16x16x32_bf16 v[24:27], a[24:27], a[196:199], v[24:27]
  ds_read_b128 a[212:215], v8 offset:24832
  v_mfma_f32_16x16x32_bf16 v[28:31], a[4:7], a[192:195], 0
  v_mfma_f32_16x16x32_bf16 v[28:31], a[28:31], a[196:199], v[28:31]
  v_mfma_f32_16x16x32_bf16 v[32:35], a[8:11], a[192:195], 0
  v_mfma_f32_16x16x32_bf16 v[32:35], a[32:35], a[196:199], v[32:35]
  v_mfma_f32_16x16x32_bf16 v[36:39], a[12:15], a[192:195], 0
  v_mfma_f32_16x16x32_bf16 v[36:39], a[36:39], a[196:199], v[36:39]
  v_mfma_f32_16x16x32_bf16 v[40:43], a[16:19], a[192:195], 0
  s_waitcnt lgkmcnt(9)
  buffer_store_dwordx4 a[216:219], v4, s[8:11], s22 offen sc1
  v_mfma_f32_16x16x32_bf16 v[40:43], a[40:43], a[196:199], v[40:43]
  s_waitcnt lgkmcnt(8)
  buffer_store_dwordx4 a[220:223], v5, s[8:11], s22 offen sc1
  s_waitcnt lgkmcnt(7)
  buffer_store_dwordx4 a[224:227], v6, s[8:11], s22 offen sc1
  v_mfma_f32_16x16x32_bf16 v[44:47], a[20:23], a[192:195], 0
  v_mfma_f32_16x16x32_bf16 v[44:47], a[44:47], a[196:199], v[44:47]
  s_waitcnt lgkmcnt(5)
  v_mfma_f32_16x16x32_bf16 v[24:27], a[48:51], a[200:203], v[24:27]
  ds_read_b128 a[192:195], v9 offset:24832
  v_mfma_f32_16x16x32_bf16 v[24:27], a[72:75], a[204:207], v[24:27]
  ds_read_b128 a[196:199], v10 offset:24832
  v_mfma_f32_16x16x32_bf16 v[28:31], a[52:55], a[200:203], v[28:31]
  v_cvt_pk_bf16_f32 v48, v48, v49
  v_mfma_f32_16x16x32_bf16 v[28:31], a[76:79], a[204:207], v[28:31]
  v_cvt_pk_bf16_f32 v49, v50, v51
  v_mfma_f32_16x16x32_bf16 v[32:35], a[56:59], a[200:203], v[32:35]
  v_cvt_pk_bf16_f32 v50, v52, v53
  v_mfma_f32_16x16x32_bf16 v[32:35], a[80:83], a[204:207], v[32:35]
  v_cvt_pk_bf16_f32 v51, v54, v55
  v_mfma_f32_16x16x32_bf16 v[36:39], a[60:63], a[200:203], v[36:39]
  v_mfma_f32_16x16x32_bf16 v[36:39], a[84:87], a[204:207], v[36:39]
  s_add_u32 m0, s42, 4096
  v_mfma_f32_16x16x32_bf16 v[40:43], a[64:67], a[200:203], v[40:43]
  s_cbranch_vccz L_sk1
  buffer_load_dwordx4 v2, s[4:7], s21 offen nt lds
L_sk1:
  v_mfma_f32_16x16x32_bf16 v[40:43], a[88:91], a[204:207], v[40:43]
  v_mfma_f32_16x16x32_bf16 v[44:47], a[68:71], a[200:203], v[44:47]
  ds_write_b128 v11, v[48:51] offset:36864
  v_mfma_f32_16x16x32_bf16 v[44:47], a[92:95], a[204:207], v[44:47]
  s_waitcnt lgkmcnt(3)
  v_mfma_f32_16x16x32_bf16 v[24:27], a[96:99], a[208:211], v[24:27]
  ds_read_b128 a[200:203], v7 offset:25088
  v_mfma_f32_16x16x32_bf16 v[24:27], a[120:123], a[212:215], v[24:27]
  ds_read_b128 a[204:207], v8 offset:25088
  v_mfma_f32_16x16x32_bf16 v[28:31], a[100:103], a[208:211], v[28:31]
  v_cvt_pk_bf16_f32 v52, v56, v57
  v_mfma_f32_16x16x32_bf16 v[28:31], a[124:127], a[212:215], v[28:31]
  v_cvt_pk_bf16_f32 v53, v58, v59
  v_mfma_f32_16x16x32_bf16 v[32:35], a[104:107], a[208:211], v[32:35]
  v_cvt_pk_bf16_f32 v54, v60, v61
  v_mfma_f32_16x16x32_bf16 v[32:35], a[128:131], a[212:215], v[32:35]
  v_cvt_pk_bf16_f32 v55, v62, v63
  v_mfma_f32_16x16x32_bf16 v[36:39], a[108:111], a[208:211], v[36:39]
  ds_write_b128 v12, v[52:55] offset:36864
  v_mfma_f32_16x16x32_bf16 v[36:39], a[132:135], a[212:215], v[36:39]
  v_mfma_f32_16x16x32_bf16 v[40:43], a[112:115], a[208:211], v[40:43]
  v_mfma_f32_16x16x32_bf16 v[40:43], a[136:139], a[212:215], v[40:43]
  v_mfma_f32_16x16x32_bf16 v[44:47], a[116:119], a[208:211], v[44:47]
  v_mfma_f32_16x16x32_bf16 v[44:47], a[140:143], a[212:215], v[44:47]
  s_waitcnt lgkmcnt(4)
  v_mfma_f32_16x16x32_bf16 v[24:27], v[112:115], a[192:195], v[24:27]
  ds_read_b128 a[208:211], v9 offset:25088
  v_mfma_f32_16x16x32_bf16 v[24:27], v[136:139], a[196:199], v[24:27]
  ds_read_b128 a[212:215], v10 offset:25088
  v_mfma_f32_16x16x32_bf16 v[28:31], v[116:119], a[192:195], v[28:31]
  v_cvt_pk_bf16_f32 v56, v64, v65
  v_mfma_f32_16x16x32_bf16 v[28:31], v[140:143], a[196:199], v[28:31]
  v_cvt_pk_bf16_f32 v57, v66, v67
  v_mfma_f32_16x16x32_bf16 v[32:35], v[120:123], a[192:195], v[32:35]
  v_cvt_pk_bf16_f32 v58, v68, v69
  v_mfma_f32_16x16x32_bf16 v[32:35], v[144:147], a[196:199], v[32:35]
  v_cvt_pk_bf16_f32 v59, v70, v71
  v_mfma_f32_16x16x32_bf16 v[36:39], v[124:127], a[192:195], v[36:39]
  v_mfma_f32_16x16x32_bf16 v[36:39], v[148:151], a[196:199], v[36:39]
  s_add_u32 m0, s42, 8192
  v_mfma_f32_16x16x32_bf16 v[40:43], v[128:131], a[192:195], v[40:43]
  s_cbranch_vccz L_sk2
  buffer_load_dwordx4 v3, s[4:7], s21 offen nt lds
L_sk2:
  v_mfma_f32_16x16x32_bf16 v[40:43], v[152:155], a[196:199], v[40:43]
  v_mfma_f32_16x16x32_bf16 v[44:47], v[132:135], a[192:195], v[44:47]
  ds_write_b128 v13, v[56:59] offset:36864
  v_mfma_f32_16x16x32_bf16 v[44:47], v[156:159], a[196:199], v[44:47]
  s_waitcnt lgkmcnt(4)
  v_mfma_f32_16x16x32_bf16 v[24:27], v[160:163], a[200:203], v[24:27]
  ds_read_b128 a[192:195], v7 offset:36864
  v_mfma_f32_16x16x32_bf16 v[24:27], v[184:187], a[204:207], v[24:27]
  ds_read_b128 a[196:199], v8 offset:36864
  v_mfma_f32_16x16x32_bf16 v[28:31], v[164:167], a[200:203], v[28:31]
  v_mfma_f32_16x16x32_bf16 v[28:31], v[188:191], a[204:207], v[28:31]
  s_add_u32 s62, s62, s44
  s_sub_u32 s61, s61, 1
  v_mfma_f32_16x16x32_bf16 v[32:35], v[168:171], a[200:203], v[32:35]
  s_cmp_eq_u32 s61, 0
  s_cselect_b32 s55, s66, s55
  s_cselect_b32 s65, 128, s65
  v_mfma_f32_16x16x32_bf16 v[32:35], v[192:195], a[204:207], v[32:35]
  v_mfma_f32_16x16x32_bf16 v[36:39], v[172:175], a[200:203], v[36:39]
  v_mfma_f32_16x16x32_bf16 v[36:39], v[196:199], a[204:207], v[36:39]
  v_mfma_f32_16x16x32_bf16 v[40:43], v[176:179], a[200:203], v[40:43]
  v_mfma_f32_16x16x32_bf16 v[40:43], v[200:203], a[204:207], v[40:43]
  v_mfma_f32_16x16x32_bf16 v[44:47], v[180:183], a[200:203], v[44:47]
  v_mfma_f32_16x16x32_bf16 v[44:47], v[204:207], a[204:207], v[44:47]
  s_waitcnt lgkmcnt(3)
  v_mfma_f32_16x16x32_bf16 v[24:27], v[208:211], a[208:211], v[24:27]
  ds_read_b128 a[200:203], v9 offset:36864
  v_mfma_f32_16x16x32_bf16 v[24:27], v[232:235], a[212:215], v[24:27]
  ds_read_b128 a[204:207], v10 offset:36864
  v_mfma_f32_16x16x32_bf16 v[28:31], v[212:215], a[208:211], v[28:31]
  v_mfma_f32_16x16x32_bf16 v[28:31], v[236:239], a[212:215], v[28:31]
  v_mfma_f32_16x16x32_bf16 v[32:35], v[216:219], a[208:211], v[32:35]
  v_mfma_f32_16x16x32_bf16 v[32:35], v[240:243], a[212:215], v[32:35]
  v_mfma_f32_16x16x32_bf16 v[36:39], v[220:223], a[208:211], v[36:39]
  v_mfma_f32_16x16x32_bf16 v[36:39], v[244:247], a[212:215], v[36:39]
  s_add_u32 m0, s42, 12288
  v_mfma_f32_16x16x32_bf16 v[40:43], v[224:227], a[208:211], v[40:43]
  s_cbranch_vccz L_sk3
  buffer_load_dwordx4 v1, s[4:7], s37 offen nt lds
L_sk3:
  v_mfma_f32_16x16x32_bf16 v[40:43], v[248:251], a[212:215], v[40:43]
  v_mfma_f32_16x16x32_bf16 v[44:47], v[228:231], a[208:211], v[44:47]
  v_mfma_f32_16x16x32_bf16 v[44:47], v[252:255], a[212:215], v[44:47]
  s_waitcnt lgkmcnt(2)
  v_mfma_f32_16x16x32_bf16 v[48:51], a[0:3], a[192:195], 0
  ds_read_b128 a[208:211], v7 offset:37120
  v_mfma_f32_16x16x32_bf16 v[48:51], a[24:27], a[196:199], v[48:51]
  ds_read_b128 a[212:215], v8 offset:37120
  v_mfma_f32_16x16x32_bf16 v[52:55], a[4:7], a[192:195], 0
  v_cvt_pk_bf16_f32 v24, v24, v25
  v_mfma_f32_16x16x32_bf16 v[52:55], a[28:31], a[196:199], v[52:55]
  v_cvt_pk_bf16_f32 v25, v26, v27
  v_mfma_f32_16x16x32_bf16 v[56:59], a[8:11], a[192:195], 0
  v_cvt_pk_bf16_f32 v26, v28, v29
  v_mfma_f32_16x16x32_bf16 v[56:59], a[32:35], a[196:199], v[56:59]
  v_cvt_pk_bf16_f32 v27, v30, v31
  v_mfma_f32_16x16x32_bf16 v[60:63], a[12:15], a[192:195], 0
  ds_write_b128 v11, v[24:27] offset:24576
  v_mfma_f32_16x16x32_bf16 v[60:63], a[36:39], a[196:199], v[60:63]
  v_mfma_f32_16x16x32_bf16 v[64:67], a[16:19], a[192:195], 0
  buffer_store_dwordx4 a[228:231], v4, s[8:11], s23 offen sc1
  v_mfma_f32_16x16x32_bf16 v[64:67], a[40:43], a[196:199], v[64:67]
  buffer_store_dwordx4 a[232:235], v5, s[8:11], s23 offen sc1
  buffer_store_dwordx4 a[236:239], v6, s[8:11], s23 offen sc1
  v_mfma_f32_16x16x32_bf16 v[68:71], a[20:23], a[192:195], 0
  v_mfma_f32_16x16x32_bf16 v[68:71], a[44:47], a[196:199], v[68:71]
  s_waitcnt lgkmcnt(3)
  v_mfma_f32_16x16x32_bf16 v[48:51], a[48:51], a[200:203], v[48:51]
  ds_read_b128 a[192:195], v9 offset:37120
  v_mfma_f32_16x16x32_bf16 v[48:51], a[72:75], a[204:207], v[48:51]
  ds_read_b128 a[196:199], v10 offset:37120
  v_mfma_f32_16x16x32_bf16 v[52:55], a[52:55], a[200:203], v[52:55]
  v_cvt_pk_bf16_f32 v28, v32, v33
  v_mfma_f32_16x16x32_bf16 v[52:55], a[76:79], a[204:207], v[52:55]
  v_cvt_pk_bf16_f32 v29, v34, v35
  v_mfma_f32_16x16x32_bf16 v[56:59], a[56:59], a[200:203], v[56:59]
  v_cvt_pk_bf16_f32 v30, v36, v37
  v_mfma_f32_16x16x32_bf16 v[56:59], a[80:83], a[204:207], v[56:59]
  v_cvt_pk_bf16_f32 v31, v38, v39
  v_mfma_f32_16x16x32_bf16 v[60:63], a[60:63], a[200:203], v[60:63]
  v_mfma_f32_16x16x32_bf16 v[60:63], a[84:87], a[204:207], v[60:63]
  s_add_u32 m0, s42, 16384
  v_mfma_f32_16x16x32_bf16 v[64:67], a[64:67], a[200:203], v[64:67]
  s_cbranch_vccz L_sk4
  buffer_load_dwordx4 v2, s[4:7], s37 offen nt lds
L_sk4:
  v_mfma_f32_16x16x32_bf16 v[64:67], a[88:91], a[204:207], v[64:67]
  v_mfma_f32_16x16x32_bf16 v[68:71], a[68:71], a[200:203], v[68:71]
  ds_write_b128 v12, v[28:31] offset:24576
  v_mfma_f32_16x16x32_bf16 v[68:71], a[92:95], a[204:207], v[68:71]
  s_waitcnt lgkmcnt(4)
  v_mfma_f32_16x16x32_bf16 v[48:51], a[96:99], a[208:211], v[48:51]
  ds_read_b128 a[200:203], v7 offset:37376
  v_mfma_f32_16x16x32_bf16 v[48:51], a[120:123], a[212:215], v[48:51]
  ds_read_b128 a[204:207], v8 offset:37376
  v_mfma_f32_16x16x32_bf16 v[52:55], a[100:103], a[208:211], v[52:55]
  v_cvt_pk_bf16_f32 v32, v40, v41
  v_mfma_f32_16x16x32_bf16 v[52:55], a[124:127], a[212:215], v[52:55]
  v_cvt_pk_bf16_f32 v33, v42, v43
  v_mfma_f32_16x16x32_bf16 v[56:59], a[104:107], a[208:211], v[56:59]
  v_cvt_pk_bf16_f32 v34, v44, v45
  v_mfma_f32_16x16x32_bf16 v[56:59], a[128:131], a[212:215], v[56:59]
  v_cvt_pk_bf16_f32 v35, v46, v47
  v_mfma_f32_16x16x32_bf16 v[60:63], a[108:111], a[208:211], v[60:63]
  ds_write_b128 v13, v[32:35] offset:24576
  v_mfma_f32_16x16x32_bf16 v[60:63], a[132:135], a[212:215], v[60:63]
  v_mfma_f32_16x16x32_bf16 v[64:67], a[112:115], a[208:211], v[64:67]
  v_mfma_f32_16x16x32_bf16 v[64:67], a[136:139], a[212:215], v[64:67]
  v_mfma_f32_16x16x32_bf16 v[68:71], a[116:119], a[208:211], v[68:71]
  v_mfma_f32_16x16x32_bf16 v[68:71], a[140:143], a[212:215], v[68:71]
  s_waitcnt lgkmcnt(0)
  v_mfma_f32_16x16x32_bf16 v[48:51], v[112:115], a[192:195], v[48:51]
  ds_read_b128 a[208:211], v9 offset:37376
  v_mfma_f32_16x16x32_bf16 v[48:51], v[136:139], a[196:199], v[48:51]
  ds_read_b128 a[212:215], v10 offset:37376
  v_mfma_f32_16x16x32_bf16 v[52:55], v[116:119], a[192:195], v[52:55]
  s_mul_i32 s56, s54, 98304
  s_add_u32 s56, s56, s57
  v_mfma_f32_16x16x32_bf16 v[52:55], v[140:143], a[196:199], v[52:55]
  v_xor_b32 v7, 0x14000, v7
  s_cmp_lt_u32 s54, 128
  s_cselect_b32 s56, s56, s6
  v_mfma_f32_16x16x32_bf16 v[56:59], v[120:123], a[192:195], v[56:59]
  v_xor_b32 v8, 0x14000, v8
  s_cmp_ge_i32 s61, 0
  s_cselect_b32 s56, s62, s56
  v_mfma_f32_16x16x32_bf16 v[56:59], v[144:147], a[196:199], v[56:59]
  v_xor_b32 v9, 0x14000, v9
  v_mov_b32 v23, s56
  v_mfma_f32_16x16x32_bf16 v[60:63], v[124:127], a[192:195], v[60:63]
  v_xor_b32 v10, 0x14000, v10
  ds_write_b32 v106, v23 offset:4
  v_mfma_f32_16x16x32_bf16 v[60:63], v[148:151], a[196:199], v[60:63]
  s_add_u32 m0, s42, 20480
  v_mfma_f32_16x16x32_bf16 v[64:67], v[128:131], a[192:195], v[64:67]
  s_cbranch_vccz L_sk5
  buffer_load_dwordx4 v3, s[4:7], s37 offen nt lds
L_sk5:
  v_mfma_f32_16x16x32_bf16 v[64:67], v[152:155], a[196:199], v[64:67]
  s_add_u32 s23, s22, 12288
  s_mov_b32 s22, s58
  v_mfma_f32_16x16x32_bf16 v[68:71], v[132:135], a[192:195], v[68:71]
  s_mov_b32 s58, s59
  s_mov_b32 s59, s60
  v_mfma_f32_16x16x32_bf16 v[68:71], v[156:159], a[196:199], v[68:71]
  s_waitcnt vmcnt(18) lgkmcnt(0)
  s_cbranch_vccz L_ow6
L_ob6:
  s_barrier
  v_mfma_f32_16x16x32_bf16 v[48:51], v[160:163], a[200:203], v[48:51]
  ds_read_b128 a[192:195], v7 offset:0
  v_mfma_f32_16x16x32_bf16 v[48:51], v[184:187], a[204:207], v[48:51]
  ds_read_b128 a[196:199], v8 offset:0
  v_mfma_f32_16x16x32_bf16 v[52:55], v[164:167], a[200:203], v[52:55]
  ds_read_b128 a[216:219], v1 offset:24576
  v_mfma_f32_16x16x32_bf16 v[52:55], v[188:191], a[204:207], v[52:55]
  ds_read_b32 v107, v105 offset:4
  v_mfma_f32_16x16x32_bf16 v[56:59], v[168:171], a[200:203], v[56:59]
  ds_read_b128 a[220:223], v2 offset:24576
  v_mfma_f32_16x16x32_bf16 v[56:59], v[192:195], a[204:207], v[56:59]
  ds_read_b128 a[224:227], v3 offset:24576
  v_mfma_f32_16x16x32_bf16 v[60:63], v[172:175], a[200:203], v[60:63]
  s_mov_b32 s60, s21
  v_mfma_f32_16x16x32_bf16 v[60:63], v[196:199], a[204:207], v[60:63]
  s_cmp_lt_u32 s54, s55
  s_cselect_b32 s54, 1, s65
  s_cbranch_scc0 L_cl7
  s_atomic_add s54, s[52:53], 0 glc
L_cl7:
  v_mfma_f32_16x16x32_bf16 v[64:67], v[176:179], a[200:203], v[64:67]
  v_mfma_f32_16x16x32_bf16 v[64:67], v[200:203], a[204:207], v[64:67]
  s_waitcnt lgkmcnt(2)
  v_readfirstlane_b32 s21, v107
  v_mfma_f32_16x16x32_bf16 v[68:71], v[180:183], a[200:203], v[68:71]
  v_mfma_f32_16x16x32_bf16 v[68:71], v[204:207], a[204:207], v[68:71]
  v_mfma_f32_16x16x32_bf16 v[48:51], v[208:211], a[208:211], v[48:51]
  ds_read_b128 a[200:203], v9 offset:0
  s_cmp_lt_u32 s21, s6
  s_cselect_b64 vcc, -1, 0
  v_mfma_f32_16x16x32_bf16 v[48:51], v[232:235], a[212:215], v[48:51]
  ds_read_b128 a[204:207], v10 offset:0
  s_cselect_b32 s32, 5, s32
  s_add_u32 s37, s21, 12288
  v_mfma_f32_16x16x32_bf16 v[52:55], v[212:215], a[208:211], v[52:55]
  ds_read_b128 a[228:231], v1 offset:36864
  v_mfma_f32_16x16x32_bf16 v[52:55], v[236:239], a[212:215], v[52:55]
  ds_read_b128 a[232:235], v2 offset:36864
  v_mfma_f32_16x16x32_bf16 v[56:59], v[216:219], a[208:211], v[56:59]
  ds_read_b128 a[236:239], v3 offset:36864
  v_mfma_f32_16x16x32_bf16 v[56:59], v[240:243], a[212:215], v[56:59]
  v_mfma_f32_16x16x32_bf16 v[60:63], v[220:223], a[208:211], v[60:63]
  v_mfma_f32_16x16x32_bf16 v[60:63], v[244:247], a[212:215], v[60:63]
  s_add_u32 m0, s42, 24576
  v_mfma_f32_16x16x32_bf16 v[64:67], v[224:227], a[208:211], v[64:67]
  s_cbranch_vccz L_sk8
  buffer_load_dwordx4 v1, s[4:7], s21 offen nt lds
L_sk8:
  v_mfma_f32_16x16x32_bf16 v[64:67], v[248:251], a[212:215], v[64:67]
  v_mfma_f32_16x16x32_bf16 v[68:71], v[228:231], a[208:211], v[68:71]
  s_sub_u32 s32, s32, 1
  s_cmp_eq_u32 s32, 0
  v_mfma_f32_16x16x32_bf16 v[68:71], v[252:255], a[212:215], v[68:71]
  s_cbranch_scc1 L_tail0
L_mid0:
  v_mfma_f32_16x16x32_bf16 v[24:27], a[0:3], a[192:195], 0
  ds_read_b128 a[208:211], v7 offset:256
  v_mfma_f32_16x16x32_bf16 v[24:27], a[24:27], a[196:199], v[24:27]
  ds_read_b128 a[212:215], v8 offset:256
  v_mfma_f32_16x16x32_bf16 v[28:31], a[4:7], a[192:195], 0
  v_mfma_f32_16x16x32_bf16 v[28:31], a[28:31], a[196:199], v[28:31]
  v_mfma_f32_16x16x32_bf16 v[32:35], a[8:11], a[192:195], 0
  v_mfma_f32_16x16x32_bf16 v[32:35], a[32:35], a[196:199], v[32:35]
  v_mfma_f32_16x16x32_bf16 v[36:39], a[12:15], a[192:195], 0
  v_mfma_f32_16x16x32_bf16 v[36:39], a[36:39], a[196:199], v[36:39]
  v_mfma_f32_16x16x32_bf16 v[40:43], a[16:19], a[192:195], 0
  buffer_store_dwordx4 a[216:219], v4, s[8:11], s22 offen sc1
  v_mfma_f32_16x16x32_bf16 v[40:43], a[40:43], a[196:199], v[40:43]
  s_waitcnt lgkmcnt(8)
  buffer_store_dwordx4 a[220:223], v5, s[8:11], s22 offen sc1
  s_waitcnt lgkmcnt(7)
  buffer_store_dwordx4 a[224:227], v6, s[8:11], s22 offen sc1
  v_mfma_f32_16x16x32_bf16 v[44:47], a[20:23], a[192:195], 0
  v_mfma_f32_16x16x32_bf16 v[44:47], a[44:47], a[196:199], v[44:47]
  s_waitcnt lgkmcnt(5)
  v_mfma_f32_16x16x32_bf16 v[24:27], a[48:51], a[200:203], v[24:27]
  ds_read_b128 a[192:195], v9 offset:256
  v_mfma_f32_16x16x32_bf16 v[24:27], a[72:75], a[204:207], v[24:27]
  ds_read_b128 a[196:199], v10 offset:256
  v_mfma_f32_16x16x32_bf16 v[28:31], a[52:55], a[200:203], v[28:31]
  v_cvt_pk_bf16_f32 v48, v48, v49
  v_mfma_f32_16x16x32_bf16 v[28:31], a[76:79], a[204:207], v[28:31]
  v_cvt_pk_bf16_f32 v49, v50, v51
  v_mfma_f32_16x16x32_bf16 v[32:35], a[56:59], a[200:203], v[32:35]
  v_cvt_pk_bf16_f32 v50, v52, v53
  v_mfma_f32_16x16x32_bf16 v[32:35], a[80:83], a[204:207], v[32:35]
  v_cvt_pk_bf16_f32 v51, v54, v55
  v_mfma_f32_16x16x32_bf16 v[36:39], a[60:63], a[200:203], v[36:39]
  v_mfma_f32_16x16x32_bf16 v[36:39], a[84:87], a[204:207], v[36:39]
  s_add_u32 m0, s42, 28672
  v_mfma_f32_16x16x32_bf16 v[40:43], a[64:67], a[200:203], v[40:43]
  s_cbranch_vccz L_sk9
  buffer_load_dwordx4 v2, s[4:7], s21 offen nt lds
L_sk9:
  v_mfma_f32_16x16x32_bf16 v[40:43], a[88:91], a[204:207], v[40:43]
  v_mfma_f32_16x16x32_bf16 v[44:47], a[68:71], a[200:203], v[44:47]
  ds_write_b128 v11, v[48:51] offset:12288
  v_mfma_f32_16x16x32_bf16 v[44:47], a[92:95], a[204:207], v[44:47]
  s_waitcnt lgkmcnt(3)
  v_mfma_f32_16x16x32_bf16 v[24:27], a[96:99], a[208:211], v[24:27]
  ds_read_b128 a[200:203], v7 offset:512
  v_mfma_f32_16x16x32_bf16 v[24:27], a[120:123], a[212:215], v[24:27]
  ds_read_b128 a[204:207], v8 offset:512
  v_mfma_f32_16x16x32_bf16 v[28:31], a[100:103], a[208:211], v[28:31]
  v_cvt_pk_bf16_f32 v52, v56, v57
  v_mfma_f32_16x16x32_bf16 v[28:31], a[124:127], a[212:215], v[28:31]
  v_cvt_pk_bf16_f32 v53, v58, v59
  v_mfma_f32_16x16x32_bf16 v[32:35], a[104:107], a[208:211], v[32:35]
  v_cvt_pk_bf16_f32 v54, v60, v61
  v_mfma_f32_16x16x32_bf16 v[32:35], a[128:131], a[212:215], v[32:35]
  v_cvt_pk_bf16_f32 v55, v62, v63
  v_mfma_f32_16x16x32_bf16 v[36:39], a[108:111], a[208:211], v[36:39]
  ds_write_b128 v12, v[52:55] offset:12288
  v_mfma_f32_16x16x32_bf16 v[36:39], a[132:135], a[212:215], v[36:39]
  v_mfma_f32_16x16x32_bf16 v[40:43], a[112:115], a[208:211], v[40:43]
  v_mfma_f32_16x16x32_bf16 v[40:43], a[136:139], a[212:215], v[40:43]
  v_mfma_f32_16x16x32_bf16 v[44:47], a[116:119], a[208:211], v[44:47]
  v_mfma_f32_16x16x32_bf16 v[44:47], a[140:143], a[212:215], v[44:47]
  s_waitcnt lgkmcnt(4)
  v_mfma_f32_16x16x32_bf16 v[24:27], v[112:115], a[192:195], v[24:27]
  ds_read_b128 a[208:211], v9 offset:512
  v_mfma_f32_16x16x32_bf16 v[24:27], v[136:139], a[196:199], v[24:27]
  ds_read_b128 a[212:215], v10 offset:512
  v_mfma_f32_16x16x32_bf16 v[28:31], v[116:119], a[192:195], v[28:31]
  v_cvt_pk_bf16_f32 v56, v64, v65
  v_mfma_f32_16x16x32_bf16 v[28:31], v[140:143], a[196:199], v[28:31]
  v_cvt_pk_bf16_f32 v57, v66, v67
  v_mfma_f32_16x16x32_bf16 v[32:35], v[120:123], a[192:195], v[32:35]
  v_cvt_pk_bf16_f32 v58, v68, v69
  v_mfma_f32_16x16x32_bf16 v[32:35], v[144:147], a[196:199], v[32:35]
  v_cvt_pk_bf16_f32 v59, v70, v71
  v_mfma_f32_16x16x32_bf16 v[36:39], v[124:127], a[192:195], v[36:39]
  v_mfma_f32_16x16x32_bf16 v[36:39], v[148:151], a[196:199], v[36:39]
  s_add_u32 m0, s42, 32768
  v_mfma_f32_16x16x32_bf16 v[40:43], v[128:131], a[192:195], v[40:43]
  s_cbranch_vccz L_sk10
  buffer_load_dwordx4 v3, s[4:7], s21 offen nt lds
L_sk10:
  v_mfma_f32_16x16x32_bf16 v[40:43], v[152:155], a[196:199], v[40:43]
  v_mfma_f32_16x16x32_bf16 v[44:47], v[132:135], a[192:195], v[44:47]
  ds_write_b128 v13, v[56:59] offset:12288
  v_mfma_f32_16x16x32_bf16 v[44:47], v[156:159], a[196:199], v[44:47]
  s_waitcnt lgkmcnt(4)
  v_mfma_f32_16x16x32_bf16 v[24:27], v[160:163], a[200:203], v[24:27]
  ds_read_b128 a[192:195], v7 offset:12288
  v_mfma_f32_16x16x32_bf16 v[24:27], v[184:187], a[204:207], v[24:27]
  ds_read_b128 a[196:199], v8 offset:12288
  v_mfma_f32_16x16x32_bf16 v[28:31], v[164:167], a[200:203], v[28:31]
  v_mfma_f32_16x16x32_bf16 v[28:31], v[188:191], a[204:207], v[28:31]
  s_add_u32 s62, s62, s44
  s_sub_u32 s61, s61, 1
  v_mfma_f32_16x16x32_bf16 v[32:35], v[168:171], a[200:203], v[32:35]
  s_cmp_eq_u32 s61, 0
  s_cselect_b32 s55, s66, s55
  s_cselect_b32 s65, 128, s65
  v_mfma_f32_16x16x32_bf16 v[32:35], v[192:195], a[204:207], v[32:35]
  v_mfma_f32_16x16x32_bf16 v[36:39], v[172:175], a[200:203], v[36:39]
  v_mfma_f32_16x16x32_bf16 v[36:39], v[196:199], a[204:207], v[36:39]
  v_mfma_f32_16x16x32_bf16 v[40:43], v[176:179], a[200:203], v[40:43]
  v_mfma_f32_16x16x32_bf16 v[40:43], v[200:203], a[204:207], v[40:43]
  v_mfma_f32_16x16x32_bf16 v[44:47], v[180:183], a[200:203], v[44:47]
  v_mfma_f32_16x16x32_bf16 v[44:47], v[204:207], a[204:207], v[44:47]
  s_waitcnt lgkmcnt(3)
  v_mfma_f32_16x16x32_bf16 v[24:27], v[208:211], a[208:211], v[24:27]
  ds_read_b128 a[200:203], v9 offset:12288
  v_mfma_f32_16x16x32_bf16 v[24:27], v[232:235], a[212:215], v[24:27]
  ds_read_b128 a[204:207], v10 offset:12288
  v_mfma_f32_16x16x32_bf16 v[28:31], v[212:215], a[208:211], v[28:31]
  v_mfma_f32_16x16x32_bf16 v[28:31], v[236:239], a[212:215], v[28:31]
  v_mfma_f32_16x16x32_bf16 v[32:35], v[216:219], a[208:211], v[32:35]
  v_mfma_f32_16x16x32_bf16 v[32:35], v[240:243], a[212:215], v[32:35]
  v_mfma_f32_16x16x32_bf16 v[36:39], v[220:223], a[208:211], v[36:39]
  v_mfma_f32_16x16x32_bf16 v[36:39], v[244:247], a[212:215], v[36:39]
  s_add_u32 m0, s42, 36864
  v_mfma_f32_16x16x32_bf16 v[40:43], v[224:227], a[208:211], v[40:43]
  s_cbranch_vccz L_sk11
  buffer_load_dwordx4 v1, s[4:7], s37 offen nt lds
L_sk11:
  v_mfma_f32_16x16x32_bf16 v[40:43], v[248:251], a[212:215], v[40:43]
  v_mfma_f32_16x16x32_bf16 v[44:47], v[228:231], a[208:211], v[44:47]
  v_mfma_f32_16x16x32_bf16 v[44:47], v[252:255], a[212:215], v[44:47]
  s_waitcnt lgkmcnt(2)
  v_mfma_f32_16x16x32_bf16 v[48:51], a[0:3], a[192:195], 0
  ds_read_b128 a[208:211], v7 offset:12544
  v_mfma_f32_16x16x32_bf16 v[48:51], a[24:27], a[196:199], v[48:51]
  ds_read_b128 a[212:215], v8 offset:12544
  v_mfma_f32_16x16x32_bf16 v[52:55], a[4:7], a[192:195], 0
  v_cvt_pk_bf16_f32 v24, v24, v25
  v_mfma_f32_16x16x32_bf16 v[52:55], a[28:31], a[196:199], v[52:55]
  v_cvt_pk_bf16_f32 v25, v26, v27
  v_mfma_f32_16x16x32_bf16 v[56:59], a[8:11], a[192:195], 0
  v_cvt_pk_bf16_f32 v26, v28, v29
  v_mfma_f32_16x16x32_bf16 v[56:59], a[32:35], a[196:199], v[56:59]
  v_cvt_pk_bf16_f32 v27, v30, v31
  v_mfma_f32_16x16x32_bf16 v[60:63], a[12:15], a[192:195], 0
  ds_write_b128 v11, v[24:27] offset:0
  v_mfma_f32_16x16x32_bf16 v[60:63], a[36:39], a[196:199], v[60:63]
  v_mfma_f32_16x16x32_bf16 v[64:67], a[16:19], a[192:195], 0
  buffer_store_dwordx4 a[228:231], v4, s[8:11], s23 offen sc1
  v_mfma_f32_16x16x32_bf16 v[64:67], a[40:43], a[196:199], v[64:67]
  buffer_store_dwordx4 a[232:235], v5, s[8:11], s23 offen sc1
  buffer_store_dwordx4 a[236:239], v6, s[8:11], s23 offen sc1
  v_mfma_f32_16x16x32_bf16 v[68:71], a[20:23], a[192:195], 0
  v_mfma_f32_16x16x32_bf16 v[68:71], a[44:47], a[196:199], v[68:71]
  s_waitcnt lgkmcnt(3)
  v_mfma_f32_16x16x32_bf16 v[48:51], a[48:51], a[200:203], v[48:51]
  ds_read_b128 a[192:195], v9 offset:12544
  v_mfma_f32_16x16x32_bf16 v[48:51], a[72:75], a[204:207], v[48:51]
  ds_read_b128 a[196:199], v10 offset:12544
  v_mfma_f32_16x16x32_bf16 v[52:55], a[52:55], a[200:203], v[52:55]
  v_cvt_pk_bf16_f32 v28, v32, v33
  v_mfma_f32_16x16x32_bf16 v[52:55], a[76:79], a[204:207], v[52:55]
  v_cvt_pk_bf16_f32 v29, v34, v35
  v_mfma_f32_16x16x32_bf16 v[56:59], a[56:59], a[200:203], v[56:59]
  v_cvt_pk_bf16_f32 v30, v36, v37
  v_mfma_f32_16x16x32_bf16 v[56:59], a[80:83], a[204:207], v[56:59]
  v_cvt_pk_bf16_f32 v31, v38, v39
  v_mfma_f32_16x16x32_bf16 v[60:63], a[60:63], a[200:203], v[60:63]
  v_mfma_f32_16x16x32_bf16 v[60:63], a[84:87], a[204:207], v[60:63]
  s_add_u32 m0, s42, 40960
  v_mfma_f32_16x16x32_bf16 v[64:67], a[64:67], a[200:203], v[64:67]
  s_cbranch_vccz L_sk12
  buffer_load_dwordx4 v2, s[4:7], s37 offen nt lds
L_sk12:
  v_mfma_f32_16x16x32_bf16 v[64:67], a[88:91], a[204:207], v[64:67]
  v_mfma_f32_16x16x32_bf16 v[68:71], a[68:71], a[200:203], v[68:71]
  ds_write_b128 v12, v[28:31] offset:0
  v_mfma_f32_16x16x32_bf16 v[68:71], a[92:95], a[204:207], v[68:71]
  s_waitcnt lgkmcnt(4)
  v_mfma_f32_16x16x32_bf16 v[48:51], a[96:99], a[208:211], v[48:51]
  ds_read_b128 a[200:203], v7 offset:12800
  v_mfma_f32_16x16x32_bf16 v[48:51], a[120:123], a[212:215], v[48:51]
  ds_read_b128 a[204:207], v8 offset:12800
  v_mfma_f32_16x16x32_bf16 v[52:55], a[100:103], a[208:211], v[52:55]
  v_cvt_pk_bf16_f32 v32, v40, v41
  v_mfma_f32_16x16x32_bf16 v[52:55], a[124:127], a[212:215], v[52:55]
  v_cvt_pk_bf16_f32 v33, v42, v43
  v_mfma_f32_16x16x32_bf16 v[56:59], a[104:107], a[208:211], v[56:59]
  v_cvt_pk_bf16_f32 v34, v44, v45
  v_mfma_f32_16x16x32_bf16 v[56:59], a[128:131], a[212:215], v[56:59]
  v_cvt_pk_bf16_f32 v35, v46, v47
  v_mfma_f32_16x16x32_bf16 v[60:63], a[108:111], a[208:211], v[60:63]
  ds_write_b128 v13, v[32:35] offset:0
  v_mfma_f32_16x16x32_bf16 v[60:63], a[132:135], a[212:215], v[60:63]
  v_mfma_f32_16x16x32_bf16 v[64:67], a[112:115], a[208:211], v[64:67]
  v_mfma_f32_16x16x32_bf16 v[64:67], a[136:139], a[212:215], v[64:67]
  v_mfma_f32_16x16x32_bf16 v[68:71], a[116:119], a[208:211], v[68:71]
  v_mfma_f32_16x16x32_bf16 v[68:71], a[140:143], a[212:215], v[68:71]
  s_waitcnt lgkmcnt(0)
  v_mfma_f32_16x16x32_bf16 v[48:51], v[112:115], a[192:195], v[48:51]
  ds_read_b128 a[208:211], v9 offset:12800
  v_mfma_f32_16x16x32_bf16 v[48:51], v[136:139], a[196:199], v[48:51]
  ds_read_b128 a[212:215], v10 offset:12800
  v_mfma_f32_16x16x32_bf16 v[52:55], v[116:119], a[192:195], v[52:55]
  s_mul_i32 s56, s54, 98304
  s_add_u32 s56, s56, s57
  v_mfma_f32_16x16x32_bf16 v[52:55], v[140:143], a[196:199], v[52:55]
  s_cmp_lt_u32 s54, 128
  s_cselect_b32 s56, s56, s6
  v_mfma_f32_16x16x32_bf16 v[56:59], v[120:123], a[192:195], v[56:59]
  s_cmp_ge_i32 s61, 0
  s_cselect_b32 s56, s62, s56
  v_mfma_f32_16x16x32_bf16 v[56:59], v[144:147], a[196:199], v[56:59]
  v_mov_b32 v23, s56
  v_mfma_f32_16x16x32_bf16 v[60:63], v[124:127], a[192:195], v[60:63]
  ds_write_b32 v106, v23 offset:0
  v_mfma_f32_16x16x32_bf16 v[60:63], v[148:151], a[196:199], v[60:63]
  s_add_u32 m0, s42, 45056
  v_mfma_f32_16x16x32_bf16 v[64:67], v[128:131], a[192:195], v[64:67]
  s_cbranch_vccz L_sk13
  buffer_load_dwordx4 v3, s[4:7], s37 offen nt lds
L_sk13:
  v_mfma_f32_16x16x32_bf16 v[64:67], v[152:155], a[196:199], v[64:67]
  s_add_u32 s23, s22, 12288
  s_mov_b32 s22, s58
  v_mfma_f32_16x16x32_bf16 v[68:71], v[132:135], a[192:195], v[68:71]
  s_mov_b32 s58, s59
  s_mov_b32 s59, s60
  v_mfma_f32_16x16x32_bf16 v[68:71], v[156:159], a[196:199], v[68:71]
  s_waitcnt vmcnt(24) lgkmcnt(0)
  s_cbranch_vccz L_ow14
L_ob14:
  s_barrier
  v_mfma_f32_16x16x32_bf16 v[48:51], v[160:163], a[200:203], v[48:51]
  ds_read_b128 a[192:195], v7 offset:24576
  v_mfma_f32_16x16x32_bf16 v[48:51], v[184:187], a[204:207], v[48:51]
  ds_read_b128 a[196:199], v8 offset:24576
  v_mfma_f32_16x16x32_bf16 v[52:55], v[164:167], a[200:203], v[52:55]
  ds_read_b128 a[216:219], v1 offset:0
  v_mfma_f32_16x16x32_bf16 v[52:55], v[188:191], a[204:207], v[52:55]
  ds_read_b32 v107, v105 offset:0
  v_mfma_f32_16x16x32_bf16 v[56:59], v[168:171], a[200:203], v[56:59]
  ds_read_b128 a[220:223], v2 offset:0
  v_mfma_f32_16x16x32_bf16 v[56:59], v[192:195], a[204:207], v[56:59]
  ds_read_b128 a[224:227], v3 offset:0
  v_mfma_f32_16x16x32_bf16 v[60:63], v[172:175], a[200:203], v[60:63]
  s_mov_b32 s60, s21
  v_mfma_f32_16x16x32_bf16 v[60:63], v[196:199], a[204:207], v[60:63]
  s_cmp_lt_u32 s54, s55
  s_cselect_b32 s54, 1, s65
  s_cbranch_scc0 L_cl15
  s_atomic_add s54, s[52:53], 0 glc
L_cl15:
  v_mfma_f32_16x16x32_bf16 v[64:67], v[176:179], a[200:203], v[64:67]
  v_mfma_f32_16x16x32_bf16 v[64:67], v[200:203], a[204:207], v[64:67]
  s_waitcnt lgkmcnt(2)
  v_readfirstlane_b32 s21, v107
  v_mfma_f32_16x16x32_bf16 v[68:71], v[180:183], a[200:203], v[68:71]
  v_mfma_f32_16x16x32_bf16 v[68:71], v[204:207], a[204:207], v[68:71]
  v_mfma_f32_16x16x32_bf16 v[48:51], v[208:211], a[208:211], v[48:51]
  ds_read_b128 a[200:203], v9 offset:24576
  s_cmp_lt_u32 s21, s6
  s_cselect_b64 vcc, -1, 0
  v_mfma_f32_16x16x32_bf16 v[48:51], v[232:235], a[212:215], v[48:51]
  ds_read_b128 a[204:207], v10 offset:24576
  s_cselect_b32 s32, 5, s32
  s_add_u32 s37, s21, 12288
  v_mfma_f32_16x16x32_bf16 v[52:55], v[212:215], a[208:211], v[52:55]
  ds_read_b128 a[228:231], v1 offset:12288
  v_mfma_f32_16x16x32_bf16 v[52:55], v[236:239], a[212:215], v[52:55]
  ds_read_b128 a[232:235], v2 offset:12288
  v_mfma_f32_16x16x32_bf16 v[56:59], v[216:219], a[208:211], v[56:59]
  ds_read_b128 a[236:239], v3 offset:12288
  v_mfma_f32_16x16x32_bf16 v[56:59], v[240:243], a[212:215], v[56:59]
  v_mfma_f32_16x16x32_bf16 v[60:63], v[220:223], a[208:211], v[60:63]
  s_xor_b32 s42, s42, 0x14000
  v_mfma_f32_16x16x32_bf16 v[60:63], v[244:247], a[212:215], v[60:63]
  s_add_u32 m0, s42, 0
  v_mfma_f32_16x16x32_bf16 v[64:67], v[224:227], a[208:211], v[64:67]
  s_cbranch_vccz L_sk16
  buffer_load_dwordx4 v1, s[4:7], s21 offen nt lds
L_sk16:
  v_mfma_f32_16x16x32_bf16 v[64:67], v[248:251], a[212:215], v[64:67]
  v_mfma_f32_16x16x32_bf16 v[68:71], v[228:231], a[208:211], v[68:71]
  s_sub_u32 s32, s32, 1
  s_cmp_eq_u32 s32, 0
  v_mfma_f32_16x16x32_bf16 v[68:71], v[252:255], a[212:215], v[68:71]
  s_cbranch_scc0 L_loop0
L_tail1:
  s_nop 1
  v_cvt_pk_bf16_f32 v48, v48, v49
  v_cvt_pk_bf16_f32 v49, v50, v51
  v_cvt_pk_bf16_f32 v50, v52, v53
  v_cvt_pk_bf16_f32 v51, v54, v55
  ds_write_b128 v11, v[48:51] offset:36864
  v_cvt_pk_bf16_f32 v52, v56, v57
  v_cvt_pk_bf16_f32 v53, v58, v59
  v_cvt_pk_bf16_f32 v54, v60, v61
  v_cvt_pk_bf16_f32 v55, v62, v63
  ds_write_b128 v12, v[52:55] offset:36864
  v_cvt_pk_bf16_f32 v56, v64, v65
  v_cvt_pk_bf16_f32 v57, v66, v67
  v_cvt_pk_bf16_f32 v58, v68, v69
  v_cvt_pk_bf16_f32 v59, v70, v71
  ds_write_b128 v13, v[56:59] offset:36864
  buffer_store_dwordx4 a[216:219], v4, s[8:11], s22 offen sc1
  s_waitcnt lgkmcnt(9)
  buffer_store_dwordx4 a[220:223], v5, s[8:11], s22 offen sc1
  s_waitcnt lgkmcnt(0)
  s_barrier
  ds_read_b128 a[192:195], v1 offset:36864
  ds_read_b128 a[196:199], v2 offset:36864
  ds_read_b128 a[200:203], v3 offset:36864
  buffer_store_dwordx4 a[224:227], v6, s[8:11], s22 offen sc1
  buffer_store_dwordx4 a[228:231], v4, s[8:11], s23 offen sc1
  buffer_store_dwordx4 a[232:235], v5, s[8:11], s23 offen sc1
  buffer_store_dwordx4 a[236:239], v6, s[8:11], s23 offen sc1
  s_add_u32 s23, s22, 12288
  s_waitcnt lgkmcnt(2)
  buffer_store_dwordx4 a[192:195], v4, s[8:11], s23 offen sc1
  s_waitcnt lgkmcnt(1)
  buffer_store_dwordx4 a[196:199], v5, s[8:11], s23 offen sc1
  s_waitcnt lgkmcnt(0)
  buffer_store_dwordx4 a[200:203], v6, s[8:11], s23 offen sc1
  s_endpgm
L_tail0:
  s_nop 1
  v_cvt_pk_bf16_f32 v48, v48, v49
  v_cvt_pk_bf16_f32 v49, v50, v51
  v_cvt_pk_bf16_f32 v50, v52, v53
  v_cvt_pk_bf16_f32 v51, v54, v55
  ds_write_b128 v11, v[48:51] offset:12288
  v_cvt_pk_bf16_f32 v52, v56, v57
  v_cvt_pk_bf16_f32 v53, v58, v59
  v_cvt_pk_bf16_f32 v54, v60, v61
  v_cvt_pk_bf16_f32 v55, v62, v63
  ds_write_b128 v12, v[52:55] offset:12288
  v_cvt_pk_bf16_f32 v56, v64, v65
  v_cvt_pk_bf16_f32 v57, v66, v67
  v_cvt_pk_bf16_f32 v58, v68, v69
  v_cvt_pk_bf16_f32 v59, v70, v71
  ds_write_b128 v13, v[56:59] offset:12288
  buffer_store_dwordx4 a[216:219], v4, s[8:11], s22 offen sc1
  s_waitcnt lgkmcnt(9)
  buffer_store_dwordx4 a[220:223], v5, s[8:11], s22 offen sc1
  s_waitcnt lgkmcnt(0)
  s_barrier
  ds_read_b128 a[192:195], v1 offset:12288
  ds_read_b128 a[196:199], v2 offset:12288
  ds_read_b128 a[200:203], v3 offset:12288
  buffer_store_dwordx4 a[224:227], v6, s[8:11], s22 offen sc1
  buffer_store_dwordx4 a[228:231], v4, s[8:11], s23 offen sc1
  buffer_store_dwordx4 a[232:235], v5, s[8:11], s23 offen sc1
  buffer_store_dwordx4 a[236:239], v6, s[8:11], s23 offen sc1
  s_add_u32 s23, s22, 12288
  s_waitcnt lgkmcnt(2)
  buffer_store_dwordx4 a[192:195], v4, s[8:11], s23 offen sc1
  s_waitcnt lgkmcnt(1)
  buffer_store_dwordx4 a[196:199], v5, s[8:11], s23 offen sc1
  s_waitcnt lgkmcnt(0)
  buffer_store_dwordx4 a[200:203], v6, s[8:11], s23 offen sc1
  s_endpgm
L_ow6:
  s_cmp_eq_u32 s32, 1
  s_cbranch_scc1 L_ob6
  s_waitcnt vmcnt(18)
  s_cmp_eq_u32 s32, 3
  s_cbranch_scc1 L_ob6
  s_waitcnt vmcnt(12)
  s_branch L_ob6
L_ow14:
  s_cmp_eq_u32 s32, 1
  s_cbranch_scc1 L_ob14
  s_waitcnt vmcnt(18)
  s_cmp_eq_u32 s32, 3
  s_cbranch_scc1 L_ob14
  s_waitcnt vmcnt(12)
  s_branch L_ob14
L_done:
  s_endpgm
.section .rodata,"a"
.p2align 6
.amdhsa_kernel standalone__depthwise_separable__vision_kernel
  .amdhsa_next_free_vgpr 512
  .amdhsa_next_free_sgpr 100
  .amdhsa_accum_offset 256
  .amdhsa_group_segment_fixed_size 0
  .amdhsa_kernarg_size 48
  .amdhsa_user_sgpr_count 2
  .amdhsa_user_sgpr_kernarg_segment_ptr 1
  .amdhsa_system_sgpr_workgroup_id_x 1
  .amdhsa_float_denorm_mode_32 3
.end_amdhsa_kernel
```

```asm
; @launch grid=(256,1,1) block=(256,1,1) lds=151552
.amdgcn_target "amdgcn-amd-amdhsa--gfx950"
.text
.globl standalone__depthwise_separable__vision_kernel
.p2align 8
.type standalone__depthwise_separable__vision_kernel,@function
standalone__depthwise_separable__vision_kernel:
  s_cmp_ge_u32 s2, 256
  s_cbranch_scc1 L_done
  s_load_dwordx4 s[28:31], s[0:1], 16
  s_load_dwordx4 s[24:27], s[0:1], 0
  s_load_dwordx2 s[52:53], s[0:1], 32
  s_getpc_b64 s[40:41]
L_pc:
  v_lshlrev_b32 v72, 7, v0
  v_min_u32 v72, L_done-L_pc, v72
  v_mov_b32 v73, s41
  v_add_co_u32 v72, vcc, s40, v72
  v_lshrrev_b32 v77, 6, v0
  v_and_b32 v74, 63, v0
  v_addc_co_u32 v73, vcc, 0, v73, vcc
  global_load_dword v23, v[72:73], off
  v_readfirstlane_b32 s20, v77
  v_and_b32 v75, 15, v74
  v_lshlrev_b32 v78, 4, v74
  v_lshlrev_b32 v79, 4, v75
  s_lshr_b32 s47, s2, 3
  s_mul_i32 s39, s47, 9216
  s_mul_i32 s38, s20, 2304
  s_add_u32 s39, s39, s38
  s_mul_i32 s38, s20, 192
  v_mul_u32_u24 v81, 0xaaab, v74
  v_lshrrev_b32 v81, 19, v81
  v_mul_u32_u24 v81, 576, v81
  v_add3_u32 v14, v81, v78, s38
  v_add_u32 v80, 64, v74
  v_mul_u32_u24 v81, 0xaaab, v80
  v_lshrrev_b32 v81, 19, v81
  v_mul_u32_u24 v81, 576, v81
  v_add3_u32 v15, v81, v78, s38
  v_add_u32 v80, 128, v74
  v_mul_u32_u24 v81, 0xaaab, v80
  v_lshrrev_b32 v81, 19, v81
  v_mul_u32_u24 v81, 576, v81
  v_add3_u32 v16, v81, v78, s38
  s_lshl_b32 s33, s20, 10
  s_mul_i32 s34, s20, 6144
  s_mov_b32 s36, 0
  s_mov_b32 s14, 294912
  s_mov_b32 s15, 0x00020000
  s_mov_b32 s18, 768
  s_mov_b32 s19, 0x00020000
  s_add_u32 m0, s33, 147456
  s_waitcnt lgkmcnt(0)
  s_mov_b32 s12, s28
  s_and_b32 s13, s29, 0xffff
  buffer_load_dwordx4 a[216:219], v78, s[12:15], s39 offen
  buffer_load_dwordx4 a[220:223], v78, s[12:15], s39 offen offset:1024
  buffer_load_dwordx4 a[224:227], v79, s[12:15], s39 offen offset:2048
  s_mov_b32 s16, s26
  s_and_b32 s17, s27, 0xffff
  buffer_load_dwordx4 v78, s[16:19], 0 offen lds
  s_and_b32 s38, s2, 7
  s_lshl_b32 s38, s38, 5
  s_add_u32 s38, s38, s47
  s_mul_i32 s21, s38, 24576
  s_mov_b32 s4, s24
  s_and_b32 s5, s25, 0xffff
  s_mov_b32 s6, 113246208
  s_mov_b32 s7, 0x00020000
  v_mul_u32_u24 v81, 0xaaab, v0
  v_lshrrev_b32 v81, 21, v81
  v_xor_b32 v80, v0, v81
  v_lshlrev_b32 v1, 4, v80
  v_add_u32 v80, 256, v0
  v_mul_u32_u24 v81, 0xaaab, v80
  v_lshrrev_b32 v81, 21, v81
  v_xor_b32 v80, v80, v81
  v_lshlrev_b32 v2, 4, v80
  v_add_u32 v80, 512, v0
  v_mul_u32_u24 v81, 0xaaab, v80
  v_lshrrev_b32 v81, 21, v81
  v_xor_b32 v80, v80, v81
  v_lshlrev_b32 v3, 4, v80
  s_add_u32 s37, s21, 12288
  s_mov_b32 s22, s21
  s_add_u32 m0, s33, 98304
  s_nop 0
  buffer_load_dwordx4 v1, s[4:7], s21 offen nt lds
  s_add_u32 m0, s33, 102400
  s_nop 0
  buffer_load_dwordx4 v2, s[4:7], s21 offen nt lds
  s_add_u32 m0, s33, 106496
  s_nop 0
  buffer_load_dwordx4 v3, s[4:7], s21 offen nt lds
  s_add_u32 m0, s33, 110592
  s_add_u32 s21, s21, 6291456
  buffer_load_dwordx4 v1, s[4:7], s37 offen nt lds
  s_add_u32 m0, s33, 114688
  s_nop 0
  buffer_load_dwordx4 v2, s[4:7], s37 offen nt lds
  s_add_u32 m0, s33, 118784
  s_nop 0
  buffer_load_dwordx4 v3, s[4:7], s37 offen nt lds
  s_add_u32 s37, s37, 6291456
  v_lshrrev_b32 v76, 4, v74
  v_lshlrev_b32 v18, 4, v76
  v_add_u32 v18, s33, v18
  v_add_u32 v18, 147456, v18
  v_bfe_u32 v81, v74, 2, 2
  v_and_b32 v82, 3, v74
  v_lshl_add_u32 v83, v76, 3, v81
  v_mul_u32_u24 v83, 192, v83
  v_mul_u32_u24 v84, 48, v82
  v_add3_u32 v17, v83, v84, s34
  v_add_u32 v104, 49152, v17
  v_lshlrev_b32 v83, 4, v82
  v_mov_b32 v84, 0xffff
  v_cmp_lt_u32 vcc, 1, v82
  v_lshlrev_b32 v84, v83, v84
  v_mul_u32_u24 v80, 0x300, v75
  v_cndmask_b32 v20, 0, v84, vcc
  v_sub_u32 v19, v84, v20
  s_add_u32 m0, s34, 49152
  s_nop 0
  buffer_load_dwordx4 v14, s[12:15], s36 offen offset:0 lds
  buffer_load_dwordx4 v15, s[12:15], s36 offen offset:1024 lds
  buffer_load_dwordx4 v16, s[12:15], s36 offen offset:2048 lds
  s_add_u32 m0, s34, 52224
  s_add_u32 s36, s36, 12288
  buffer_load_dwordx4 v14, s[12:15], s36 offen offset:0 lds
  buffer_load_dwordx4 v15, s[12:15], s36 offen offset:1024 lds
  buffer_load_dwordx4 v16, s[12:15], s36 offen offset:2048 lds
  s_mov_b32 s8, s30
  s_and_b32 s9, s31, 0xffff
  s_mov_b32 s10, 113246208
  s_mov_b32 s11, 0x00020000
  v_lshlrev_b32 v4, 4, v0
  v_add_u32 v5, 4096, v4
  v_add_u32 v6, 8192, v4
  v_xor_b32 v81, v76, v75
  v_lshl_add_u32 v7, v81, 4, v80
  v_add_u32 v7, 98304, v7
  v_xor_b32 v8, 64, v7
  v_xor_b32 v9, 128, v7
  v_xor_b32 v10, 192, v7
  s_mul_i32 s38, s20, 12
  v_mul_u32_u24 v81, 3, v76
  v_add_u32 v81, s38, v81
  v_add_u32 v82, 0, v81
  v_xor_b32 v82, v82, v75
  v_lshl_add_u32 v11, v82, 4, v80
  v_add_u32 v82, 1, v81
  v_xor_b32 v82, v82, v75
  v_lshl_add_u32 v12, v82, 4, v80
  v_add_u32 v82, 2, v81
  v_xor_b32 v82, v82, v75
  v_lshl_add_u32 v13, v82, 4, v80
  s_mov_b32 s23, 113246208
  s_mov_b32 s44, 6291456
  s_add_u32 s42, s33, 49152
  s_mov_b32 s51, 1
  s_and_b32 s38, s47, 3
  s_mul_i32 s57, s38, 24576
  s_add_u32 s57, s57, 100663296
  s_lshl_b32 s38, s38, 6
  s_add_u32 s52, s52, s38
  s_addc_u32 s53, s53, 0
  s_mov_b32 s55, 112
  s_mov_b32 s68, 0
  s_cmp_eq_u32 s20, 0
  s_cselect_b32 s66, s55, 0
  s_mov_b32 s55, 0
  s_mov_b32 s65, 0
  s_mov_b32 s61, 12
  s_add_u32 s62, s22, 18874368
  s_mov_b32 s54, 0
  s_add_u32 s58, s22, 6291456
  s_add_u32 s59, s22, 12582912
  s_mov_b32 s32, 3
  v_mov_b32 v105, 147456
  v_add_u32 v106, s33, v105
  s_add_u32 m0, s34, 73728
  s_add_u32 s36, s36, 12288
  buffer_load_dwordx4 v14, s[12:15], s36 offen offset:0 lds
  buffer_load_dwordx4 v15, s[12:15], s36 offen offset:1024 lds
  buffer_load_dwordx4 v16, s[12:15], s36 offen offset:2048 lds
  s_add_u32 m0, s34, 76800
  s_add_u32 s36, s36, 12288
  buffer_load_dwordx4 v14, s[12:15], s36 offen offset:0 lds
  buffer_load_dwordx4 v15, s[12:15], s36 offen offset:1024 lds
  buffer_load_dwordx4 v16, s[12:15], s36 offen offset:2048 lds
  s_waitcnt vmcnt(6)
  ds_read_b128 v[96:99], v18 offset:0
  ds_read_b64_tr_b16 a[144:145], v104 offset:0
  ds_read_b64_tr_b16 a[146:147], v104 offset:768
  ds_read_b64_tr_b16 a[148:149], v104 offset:8
  ds_read_b64_tr_b16 a[150:151], v104 offset:776
  ds_read_b64_tr_b16 a[152:153], v104 offset:16
  ds_read_b64_tr_b16 a[154:155], v104 offset:784
  ds_read_b64_tr_b16 a[156:157], v104 offset:24
  ds_read_b64_tr_b16 a[158:159], v104 offset:792
  ds_read_b64_tr_b16 a[160:161], v104 offset:32
  ds_read_b64_tr_b16 a[162:163], v104 offset:800
  ds_read_b64_tr_b16 a[164:165], v104 offset:40
  ds_read_b64_tr_b16 a[166:167], v104 offset:808
  s_add_u32 m0, s34, 0
  s_add_u32 s36, s36, 12288
  buffer_load_dwordx4 v14, s[12:15], s36 offen offset:0 lds
  buffer_load_dwordx4 v15, s[12:15], s36 offen offset:1024 lds
  buffer_load_dwordx4 v16, s[12:15], s36 offen offset:2048 lds
  s_add_u32 m0, s34, 3072
  s_add_u32 s36, s36, 12288
  buffer_load_dwordx4 v14, s[12:15], s36 offen offset:0 lds
  buffer_load_dwordx4 v15, s[12:15], s36 offen offset:1024 lds
  buffer_load_dwordx4 v16, s[12:15], s36 offen offset:2048 lds
  s_waitcnt lgkmcnt(12)
  v_and_b32 v96, v19, v96
  v_and_b32 v97, v20, v97
  v_and_b32 v98, v19, v98
  v_and_b32 v99, v20, v99
  s_waitcnt lgkmcnt(10)
  v_mfma_f32_4x4x4_16b_bf16 v[72:75], v[96:97], a[144:145], 0
  v_mfma_f32_4x4x4_16b_bf16 v[76:79], v[98:99], a[146:147], 0
  s_waitcnt vmcnt(6)
  s_add_u32 m0, s34, 24576
  s_add_u32 s36, s36, 12288
  s_nop 0
  ds_read_b64_tr_b16 a[168:169], v104 offset:24576
  ds_read_b64_tr_b16 a[170:171], v104 offset:25344
  buffer_load_dwordx4 v14, s[12:15], s36 offen offset:0 lds
  s_waitcnt lgkmcnt(10)
  v_mfma_f32_4x4x4_16b_bf16 v[80:83], v[96:97], a[148:149], 0
  v_mfma_f32_4x4x4_16b_bf16 v[84:87], v[98:99], a[150:151], 0
  ds_read_b64_tr_b16 a[172:173], v104 offset:24584
  ds_read_b128 v[100:103], v18 offset:64
  ds_read_b64_tr_b16 a[174:175], v104 offset:25352
  buffer_load_dwordx4 v15, s[12:15], s36 offen offset:1024 lds
  s_waitcnt lgkmcnt(11)
  v_mfma_f32_4x4x4_16b_bf16 v[88:91], v[96:97], a[152:153], 0
  v_mfma_f32_4x4x4_16b_bf16 v[92:95], v[98:99], a[154:155], 0
  v_cvt_pk_bf16_f32 v72, v72, v73
  v_cvt_pk_bf16_f32 v74, v74, v75
  ds_read_b64_tr_b16 a[176:177], v104 offset:24592
  ds_read_b64_tr_b16 a[178:179], v104 offset:25360
  buffer_load_dwordx4 v16, s[12:15], s36 offen offset:2048 lds
  v_cvt_pk_bf16_f32 v76, v76, v77
  v_accvgpr_write_b32 a0, v72
  v_cvt_pk_bf16_f32 v78, v78, v79
  v_accvgpr_write_b32 a1, v74
  v_accvgpr_write_b32 a2, v76
  v_accvgpr_write_b32 a3, v78
  s_waitcnt lgkmcnt(11)
  v_mfma_f32_4x4x4_16b_bf16 v[72:75], v[96:97], a[156:157], 0
  v_mfma_f32_4x4x4_16b_bf16 v[76:79], v[98:99], a[158:159], 0
  v_cvt_pk_bf16_f32 v80, v80, v81
  v_cvt_pk_bf16_f32 v82, v82, v83
  s_add_u32 m0, s34, 27648
  s_add_u32 s36, s36, 12288
  s_nop 0
  ds_read_b64_tr_b16 a[180:181], v104 offset:24600
  ds_read_b64_tr_b16 a[182:183], v104 offset:25368
  buffer_load_dwordx4 v14, s[12:15], s36 offen offset:0 lds
  v_cvt_pk_bf16_f32 v84, v84, v85
  v_accvgpr_write_b32 a4, v80
  v_cvt_pk_bf16_f32 v86, v86, v87
  v_accvgpr_write_b32 a5, v82
  v_accvgpr_write_b32 a6, v84
  v_accvgpr_write_b32 a7, v86
  s_waitcnt lgkmcnt(11)
  v_mfma_f32_4x4x4_16b_bf16 v[80:83], v[96:97], a[160:161], 0
  v_mfma_f32_4x4x4_16b_bf16 v[84:87], v[98:99], a[162:163], 0
  v_cvt_pk_bf16_f32 v88, v88, v89
  v_cvt_pk_bf16_f32 v90, v90, v91
  ds_read_b64_tr_b16 a[184:185], v104 offset:24608
  ds_read_b64_tr_b16 a[186:187], v104 offset:25376
  buffer_load_dwordx4 v15, s[12:15], s36 offen offset:1024 lds
  v_cvt_pk_bf16_f32 v92, v92, v93
  v_accvgpr_write_b32 a8, v88
  v_cvt_pk_bf16_f32 v94, v94, v95
  v_accvgpr_write_b32 a9, v90
  v_accvgpr_write_b32 a10, v92
  v_accvgpr_write_b32 a11, v94
  s_waitcnt lgkmcnt(7)
  v_and_b32 v100, v19, v100
  v_and_b32 v101, v20, v101
  v_mfma_f32_4x4x4_16b_bf16 v[88:91], v[96:97], a[164:165], 0
  v_mfma_f32_4x4x4_16b_bf16 v[92:95], v[98:99], a[166:167], 0
  v_and_b32 v102, v19, v102
  v_and_b32 v103, v20, v103
  ds_read_b64_tr_b16 a[188:189], v104 offset:24616
  ds_read_b64_tr_b16 a[190:191], v104 offset:25384
  buffer_load_dwordx4 v16, s[12:15], s36 offen offset:2048 lds
  v_cvt_pk_bf16_f32 v72, v72, v73
  v_cvt_pk_bf16_f32 v74, v74, v75
  v_cvt_pk_bf16_f32 v76, v76, v77
  v_accvgpr_write_b32 a12, v72
  v_cvt_pk_bf16_f32 v78, v78, v79
  v_accvgpr_write_b32 a13, v74
  v_accvgpr_write_b32 a14, v76
  v_accvgpr_write_b32 a15, v78
  s_waitcnt lgkmcnt(0)
  s_barrier
  ds_read_b128 a[192:195], v7 offset:0
  ds_read_b128 a[196:199], v7 offset:12288
  ds_read_b128 a[200:203], v8 offset:0
  ds_read_b128 a[204:207], v8 offset:12288
  v_mfma_f32_4x4x4_16b_bf16 v[72:75], v[100:101], a[168:169], 0
  v_mfma_f32_4x4x4_16b_bf16 v[76:79], v[102:103], a[170:171], 0
  v_cvt_pk_bf16_f32 v80, v80, v81
  v_cvt_pk_bf16_f32 v82, v82, v83
  s_waitcnt vmcnt(6)
  s_add_u32 m0, s34, 49152
  s_add_u32 s36, s36, 12288
  s_nop 0
  ds_read_b64_tr_b16 a[144:145], v17 offset:0
  ds_read_b64_tr_b16 a[146:147], v17 offset:768
  buffer_load_dwordx4 v14, s[12:15], s36 offen offset:0 lds
  v_cvt_pk_bf16_f32 v84, v84, v85
  v_accvgpr_write_b32 a16, v80
  v_cvt_pk_bf16_f32 v86, v86, v87
  v_accvgpr_write_b32 a17, v82
  v_accvgpr_write_b32 a18, v84
  v_accvgpr_write_b32 a19, v86
  v_mfma_f32_4x4x4_16b_bf16 v[80:83], v[100:101], a[172:173], 0
  v_mfma_f32_4x4x4_16b_bf16 v[84:87], v[102:103], a[174:175], 0
  v_cvt_pk_bf16_f32 v88, v88, v89
  v_cvt_pk_bf16_f32 v90, v90, v91
  s_waitcnt lgkmcnt(4)
  v_mfma_f32_16x16x32_bf16 v[24:27], a[0:3], a[192:195], 0
  ds_read_b64_tr_b16 a[148:149], v17 offset:8
  v_cvt_pk_bf16_f32 v92, v92, v93
  v_mfma_f32_16x16x32_bf16 v[48:51], a[0:3], a[196:199], 0
  ds_read_b128 v[96:99], v18 offset:128
  v_accvgpr_write_b32 a20, v88
  v_mfma_f32_16x16x32_bf16 v[28:31], a[4:7], a[192:195], 0
  ds_read_b64_tr_b16 a[150:151], v17 offset:776
  v_cvt_pk_bf16_f32 v94, v94, v95
  v_mfma_f32_16x16x32_bf16 v[52:55], a[4:7], a[196:199], 0
  buffer_load_dwordx4 v15, s[12:15], s36 offen offset:1024 lds
  v_accvgpr_write_b32 a21, v90
  v_accvgpr_write_b32 a22, v92
  v_accvgpr_write_b32 a23, v94
  v_mfma_f32_4x4x4_16b_bf16 v[88:91], v[100:101], a[176:177], 0
  v_mfma_f32_4x4x4_16b_bf16 v[92:95], v[102:103], a[178:179], 0
  v_cvt_pk_bf16_f32 v72, v72, v73
  v_cvt_pk_bf16_f32 v74, v74, v75
  v_mfma_f32_16x16x32_bf16 v[32:35], a[8:11], a[192:195], 0
  ds_read_b64_tr_b16 a[152:153], v17 offset:16
  ds_read_b128 a[208:211], v9 offset:0
  v_cvt_pk_bf16_f32 v76, v76, v77
  v_mfma_f32_16x16x32_bf16 v[56:59], a[8:11], a[196:199], 0
  ds_read_b64_tr_b16 a[154:155], v17 offset:784
  buffer_load_dwordx4 v16, s[12:15], s36 offen offset:2048 lds
  v_accvgpr_write_b32 a24, v72
  v_cvt_pk_bf16_f32 v78, v78, v79
  v_accvgpr_write_b32 a25, v74
  v_accvgpr_write_b32 a26, v76
  v_accvgpr_write_b32 a27, v78
  v_mfma_f32_4x4x4_16b_bf16 v[72:75], v[100:101], a[180:181], 0
  v_mfma_f32_4x4x4_16b_bf16 v[76:79], v[102:103], a[182:183], 0
  v_cvt_pk_bf16_f32 v80, v80, v81
  v_cvt_pk_bf16_f32 v82, v82, v83
  v_mfma_f32_16x16x32_bf16 v[36:39], a[12:15], a[192:195], 0
  ds_read_b64_tr_b16 a[156:157], v17 offset:24
  ds_read_b128 a[212:215], v9 offset:12288
  v_cvt_pk_bf16_f32 v84, v84, v85
  s_add_u32 m0, s34, 52224
  s_add_u32 s36, s36, 12288
  v_mfma_f32_16x16x32_bf16 v[60:63], a[12:15], a[196:199], 0
  ds_read_b64_tr_b16 a[158:159], v17 offset:792
  buffer_load_dwordx4 v14, s[12:15], s36 offen offset:0 lds
  v_accvgpr_write_b32 a28, v80
  v_cvt_pk_bf16_f32 v86, v86, v87
  v_accvgpr_write_b32 a29, v82
  v_accvgpr_write_b32 a30, v84
  v_accvgpr_write_b32 a31, v86
  v_mfma_f32_4x4x4_16b_bf16 v[80:83], v[100:101], a[184:185], 0
  v_mfma_f32_4x4x4_16b_bf16 v[84:87], v[102:103], a[186:187], 0
  v_cvt_pk_bf16_f32 v88, v88, v89
  v_cvt_pk_bf16_f32 v90, v90, v91
  v_mfma_f32_16x16x32_bf16 v[40:43], a[16:19], a[192:195], 0
  ds_read_b64_tr_b16 a[160:161], v17 offset:32
  v_cvt_pk_bf16_f32 v92, v92, v93
  v_accvgpr_write_b32 a32, v88
  v_mfma_f32_16x16x32_bf16 v[64:67], a[16:19], a[196:199], 0
  ds_read_b64_tr_b16 a[162:163], v17 offset:800
  buffer_load_dwordx4 v15, s[12:15], s36 offen offset:1024 lds
  v_cvt_pk_bf16_f32 v94, v94, v95
  v_accvgpr_write_b32 a33, v90
  v_accvgpr_write_b32 a34, v92
  v_accvgpr_write_b32 a35, v94
  s_waitcnt lgkmcnt(9)
  v_and_b32 v96, v19, v96
  v_and_b32 v97, v20, v97
  v_mfma_f32_4x4x4_16b_bf16 v[88:91], v[100:101], a[188:189], 0
  v_mfma_f32_4x4x4_16b_bf16 v[92:95], v[102:103], a[190:191], 0
  v_and_b32 v98, v19, v98
  v_and_b32 v99, v20, v99
  v_mfma_f32_16x16x32_bf16 v[44:47], a[20:23], a[192:195], 0
  ds_read_b64_tr_b16 a[164:165], v17 offset:40
  v_cvt_pk_bf16_f32 v72, v72, v73
  v_cvt_pk_bf16_f32 v74, v74, v75
  v_mfma_f32_16x16x32_bf16 v[68:71], a[20:23], a[196:199], 0
  ds_read_b64_tr_b16 a[166:167], v17 offset:808
  buffer_load_dwordx4 v16, s[12:15], s36 offen offset:2048 lds
  v_cvt_pk_bf16_f32 v76, v76, v77
  v_accvgpr_write_b32 a36, v72
  v_cvt_pk_bf16_f32 v78, v78, v79
  v_accvgpr_write_b32 a37, v74
  v_accvgpr_write_b32 a38, v76
  v_accvgpr_write_b32 a39, v78
  v_mfma_f32_4x4x4_16b_bf16 v[72:75], v[96:97], a[144:145], 0
  v_mfma_f32_4x4x4_16b_bf16 v[76:79], v[98:99], a[146:147], 0
  v_cvt_pk_bf16_f32 v80, v80, v81
  v_cvt_pk_bf16_f32 v82, v82, v83
  s_waitcnt vmcnt(6)
  v_mfma_f32_16x16x32_bf16 v[24:27], a[24:27], a[200:203], v[24:27]
  ds_read_b64_tr_b16 a[168:169], v17 offset:24576
  v_cvt_pk_bf16_f32 v84, v84, v85
  s_add_u32 m0, s34, 73728
  s_add_u32 s36, s36, 12288
  v_mfma_f32_16x16x32_bf16 v[48:51], a[24:27], a[204:207], v[48:51]
  ds_read_b64_tr_b16 a[170:171], v17 offset:25344
  buffer_load_dwordx4 v14, s[12:15], s36 offen offset:0 lds
  v_accvgpr_write_b32 a40, v80
  v_cvt_pk_bf16_f32 v86, v86, v87
  v_accvgpr_write_b32 a41, v82
  v_accvgpr_write_b32 a42, v84
  v_accvgpr_write_b32 a43, v86
  s_waitcnt lgkmcnt(12)
  v_mfma_f32_4x4x4_16b_bf16 v[80:83], v[96:97], a[148:149], 0
  v_mfma_f32_4x4x4_16b_bf16 v[84:87], v[98:99], a[150:151], 0
  v_cvt_pk_bf16_f32 v88, v88, v89
  v_cvt_pk_bf16_f32 v90, v90, v91
  v_mfma_f32_16x16x32_bf16 v[28:31], a[28:31], a[200:203], v[28:31]
  ds_read_b64_tr_b16 a[172:173], v17 offset:24584
  ds_read_b128 v[100:103], v18 offset:192
  v_cvt_pk_bf16_f32 v92, v92, v93
  v_mfma_f32_16x16x32_bf16 v[52:55], a[28:31], a[204:207], v[52:55]
  ds_read_b64_tr_b16 a[174:175], v17 offset:25352
  buffer_load_dwordx4 v15, s[12:15], s36 offen offset:1024 lds
  v_accvgpr_write_b32 a44, v88
  v_cvt_pk_bf16_f32 v94, v94, v95
  v_accvgpr_write_b32 a45, v90
  v_accvgpr_write_b32 a46, v92
  v_accvgpr_write_b32 a47, v94
  s_waitcnt lgkmcnt(12)
  v_mfma_f32_4x4x4_16b_bf16 v[88:91], v[96:97], a[152:153], 0
  v_mfma_f32_4x4x4_16b_bf16 v[92:95], v[98:99], a[154:155], 0
  v_cvt_pk_bf16_f32 v72, v72, v73
  v_cvt_pk_bf16_f32 v74, v74, v75
  v_mfma_f32_16x16x32_bf16 v[32:35], a[32:35], a[200:203], v[32:35]
  ds_read_b64_tr_b16 a[176:177], v17 offset:24592
  ds_read_b128 a[192:195], v10 offset:0
  v_cvt_pk_bf16_f32 v76, v76, v77
  v_mfma_f32_16x16x32_bf16 v[56:59], a[32:35], a[204:207], v[56:59]
  ds_read_b64_tr_b16 a[178:179], v17 offset:25360
  buffer_load_dwordx4 v16, s[12:15], s36 offen offset:2048 lds
  v_accvgpr_write_b32 a48, v72
  v_cvt_pk_bf16_f32 v78, v78, v79
  v_accvgpr_write_b32 a49, v74
  v_accvgpr_write_b32 a50, v76
  v_accvgpr_write_b32 a51, v78
  s_waitcnt lgkmcnt(12)
  v_mfma_f32_4x4x4_16b_bf16 v[72:75], v[96:97], a[156:157], 0
  v_mfma_f32_4x4x4_16b_bf16 v[76:79], v[98:99], a[158:159], 0
  v_cvt_pk_bf16_f32 v80, v80, v81
  v_cvt_pk_bf16_f32 v82, v82, v83
  v_mfma_f32_16x16x32_bf16 v[36:39], a[36:39], a[200:203], v[36:39]
  ds_read_b64_tr_b16 a[180:181], v17 offset:24600
  ds_read_b128 a[196:199], v10 offset:12288
  v_cvt_pk_bf16_f32 v84, v84, v85
  s_add_u32 m0, s34, 76800
  s_add_u32 s36, s36, 12288
  v_mfma_f32_16x16x32_bf16 v[60:63], a[36:39], a[204:207], v[60:63]
  ds_read_b64_tr_b16 a[182:183], v17 offset:25368
  buffer_load_dwordx4 v14, s[12:15], s36 offen offset:0 lds
  v_accvgpr_write_b32 a52, v80
  v_cvt_pk_bf16_f32 v86, v86, v87
  v_accvgpr_write_b32 a53, v82
  v_accvgpr_write_b32 a54, v84
  v_accvgpr_write_b32 a55, v86
  s_waitcnt lgkmcnt(13)
  v_mfma_f32_4x4x4_16b_bf16 v[80:83], v[96:97], a[160:161], 0
  v_mfma_f32_4x4x4_16b_bf16 v[84:87], v[98:99], a[162:163], 0
  v_cvt_pk_bf16_f32 v88, v88, v89
  v_cvt_pk_bf16_f32 v90, v90, v91
  v_mfma_f32_16x16x32_bf16 v[40:43], a[40:43], a[200:203], v[40:43]
  ds_read_b64_tr_b16 a[184:185], v17 offset:24608
  v_cvt_pk_bf16_f32 v92, v92, v93
  v_accvgpr_write_b32 a56, v88
  v_mfma_f32_16x16x32_bf16 v[64:67], a[40:43], a[204:207], v[64:67]
  ds_read_b64_tr_b16 a[186:187], v17 offset:25376
  buffer_load_dwordx4 v15, s[12:15], s36 offen offset:1024 lds
  v_cvt_pk_bf16_f32 v94, v94, v95
  v_accvgpr_write_b32 a57, v90
  v_accvgpr_write_b32 a58, v92
  v_accvgpr_write_b32 a59, v94
  s_waitcnt lgkmcnt(9)
  v_and_b32 v100, v19, v100
  v_and_b32 v101, v20, v101
  v_mfma_f32_4x4x4_16b_bf16 v[88:91], v[96:97], a[164:165], 0
  v_mfma_f32_4x4x4_16b_bf16 v[92:95], v[98:99], a[166:167], 0
  v_and_b32 v102, v19, v102
  v_and_b32 v103, v20, v103
  v_mfma_f32_16x16x32_bf16 v[44:47], a[44:47], a[200:203], v[44:47]
  ds_read_b64_tr_b16 a[188:189], v17 offset:24616
  v_cvt_pk_bf16_f32 v72, v72, v73
  v_cvt_pk_bf16_f32 v74, v74, v75
  v_mfma_f32_16x16x32_bf16 v[68:71], a[44:47], a[204:207], v[68:71]
  ds_read_b64_tr_b16 a[190:191], v17 offset:25384
  buffer_load_dwordx4 v16, s[12:15], s36 offen offset:2048 lds
  v_cvt_pk_bf16_f32 v76, v76, v77
  v_accvgpr_write_b32 a60, v72
  v_cvt_pk_bf16_f32 v78, v78, v79
  v_accvgpr_write_b32 a61, v74
  v_accvgpr_write_b32 a62, v76
  v_accvgpr_write_b32 a63, v78
  v_mfma_f32_4x4x4_16b_bf16 v[72:75], v[100:101], a[168:169], 0
  v_mfma_f32_4x4x4_16b_bf16 v[76:79], v[102:103], a[170:171], 0
  v_cvt_pk_bf16_f32 v80, v80, v81
  v_cvt_pk_bf16_f32 v82, v82, v83
  s_waitcnt vmcnt(6)
  v_mfma_f32_16x16x32_bf16 v[24:27], a[48:51], a[208:211], v[24:27]
  ds_read_b64_tr_b16 a[144:145], v104 offset:0
  v_cvt_pk_bf16_f32 v84, v84, v85
  s_add_u32 m0, s34, 0
  s_add_u32 s36, s36, 12288
  v_mfma_f32_16x16x32_bf16 v[48:51], a[48:51], a[212:215], v[48:51]
  ds_read_b64_tr_b16 a[146:147], v104 offset:768
  buffer_load_dwordx4 v14, s[12:15], s36 offen offset:0 lds
  v_accvgpr_write_b32 a64, v80
  v_cvt_pk_bf16_f32 v86, v86, v87
  v_accvgpr_write_b32 a65, v82
  v_accvgpr_write_b32 a66, v84
  v_accvgpr_write_b32 a67, v86
  s_waitcnt lgkmcnt(12)
  v_mfma_f32_4x4x4_16b_bf16 v[80:83], v[100:101], a[172:173], 0
  v_mfma_f32_4x4x4_16b_bf16 v[84:87], v[102:103], a[174:175], 0
  v_cvt_pk_bf16_f32 v88, v88, v89
  v_cvt_pk_bf16_f32 v90, v90, v91
  v_mfma_f32_16x16x32_bf16 v[28:31], a[52:55], a[208:211], v[28:31]
  ds_read_b64_tr_b16 a[148:149], v104 offset:8
  ds_read_b128 v[96:99], v18 offset:256
  v_cvt_pk_bf16_f32 v92, v92, v93
  v_mfma_f32_16x16x32_bf16 v[52:55], a[52:55], a[212:215], v[52:55]
  ds_read_b64_tr_b16 a[150:151], v104 offset:776
  buffer_load_dwordx4 v15, s[12:15], s36 offen offset:1024 lds
  v_accvgpr_write_b32 a68, v88
  v_cvt_pk_bf16_f32 v94, v94, v95
  v_accvgpr_write_b32 a69, v90
  v_accvgpr_write_b32 a70, v92
  v_accvgpr_write_b32 a71, v94
  s_waitcnt lgkmcnt(12)
  v_mfma_f32_4x4x4_16b_bf16 v[88:91], v[100:101], a[176:177], 0
  v_mfma_f32_4x4x4_16b_bf16 v[92:95], v[102:103], a[178:179], 0
  v_cvt_pk_bf16_f32 v72, v72, v73
  v_cvt_pk_bf16_f32 v74, v74, v75
  v_mfma_f32_16x16x32_bf16 v[32:35], a[56:59], a[208:211], v[32:35]
  ds_read_b64_tr_b16 a[152:153], v104 offset:16
  ds_read_b128 a[200:203], v7 offset:256
  v_cvt_pk_bf16_f32 v76, v76, v77
  v_mfma_f32_16x16x32_bf16 v[56:59], a[56:59], a[212:215], v[56:59]
  ds_read_b64_tr_b16 a[154:155], v104 offset:784
  buffer_load_dwordx4 v16, s[12:15], s36 offen offset:2048 lds
  v_accvgpr_write_b32 a72, v72
  v_cvt_pk_bf16_f32 v78, v78, v79
  v_accvgpr_write_b32 a73, v74
  v_accvgpr_write_b32 a74, v76
  v_accvgpr_write_b32 a75, v78
  s_waitcnt lgkmcnt(12)
  v_mfma_f32_4x4x4_16b_bf16 v[72:75], v[100:101], a[180:181], 0
  v_mfma_f32_4x4x4_16b_bf16 v[76:79], v[102:103], a[182:183], 0
  v_cvt_pk_bf16_f32 v80, v80, v81
  v_cvt_pk_bf16_f32 v82, v82, v83
  v_mfma_f32_16x16x32_bf16 v[36:39], a[60:63], a[208:211], v[36:39]
  ds_read_b64_tr_b16 a[156:157], v104 offset:24
  ds_read_b128 a[204:207], v7 offset:12544
  v_cvt_pk_bf16_f32 v84, v84, v85
  s_add_u32 m0, s34, 3072
  s_add_u32 s36, s36, 12288
  v_mfma_f32_16x16x32_bf16 v[60:63], a[60:63], a[212:215], v[60:63]
  ds_read_b64_tr_b16 a[158:159], v104 offset:792
  buffer_load_dwordx4 v14, s[12:15], s36 offen offset:0 lds
  v_accvgpr_write_b32 a76, v80
  v_cvt_pk_bf16_f32 v86, v86, v87
  v_accvgpr_write_b32 a77, v82
  v_accvgpr_write_b32 a78, v84
  v_accvgpr_write_b32 a79, v86
  s_waitcnt lgkmcnt(13)
  v_mfma_f32_4x4x4_16b_bf16 v[80:83], v[100:101], a[184:185], 0
  v_mfma_f32_4x4x4_16b_bf16 v[84:87], v[102:103], a[186:187], 0
  v_cvt_pk_bf16_f32 v88, v88, v89
  v_cvt_pk_bf16_f32 v90, v90, v91
  v_mfma_f32_16x16x32_bf16 v[40:43], a[64:67], a[208:211], v[40:43]
  ds_read_b64_tr_b16 a[160:161], v104 offset:32
  v_cvt_pk_bf16_f32 v92, v92, v93
  v_accvgpr_write_b32 a80, v88
  v_mfma_f32_16x16x32_bf16 v[64:67], a[64:67], a[212:215], v[64:67]
  ds_read_b64_tr_b16 a[162:163], v104 offset:800
  buffer_load_dwordx4 v15, s[12:15], s36 offen offset:1024 lds
  v_cvt_pk_bf16_f32 v94, v94, v95
  v_accvgpr_write_b32 a81, v90
  v_accvgpr_write_b32 a82, v92
  v_accvgpr_write_b32 a83, v94
  s_waitcnt lgkmcnt(9)
  v_and_b32 v96, v19, v96
  v_and_b32 v97, v20, v97
  v_mfma_f32_4x4x4_16b_bf16 v[88:91], v[100:101], a[188:189], 0
  v_mfma_f32_4x4x4_16b_bf16 v[92:95], v[102:103], a[190:191], 0
  v_and_b32 v98, v19, v98
  v_and_b32 v99, v20, v99
  v_mfma_f32_16x16x32_bf16 v[44:47], a[68:71], a[208:211], v[44:47]
  ds_read_b64_tr_b16 a[164:165], v104 offset:40
  v_cvt_pk_bf16_f32 v72, v72, v73
  v_cvt_pk_bf16_f32 v74, v74, v75
  v_mfma_f32_16x16x32_bf16 v[68:71], a[68:71], a[212:215], v[68:71]
  ds_read_b64_tr_b16 a[166:167], v104 offset:808
  buffer_load_dwordx4 v16, s[12:15], s36 offen offset:2048 lds
  v_cvt_pk_bf16_f32 v76, v76, v77
  v_accvgpr_write_b32 a84, v72
  v_cvt_pk_bf16_f32 v78, v78, v79
  v_accvgpr_write_b32 a85, v74
  v_accvgpr_write_b32 a86, v76
  v_accvgpr_write_b32 a87, v78
  v_mfma_f32_4x4x4_16b_bf16 v[72:75], v[96:97], a[144:145], 0
  v_mfma_f32_4x4x4_16b_bf16 v[76:79], v[98:99], a[146:147], 0
  v_cvt_pk_bf16_f32 v80, v80, v81
  v_cvt_pk_bf16_f32 v82, v82, v83
  s_waitcnt vmcnt(6)
  v_mfma_f32_16x16x32_bf16 v[24:27], a[72:75], a[192:195], v[24:27]
  ds_read_b64_tr_b16 a[168:169], v104 offset:24576
  v_cvt_pk_bf16_f32 v84, v84, v85
  s_add_u32 m0, s34, 24576
  s_add_u32 s36, s36, 12288
  v_mfma_f32_16x16x32_bf16 v[48:51], a[72:75], a[196:199], v[48:51]
  ds_read_b64_tr_b16 a[170:171], v104 offset:25344
  buffer_load_dwordx4 v14, s[12:15], s36 offen offset:0 lds
  v_accvgpr_write_b32 a88, v80
  v_cvt_pk_bf16_f32 v86, v86, v87
  v_accvgpr_write_b32 a89, v82
  v_accvgpr_write_b32 a90, v84
  v_accvgpr_write_b32 a91, v86
  s_waitcnt lgkmcnt(12)
  v_mfma_f32_4x4x4_16b_bf16 v[80:83], v[96:97], a[148:149], 0
  v_mfma_f32_4x4x4_16b_bf16 v[84:87], v[98:99], a[150:151], 0
  v_cvt_pk_bf16_f32 v88, v88, v89
  v_cvt_pk_bf16_f32 v90, v90, v91
  v_mfma_f32_16x16x32_bf16 v[28:31], a[76:79], a[192:195], v[28:31]
  ds_read_b64_tr_b16 a[172:173], v104 offset:24584
  ds_read_b128 v[100:103], v18 offset:320
  v_cvt_pk_bf16_f32 v92, v92, v93
  v_mfma_f32_16x16x32_bf16 v[52:55], a[76:79], a[196:199], v[52:55]
  ds_read_b64_tr_b16 a[174:175], v104 offset:25352
  buffer_load_dwordx4 v15, s[12:15], s36 offen offset:1024 lds
  v_accvgpr_write_b32 a92, v88
  v_cvt_pk_bf16_f32 v94, v94, v95
  v_accvgpr_write_b32 a93, v90
  v_accvgpr_write_b32 a94, v92
  v_accvgpr_write_b32 a95, v94
  s_waitcnt lgkmcnt(12)
  v_mfma_f32_4x4x4_16b_bf16 v[88:91], v[96:97], a[152:153], 0
  v_mfma_f32_4x4x4_16b_bf16 v[92:95], v[98:99], a[154:155], 0
  v_cvt_pk_bf16_f32 v72, v72, v73
  v_cvt_pk_bf16_f32 v74, v74, v75
  v_mfma_f32_16x16x32_bf16 v[32:35], a[80:83], a[192:195], v[32:35]
  ds_read_b64_tr_b16 a[176:177], v104 offset:24592
  ds_read_b128 a[208:211], v8 offset:256
  v_cvt_pk_bf16_f32 v76, v76, v77
  v_mfma_f32_16x16x32_bf16 v[56:59], a[80:83], a[196:199], v[56:59]
  ds_read_b64_tr_b16 a[178:179], v104 offset:25360
  buffer_load_dwordx4 v16, s[12:15], s36 offen offset:2048 lds
  v_accvgpr_write_b32 a96, v72
  v_cvt_pk_bf16_f32 v78, v78, v79
  v_accvgpr_write_b32 a97, v74
  v_accvgpr_write_b32 a98, v76
  v_accvgpr_write_b32 a99, v78
  s_waitcnt lgkmcnt(12)
  v_mfma_f32_4x4x4_16b_bf16 v[72:75], v[96:97], a[156:157], 0
  v_mfma_f32_4x4x4_16b_bf16 v[76:79], v[98:99], a[158:159], 0
  v_cvt_pk_bf16_f32 v80, v80, v81
  v_cvt_pk_bf16_f32 v82, v82, v83
  v_mfma_f32_16x16x32_bf16 v[36:39], a[84:87], a[192:195], v[36:39]
  ds_read_b64_tr_b16 a[180:181], v104 offset:24600
  ds_read_b128 a[212:215], v8 offset:12544
  v_cvt_pk_bf16_f32 v84, v84, v85
  s_add_u32 m0, s34, 27648
  s_add_u32 s36, s36, 12288
  v_mfma_f32_16x16x32_bf16 v[60:63], a[84:87], a[196:199], v[60:63]
  ds_read_b64_tr_b16 a[182:183], v104 offset:25368
  buffer_load_dwordx4 v14, s[12:15], s36 offen offset:0 lds
  v_accvgpr_write_b32 a100, v80
  v_cvt_pk_bf16_f32 v86, v86, v87
  v_accvgpr_write_b32 a101, v82
  v_accvgpr_write_b32 a102, v84
  v_accvgpr_write_b32 a103, v86
  s_waitcnt lgkmcnt(13)
  v_mfma_f32_4x4x4_16b_bf16 v[80:83], v[96:97], a[160:161], 0
  v_mfma_f32_4x4x4_16b_bf16 v[84:87], v[98:99], a[162:163], 0
  v_cvt_pk_bf16_f32 v88, v88, v89
  v_cvt_pk_bf16_f32 v90, v90, v91
  v_mfma_f32_16x16x32_bf16 v[40:43], a[88:91], a[192:195], v[40:43]
  ds_read_b64_tr_b16 a[184:185], v104 offset:24608
  v_cvt_pk_bf16_f32 v92, v92, v93
  v_accvgpr_write_b32 a104, v88
  v_mfma_f32_16x16x32_bf16 v[64:67], a[88:91], a[196:199], v[64:67]
  ds_read_b64_tr_b16 a[186:187], v104 offset:25376
  buffer_load_dwordx4 v15, s[12:15], s36 offen offset:1024 lds
  v_cvt_pk_bf16_f32 v94, v94, v95
  v_accvgpr_write_b32 a105, v90
  v_accvgpr_write_b32 a106, v92
  v_accvgpr_write_b32 a107, v94
  s_waitcnt lgkmcnt(9)
  v_and_b32 v100, v19, v100
  v_and_b32 v101, v20, v101
  v_mfma_f32_4x4x4_16b_bf16 v[88:91], v[96:97], a[164:165], 0
  v_mfma_f32_4x4x4_16b_bf16 v[92:95], v[98:99], a[166:167], 0
  v_and_b32 v102, v19, v102
  v_and_b32 v103, v20, v103
  v_mfma_f32_16x16x32_bf16 v[44:47], a[92:95], a[192:195], v[44:47]
  ds_read_b64_tr_b16 a[188:189], v104 offset:24616
  v_cvt_pk_bf16_f32 v72, v72, v73
  v_cvt_pk_bf16_f32 v74, v74, v75
  v_mfma_f32_16x16x32_bf16 v[68:71], a[92:95], a[196:199], v[68:71]
  ds_read_b64_tr_b16 a[190:191], v104 offset:25384
  buffer_load_dwordx4 v16, s[12:15], s36 offen offset:2048 lds
  v_cvt_pk_bf16_f32 v76, v76, v77
  v_accvgpr_write_b32 a108, v72
  v_cvt_pk_bf16_f32 v78, v78, v79
  v_accvgpr_write_b32 a109, v74
  v_accvgpr_write_b32 a110, v76
  v_accvgpr_write_b32 a111, v78
  v_mfma_f32_4x4x4_16b_bf16 v[72:75], v[100:101], a[168:169], 0
  v_mfma_f32_4x4x4_16b_bf16 v[76:79], v[102:103], a[170:171], 0
  v_cvt_pk_bf16_f32 v80, v80, v81
  v_cvt_pk_bf16_f32 v82, v82, v83
  s_waitcnt vmcnt(6)
  v_mfma_f32_16x16x32_bf16 v[24:27], a[96:99], a[200:203], v[24:27]
  ds_read_b64_tr_b16 a[144:145], v17 offset:0
  v_cvt_pk_bf16_f32 v84, v84, v85
  s_add_u32 m0, s34, 49152
  s_add_u32 s36, s36, 12288
  v_mfma_f32_16x16x32_bf16 v[48:51], a[96:99], a[204:207], v[48:51]
  ds_read_b64_tr_b16 a[146:147], v17 offset:768
  buffer_load_dwordx4 v14, s[12:15], s36 offen offset:0 lds
  v_accvgpr_write_b32 a112, v80
  v_cvt_pk_bf16_f32 v86, v86, v87
  v_accvgpr_write_b32 a113, v82
  v_accvgpr_write_b32 a114, v84
  v_accvgpr_write_b32 a115, v86
  s_waitcnt lgkmcnt(12)
  v_mfma_f32_4x4x4_16b_bf16 v[80:83], v[100:101], a[172:173], 0
  v_mfma_f32_4x4x4_16b_bf16 v[84:87], v[102:103], a[174:175], 0
  v_cvt_pk_bf16_f32 v88, v88, v89
  v_cvt_pk_bf16_f32 v90, v90, v91
  v_mfma_f32_16x16x32_bf16 v[28:31], a[100:103], a[200:203], v[28:31]
  ds_read_b64_tr_b16 a[148:149], v17 offset:8
  ds_read_b128 v[96:99], v18 offset:384
  v_cvt_pk_bf16_f32 v92, v92, v93
  v_mfma_f32_16x16x32_bf16 v[52:55], a[100:103], a[204:207], v[52:55]
  ds_read_b64_tr_b16 a[150:151], v17 offset:776
  buffer_load_dwordx4 v15, s[12:15], s36 offen offset:1024 lds
  v_accvgpr_write_b32 a116, v88
  v_cvt_pk_bf16_f32 v94, v94, v95
  v_accvgpr_write_b32 a117, v90
  v_accvgpr_write_b32 a118, v92
  v_accvgpr_write_b32 a119, v94
  s_waitcnt lgkmcnt(12)
  v_mfma_f32_4x4x4_16b_bf16 v[88:91], v[100:101], a[176:177], 0
  v_mfma_f32_4x4x4_16b_bf16 v[92:95], v[102:103], a[178:179], 0
  v_cvt_pk_bf16_f32 v72, v72, v73
  v_cvt_pk_bf16_f32 v74, v74, v75
  v_mfma_f32_16x16x32_bf16 v[32:35], a[104:107], a[200:203], v[32:35]
  ds_read_b64_tr_b16 a[152:153], v17 offset:16
  ds_read_b128 a[192:195], v9 offset:256
  v_cvt_pk_bf16_f32 v76, v76, v77
  v_mfma_f32_16x16x32_bf16 v[56:59], a[104:107], a[204:207], v[56:59]
  ds_read_b64_tr_b16 a[154:155], v17 offset:784
  buffer_load_dwordx4 v16, s[12:15], s36 offen offset:2048 lds
  v_accvgpr_write_b32 a120, v72
  v_cvt_pk_bf16_f32 v78, v78, v79
  v_accvgpr_write_b32 a121, v74
  v_accvgpr_write_b32 a122, v76
  v_accvgpr_write_b32 a123, v78
  s_waitcnt lgkmcnt(12)
  v_mfma_f32_4x4x4_16b_bf16 v[72:75], v[100:101], a[180:181], 0
  v_mfma_f32_4x4x4_16b_bf16 v[76:79], v[102:103], a[182:183], 0
  v_cvt_pk_bf16_f32 v80, v80, v81
  v_cvt_pk_bf16_f32 v82, v82, v83
  v_mfma_f32_16x16x32_bf16 v[36:39], a[108:111], a[200:203], v[36:39]
  ds_read_b64_tr_b16 a[156:157], v17 offset:24
  ds_read_b128 a[196:199], v9 offset:12544
  v_cvt_pk_bf16_f32 v84, v84, v85
  s_add_u32 m0, s34, 52224
  s_add_u32 s36, s36, 12288
  v_mfma_f32_16x16x32_bf16 v[60:63], a[108:111], a[204:207], v[60:63]
  ds_read_b64_tr_b16 a[158:159], v17 offset:792
  buffer_load_dwordx4 v14, s[12:15], s36 offen offset:0 lds
  v_accvgpr_write_b32 a124, v80
  v_cvt_pk_bf16_f32 v86, v86, v87
  v_accvgpr_write_b32 a125, v82
  v_accvgpr_write_b32 a126, v84
  v_accvgpr_write_b32 a127, v86
  s_waitcnt lgkmcnt(13)
  v_mfma_f32_4x4x4_16b_bf16 v[80:83], v[100:101], a[184:185], 0
  v_mfma_f32_4x4x4_16b_bf16 v[84:87], v[102:103], a[186:187], 0
  v_cvt_pk_bf16_f32 v88, v88, v89
  v_cvt_pk_bf16_f32 v90, v90, v91
  v_mfma_f32_16x16x32_bf16 v[40:43], a[112:115], a[200:203], v[40:43]
  ds_read_b64_tr_b16 a[160:161], v17 offset:32
  v_cvt_pk_bf16_f32 v92, v92, v93
  v_accvgpr_write_b32 a128, v88
  v_mfma_f32_16x16x32_bf16 v[64:67], a[112:115], a[204:207], v[64:67]
  ds_read_b64_tr_b16 a[162:163], v17 offset:800
  buffer_load_dwordx4 v15, s[12:15], s36 offen offset:1024 lds
  v_cvt_pk_bf16_f32 v94, v94, v95
  v_accvgpr_write_b32 a129, v90
  v_accvgpr_write_b32 a130, v92
  v_accvgpr_write_b32 a131, v94
  s_waitcnt lgkmcnt(9)
  v_and_b32 v96, v19, v96
  v_and_b32 v97, v20, v97
  v_mfma_f32_4x4x4_16b_bf16 v[88:91], v[100:101], a[188:189], 0
  v_mfma_f32_4x4x4_16b_bf16 v[92:95], v[102:103], a[190:191], 0
  v_and_b32 v98, v19, v98
  v_and_b32 v99, v20, v99
  v_mfma_f32_16x16x32_bf16 v[44:47], a[116:119], a[200:203], v[44:47]
  ds_read_b64_tr_b16 a[164:165], v17 offset:40
  v_cvt_pk_bf16_f32 v72, v72, v73
  v_cvt_pk_bf16_f32 v74, v74, v75
  v_mfma_f32_16x16x32_bf16 v[68:71], a[116:119], a[204:207], v[68:71]
  ds_read_b64_tr_b16 a[166:167], v17 offset:808
  buffer_load_dwordx4 v16, s[12:15], s36 offen offset:2048 lds
  v_cvt_pk_bf16_f32 v76, v76, v77
  v_accvgpr_write_b32 a132, v72
  v_cvt_pk_bf16_f32 v78, v78, v79
  v_accvgpr_write_b32 a133, v74
  v_accvgpr_write_b32 a134, v76
  v_accvgpr_write_b32 a135, v78
  v_mfma_f32_4x4x4_16b_bf16 v[72:75], v[96:97], a[144:145], 0
  v_mfma_f32_4x4x4_16b_bf16 v[76:79], v[98:99], a[146:147], 0
  v_cvt_pk_bf16_f32 v80, v80, v81
  v_cvt_pk_bf16_f32 v82, v82, v83
  s_waitcnt vmcnt(6)
  v_mfma_f32_16x16x32_bf16 v[24:27], a[120:123], a[208:211], v[24:27]
  ds_read_b64_tr_b16 a[168:169], v17 offset:24576
  v_cvt_pk_bf16_f32 v84, v84, v85
  s_add_u32 m0, s34, 73728
  s_add_u32 s36, s36, 12288
  v_mfma_f32_16x16x32_bf16 v[48:51], a[120:123], a[212:215], v[48:51]
  ds_read_b64_tr_b16 a[170:171], v17 offset:25344
  buffer_load_dwordx4 v14, s[12:15], s36 offen offset:0 lds
  v_accvgpr_write_b32 a136, v80
  v_cvt_pk_bf16_f32 v86, v86, v87
  v_accvgpr_write_b32 a137, v82
  v_accvgpr_write_b32 a138, v84
  v_accvgpr_write_b32 a139, v86
  s_waitcnt lgkmcnt(12)
  v_mfma_f32_4x4x4_16b_bf16 v[80:83], v[96:97], a[148:149], 0
  v_mfma_f32_4x4x4_16b_bf16 v[84:87], v[98:99], a[150:151], 0
  v_cvt_pk_bf16_f32 v88, v88, v89
  v_cvt_pk_bf16_f32 v90, v90, v91
  v_mfma_f32_16x16x32_bf16 v[28:31], a[124:127], a[208:211], v[28:31]
  ds_read_b64_tr_b16 a[172:173], v17 offset:24584
  ds_read_b128 v[100:103], v18 offset:448
  v_cvt_pk_bf16_f32 v92, v92, v93
  v_mfma_f32_16x16x32_bf16 v[52:55], a[124:127], a[212:215], v[52:55]
  ds_read_b64_tr_b16 a[174:175], v17 offset:25352
  buffer_load_dwordx4 v15, s[12:15], s36 offen offset:1024 lds
  v_accvgpr_write_b32 a140, v88
  v_cvt_pk_bf16_f32 v94, v94, v95
  v_accvgpr_write_b32 a141, v90
  v_accvgpr_write_b32 a142, v92
  v_accvgpr_write_b32 a143, v94
  s_waitcnt lgkmcnt(12)
  v_mfma_f32_4x4x4_16b_bf16 v[88:91], v[96:97], a[152:153], 0
  v_mfma_f32_4x4x4_16b_bf16 v[92:95], v[98:99], a[154:155], 0
  v_cvt_pk_bf16_f32 v112, v72, v73
  v_cvt_pk_bf16_f32 v113, v74, v75
  v_mfma_f32_16x16x32_bf16 v[32:35], a[128:131], a[208:211], v[32:35]
  ds_read_b64_tr_b16 a[176:177], v17 offset:24592
  ds_read_b128 a[200:203], v10 offset:256
  v_cvt_pk_bf16_f32 v114, v76, v77
  v_mfma_f32_16x16x32_bf16 v[56:59], a[128:131], a[212:215], v[56:59]
  ds_read_b64_tr_b16 a[178:179], v17 offset:25360
  buffer_load_dwordx4 v16, s[12:15], s36 offen offset:2048 lds
  v_cvt_pk_bf16_f32 v115, v78, v79
  s_waitcnt lgkmcnt(12)
  v_mfma_f32_4x4x4_16b_bf16 v[72:75], v[96:97], a[156:157], 0
  v_mfma_f32_4x4x4_16b_bf16 v[76:79], v[98:99], a[158:159], 0
  v_cvt_pk_bf16_f32 v116, v80, v81
  v_cvt_pk_bf16_f32 v117, v82, v83
  v_mfma_f32_16x16x32_bf16 v[36:39], a[132:135], a[208:211], v[36:39]
  ds_read_b64_tr_b16 a[180:181], v17 offset:24600
  ds_read_b128 a[204:207], v10 offset:12544
  v_cvt_pk_bf16_f32 v118, v84, v85
  s_add_u32 m0, s34, 76800
  s_add_u32 s36, s36, 12288
  v_mfma_f32_16x16x32_bf16 v[60:63], a[132:135], a[212:215], v[60:63]
  ds_read_b64_tr_b16 a[182:183], v17 offset:25368
  buffer_load_dwordx4 v14, s[12:15], s36 offen offset:0 lds
  v_cvt_pk_bf16_f32 v119, v86, v87
  s_waitcnt lgkmcnt(13)
  v_mfma_f32_4x4x4_16b_bf16 v[80:83], v[96:97], a[160:161], 0
  v_mfma_f32_4x4x4_16b_bf16 v[84:87], v[98:99], a[162:163], 0
  v_cvt_pk_bf16_f32 v120, v88, v89
  v_cvt_pk_bf16_f32 v121, v90, v91
  v_mfma_f32_16x16x32_bf16 v[40:43], a[136:139], a[208:211], v[40:43]
  ds_read_b64_tr_b16 a[184:185], v17 offset:24608
  v_cvt_pk_bf16_f32 v122, v92, v93
  v_mfma_f32_16x16x32_bf16 v[64:67], a[136:139], a[212:215], v[64:67]
  ds_read_b64_tr_b16 a[186:187], v17 offset:25376
  buffer_load_dwordx4 v15, s[12:15], s36 offen offset:1024 lds
  v_cvt_pk_bf16_f32 v123, v94, v95
  s_waitcnt lgkmcnt(9)
  v_and_b32 v100, v19, v100
  v_and_b32 v101, v20, v101
  v_mfma_f32_4x4x4_16b_bf16 v[88:91], v[96:97], a[164:165], 0
  v_mfma_f32_4x4x4_16b_bf16 v[92:95], v[98:99], a[166:167], 0
  v_and_b32 v102, v19, v102
  v_and_b32 v103, v20, v103
  v_mfma_f32_16x16x32_bf16 v[44:47], a[140:143], a[208:211], v[44:47]
  ds_read_b64_tr_b16 a[188:189], v17 offset:24616
  v_cvt_pk_bf16_f32 v124, v72, v73
  v_mfma_f32_16x16x32_bf16 v[68:71], a[140:143], a[212:215], v[68:71]
  ds_read_b64_tr_b16 a[190:191], v17 offset:25384
  buffer_load_dwordx4 v16, s[12:15], s36 offen offset:2048 lds
  v_cvt_pk_bf16_f32 v125, v74, v75
  v_cvt_pk_bf16_f32 v126, v76, v77
  v_cvt_pk_bf16_f32 v127, v78, v79
  v_mfma_f32_4x4x4_16b_bf16 v[72:75], v[100:101], a[168:169], 0
  v_mfma_f32_4x4x4_16b_bf16 v[76:79], v[102:103], a[170:171], 0
  v_cvt_pk_bf16_f32 v128, v80, v81
  v_cvt_pk_bf16_f32 v129, v82, v83
  s_waitcnt vmcnt(6)
  v_mfma_f32_16x16x32_bf16 v[24:27], v[112:115], a[192:195], v[24:27]
  ds_read_b64_tr_b16 a[144:145], v104 offset:0
  v_cvt_pk_bf16_f32 v130, v84, v85
  s_add_u32 m0, s34, 0
  s_add_u32 s36, s36, 12288
  v_mfma_f32_16x16x32_bf16 v[48:51], v[112:115], a[196:199], v[48:51]
  ds_read_b64_tr_b16 a[146:147], v104 offset:768
  buffer_load_dwordx4 v14, s[12:15], s36 offen offset:0 lds
  v_cvt_pk_bf16_f32 v131, v86, v87
  s_waitcnt lgkmcnt(12)
  v_mfma_f32_4x4x4_16b_bf16 v[80:83], v[100:101], a[172:173], 0
  v_mfma_f32_4x4x4_16b_bf16 v[84:87], v[102:103], a[174:175], 0
  v_cvt_pk_bf16_f32 v132, v88, v89
  v_cvt_pk_bf16_f32 v133, v90, v91
  v_mfma_f32_16x16x32_bf16 v[28:31], v[116:119], a[192:195], v[28:31]
  ds_read_b64_tr_b16 a[148:149], v104 offset:8
  ds_read_b128 v[96:99], v18 offset:512
  v_cvt_pk_bf16_f32 v134, v92, v93
  v_mfma_f32_16x16x32_bf16 v[52:55], v[116:119], a[196:199], v[52:55]
  ds_read_b64_tr_b16 a[150:151], v104 offset:776
  buffer_load_dwordx4 v15, s[12:15], s36 offen offset:1024 lds
  v_cvt_pk_bf16_f32 v135, v94, v95
  s_waitcnt lgkmcnt(12)
  v_mfma_f32_4x4x4_16b_bf16 v[88:91], v[100:101], a[176:177], 0
  v_mfma_f32_4x4x4_16b_bf16 v[92:95], v[102:103], a[178:179], 0
  v_cvt_pk_bf16_f32 v136, v72, v73
  v_cvt_pk_bf16_f32 v137, v74, v75
  v_mfma_f32_16x16x32_bf16 v[32:35], v[120:123], a[192:195], v[32:35]
  ds_read_b64_tr_b16 a[152:153], v104 offset:16
  ds_read_b128 a[208:211], v7 offset:512
  v_cvt_pk_bf16_f32 v138, v76, v77
  v_mfma_f32_16x16x32_bf16 v[56:59], v[120:123], a[196:199], v[56:59]
  ds_read_b64_tr_b16 a[154:155], v104 offset:784
  buffer_load_dwordx4 v16, s[12:15], s36 offen offset:2048 lds
  v_cvt_pk_bf16_f32 v139, v78, v79
  s_waitcnt lgkmcnt(12)
  v_mfma_f32_4x4x4_16b_bf16 v[72:75], v[100:101], a[180:181], 0
  v_mfma_f32_4x4x4_16b_bf16 v[76:79], v[102:103], a[182:183], 0
  v_cvt_pk_bf16_f32 v140, v80, v81
  v_cvt_pk_bf16_f32 v141, v82, v83
  v_mfma_f32_16x16x32_bf16 v[36:39], v[124:127], a[192:195], v[36:39]
  ds_read_b64_tr_b16 a[156:157], v104 offset:24
  ds_read_b128 a[212:215], v7 offset:12800
  v_cvt_pk_bf16_f32 v142, v84, v85
  s_add_u32 m0, s34, 3072
  s_add_u32 s36, s36, 12288
  v_mfma_f32_16x16x32_bf16 v[60:63], v[124:127], a[196:199], v[60:63]
  ds_read_b64_tr_b16 a[158:159], v104 offset:792
  buffer_load_dwordx4 v14, s[12:15], s36 offen offset:0 lds
  v_cvt_pk_bf16_f32 v143, v86, v87
  s_waitcnt lgkmcnt(13)
  v_mfma_f32_4x4x4_16b_bf16 v[80:83], v[100:101], a[184:185], 0
  v_mfma_f32_4x4x4_16b_bf16 v[84:87], v[102:103], a[186:187], 0
  v_cvt_pk_bf16_f32 v144, v88, v89
  v_cvt_pk_bf16_f32 v145, v90, v91
  v_mfma_f32_16x16x32_bf16 v[40:43], v[128:131], a[192:195], v[40:43]
  ds_read_b64_tr_b16 a[160:161], v104 offset:32
  v_cvt_pk_bf16_f32 v146, v92, v93
  v_mfma_f32_16x16x32_bf16 v[64:67], v[128:131], a[196:199], v[64:67]
  ds_read_b64_tr_b16 a[162:163], v104 offset:800
  buffer_load_dwordx4 v15, s[12:15], s36 offen offset:1024 lds
  v_cvt_pk_bf16_f32 v147, v94, v95
  s_waitcnt lgkmcnt(9)
  v_and_b32 v96, v19, v96
  v_and_b32 v97, v20, v97
  v_mfma_f32_4x4x4_16b_bf16 v[88:91], v[100:101], a[188:189], 0
  v_mfma_f32_4x4x4_16b_bf16 v[92:95], v[102:103], a[190:191], 0
  v_and_b32 v98, v19, v98
  v_and_b32 v99, v20, v99
  v_mfma_f32_16x16x32_bf16 v[44:47], v[132:135], a[192:195], v[44:47]
  ds_read_b64_tr_b16 a[164:165], v104 offset:40
  v_cvt_pk_bf16_f32 v148, v72, v73
  v_mfma_f32_16x16x32_bf16 v[68:71], v[132:135], a[196:199], v[68:71]
  ds_read_b64_tr_b16 a[166:167], v104 offset:808
  buffer_load_dwordx4 v16, s[12:15], s36 offen offset:2048 lds
  v_cvt_pk_bf16_f32 v149, v74, v75
  v_cvt_pk_bf16_f32 v150, v76, v77
  v_cvt_pk_bf16_f32 v151, v78, v79
  v_mfma_f32_4x4x4_16b_bf16 v[72:75], v[96:97], a[144:145], 0
  v_mfma_f32_4x4x4_16b_bf16 v[76:79], v[98:99], a[146:147], 0
  v_cvt_pk_bf16_f32 v152, v80, v81
  v_cvt_pk_bf16_f32 v153, v82, v83
  s_waitcnt vmcnt(6)
  v_mfma_f32_16x16x32_bf16 v[24:27], v[136:139], a[200:203], v[24:27]
  ds_read_b64_tr_b16 a[168:169], v104 offset:24576
  v_cvt_pk_bf16_f32 v154, v84, v85
  s_add_u32 m0, s34, 24576
  s_add_u32 s36, s36, 12288
  v_mfma_f32_16x16x32_bf16 v[48:51], v[136:139], a[204:207], v[48:51]
  ds_read_b64_tr_b16 a[170:171], v104 offset:25344
  buffer_load_dwordx4 v14, s[12:15], s36 offen offset:0 lds
  v_cvt_pk_bf16_f32 v155, v86, v87
  s_waitcnt lgkmcnt(12)
  v_mfma_f32_4x4x4_16b_bf16 v[80:83], v[96:97], a[148:149], 0
  v_mfma_f32_4x4x4_16b_bf16 v[84:87], v[98:99], a[150:151], 0
  v_cvt_pk_bf16_f32 v156, v88, v89
  v_cvt_pk_bf16_f32 v157, v90, v91
  v_mfma_f32_16x16x32_bf16 v[28:31], v[140:143], a[200:203], v[28:31]
  ds_read_b64_tr_b16 a[172:173], v104 offset:24584
  ds_read_b128 v[100:103], v18 offset:576
  v_cvt_pk_bf16_f32 v158, v92, v93
  v_mfma_f32_16x16x32_bf16 v[52:55], v[140:143], a[204:207], v[52:55]
  ds_read_b64_tr_b16 a[174:175], v104 offset:25352
  buffer_load_dwordx4 v15, s[12:15], s36 offen offset:1024 lds
  v_cvt_pk_bf16_f32 v159, v94, v95
  s_waitcnt lgkmcnt(12)
  v_mfma_f32_4x4x4_16b_bf16 v[88:91], v[96:97], a[152:153], 0
  v_mfma_f32_4x4x4_16b_bf16 v[92:95], v[98:99], a[154:155], 0
  v_cvt_pk_bf16_f32 v160, v72, v73
  v_cvt_pk_bf16_f32 v161, v74, v75
  v_mfma_f32_16x16x32_bf16 v[32:35], v[144:147], a[200:203], v[32:35]
  ds_read_b64_tr_b16 a[176:177], v104 offset:24592
  ds_read_b128 a[192:195], v8 offset:512
  v_cvt_pk_bf16_f32 v162, v76, v77
  v_mfma_f32_16x16x32_bf16 v[56:59], v[144:147], a[204:207], v[56:59]
  ds_read_b64_tr_b16 a[178:179], v104 offset:25360
  buffer_load_dwordx4 v16, s[12:15], s36 offen offset:2048 lds
  v_cvt_pk_bf16_f32 v163, v78, v79
  s_waitcnt lgkmcnt(12)
  v_mfma_f32_4x4x4_16b_bf16 v[72:75], v[96:97], a[156:157], 0
  v_mfma_f32_4x4x4_16b_bf16 v[76:79], v[98:99], a[158:159], 0
  v_cvt_pk_bf16_f32 v164, v80, v81
  v_cvt_pk_bf16_f32 v165, v82, v83
  v_mfma_f32_16x16x32_bf16 v[36:39], v[148:151], a[200:203], v[36:39]
  ds_read_b64_tr_b16 a[180:181], v104 offset:24600
  ds_read_b128 a[196:199], v8 offset:12800
  v_cvt_pk_bf16_f32 v166, v84, v85
  s_add_u32 m0, s34, 27648
  s_add_u32 s36, s36, 12288
  v_mfma_f32_16x16x32_bf16 v[60:63], v[148:151], a[204:207], v[60:63]
  ds_read_b64_tr_b16 a[182:183], v104 offset:25368
  buffer_load_dwordx4 v14, s[12:15], s36 offen offset:0 lds
  v_cvt_pk_bf16_f32 v167, v86, v87
  s_waitcnt lgkmcnt(13)
  v_mfma_f32_4x4x4_16b_bf16 v[80:83], v[96:97], a[160:161], 0
  v_mfma_f32_4x4x4_16b_bf16 v[84:87], v[98:99], a[162:163], 0
  v_cvt_pk_bf16_f32 v168, v88, v89
  v_cvt_pk_bf16_f32 v169, v90, v91
  v_mfma_f32_16x16x32_bf16 v[40:43], v[152:155], a[200:203], v[40:43]
  ds_read_b64_tr_b16 a[184:185], v104 offset:24608
  v_cvt_pk_bf16_f32 v170, v92, v93
  v_mfma_f32_16x16x32_bf16 v[64:67], v[152:155], a[204:207], v[64:67]
  ds_read_b64_tr_b16 a[186:187], v104 offset:25376
  buffer_load_dwordx4 v15, s[12:15], s36 offen offset:1024 lds
  v_cvt_pk_bf16_f32 v171, v94, v95
  s_waitcnt lgkmcnt(9)
  v_and_b32 v100, v19, v100
  v_and_b32 v101, v20, v101
  v_mfma_f32_4x4x4_16b_bf16 v[88:91], v[96:97], a[164:165], 0
  v_mfma_f32_4x4x4_16b_bf16 v[92:95], v[98:99], a[166:167], 0
  v_and_b32 v102, v19, v102
  v_and_b32 v103, v20, v103
  v_mfma_f32_16x16x32_bf16 v[44:47], v[156:159], a[200:203], v[44:47]
  ds_read_b64_tr_b16 a[188:189], v104 offset:24616
  v_cvt_pk_bf16_f32 v172, v72, v73
  v_mfma_f32_16x16x32_bf16 v[68:71], v[156:159], a[204:207], v[68:71]
  ds_read_b64_tr_b16 a[190:191], v104 offset:25384
  buffer_load_dwordx4 v16, s[12:15], s36 offen offset:2048 lds
  v_cvt_pk_bf16_f32 v173, v74, v75
  v_cvt_pk_bf16_f32 v174, v76, v77
  v_cvt_pk_bf16_f32 v175, v78, v79
  v_mfma_f32_4x4x4_16b_bf16 v[72:75], v[100:101], a[168:169], 0
  v_mfma_f32_4x4x4_16b_bf16 v[76:79], v[102:103], a[170:171], 0
  v_cvt_pk_bf16_f32 v176, v80, v81
  v_cvt_pk_bf16_f32 v177, v82, v83
  s_waitcnt vmcnt(6)
  v_mfma_f32_16x16x32_bf16 v[24:27], v[160:163], a[208:211], v[24:27]
  ds_read_b64_tr_b16 a[144:145], v17 offset:0
  v_cvt_pk_bf16_f32 v178, v84, v85
  s_add_u32 m0, s33, 122880
  v_mfma_f32_16x16x32_bf16 v[48:51], v[160:163], a[212:215], v[48:51]
  ds_read_b64_tr_b16 a[146:147], v17 offset:768
  buffer_load_dwordx4 v1, s[4:7], s21 offen nt lds
  v_cvt_pk_bf16_f32 v179, v86, v87
  s_waitcnt lgkmcnt(12)
  v_mfma_f32_4x4x4_16b_bf16 v[80:83], v[100:101], a[172:173], 0
  v_mfma_f32_4x4x4_16b_bf16 v[84:87], v[102:103], a[174:175], 0
  v_cvt_pk_bf16_f32 v180, v88, v89
  v_cvt_pk_bf16_f32 v181, v90, v91
  v_mfma_f32_16x16x32_bf16 v[28:31], v[164:167], a[208:211], v[28:31]
  ds_read_b64_tr_b16 a[148:149], v17 offset:8
  ds_read_b128 v[96:99], v18 offset:640
  v_cvt_pk_bf16_f32 v182, v92, v93
  s_add_u32 m0, s33, 126976
  v_mfma_f32_16x16x32_bf16 v[52:55], v[164:167], a[212:215], v[52:55]
  ds_read_b64_tr_b16 a[150:151], v17 offset:776
  buffer_load_dwordx4 v2, s[4:7], s21 offen nt lds
  v_cvt_pk_bf16_f32 v183, v94, v95
  s_waitcnt lgkmcnt(12)
  v_mfma_f32_4x4x4_16b_bf16 v[88:91], v[100:101], a[176:177], 0
  v_mfma_f32_4x4x4_16b_bf16 v[92:95], v[102:103], a[178:179], 0
  v_cvt_pk_bf16_f32 v184, v72, v73
  v_cvt_pk_bf16_f32 v185, v74, v75
  v_mfma_f32_16x16x32_bf16 v[32:35], v[168:171], a[208:211], v[32:35]
  ds_read_b64_tr_b16 a[152:153], v17 offset:16
  ds_read_b128 a[200:203], v9 offset:512
  v_cvt_pk_bf16_f32 v186, v76, v77
  s_add_u32 m0, s33, 131072
  v_mfma_f32_16x16x32_bf16 v[56:59], v[168:171], a[212:215], v[56:59]
  ds_read_b64_tr_b16 a[154:155], v17 offset:784
  buffer_load_dwordx4 v3, s[4:7], s21 offen nt lds
  v_cvt_pk_bf16_f32 v187, v78, v79
  s_waitcnt lgkmcnt(12)
  v_mfma_f32_4x4x4_16b_bf16 v[72:75], v[100:101], a[180:181], 0
  v_mfma_f32_4x4x4_16b_bf16 v[76:79], v[102:103], a[182:183], 0
  v_cvt_pk_bf16_f32 v188, v80, v81
  v_cvt_pk_bf16_f32 v189, v82, v83
  v_mfma_f32_16x16x32_bf16 v[36:39], v[172:175], a[208:211], v[36:39]
  ds_read_b64_tr_b16 a[156:157], v17 offset:24
  ds_read_b128 a[204:207], v9 offset:12800
  v_cvt_pk_bf16_f32 v190, v84, v85
  s_add_u32 m0, s33, 135168
  s_add_u32 s21, s21, 6291456
  v_mfma_f32_16x16x32_bf16 v[60:63], v[172:175], a[212:215], v[60:63]
  ds_read_b64_tr_b16 a[158:159], v17 offset:792
  buffer_load_dwordx4 v1, s[4:7], s37 offen nt lds
  v_cvt_pk_bf16_f32 v191, v86, v87
  s_waitcnt lgkmcnt(13)
  v_mfma_f32_4x4x4_16b_bf16 v[80:83], v[100:101], a[184:185], 0
  v_mfma_f32_4x4x4_16b_bf16 v[84:87], v[102:103], a[186:187], 0
  v_cvt_pk_bf16_f32 v192, v88, v89
  v_cvt_pk_bf16_f32 v193, v90, v91
  v_mfma_f32_16x16x32_bf16 v[40:43], v[176:179], a[208:211], v[40:43]
  ds_read_b64_tr_b16 a[160:161], v17 offset:32
  v_cvt_pk_bf16_f32 v194, v92, v93
  s_add_u32 m0, s33, 139264
  v_mfma_f32_16x16x32_bf16 v[64:67], v[176:179], a[212:215], v[64:67]
  ds_read_b64_tr_b16 a[162:163], v17 offset:800
  buffer_load_dwordx4 v2, s[4:7], s37 offen nt lds
  v_cvt_pk_bf16_f32 v195, v94, v95
  s_waitcnt lgkmcnt(9)
  v_and_b32 v96, v19, v96
  v_and_b32 v97, v20, v97
  v_mfma_f32_4x4x4_16b_bf16 v[88:91], v[100:101], a[188:189], 0
  v_mfma_f32_4x4x4_16b_bf16 v[92:95], v[102:103], a[190:191], 0
  v_and_b32 v98, v19, v98
  v_and_b32 v99, v20, v99
  v_mfma_f32_16x16x32_bf16 v[44:47], v[180:183], a[208:211], v[44:47]
  ds_read_b64_tr_b16 a[164:165], v17 offset:40
  v_cvt_pk_bf16_f32 v196, v72, v73
  s_add_u32 m0, s33, 143360
  v_mfma_f32_16x16x32_bf16 v[68:71], v[180:183], a[212:215], v[68:71]
  ds_read_b64_tr_b16 a[166:167], v17 offset:808
  buffer_load_dwordx4 v3, s[4:7], s37 offen nt lds
  s_add_u32 s37, s37, 6291456
  v_cvt_pk_bf16_f32 v197, v74, v75
  v_cvt_pk_bf16_f32 v198, v76, v77
  v_cvt_pk_bf16_f32 v199, v78, v79
  s_waitcnt lgkmcnt(0)
  s_barrier
  v_mfma_f32_4x4x4_16b_bf16 v[72:75], v[96:97], a[144:145], 0
  v_mfma_f32_4x4x4_16b_bf16 v[76:79], v[98:99], a[146:147], 0
  v_cvt_pk_bf16_f32 v200, v80, v81
  v_cvt_pk_bf16_f32 v201, v82, v83
  s_waitcnt vmcnt(6)
  v_mfma_f32_16x16x32_bf16 v[24:27], v[184:187], a[192:195], v[24:27]
  ds_read_b64_tr_b16 a[168:169], v17 offset:24576
  v_cvt_pk_bf16_f32 v202, v84, v85
  s_add_u32 m0, s33, 49152
  v_mfma_f32_16x16x32_bf16 v[48:51], v[184:187], a[196:199], v[48:51]
  ds_read_b64_tr_b16 a[170:171], v17 offset:25344
  buffer_load_dwordx4 v1, s[4:7], s21 offen nt lds
  v_cvt_pk_bf16_f32 v203, v86, v87
  v_mfma_f32_4x4x4_16b_bf16 v[80:83], v[96:97], a[148:149], 0
  v_mfma_f32_4x4x4_16b_bf16 v[84:87], v[98:99], a[150:151], 0
  v_cvt_pk_bf16_f32 v204, v88, v89
  v_cvt_pk_bf16_f32 v205, v90, v91
  v_mfma_f32_16x16x32_bf16 v[28:31], v[188:191], a[192:195], v[28:31]
  ds_read_b64_tr_b16 a[172:173], v17 offset:24584
  ds_read_b128 v[100:103], v18 offset:704
  v_cvt_pk_bf16_f32 v206, v92, v93
  s_add_u32 m0, s33, 53248
  v_mfma_f32_16x16x32_bf16 v[52:55], v[188:191], a[196:199], v[52:55]
  ds_read_b64_tr_b16 a[174:175], v17 offset:25352
  buffer_load_dwordx4 v2, s[4:7], s21 offen nt lds
  v_cvt_pk_bf16_f32 v207, v94, v95
  v_mfma_f32_4x4x4_16b_bf16 v[88:91], v[96:97], a[152:153], 0
  v_mfma_f32_4x4x4_16b_bf16 v[92:95], v[98:99], a[154:155], 0
  v_cvt_pk_bf16_f32 v208, v72, v73
  v_cvt_pk_bf16_f32 v209, v74, v75
  v_mfma_f32_16x16x32_bf16 v[32:35], v[192:195], a[192:195], v[32:35]
  ds_read_b64_tr_b16 a[176:177], v17 offset:24592
  ds_read_b128 a[208:211], v10 offset:512
  v_cvt_pk_bf16_f32 v210, v76, v77
  s_add_u32 m0, s33, 57344
  v_mfma_f32_16x16x32_bf16 v[56:59], v[192:195], a[196:199], v[56:59]
  ds_read_b64_tr_b16 a[178:179], v17 offset:25360
  buffer_load_dwordx4 v3, s[4:7], s21 offen nt lds
  v_cvt_pk_bf16_f32 v211, v78, v79
  v_mfma_f32_4x4x4_16b_bf16 v[72:75], v[96:97], a[156:157], 0
  v_mfma_f32_4x4x4_16b_bf16 v[76:79], v[98:99], a[158:159], 0
  v_cvt_pk_bf16_f32 v212, v80, v81
  v_cvt_pk_bf16_f32 v213, v82, v83
  v_mfma_f32_16x16x32_bf16 v[36:39], v[196:199], a[192:195], v[36:39]
  ds_read_b64_tr_b16 a[180:181], v17 offset:24600
  ds_read_b128 a[212:215], v10 offset:12800
  v_cvt_pk_bf16_f32 v214, v84, v85
  s_add_u32 m0, s33, 61440
  s_add_u32 s21, s21, 6291456
  v_mfma_f32_16x16x32_bf16 v[60:63], v[196:199], a[196:199], v[60:63]
  ds_read_b64_tr_b16 a[182:183], v17 offset:25368
  buffer_load_dwordx4 v1, s[4:7], s37 offen nt lds
  v_cvt_pk_bf16_f32 v215, v86, v87
  v_mfma_f32_4x4x4_16b_bf16 v[80:83], v[96:97], a[160:161], 0
  v_mfma_f32_4x4x4_16b_bf16 v[84:87], v[98:99], a[162:163], 0
  v_cvt_pk_bf16_f32 v216, v88, v89
  v_cvt_pk_bf16_f32 v217, v90, v91
  v_mfma_f32_16x16x32_bf16 v[40:43], v[200:203], a[192:195], v[40:43]
  ds_read_b64_tr_b16 a[184:185], v17 offset:24608
  v_cvt_pk_bf16_f32 v218, v92, v93
  s_add_u32 m0, s33, 65536
  v_mfma_f32_16x16x32_bf16 v[64:67], v[200:203], a[196:199], v[64:67]
  ds_read_b64_tr_b16 a[186:187], v17 offset:25376
  buffer_load_dwordx4 v2, s[4:7], s37 offen nt lds
  v_cvt_pk_bf16_f32 v219, v94, v95
  s_waitcnt lgkmcnt(9)
  v_and_b32 v100, v19, v100
  v_and_b32 v101, v20, v101
  v_mfma_f32_4x4x4_16b_bf16 v[88:91], v[96:97], a[164:165], 0
  v_mfma_f32_4x4x4_16b_bf16 v[92:95], v[98:99], a[166:167], 0
  v_and_b32 v102, v19, v102
  v_and_b32 v103, v20, v103
  v_mfma_f32_16x16x32_bf16 v[44:47], v[204:207], a[192:195], v[44:47]
  ds_read_b64_tr_b16 a[188:189], v17 offset:24616
  v_cvt_pk_bf16_f32 v220, v72, v73
  s_add_u32 m0, s33, 69632
  v_mfma_f32_16x16x32_bf16 v[68:71], v[204:207], a[196:199], v[68:71]
  ds_read_b64_tr_b16 a[190:191], v17 offset:25384
  buffer_load_dwordx4 v3, s[4:7], s37 offen nt lds
  s_add_u32 s37, s37, 6291456
  v_cvt_pk_bf16_f32 v221, v74, v75
  v_cvt_pk_bf16_f32 v222, v76, v77
  v_cvt_pk_bf16_f32 v223, v78, v79
  v_mfma_f32_4x4x4_16b_bf16 v[72:75], v[100:101], a[168:169], 0
  v_mfma_f32_4x4x4_16b_bf16 v[76:79], v[102:103], a[170:171], 0
  v_cvt_pk_bf16_f32 v224, v80, v81
  v_cvt_pk_bf16_f32 v225, v82, v83
  v_mfma_f32_16x16x32_bf16 v[24:27], v[208:211], a[200:203], v[24:27]
  v_cvt_pk_bf16_f32 v226, v84, v85
  v_mfma_f32_16x16x32_bf16 v[48:51], v[208:211], a[204:207], v[48:51]
  v_cvt_pk_bf16_f32 v227, v86, v87
  s_waitcnt lgkmcnt(10)
  v_mfma_f32_4x4x4_16b_bf16 v[80:83], v[100:101], a[172:173], 0
  v_mfma_f32_4x4x4_16b_bf16 v[84:87], v[102:103], a[174:175], 0
  v_cvt_pk_bf16_f32 v228, v88, v89
  v_cvt_pk_bf16_f32 v229, v90, v91
  v_mfma_f32_16x16x32_bf16 v[28:31], v[212:215], a[200:203], v[28:31]
  v_cvt_pk_bf16_f32 v230, v92, v93
  v_mfma_f32_16x16x32_bf16 v[52:55], v[212:215], a[204:207], v[52:55]
  v_cvt_pk_bf16_f32 v231, v94, v95
  s_waitcnt lgkmcnt(7)
  v_mfma_f32_4x4x4_16b_bf16 v[88:91], v[100:101], a[176:177], 0
  v_mfma_f32_4x4x4_16b_bf16 v[92:95], v[102:103], a[178:179], 0
  v_cvt_pk_bf16_f32 v232, v72, v73
  v_cvt_pk_bf16_f32 v233, v74, v75
  v_mfma_f32_16x16x32_bf16 v[32:35], v[216:219], a[200:203], v[32:35]
  v_cvt_pk_bf16_f32 v234, v76, v77
  v_mfma_f32_16x16x32_bf16 v[56:59], v[216:219], a[204:207], v[56:59]
  v_cvt_pk_bf16_f32 v235, v78, v79
  s_waitcnt lgkmcnt(4)
  v_mfma_f32_4x4x4_16b_bf16 v[72:75], v[100:101], a[180:181], 0
  v_mfma_f32_4x4x4_16b_bf16 v[76:79], v[102:103], a[182:183], 0
  v_cvt_pk_bf16_f32 v236, v80, v81
  v_cvt_pk_bf16_f32 v237, v82, v83
  v_mfma_f32_16x16x32_bf16 v[36:39], v[220:223], a[200:203], v[36:39]
  v_cvt_pk_bf16_f32 v238, v84, v85
  v_mfma_f32_16x16x32_bf16 v[60:63], v[220:223], a[204:207], v[60:63]
  v_cvt_pk_bf16_f32 v239, v86, v87
  s_waitcnt lgkmcnt(2)
  v_mfma_f32_4x4x4_16b_bf16 v[80:83], v[100:101], a[184:185], 0
  v_mfma_f32_4x4x4_16b_bf16 v[84:87], v[102:103], a[186:187], 0
  v_cvt_pk_bf16_f32 v240, v88, v89
  v_cvt_pk_bf16_f32 v241, v90, v91
  v_mfma_f32_16x16x32_bf16 v[40:43], v[224:227], a[200:203], v[40:43]
  v_cvt_pk_bf16_f32 v242, v92, v93
  v_mfma_f32_16x16x32_bf16 v[64:67], v[224:227], a[204:207], v[64:67]
  v_cvt_pk_bf16_f32 v243, v94, v95
  s_waitcnt lgkmcnt(0)
  v_mfma_f32_4x4x4_16b_bf16 v[88:91], v[100:101], a[188:189], 0
  v_mfma_f32_4x4x4_16b_bf16 v[92:95], v[102:103], a[190:191], 0
  v_cvt_pk_bf16_f32 v244, v72, v73
  v_cvt_pk_bf16_f32 v245, v74, v75
  v_mfma_f32_16x16x32_bf16 v[44:47], v[228:231], a[200:203], v[44:47]
  v_cvt_pk_bf16_f32 v246, v76, v77
  v_mfma_f32_16x16x32_bf16 v[68:71], v[228:231], a[204:207], v[68:71]
  v_cvt_pk_bf16_f32 v247, v78, v79
  v_mfma_f32_16x16x32_bf16 v[24:27], v[232:235], a[208:211], v[24:27]
  v_cvt_pk_bf16_f32 v248, v80, v81
  v_mfma_f32_16x16x32_bf16 v[48:51], v[232:235], a[212:215], v[48:51]
  v_cvt_pk_bf16_f32 v249, v82, v83
  v_cvt_pk_bf16_f32 v250, v84, v85
  v_cvt_pk_bf16_f32 v251, v86, v87
  v_mfma_f32_16x16x32_bf16 v[28:31], v[236:239], a[208:211], v[28:31]
  v_cvt_pk_bf16_f32 v252, v88, v89
  v_mfma_f32_16x16x32_bf16 v[52:55], v[236:239], a[212:215], v[52:55]
  v_cvt_pk_bf16_f32 v253, v90, v91
  v_cvt_pk_bf16_f32 v254, v92, v93
  v_cvt_pk_bf16_f32 v255, v94, v95
  v_mfma_f32_16x16x32_bf16 v[32:35], v[240:243], a[208:211], v[32:35]
  v_mfma_f32_16x16x32_bf16 v[56:59], v[240:243], a[212:215], v[56:59]
  v_mfma_f32_16x16x32_bf16 v[36:39], v[244:247], a[208:211], v[36:39]
  v_mfma_f32_16x16x32_bf16 v[60:63], v[244:247], a[212:215], v[60:63]
  v_mfma_f32_16x16x32_bf16 v[40:43], v[248:251], a[208:211], v[40:43]
  v_mfma_f32_16x16x32_bf16 v[64:67], v[248:251], a[212:215], v[64:67]
  v_mfma_f32_16x16x32_bf16 v[44:47], v[252:255], a[208:211], v[44:47]
  v_mfma_f32_16x16x32_bf16 v[68:71], v[252:255], a[212:215], v[68:71]
  s_mov_b64 vcc, -1
  s_nop 4
  v_cvt_pk_bf16_f32 v24, v24, v25
  v_cvt_pk_bf16_f32 v25, v26, v27
  v_cvt_pk_bf16_f32 v26, v28, v29
  v_cvt_pk_bf16_f32 v27, v30, v31
  ds_write_b128 v11, v[24:27] offset:0
  v_cvt_pk_bf16_f32 v28, v32, v33
  v_cvt_pk_bf16_f32 v29, v34, v35
  v_cvt_pk_bf16_f32 v30, v36, v37
  v_cvt_pk_bf16_f32 v31, v38, v39
  ds_write_b128 v12, v[28:31] offset:0
  v_cvt_pk_bf16_f32 v32, v40, v41
  v_cvt_pk_bf16_f32 v33, v42, v43
  v_cvt_pk_bf16_f32 v34, v44, v45
  v_cvt_pk_bf16_f32 v35, v46, v47
  ds_write_b128 v13, v[32:35] offset:0
  s_waitcnt vmcnt(6) lgkmcnt(0)
  s_barrier
  ds_read_b128 a[192:195], v7 offset:24576
  ds_read_b128 a[196:199], v8 offset:24576
  ds_read_b128 a[216:219], v1 offset:0
  ds_read_b128 a[220:223], v2 offset:0
  ds_read_b128 a[224:227], v3 offset:0
  ds_read_b128 a[200:203], v9 offset:24576
  ds_read_b128 a[204:207], v10 offset:24576
  ds_read_b128 a[228:231], v1 offset:12288
  ds_read_b128 a[232:235], v2 offset:12288
  ds_read_b128 a[236:239], v3 offset:12288
  s_add_u32 m0, s42, 24576
  s_nop 0
  buffer_load_dwordx4 v1, s[4:7], s21 offen nt lds
  s_add_u32 m0, s42, 28672
  s_nop 0
  s_nop 0
  buffer_load_dwordx4 v2, s[4:7], s21 offen nt lds
  s_add_u32 m0, s42, 32768
  s_nop 0
  s_nop 0
  buffer_load_dwordx4 v3, s[4:7], s21 offen nt lds
  s_waitcnt lgkmcnt(8)
.p2align 6
L_loop0:
  v_mfma_f32_16x16x32_bf16 v[24:27], a[0:3], a[192:195], 0
  ds_read_b128 a[208:211], v7 offset:24832
  v_mfma_f32_16x16x32_bf16 v[24:27], a[24:27], a[196:199], v[24:27]
  ds_read_b128 a[212:215], v8 offset:24832
  v_mfma_f32_16x16x32_bf16 v[28:31], a[4:7], a[192:195], 0
  v_mfma_f32_16x16x32_bf16 v[28:31], a[28:31], a[196:199], v[28:31]
  v_mfma_f32_16x16x32_bf16 v[32:35], a[8:11], a[192:195], 0
  v_mfma_f32_16x16x32_bf16 v[32:35], a[32:35], a[196:199], v[32:35]
  v_mfma_f32_16x16x32_bf16 v[36:39], a[12:15], a[192:195], 0
  v_mfma_f32_16x16x32_bf16 v[36:39], a[36:39], a[196:199], v[36:39]
  v_mfma_f32_16x16x32_bf16 v[40:43], a[16:19], a[192:195], 0
  v_mfma_f32_16x16x32_bf16 v[40:43], a[40:43], a[196:199], v[40:43]
  v_mfma_f32_16x16x32_bf16 v[44:47], a[20:23], a[192:195], 0
  v_mfma_f32_16x16x32_bf16 v[44:47], a[44:47], a[196:199], v[44:47]
  s_waitcnt lgkmcnt(5)
  v_mfma_f32_16x16x32_bf16 v[24:27], a[48:51], a[200:203], v[24:27]
  ds_read_b128 a[192:195], v9 offset:24832
  v_mfma_f32_16x16x32_bf16 v[24:27], a[72:75], a[204:207], v[24:27]
  ds_read_b128 a[196:199], v10 offset:24832
  v_mfma_f32_16x16x32_bf16 v[28:31], a[52:55], a[200:203], v[28:31]
  v_cvt_pk_bf16_f32 v48, v48, v49
  v_mfma_f32_16x16x32_bf16 v[28:31], a[76:79], a[204:207], v[28:31]
  v_cvt_pk_bf16_f32 v49, v50, v51
  v_mfma_f32_16x16x32_bf16 v[32:35], a[56:59], a[200:203], v[32:35]
  v_cvt_pk_bf16_f32 v50, v52, v53
  v_mfma_f32_16x16x32_bf16 v[32:35], a[80:83], a[204:207], v[32:35]
  v_cvt_pk_bf16_f32 v51, v54, v55
  v_mfma_f32_16x16x32_bf16 v[36:39], a[60:63], a[200:203], v[36:39]
  v_mfma_f32_16x16x32_bf16 v[36:39], a[84:87], a[204:207], v[36:39]
  v_mfma_f32_16x16x32_bf16 v[40:43], a[64:67], a[200:203], v[40:43]
  v_mfma_f32_16x16x32_bf16 v[40:43], a[88:91], a[204:207], v[40:43]
  v_mfma_f32_16x16x32_bf16 v[44:47], a[68:71], a[200:203], v[44:47]
  ds_write_b128 v11, v[48:51] offset:36864
  v_mfma_f32_16x16x32_bf16 v[44:47], a[92:95], a[204:207], v[44:47]
  s_waitcnt lgkmcnt(3)
  v_mfma_f32_16x16x32_bf16 v[24:27], a[96:99], a[208:211], v[24:27]
  ds_read_b128 a[200:203], v7 offset:25088
  v_mfma_f32_16x16x32_bf16 v[24:27], a[120:123], a[212:215], v[24:27]
  ds_read_b128 a[204:207], v8 offset:25088
  v_mfma_f32_16x16x32_bf16 v[28:31], a[100:103], a[208:211], v[28:31]
  v_cvt_pk_bf16_f32 v52, v56, v57
  v_mfma_f32_16x16x32_bf16 v[28:31], a[124:127], a[212:215], v[28:31]
  v_cvt_pk_bf16_f32 v53, v58, v59
  v_mfma_f32_16x16x32_bf16 v[32:35], a[104:107], a[208:211], v[32:35]
  v_cvt_pk_bf16_f32 v54, v60, v61
  v_mfma_f32_16x16x32_bf16 v[32:35], a[128:131], a[212:215], v[32:35]
  v_cvt_pk_bf16_f32 v55, v62, v63
  v_mfma_f32_16x16x32_bf16 v[36:39], a[108:111], a[208:211], v[36:39]
  ds_write_b128 v12, v[52:55] offset:36864
  v_mfma_f32_16x16x32_bf16 v[36:39], a[132:135], a[212:215], v[36:39]
  v_mfma_f32_16x16x32_bf16 v[40:43], a[112:115], a[208:211], v[40:43]
  buffer_store_dwordx4 a[216:219], v4, s[8:11], s22 offen sc1
  v_mfma_f32_16x16x32_bf16 v[40:43], a[136:139], a[212:215], v[40:43]
  buffer_store_dwordx4 a[220:223], v5, s[8:11], s22 offen sc1
  buffer_store_dwordx4 a[224:227], v6, s[8:11], s22 offen sc1
  v_mfma_f32_16x16x32_bf16 v[44:47], a[116:119], a[208:211], v[44:47]
  v_mfma_f32_16x16x32_bf16 v[44:47], a[140:143], a[212:215], v[44:47]
  s_waitcnt lgkmcnt(4)
  v_mfma_f32_16x16x32_bf16 v[24:27], v[112:115], a[192:195], v[24:27]
  ds_read_b128 a[208:211], v9 offset:25088
  v_mfma_f32_16x16x32_bf16 v[24:27], v[136:139], a[196:199], v[24:27]
  ds_read_b128 a[212:215], v10 offset:25088
  v_mfma_f32_16x16x32_bf16 v[28:31], v[116:119], a[192:195], v[28:31]
  v_cvt_pk_bf16_f32 v56, v64, v65
  v_mfma_f32_16x16x32_bf16 v[28:31], v[140:143], a[196:199], v[28:31]
  v_cvt_pk_bf16_f32 v57, v66, v67
  v_mfma_f32_16x16x32_bf16 v[32:35], v[120:123], a[192:195], v[32:35]
  v_cvt_pk_bf16_f32 v58, v68, v69
  v_mfma_f32_16x16x32_bf16 v[32:35], v[144:147], a[196:199], v[32:35]
  v_cvt_pk_bf16_f32 v59, v70, v71
  v_mfma_f32_16x16x32_bf16 v[36:39], v[124:127], a[192:195], v[36:39]
  v_mfma_f32_16x16x32_bf16 v[36:39], v[148:151], a[196:199], v[36:39]
  v_mfma_f32_16x16x32_bf16 v[40:43], v[128:131], a[192:195], v[40:43]
  v_mfma_f32_16x16x32_bf16 v[40:43], v[152:155], a[196:199], v[40:43]
  v_mfma_f32_16x16x32_bf16 v[44:47], v[132:135], a[192:195], v[44:47]
  ds_write_b128 v13, v[56:59] offset:36864
  v_mfma_f32_16x16x32_bf16 v[44:47], v[156:159], a[196:199], v[44:47]
  s_waitcnt lgkmcnt(4)
  v_mfma_f32_16x16x32_bf16 v[24:27], v[160:163], a[200:203], v[24:27]
  ds_read_b128 a[192:195], v7 offset:36864
  v_mfma_f32_16x16x32_bf16 v[24:27], v[184:187], a[204:207], v[24:27]
  ds_read_b128 a[196:199], v8 offset:36864
  v_mfma_f32_16x16x32_bf16 v[28:31], v[164:167], a[200:203], v[28:31]
  v_mfma_f32_16x16x32_bf16 v[28:31], v[188:191], a[204:207], v[28:31]
  s_add_u32 s62, s62, s44
  s_sub_u32 s61, s61, 1
  v_mfma_f32_16x16x32_bf16 v[32:35], v[168:171], a[200:203], v[32:35]
  s_cmp_eq_u32 s61, 0
  s_cselect_b32 s55, s66, s55
  s_cselect_b32 s65, 144, s65
  v_mfma_f32_16x16x32_bf16 v[32:35], v[192:195], a[204:207], v[32:35]
  v_mfma_f32_16x16x32_bf16 v[36:39], v[172:175], a[200:203], v[36:39]
  v_mfma_f32_16x16x32_bf16 v[36:39], v[196:199], a[204:207], v[36:39]
  v_mfma_f32_16x16x32_bf16 v[40:43], v[176:179], a[200:203], v[40:43]
  v_mfma_f32_16x16x32_bf16 v[40:43], v[200:203], a[204:207], v[40:43]
  v_mfma_f32_16x16x32_bf16 v[44:47], v[180:183], a[200:203], v[44:47]
  v_mfma_f32_16x16x32_bf16 v[44:47], v[204:207], a[204:207], v[44:47]
  s_waitcnt lgkmcnt(3)
  v_mfma_f32_16x16x32_bf16 v[24:27], v[208:211], a[208:211], v[24:27]
  ds_read_b128 a[200:203], v9 offset:36864
  v_mfma_f32_16x16x32_bf16 v[24:27], v[232:235], a[212:215], v[24:27]
  ds_read_b128 a[204:207], v10 offset:36864
  v_mfma_f32_16x16x32_bf16 v[28:31], v[212:215], a[208:211], v[28:31]
  v_mfma_f32_16x16x32_bf16 v[28:31], v[236:239], a[212:215], v[28:31]
  v_mfma_f32_16x16x32_bf16 v[32:35], v[216:219], a[208:211], v[32:35]
  v_mfma_f32_16x16x32_bf16 v[32:35], v[240:243], a[212:215], v[32:35]
  v_mfma_f32_16x16x32_bf16 v[36:39], v[220:223], a[208:211], v[36:39]
  v_mfma_f32_16x16x32_bf16 v[36:39], v[244:247], a[212:215], v[36:39]
  s_add_u32 m0, s42, 36864
  v_mfma_f32_16x16x32_bf16 v[40:43], v[224:227], a[208:211], v[40:43]
  s_cbranch_vccz L_sk1
  buffer_load_dwordx4 v1, s[4:7], s37 offen nt lds
  s_add_u32 m0, s42, 40960
  s_nop 0
  buffer_load_dwordx4 v2, s[4:7], s37 offen nt lds
  s_add_u32 m0, s42, 45056
  s_nop 0
  buffer_load_dwordx4 v3, s[4:7], s37 offen nt lds
L_sk1:
  v_mfma_f32_16x16x32_bf16 v[40:43], v[248:251], a[212:215], v[40:43]
  v_mfma_f32_16x16x32_bf16 v[44:47], v[228:231], a[208:211], v[44:47]
  s_cmp_eq_u32 s32, s68
  v_mfma_f32_16x16x32_bf16 v[44:47], v[252:255], a[212:215], v[44:47]
  s_waitcnt lgkmcnt(2)
  s_cbranch_scc1 L_half1
  v_mfma_f32_16x16x32_bf16 v[48:51], a[0:3], a[192:195], 0
  ds_read_b128 a[208:211], v7 offset:37120
  v_mfma_f32_16x16x32_bf16 v[48:51], a[24:27], a[196:199], v[48:51]
  ds_read_b128 a[212:215], v8 offset:37120
  v_mfma_f32_16x16x32_bf16 v[52:55], a[4:7], a[192:195], 0
  v_cvt_pk_bf16_f32 v24, v24, v25
  v_mfma_f32_16x16x32_bf16 v[52:55], a[28:31], a[196:199], v[52:55]
  v_cvt_pk_bf16_f32 v25, v26, v27
  v_mfma_f32_16x16x32_bf16 v[56:59], a[8:11], a[192:195], 0
  v_cvt_pk_bf16_f32 v26, v28, v29
  v_mfma_f32_16x16x32_bf16 v[56:59], a[32:35], a[196:199], v[56:59]
  v_cvt_pk_bf16_f32 v27, v30, v31
  v_mfma_f32_16x16x32_bf16 v[60:63], a[12:15], a[192:195], 0
  ds_write_b128 v11, v[24:27] offset:24576
  v_mfma_f32_16x16x32_bf16 v[60:63], a[36:39], a[196:199], v[60:63]
  v_mfma_f32_16x16x32_bf16 v[64:67], a[16:19], a[192:195], 0
  v_mfma_f32_16x16x32_bf16 v[64:67], a[40:43], a[196:199], v[64:67]
  v_mfma_f32_16x16x32_bf16 v[68:71], a[20:23], a[192:195], 0
  v_mfma_f32_16x16x32_bf16 v[68:71], a[44:47], a[196:199], v[68:71]
  s_waitcnt lgkmcnt(3)
  v_mfma_f32_16x16x32_bf16 v[48:51], a[48:51], a[200:203], v[48:51]
  ds_read_b128 a[192:195], v9 offset:37120
  v_mfma_f32_16x16x32_bf16 v[48:51], a[72:75], a[204:207], v[48:51]
  ds_read_b128 a[196:199], v10 offset:37120
  v_mfma_f32_16x16x32_bf16 v[52:55], a[52:55], a[200:203], v[52:55]
  v_cvt_pk_bf16_f32 v28, v32, v33
  v_mfma_f32_16x16x32_bf16 v[52:55], a[76:79], a[204:207], v[52:55]
  v_cvt_pk_bf16_f32 v29, v34, v35
  v_mfma_f32_16x16x32_bf16 v[56:59], a[56:59], a[200:203], v[56:59]
  v_cvt_pk_bf16_f32 v30, v36, v37
  v_mfma_f32_16x16x32_bf16 v[56:59], a[80:83], a[204:207], v[56:59]
  v_cvt_pk_bf16_f32 v31, v38, v39
  v_mfma_f32_16x16x32_bf16 v[60:63], a[60:63], a[200:203], v[60:63]
  v_mfma_f32_16x16x32_bf16 v[60:63], a[84:87], a[204:207], v[60:63]
  v_mfma_f32_16x16x32_bf16 v[64:67], a[64:67], a[200:203], v[64:67]
  v_mfma_f32_16x16x32_bf16 v[64:67], a[88:91], a[204:207], v[64:67]
  v_mfma_f32_16x16x32_bf16 v[68:71], a[68:71], a[200:203], v[68:71]
  ds_write_b128 v12, v[28:31] offset:24576
  v_mfma_f32_16x16x32_bf16 v[68:71], a[92:95], a[204:207], v[68:71]
  s_waitcnt lgkmcnt(4)
  v_mfma_f32_16x16x32_bf16 v[48:51], a[96:99], a[208:211], v[48:51]
  ds_read_b128 a[200:203], v7 offset:37376
  v_mfma_f32_16x16x32_bf16 v[48:51], a[120:123], a[212:215], v[48:51]
  ds_read_b128 a[204:207], v8 offset:37376
  v_mfma_f32_16x16x32_bf16 v[52:55], a[100:103], a[208:211], v[52:55]
  v_cvt_pk_bf16_f32 v32, v40, v41
  v_mfma_f32_16x16x32_bf16 v[52:55], a[124:127], a[212:215], v[52:55]
  v_cvt_pk_bf16_f32 v33, v42, v43
  v_mfma_f32_16x16x32_bf16 v[56:59], a[104:107], a[208:211], v[56:59]
  v_cvt_pk_bf16_f32 v34, v44, v45
  v_mfma_f32_16x16x32_bf16 v[56:59], a[128:131], a[212:215], v[56:59]
  v_cvt_pk_bf16_f32 v35, v46, v47
  v_mfma_f32_16x16x32_bf16 v[60:63], a[108:111], a[208:211], v[60:63]
  ds_write_b128 v13, v[32:35] offset:24576
  v_mfma_f32_16x16x32_bf16 v[60:63], a[132:135], a[212:215], v[60:63]
  v_mfma_f32_16x16x32_bf16 v[64:67], a[112:115], a[208:211], v[64:67]
  buffer_store_dwordx4 a[228:231], v4, s[8:11], s23 offen sc1
  v_mfma_f32_16x16x32_bf16 v[64:67], a[136:139], a[212:215], v[64:67]
  buffer_store_dwordx4 a[232:235], v5, s[8:11], s23 offen sc1
  buffer_store_dwordx4 a[236:239], v6, s[8:11], s23 offen sc1
  v_mfma_f32_16x16x32_bf16 v[68:71], a[116:119], a[208:211], v[68:71]
  v_mfma_f32_16x16x32_bf16 v[68:71], a[140:143], a[212:215], v[68:71]
  s_waitcnt lgkmcnt(0)
  v_mfma_f32_16x16x32_bf16 v[48:51], v[112:115], a[192:195], v[48:51]
  ds_read_b128 a[208:211], v9 offset:37376
  s_add_u32 s69, s54, 112
  s_lshr_b32 s56, s69, 1
  v_mfma_f32_16x16x32_bf16 v[48:51], v[136:139], a[196:199], v[48:51]
  ds_read_b128 a[212:215], v10 offset:37376
  s_bitcmp1_b32 s69, 0
  s_cselect_b32 s69, 12289, 1
  v_mfma_f32_16x16x32_bf16 v[52:55], v[116:119], a[192:195], v[52:55]
  s_cmp_lt_u32 s54, 112
  s_cselect_b32 s56, s54, s56
  s_cselect_b32 s69, 0, s69
  v_mfma_f32_16x16x32_bf16 v[52:55], v[140:143], a[196:199], v[52:55]
  v_xor_b32 v7, 0x14000, v7
  s_mul_i32 s56, s56, 98304
  s_add_u32 s69, s69, s57
  v_mfma_f32_16x16x32_bf16 v[56:59], v[120:123], a[192:195], v[56:59]
  v_xor_b32 v8, 0x14000, v8
  s_add_u32 s56, s56, s69
  s_cmp_lt_u32 s54, 144
  s_cselect_b32 s56, s56, s6
  v_mfma_f32_16x16x32_bf16 v[56:59], v[144:147], a[196:199], v[56:59]
  v_xor_b32 v9, 0x14000, v9
  s_cmp_ge_i32 s61, 0
  s_cselect_b32 s56, s62, s56
  v_mfma_f32_16x16x32_bf16 v[60:63], v[124:127], a[192:195], v[60:63]
  v_xor_b32 v10, 0x14000, v10
  v_mov_b32 v23, s56
  v_mfma_f32_16x16x32_bf16 v[60:63], v[148:151], a[196:199], v[60:63]
  ds_write_b32 v106, v23 offset:4
  v_mfma_f32_16x16x32_bf16 v[64:67], v[128:131], a[192:195], v[64:67]
  v_mfma_f32_16x16x32_bf16 v[64:67], v[152:155], a[196:199], v[64:67]
  s_add_u32 s23, s22, 12288
  s_mov_b32 s22, s58
  v_mfma_f32_16x16x32_bf16 v[68:71], v[132:135], a[192:195], v[68:71]
  s_mov_b32 s58, s59
  v_mfma_f32_16x16x32_bf16 v[68:71], v[156:159], a[196:199], v[68:71]
  s_waitcnt vmcnt(12) lgkmcnt(0)
  s_cbranch_vccz L_ow2
L_ob2:
  s_barrier
  s_cmp_eq_u32 s32, 1
  s_cbranch_scc1 L_tail1
  v_mfma_f32_16x16x32_bf16 v[48:51], v[160:163], a[200:203], v[48:51]
  ds_read_b128 a[192:195], v7 offset:0
  v_mfma_f32_16x16x32_bf16 v[48:51], v[184:187], a[204:207], v[48:51]
  ds_read_b128 a[196:199], v8 offset:0
  v_mfma_f32_16x16x32_bf16 v[52:55], v[164:167], a[200:203], v[52:55]
  ds_read_b128 a[216:219], v1 offset:24576
  v_mfma_f32_16x16x32_bf16 v[52:55], v[188:191], a[204:207], v[52:55]
  ds_read_b32 v107, v105 offset:4
  v_mfma_f32_16x16x32_bf16 v[56:59], v[168:171], a[200:203], v[56:59]
  ds_read_b128 a[220:223], v2 offset:24576
  v_mfma_f32_16x16x32_bf16 v[56:59], v[192:195], a[204:207], v[56:59]
  ds_read_b128 a[224:227], v3 offset:24576
  v_mfma_f32_16x16x32_bf16 v[60:63], v[172:175], a[200:203], v[60:63]
  s_mov_b32 s59, s21
  v_mfma_f32_16x16x32_bf16 v[60:63], v[196:199], a[204:207], v[60:63]
  s_cmp_lt_u32 s54, s55
  s_cselect_b32 s54, 1, s65
  s_cbranch_scc0 L_cl3
  s_atomic_add s54, s[52:53], 0 glc
L_cl3:
  v_mfma_f32_16x16x32_bf16 v[64:67], v[176:179], a[200:203], v[64:67]
  v_mfma_f32_16x16x32_bf16 v[64:67], v[200:203], a[204:207], v[64:67]
  s_waitcnt lgkmcnt(2)
  v_readfirstlane_b32 s21, v107
  v_mfma_f32_16x16x32_bf16 v[68:71], v[180:183], a[200:203], v[68:71]
  v_mfma_f32_16x16x32_bf16 v[68:71], v[204:207], a[204:207], v[68:71]
  s_cmp_lt_u32 s21, s6
  s_cselect_b32 s32, 4, s32
  s_cselect_b64 vcc, -1, 0
  v_mfma_f32_16x16x32_bf16 v[48:51], v[208:211], a[208:211], v[48:51]
  ds_read_b128 a[200:203], v9 offset:0
  s_add_u32 s37, s21, 12288
  s_bitcmp1_b32 s21, 0
  v_mfma_f32_16x16x32_bf16 v[48:51], v[232:235], a[212:215], v[48:51]
  ds_read_b128 a[204:207], v10 offset:0
  s_cselect_b32 s37, s6, s37
  s_cselect_b32 s68, 1, s68
  s_andn2_b32 s21, s21, 1
  v_mfma_f32_16x16x32_bf16 v[52:55], v[212:215], a[208:211], v[52:55]
  ds_read_b128 a[228:231], v1 offset:36864
  v_mfma_f32_16x16x32_bf16 v[52:55], v[236:239], a[212:215], v[52:55]
  ds_read_b128 a[232:235], v2 offset:36864
  v_mfma_f32_16x16x32_bf16 v[56:59], v[216:219], a[208:211], v[56:59]
  ds_read_b128 a[236:239], v3 offset:36864
  v_mfma_f32_16x16x32_bf16 v[56:59], v[240:243], a[212:215], v[56:59]
  s_sub_u32 s32, s32, 1
  v_mfma_f32_16x16x32_bf16 v[60:63], v[220:223], a[208:211], v[60:63]
  s_xor_b32 s42, s42, 0x14000
  v_mfma_f32_16x16x32_bf16 v[60:63], v[244:247], a[212:215], v[60:63]
  s_add_u32 m0, s42, 0
  v_mfma_f32_16x16x32_bf16 v[64:67], v[224:227], a[208:211], v[64:67]
  s_cbranch_vccz L_sk4
  buffer_load_dwordx4 v1, s[4:7], s21 offen nt lds
  s_add_u32 m0, s42, 4096
  s_nop 0
  buffer_load_dwordx4 v2, s[4:7], s21 offen nt lds
  s_add_u32 m0, s42, 8192
  s_nop 0
  buffer_load_dwordx4 v3, s[4:7], s21 offen nt lds
L_sk4:
  v_mfma_f32_16x16x32_bf16 v[64:67], v[248:251], a[212:215], v[64:67]
  v_mfma_f32_16x16x32_bf16 v[68:71], v[228:231], a[208:211], v[68:71]
  v_mfma_f32_16x16x32_bf16 v[68:71], v[252:255], a[212:215], v[68:71]
L_mid0:
  v_mfma_f32_16x16x32_bf16 v[24:27], a[0:3], a[192:195], 0
  ds_read_b128 a[208:211], v7 offset:256
  v_mfma_f32_16x16x32_bf16 v[24:27], a[24:27], a[196:199], v[24:27]
  ds_read_b128 a[212:215], v8 offset:256
  v_mfma_f32_16x16x32_bf16 v[28:31], a[4:7], a[192:195], 0
  v_mfma_f32_16x16x32_bf16 v[28:31], a[28:31], a[196:199], v[28:31]
  v_mfma_f32_16x16x32_bf16 v[32:35], a[8:11], a[192:195], 0
  v_mfma_f32_16x16x32_bf16 v[32:35], a[32:35], a[196:199], v[32:35]
  v_mfma_f32_16x16x32_bf16 v[36:39], a[12:15], a[192:195], 0
  v_mfma_f32_16x16x32_bf16 v[36:39], a[36:39], a[196:199], v[36:39]
  v_mfma_f32_16x16x32_bf16 v[40:43], a[16:19], a[192:195], 0
  v_mfma_f32_16x16x32_bf16 v[40:43], a[40:43], a[196:199], v[40:43]
  v_mfma_f32_16x16x32_bf16 v[44:47], a[20:23], a[192:195], 0
  v_mfma_f32_16x16x32_bf16 v[44:47], a[44:47], a[196:199], v[44:47]
  s_waitcnt lgkmcnt(5)
  v_mfma_f32_16x16x32_bf16 v[24:27], a[48:51], a[200:203], v[24:27]
  ds_read_b128 a[192:195], v9 offset:256
  v_mfma_f32_16x16x32_bf16 v[24:27], a[72:75], a[204:207], v[24:27]
  ds_read_b128 a[196:199], v10 offset:256
  v_mfma_f32_16x16x32_bf16 v[28:31], a[52:55], a[200:203], v[28:31]
  v_cvt_pk_bf16_f32 v48, v48, v49
  v_mfma_f32_16x16x32_bf16 v[28:31], a[76:79], a[204:207], v[28:31]
  v_cvt_pk_bf16_f32 v49, v50, v51
  v_mfma_f32_16x16x32_bf16 v[32:35], a[56:59], a[200:203], v[32:35]
  v_cvt_pk_bf16_f32 v50, v52, v53
  v_mfma_f32_16x16x32_bf16 v[32:35], a[80:83], a[204:207], v[32:35]
  v_cvt_pk_bf16_f32 v51, v54, v55
  v_mfma_f32_16x16x32_bf16 v[36:39], a[60:63], a[200:203], v[36:39]
  v_mfma_f32_16x16x32_bf16 v[36:39], a[84:87], a[204:207], v[36:39]
  v_mfma_f32_16x16x32_bf16 v[40:43], a[64:67], a[200:203], v[40:43]
  v_mfma_f32_16x16x32_bf16 v[40:43], a[88:91], a[204:207], v[40:43]
  v_mfma_f32_16x16x32_bf16 v[44:47], a[68:71], a[200:203], v[44:47]
  ds_write_b128 v11, v[48:51] offset:12288
  v_mfma_f32_16x16x32_bf16 v[44:47], a[92:95], a[204:207], v[44:47]
  s_waitcnt lgkmcnt(3)
  v_mfma_f32_16x16x32_bf16 v[24:27], a[96:99], a[208:211], v[24:27]
  ds_read_b128 a[200:203], v7 offset:512
  v_mfma_f32_16x16x32_bf16 v[24:27], a[120:123], a[212:215], v[24:27]
  ds_read_b128 a[204:207], v8 offset:512
  v_mfma_f32_16x16x32_bf16 v[28:31], a[100:103], a[208:211], v[28:31]
  v_cvt_pk_bf16_f32 v52, v56, v57
  v_mfma_f32_16x16x32_bf16 v[28:31], a[124:127], a[212:215], v[28:31]
  v_cvt_pk_bf16_f32 v53, v58, v59
  v_mfma_f32_16x16x32_bf16 v[32:35], a[104:107], a[208:211], v[32:35]
  v_cvt_pk_bf16_f32 v54, v60, v61
  v_mfma_f32_16x16x32_bf16 v[32:35], a[128:131], a[212:215], v[32:35]
  v_cvt_pk_bf16_f32 v55, v62, v63
  v_mfma_f32_16x16x32_bf16 v[36:39], a[108:111], a[208:211], v[36:39]
  ds_write_b128 v12, v[52:55] offset:12288
  v_mfma_f32_16x16x32_bf16 v[36:39], a[132:135], a[212:215], v[36:39]
  v_mfma_f32_16x16x32_bf16 v[40:43], a[112:115], a[208:211], v[40:43]
  buffer_store_dwordx4 a[216:219], v4, s[8:11], s22 offen sc1
  v_mfma_f32_16x16x32_bf16 v[40:43], a[136:139], a[212:215], v[40:43]
  buffer_store_dwordx4 a[220:223], v5, s[8:11], s22 offen sc1
  buffer_store_dwordx4 a[224:227], v6, s[8:11], s22 offen sc1
  v_mfma_f32_16x16x32_bf16 v[44:47], a[116:119], a[208:211], v[44:47]
  v_mfma_f32_16x16x32_bf16 v[44:47], a[140:143], a[212:215], v[44:47]
  s_waitcnt lgkmcnt(4)
  v_mfma_f32_16x16x32_bf16 v[24:27], v[112:115], a[192:195], v[24:27]
  ds_read_b128 a[208:211], v9 offset:512
  v_mfma_f32_16x16x32_bf16 v[24:27], v[136:139], a[196:199], v[24:27]
  ds_read_b128 a[212:215], v10 offset:512
  v_mfma_f32_16x16x32_bf16 v[28:31], v[116:119], a[192:195], v[28:31]
  v_cvt_pk_bf16_f32 v56, v64, v65
  v_mfma_f32_16x16x32_bf16 v[28:31], v[140:143], a[196:199], v[28:31]
  v_cvt_pk_bf16_f32 v57, v66, v67
  v_mfma_f32_16x16x32_bf16 v[32:35], v[120:123], a[192:195], v[32:35]
  v_cvt_pk_bf16_f32 v58, v68, v69
  v_mfma_f32_16x16x32_bf16 v[32:35], v[144:147], a[196:199], v[32:35]
  v_cvt_pk_bf16_f32 v59, v70, v71
  v_mfma_f32_16x16x32_bf16 v[36:39], v[124:127], a[192:195], v[36:39]
  v_mfma_f32_16x16x32_bf16 v[36:39], v[148:151], a[196:199], v[36:39]
  v_mfma_f32_16x16x32_bf16 v[40:43], v[128:131], a[192:195], v[40:43]
  v_mfma_f32_16x16x32_bf16 v[40:43], v[152:155], a[196:199], v[40:43]
  v_mfma_f32_16x16x32_bf16 v[44:47], v[132:135], a[192:195], v[44:47]
  ds_write_b128 v13, v[56:59] offset:12288
  v_mfma_f32_16x16x32_bf16 v[44:47], v[156:159], a[196:199], v[44:47]
  s_waitcnt lgkmcnt(4)
  v_mfma_f32_16x16x32_bf16 v[24:27], v[160:163], a[200:203], v[24:27]
  ds_read_b128 a[192:195], v7 offset:12288
  v_mfma_f32_16x16x32_bf16 v[24:27], v[184:187], a[204:207], v[24:27]
  ds_read_b128 a[196:199], v8 offset:12288
  v_mfma_f32_16x16x32_bf16 v[28:31], v[164:167], a[200:203], v[28:31]
  v_mfma_f32_16x16x32_bf16 v[28:31], v[188:191], a[204:207], v[28:31]
  s_add_u32 s62, s62, s44
  s_sub_u32 s61, s61, 1
  v_mfma_f32_16x16x32_bf16 v[32:35], v[168:171], a[200:203], v[32:35]
  s_cmp_eq_u32 s61, 0
  s_cselect_b32 s55, s66, s55
  s_cselect_b32 s65, 144, s65
  v_mfma_f32_16x16x32_bf16 v[32:35], v[192:195], a[204:207], v[32:35]
  v_mfma_f32_16x16x32_bf16 v[36:39], v[172:175], a[200:203], v[36:39]
  v_mfma_f32_16x16x32_bf16 v[36:39], v[196:199], a[204:207], v[36:39]
  v_mfma_f32_16x16x32_bf16 v[40:43], v[176:179], a[200:203], v[40:43]
  v_mfma_f32_16x16x32_bf16 v[40:43], v[200:203], a[204:207], v[40:43]
  v_mfma_f32_16x16x32_bf16 v[44:47], v[180:183], a[200:203], v[44:47]
  v_mfma_f32_16x16x32_bf16 v[44:47], v[204:207], a[204:207], v[44:47]
  s_waitcnt lgkmcnt(3)
  v_mfma_f32_16x16x32_bf16 v[24:27], v[208:211], a[208:211], v[24:27]
  ds_read_b128 a[200:203], v9 offset:12288
  v_mfma_f32_16x16x32_bf16 v[24:27], v[232:235], a[212:215], v[24:27]
  ds_read_b128 a[204:207], v10 offset:12288
  v_mfma_f32_16x16x32_bf16 v[28:31], v[212:215], a[208:211], v[28:31]
  v_mfma_f32_16x16x32_bf16 v[28:31], v[236:239], a[212:215], v[28:31]
  v_mfma_f32_16x16x32_bf16 v[32:35], v[216:219], a[208:211], v[32:35]
  v_mfma_f32_16x16x32_bf16 v[32:35], v[240:243], a[212:215], v[32:35]
  v_mfma_f32_16x16x32_bf16 v[36:39], v[220:223], a[208:211], v[36:39]
  v_mfma_f32_16x16x32_bf16 v[36:39], v[244:247], a[212:215], v[36:39]
  s_add_u32 m0, s42, 12288
  v_mfma_f32_16x16x32_bf16 v[40:43], v[224:227], a[208:211], v[40:43]
  s_cbranch_vccz L_sk5
  buffer_load_dwordx4 v1, s[4:7], s37 offen nt lds
  s_add_u32 m0, s42, 16384
  s_nop 0
  buffer_load_dwordx4 v2, s[4:7], s37 offen nt lds
  s_add_u32 m0, s42, 20480
  s_nop 0
  buffer_load_dwordx4 v3, s[4:7], s37 offen nt lds
L_sk5:
  v_mfma_f32_16x16x32_bf16 v[40:43], v[248:251], a[212:215], v[40:43]
  v_mfma_f32_16x16x32_bf16 v[44:47], v[228:231], a[208:211], v[44:47]
  s_cmp_eq_u32 s32, s68
  v_mfma_f32_16x16x32_bf16 v[44:47], v[252:255], a[212:215], v[44:47]
  s_waitcnt lgkmcnt(2)
  s_cbranch_scc1 L_half0
  v_mfma_f32_16x16x32_bf16 v[48:51], a[0:3], a[192:195], 0
  ds_read_b128 a[208:211], v7 offset:12544
  v_mfma_f32_16x16x32_bf16 v[48:51], a[24:27], a[196:199], v[48:51]
  ds_read_b128 a[212:215], v8 offset:12544
  v_mfma_f32_16x16x32_bf16 v[52:55], a[4:7], a[192:195], 0
  v_cvt_pk_bf16_f32 v24, v24, v25
  v_mfma_f32_16x16x32_bf16 v[52:55], a[28:31], a[196:199], v[52:55]
  v_cvt_pk_bf16_f32 v25, v26, v27
  v_mfma_f32_16x16x32_bf16 v[56:59], a[8:11], a[192:195], 0
  v_cvt_pk_bf16_f32 v26, v28, v29
  v_mfma_f32_16x16x32_bf16 v[56:59], a[32:35], a[196:199], v[56:59]
  v_cvt_pk_bf16_f32 v27, v30, v31
  v_mfma_f32_16x16x32_bf16 v[60:63], a[12:15], a[192:195], 0
  ds_write_b128 v11, v[24:27] offset:0
  v_mfma_f32_16x16x32_bf16 v[60:63], a[36:39], a[196:199], v[60:63]
  v_mfma_f32_16x16x32_bf16 v[64:67], a[16:19], a[192:195], 0
  v_mfma_f32_16x16x32_bf16 v[64:67], a[40:43], a[196:199], v[64:67]
  v_mfma_f32_16x16x32_bf16 v[68:71], a[20:23], a[192:195], 0
  v_mfma_f32_16x16x32_bf16 v[68:71], a[44:47], a[196:199], v[68:71]
  s_waitcnt lgkmcnt(3)
  v_mfma_f32_16x16x32_bf16 v[48:51], a[48:51], a[200:203], v[48:51]
  ds_read_b128 a[192:195], v9 offset:12544
  v_mfma_f32_16x16x32_bf16 v[48:51], a[72:75], a[204:207], v[48:51]
  ds_read_b128 a[196:199], v10 offset:12544
  v_mfma_f32_16x16x32_bf16 v[52:55], a[52:55], a[200:203], v[52:55]
  v_cvt_pk_bf16_f32 v28, v32, v33
  v_mfma_f32_16x16x32_bf16 v[52:55], a[76:79], a[204:207], v[52:55]
  v_cvt_pk_bf16_f32 v29, v34, v35
  v_mfma_f32_16x16x32_bf16 v[56:59], a[56:59], a[200:203], v[56:59]
  v_cvt_pk_bf16_f32 v30, v36, v37
  v_mfma_f32_16x16x32_bf16 v[56:59], a[80:83], a[204:207], v[56:59]
  v_cvt_pk_bf16_f32 v31, v38, v39
  v_mfma_f32_16x16x32_bf16 v[60:63], a[60:63], a[200:203], v[60:63]
  v_mfma_f32_16x16x32_bf16 v[60:63], a[84:87], a[204:207], v[60:63]
  v_mfma_f32_16x16x32_bf16 v[64:67], a[64:67], a[200:203], v[64:67]
  v_mfma_f32_16x16x32_bf16 v[64:67], a[88:91], a[204:207], v[64:67]
  v_mfma_f32_16x16x32_bf16 v[68:71], a[68:71], a[200:203], v[68:71]
  ds_write_b128 v12, v[28:31] offset:0
  v_mfma_f32_16x16x32_bf16 v[68:71], a[92:95], a[204:207], v[68:71]
  s_waitcnt lgkmcnt(4)
  v_mfma_f32_16x16x32_bf16 v[48:51], a[96:99], a[208:211], v[48:51]
  ds_read_b128 a[200:203], v7 offset:12800
  v_mfma_f32_16x16x32_bf16 v[48:51], a[120:123], a[212:215], v[48:51]
  ds_read_b128 a[204:207], v8 offset:12800
  v_mfma_f32_16x16x32_bf16 v[52:55], a[100:103], a[208:211], v[52:55]
  v_cvt_pk_bf16_f32 v32, v40, v41
  v_mfma_f32_16x16x32_bf16 v[52:55], a[124:127], a[212:215], v[52:55]
  v_cvt_pk_bf16_f32 v33, v42, v43
  v_mfma_f32_16x16x32_bf16 v[56:59], a[104:107], a[208:211], v[56:59]
  v_cvt_pk_bf16_f32 v34, v44, v45
  v_mfma_f32_16x16x32_bf16 v[56:59], a[128:131], a[212:215], v[56:59]
  v_cvt_pk_bf16_f32 v35, v46, v47
  v_mfma_f32_16x16x32_bf16 v[60:63], a[108:111], a[208:211], v[60:63]
  ds_write_b128 v13, v[32:35] offset:0
  v_mfma_f32_16x16x32_bf16 v[60:63], a[132:135], a[212:215], v[60:63]
  v_mfma_f32_16x16x32_bf16 v[64:67], a[112:115], a[208:211], v[64:67]
  buffer_store_dwordx4 a[228:231], v4, s[8:11], s23 offen sc1
  v_mfma_f32_16x16x32_bf16 v[64:67], a[136:139], a[212:215], v[64:67]
  buffer_store_dwordx4 a[232:235], v5, s[8:11], s23 offen sc1
  buffer_store_dwordx4 a[236:239], v6, s[8:11], s23 offen sc1
  v_mfma_f32_16x16x32_bf16 v[68:71], a[116:119], a[208:211], v[68:71]
  v_mfma_f32_16x16x32_bf16 v[68:71], a[140:143], a[212:215], v[68:71]
  s_waitcnt lgkmcnt(0)
  v_mfma_f32_16x16x32_bf16 v[48:51], v[112:115], a[192:195], v[48:51]
  ds_read_b128 a[208:211], v9 offset:12800
  s_add_u32 s69, s54, 112
  s_lshr_b32 s56, s69, 1
  v_mfma_f32_16x16x32_bf16 v[48:51], v[136:139], a[196:199], v[48:51]
  ds_read_b128 a[212:215], v10 offset:12800
  s_bitcmp1_b32 s69, 0
  s_cselect_b32 s69, 12289, 1
  v_mfma_f32_16x16x32_bf16 v[52:55], v[116:119], a[192:195], v[52:55]
  s_cmp_lt_u32 s54, 112
  s_cselect_b32 s56, s54, s56
  s_cselect_b32 s69, 0, s69
  v_mfma_f32_16x16x32_bf16 v[52:55], v[140:143], a[196:199], v[52:55]
  s_mul_i32 s56, s56, 98304
  s_add_u32 s69, s69, s57
  v_mfma_f32_16x16x32_bf16 v[56:59], v[120:123], a[192:195], v[56:59]
  s_add_u32 s56, s56, s69
  s_cmp_lt_u32 s54, 144
  s_cselect_b32 s56, s56, s6
  v_mfma_f32_16x16x32_bf16 v[56:59], v[144:147], a[196:199], v[56:59]
  s_cmp_ge_i32 s61, 0
  s_cselect_b32 s56, s62, s56
  v_mfma_f32_16x16x32_bf16 v[60:63], v[124:127], a[192:195], v[60:63]
  v_mov_b32 v23, s56
  v_mfma_f32_16x16x32_bf16 v[60:63], v[148:151], a[196:199], v[60:63]
  ds_write_b32 v106, v23 offset:0
  v_mfma_f32_16x16x32_bf16 v[64:67], v[128:131], a[192:195], v[64:67]
  v_mfma_f32_16x16x32_bf16 v[64:67], v[152:155], a[196:199], v[64:67]
  s_add_u32 s23, s22, 12288
  s_mov_b32 s22, s58
  v_mfma_f32_16x16x32_bf16 v[68:71], v[132:135], a[192:195], v[68:71]
  s_mov_b32 s58, s59
  v_mfma_f32_16x16x32_bf16 v[68:71], v[156:159], a[196:199], v[68:71]
  s_waitcnt vmcnt(15) lgkmcnt(0)
  s_cbranch_vccz L_ow6
L_ob6:
  s_barrier
  s_cmp_eq_u32 s32, 1
  s_cbranch_scc1 L_tail0
  v_mfma_f32_16x16x32_bf16 v[48:51], v[160:163], a[200:203], v[48:51]
  ds_read_b128 a[192:195], v7 offset:24576
  v_mfma_f32_16x16x32_bf16 v[48:51], v[184:187], a[204:207], v[48:51]
  ds_read_b128 a[196:199], v8 offset:24576
  v_mfma_f32_16x16x32_bf16 v[52:55], v[164:167], a[200:203], v[52:55]
  ds_read_b128 a[216:219], v1 offset:0
  v_mfma_f32_16x16x32_bf16 v[52:55], v[188:191], a[204:207], v[52:55]
  ds_read_b32 v107, v105 offset:0
  v_mfma_f32_16x16x32_bf16 v[56:59], v[168:171], a[200:203], v[56:59]
  ds_read_b128 a[220:223], v2 offset:0
  v_mfma_f32_16x16x32_bf16 v[56:59], v[192:195], a[204:207], v[56:59]
  ds_read_b128 a[224:227], v3 offset:0
  v_mfma_f32_16x16x32_bf16 v[60:63], v[172:175], a[200:203], v[60:63]
  s_mov_b32 s59, s21
  v_mfma_f32_16x16x32_bf16 v[60:63], v[196:199], a[204:207], v[60:63]
  s_cmp_lt_u32 s54, s55
  s_cselect_b32 s54, 1, s65
  s_cbranch_scc0 L_cl7
  s_atomic_add s54, s[52:53], 0 glc
L_cl7:
  v_mfma_f32_16x16x32_bf16 v[64:67], v[176:179], a[200:203], v[64:67]
  v_mfma_f32_16x16x32_bf16 v[64:67], v[200:203], a[204:207], v[64:67]
  s_waitcnt lgkmcnt(2)
  v_readfirstlane_b32 s21, v107
  v_mfma_f32_16x16x32_bf16 v[68:71], v[180:183], a[200:203], v[68:71]
  v_mfma_f32_16x16x32_bf16 v[68:71], v[204:207], a[204:207], v[68:71]
  s_cmp_lt_u32 s21, s6
  s_cselect_b32 s32, 4, s32
  s_cselect_b64 vcc, -1, 0
  v_mfma_f32_16x16x32_bf16 v[48:51], v[208:211], a[208:211], v[48:51]
  ds_read_b128 a[200:203], v9 offset:24576
  s_add_u32 s37, s21, 12288
  s_bitcmp1_b32 s21, 0
  v_mfma_f32_16x16x32_bf16 v[48:51], v[232:235], a[212:215], v[48:51]
  ds_read_b128 a[204:207], v10 offset:24576
  s_cselect_b32 s37, s6, s37
  s_cselect_b32 s68, 1, s68
  s_andn2_b32 s21, s21, 1
  v_mfma_f32_16x16x32_bf16 v[52:55], v[212:215], a[208:211], v[52:55]
  ds_read_b128 a[228:231], v1 offset:12288
  v_mfma_f32_16x16x32_bf16 v[52:55], v[236:239], a[212:215], v[52:55]
  ds_read_b128 a[232:235], v2 offset:12288
  v_mfma_f32_16x16x32_bf16 v[56:59], v[216:219], a[208:211], v[56:59]
  ds_read_b128 a[236:239], v3 offset:12288
  v_mfma_f32_16x16x32_bf16 v[56:59], v[240:243], a[212:215], v[56:59]
  s_sub_u32 s32, s32, 1
  v_mfma_f32_16x16x32_bf16 v[60:63], v[220:223], a[208:211], v[60:63]
  v_mfma_f32_16x16x32_bf16 v[60:63], v[244:247], a[212:215], v[60:63]
  s_add_u32 m0, s42, 24576
  v_mfma_f32_16x16x32_bf16 v[64:67], v[224:227], a[208:211], v[64:67]
  s_cbranch_vccz L_sk8
  buffer_load_dwordx4 v1, s[4:7], s21 offen nt lds
  s_add_u32 m0, s42, 28672
  s_nop 0
  buffer_load_dwordx4 v2, s[4:7], s21 offen nt lds
  s_add_u32 m0, s42, 32768
  s_nop 0
  buffer_load_dwordx4 v3, s[4:7], s21 offen nt lds
L_sk8:
  v_mfma_f32_16x16x32_bf16 v[64:67], v[248:251], a[212:215], v[64:67]
  v_mfma_f32_16x16x32_bf16 v[68:71], v[228:231], a[208:211], v[68:71]
  v_mfma_f32_16x16x32_bf16 v[68:71], v[252:255], a[212:215], v[68:71]
  s_branch L_loop0
L_tail1:
  v_mfma_f32_16x16x32_bf16 v[48:51], v[160:163], a[200:203], v[48:51]
  ds_read_b128 a[216:219], v1 offset:24576
  v_mfma_f32_16x16x32_bf16 v[48:51], v[184:187], a[204:207], v[48:51]
  ds_read_b128 a[220:223], v2 offset:24576
  v_mfma_f32_16x16x32_bf16 v[48:51], v[208:211], a[208:211], v[48:51]
  ds_read_b128 a[224:227], v3 offset:24576
  v_mfma_f32_16x16x32_bf16 v[48:51], v[232:235], a[212:215], v[48:51]
  ds_read_b128 a[228:231], v1 offset:36864
  v_mfma_f32_16x16x32_bf16 v[52:55], v[164:167], a[200:203], v[52:55]
  ds_read_b128 a[232:235], v2 offset:36864
  v_mfma_f32_16x16x32_bf16 v[52:55], v[188:191], a[204:207], v[52:55]
  ds_read_b128 a[236:239], v3 offset:36864
  v_mfma_f32_16x16x32_bf16 v[52:55], v[212:215], a[208:211], v[52:55]
  s_waitcnt lgkmcnt(5)
  buffer_store_dwordx4 a[216:219], v4, s[8:11], s22 offen sc1
  v_mfma_f32_16x16x32_bf16 v[52:55], v[236:239], a[212:215], v[52:55]
  v_mfma_f32_16x16x32_bf16 v[56:59], v[168:171], a[200:203], v[56:59]
  s_waitcnt lgkmcnt(4)
  buffer_store_dwordx4 a[220:223], v5, s[8:11], s22 offen sc1
  v_mfma_f32_16x16x32_bf16 v[56:59], v[192:195], a[204:207], v[56:59]
  v_mfma_f32_16x16x32_bf16 v[56:59], v[216:219], a[208:211], v[56:59]
  s_waitcnt lgkmcnt(3)
  buffer_store_dwordx4 a[224:227], v6, s[8:11], s22 offen sc1
  v_mfma_f32_16x16x32_bf16 v[56:59], v[240:243], a[212:215], v[56:59]
  v_mfma_f32_16x16x32_bf16 v[60:63], v[172:175], a[200:203], v[60:63]
  s_waitcnt lgkmcnt(2)
  buffer_store_dwordx4 a[228:231], v4, s[8:11], s23 offen sc1
  v_mfma_f32_16x16x32_bf16 v[60:63], v[196:199], a[204:207], v[60:63]
  v_mfma_f32_16x16x32_bf16 v[60:63], v[220:223], a[208:211], v[60:63]
  s_waitcnt lgkmcnt(1)
  buffer_store_dwordx4 a[232:235], v5, s[8:11], s23 offen sc1
  v_mfma_f32_16x16x32_bf16 v[60:63], v[244:247], a[212:215], v[60:63]
  v_mfma_f32_16x16x32_bf16 v[64:67], v[176:179], a[200:203], v[64:67]
  s_waitcnt lgkmcnt(0)
  buffer_store_dwordx4 a[236:239], v6, s[8:11], s23 offen sc1
  v_mfma_f32_16x16x32_bf16 v[64:67], v[200:203], a[204:207], v[64:67]
  v_cvt_pk_bf16_f32 v48, v48, v49
  v_cvt_pk_bf16_f32 v49, v50, v51
  v_mfma_f32_16x16x32_bf16 v[64:67], v[224:227], a[208:211], v[64:67]
  v_mfma_f32_16x16x32_bf16 v[64:67], v[248:251], a[212:215], v[64:67]
  v_cvt_pk_bf16_f32 v50, v52, v53
  v_cvt_pk_bf16_f32 v51, v54, v55
  v_mfma_f32_16x16x32_bf16 v[68:71], v[180:183], a[200:203], v[68:71]
  ds_write_b128 v11, v[48:51] offset:12288
  v_mfma_f32_16x16x32_bf16 v[68:71], v[204:207], a[204:207], v[68:71]
  v_mfma_f32_16x16x32_bf16 v[68:71], v[228:231], a[208:211], v[68:71]
  v_mfma_f32_16x16x32_bf16 v[68:71], v[252:255], a[212:215], v[68:71]
  s_add_u32 s23, s22, 12288
  v_cvt_pk_bf16_f32 v52, v56, v57
  v_cvt_pk_bf16_f32 v53, v58, v59
  v_cvt_pk_bf16_f32 v54, v60, v61
  v_cvt_pk_bf16_f32 v55, v62, v63
  ds_write_b128 v12, v[52:55] offset:12288
  v_cvt_pk_bf16_f32 v56, v64, v65
  v_cvt_pk_bf16_f32 v57, v66, v67
  v_cvt_pk_bf16_f32 v58, v68, v69
  v_cvt_pk_bf16_f32 v59, v70, v71
  ds_write_b128 v13, v[56:59] offset:12288
  s_waitcnt lgkmcnt(0)
  s_barrier
  ds_read_b128 a[192:195], v1 offset:12288
  ds_read_b128 a[196:199], v2 offset:12288
  ds_read_b128 a[200:203], v3 offset:12288
  s_waitcnt lgkmcnt(2)
  buffer_store_dwordx4 a[192:195], v4, s[8:11], s23 offen sc1
  s_waitcnt lgkmcnt(1)
  buffer_store_dwordx4 a[196:199], v5, s[8:11], s23 offen sc1
  s_waitcnt lgkmcnt(0)
  buffer_store_dwordx4 a[200:203], v6, s[8:11], s23 offen sc1
  s_endpgm
L_tail0:
  v_mfma_f32_16x16x32_bf16 v[48:51], v[160:163], a[200:203], v[48:51]
  ds_read_b128 a[216:219], v1 offset:0
  v_mfma_f32_16x16x32_bf16 v[48:51], v[184:187], a[204:207], v[48:51]
  ds_read_b128 a[220:223], v2 offset:0
  v_mfma_f32_16x16x32_bf16 v[48:51], v[208:211], a[208:211], v[48:51]
  ds_read_b128 a[224:227], v3 offset:0
  v_mfma_f32_16x16x32_bf16 v[48:51], v[232:235], a[212:215], v[48:51]
  ds_read_b128 a[228:231], v1 offset:12288
  v_mfma_f32_16x16x32_bf16 v[52:55], v[164:167], a[200:203], v[52:55]
  ds_read_b128 a[232:235], v2 offset:12288
  v_mfma_f32_16x16x32_bf16 v[52:55], v[188:191], a[204:207], v[52:55]
  ds_read_b128 a[236:239], v3 offset:12288
  v_mfma_f32_16x16x32_bf16 v[52:55], v[212:215], a[208:211], v[52:55]
  s_waitcnt lgkmcnt(5)
  buffer_store_dwordx4 a[216:219], v4, s[8:11], s22 offen sc1
  v_mfma_f32_16x16x32_bf16 v[52:55], v[236:239], a[212:215], v[52:55]
  v_mfma_f32_16x16x32_bf16 v[56:59], v[168:171], a[200:203], v[56:59]
  s_waitcnt lgkmcnt(4)
  buffer_store_dwordx4 a[220:223], v5, s[8:11], s22 offen sc1
  v_mfma_f32_16x16x32_bf16 v[56:59], v[192:195], a[204:207], v[56:59]
  v_mfma_f32_16x16x32_bf16 v[56:59], v[216:219], a[208:211], v[56:59]
  s_waitcnt lgkmcnt(3)
  buffer_store_dwordx4 a[224:227], v6, s[8:11], s22 offen sc1
  v_mfma_f32_16x16x32_bf16 v[56:59], v[240:243], a[212:215], v[56:59]
  v_mfma_f32_16x16x32_bf16 v[60:63], v[172:175], a[200:203], v[60:63]
  s_waitcnt lgkmcnt(2)
  buffer_store_dwordx4 a[228:231], v4, s[8:11], s23 offen sc1
  v_mfma_f32_16x16x32_bf16 v[60:63], v[196:199], a[204:207], v[60:63]
  v_mfma_f32_16x16x32_bf16 v[60:63], v[220:223], a[208:211], v[60:63]
  s_waitcnt lgkmcnt(1)
  buffer_store_dwordx4 a[232:235], v5, s[8:11], s23 offen sc1
  v_mfma_f32_16x16x32_bf16 v[60:63], v[244:247], a[212:215], v[60:63]
  v_mfma_f32_16x16x32_bf16 v[64:67], v[176:179], a[200:203], v[64:67]
  s_waitcnt lgkmcnt(0)
  buffer_store_dwordx4 a[236:239], v6, s[8:11], s23 offen sc1
  v_mfma_f32_16x16x32_bf16 v[64:67], v[200:203], a[204:207], v[64:67]
  v_cvt_pk_bf16_f32 v48, v48, v49
  v_cvt_pk_bf16_f32 v49, v50, v51
  v_mfma_f32_16x16x32_bf16 v[64:67], v[224:227], a[208:211], v[64:67]
  v_mfma_f32_16x16x32_bf16 v[64:67], v[248:251], a[212:215], v[64:67]
  v_cvt_pk_bf16_f32 v50, v52, v53
  v_cvt_pk_bf16_f32 v51, v54, v55
  v_mfma_f32_16x16x32_bf16 v[68:71], v[180:183], a[200:203], v[68:71]
  ds_write_b128 v11, v[48:51] offset:36864
  v_mfma_f32_16x16x32_bf16 v[68:71], v[204:207], a[204:207], v[68:71]
  v_mfma_f32_16x16x32_bf16 v[68:71], v[228:231], a[208:211], v[68:71]
  v_mfma_f32_16x16x32_bf16 v[68:71], v[252:255], a[212:215], v[68:71]
  s_add_u32 s23, s22, 12288
  v_cvt_pk_bf16_f32 v52, v56, v57
  v_cvt_pk_bf16_f32 v53, v58, v59
  v_cvt_pk_bf16_f32 v54, v60, v61
  v_cvt_pk_bf16_f32 v55, v62, v63
  ds_write_b128 v12, v[52:55] offset:36864
  v_cvt_pk_bf16_f32 v56, v64, v65
  v_cvt_pk_bf16_f32 v57, v66, v67
  v_cvt_pk_bf16_f32 v58, v68, v69
  v_cvt_pk_bf16_f32 v59, v70, v71
  ds_write_b128 v13, v[56:59] offset:36864
  s_waitcnt lgkmcnt(0)
  s_barrier
  ds_read_b128 a[192:195], v1 offset:36864
  ds_read_b128 a[196:199], v2 offset:36864
  ds_read_b128 a[200:203], v3 offset:36864
  s_waitcnt lgkmcnt(2)
  buffer_store_dwordx4 a[192:195], v4, s[8:11], s23 offen sc1
  s_waitcnt lgkmcnt(1)
  buffer_store_dwordx4 a[196:199], v5, s[8:11], s23 offen sc1
  s_waitcnt lgkmcnt(0)
  buffer_store_dwordx4 a[200:203], v6, s[8:11], s23 offen sc1
  s_endpgm
L_half0:
  s_nop 1
  v_cvt_pk_bf16_f32 v24, v24, v25
  v_cvt_pk_bf16_f32 v25, v26, v27
  v_cvt_pk_bf16_f32 v26, v28, v29
  v_cvt_pk_bf16_f32 v27, v30, v31
  ds_write_b128 v11, v[24:27] offset:0
  v_cvt_pk_bf16_f32 v28, v32, v33
  v_cvt_pk_bf16_f32 v29, v34, v35
  v_cvt_pk_bf16_f32 v30, v36, v37
  v_cvt_pk_bf16_f32 v31, v38, v39
  ds_write_b128 v12, v[28:31] offset:0
  v_cvt_pk_bf16_f32 v32, v40, v41
  v_cvt_pk_bf16_f32 v33, v42, v43
  v_cvt_pk_bf16_f32 v34, v44, v45
  v_cvt_pk_bf16_f32 v35, v46, v47
  ds_write_b128 v13, v[32:35] offset:0
  buffer_store_dwordx4 a[228:231], v4, s[8:11], s23 offen sc1
  buffer_store_dwordx4 a[232:235], v5, s[8:11], s23 offen sc1
  buffer_store_dwordx4 a[236:239], v6, s[8:11], s23 offen sc1
  s_add_u32 s23, s22, 12288
  s_mov_b32 s22, s58
  s_waitcnt lgkmcnt(0)
  s_barrier
  ds_read_b128 a[216:219], v1 offset:0
  ds_read_b128 a[220:223], v2 offset:0
  ds_read_b128 a[224:227], v3 offset:0
  ds_read_b128 a[228:231], v1 offset:12288
  ds_read_b128 a[232:235], v2 offset:12288
  ds_read_b128 a[236:239], v3 offset:12288
  s_waitcnt lgkmcnt(5)
  buffer_store_dwordx4 a[216:219], v4, s[8:11], s22 offen sc1
  s_waitcnt lgkmcnt(4)
  buffer_store_dwordx4 a[220:223], v5, s[8:11], s22 offen sc1
  s_waitcnt lgkmcnt(3)
  buffer_store_dwordx4 a[224:227], v6, s[8:11], s22 offen sc1
  s_waitcnt lgkmcnt(2)
  buffer_store_dwordx4 a[228:231], v4, s[8:11], s23 offen sc1
  s_waitcnt lgkmcnt(1)
  buffer_store_dwordx4 a[232:235], v5, s[8:11], s23 offen sc1
  s_waitcnt lgkmcnt(0)
  buffer_store_dwordx4 a[236:239], v6, s[8:11], s23 offen sc1
  s_endpgm
L_half1:
  s_nop 1
  v_cvt_pk_bf16_f32 v24, v24, v25
  v_cvt_pk_bf16_f32 v25, v26, v27
  v_cvt_pk_bf16_f32 v26, v28, v29
  v_cvt_pk_bf16_f32 v27, v30, v31
  ds_write_b128 v11, v[24:27] offset:24576
  v_cvt_pk_bf16_f32 v28, v32, v33
  v_cvt_pk_bf16_f32 v29, v34, v35
  v_cvt_pk_bf16_f32 v30, v36, v37
  v_cvt_pk_bf16_f32 v31, v38, v39
  ds_write_b128 v12, v[28:31] offset:24576
  v_cvt_pk_bf16_f32 v32, v40, v41
  v_cvt_pk_bf16_f32 v33, v42, v43
  v_cvt_pk_bf16_f32 v34, v44, v45
  v_cvt_pk_bf16_f32 v35, v46, v47
  ds_write_b128 v13, v[32:35] offset:24576
  buffer_store_dwordx4 a[228:231], v4, s[8:11], s23 offen sc1
  buffer_store_dwordx4 a[232:235], v5, s[8:11], s23 offen sc1
  buffer_store_dwordx4 a[236:239], v6, s[8:11], s23 offen sc1
  s_add_u32 s23, s22, 12288
  s_mov_b32 s22, s58
  s_waitcnt lgkmcnt(0)
  s_barrier
  ds_read_b128 a[216:219], v1 offset:24576
  ds_read_b128 a[220:223], v2 offset:24576
  ds_read_b128 a[224:227], v3 offset:24576
  ds_read_b128 a[228:231], v1 offset:36864
  ds_read_b128 a[232:235], v2 offset:36864
  ds_read_b128 a[236:239], v3 offset:36864
  s_waitcnt lgkmcnt(5)
  buffer_store_dwordx4 a[216:219], v4, s[8:11], s22 offen sc1
  s_waitcnt lgkmcnt(4)
  buffer_store_dwordx4 a[220:223], v5, s[8:11], s22 offen sc1
  s_waitcnt lgkmcnt(3)
  buffer_store_dwordx4 a[224:227], v6, s[8:11], s22 offen sc1
  s_waitcnt lgkmcnt(2)
  buffer_store_dwordx4 a[228:231], v4, s[8:11], s23 offen sc1
  s_waitcnt lgkmcnt(1)
  buffer_store_dwordx4 a[232:235], v5, s[8:11], s23 offen sc1
  s_waitcnt lgkmcnt(0)
  buffer_store_dwordx4 a[236:239], v6, s[8:11], s23 offen sc1
  s_endpgm
L_ow2:
  s_cmp_eq_u32 s32, 1
  s_cbranch_scc1 L_ob2
  s_waitcnt vmcnt(9)
  s_branch L_ob2
L_ow6:
  s_cmp_eq_u32 s32, 1
  s_cbranch_scc1 L_ob6
  s_waitcnt vmcnt(9)
  s_branch L_ob6
L_done:
  s_endpgm
.section .rodata,"a"
.p2align 6
.amdhsa_kernel standalone__depthwise_separable__vision_kernel
  .amdhsa_next_free_vgpr 512
  .amdhsa_next_free_sgpr 100
  .amdhsa_accum_offset 256
  .amdhsa_group_segment_fixed_size 0
  .amdhsa_kernarg_size 48
  .amdhsa_user_sgpr_count 2
  .amdhsa_user_sgpr_kernarg_segment_ptr 1
  .amdhsa_system_sgpr_workgroup_id_x 1
  .amdhsa_float_denorm_mode_32 3
.end_amdhsa_kernel
```

```asm
; @launch grid=(256,1,1) block=(256,1,1) lds=151552
.amdgcn_target "amdgcn-amd-amdhsa--gfx950"
.text
.globl standalone__depthwise_separable__vision_kernel
.p2align 8
.type standalone__depthwise_separable__vision_kernel,@function
standalone__depthwise_separable__vision_kernel:
  s_cmp_ge_u32 s2, 256
  s_cbranch_scc1 L_done
  s_load_dwordx4 s[28:31], s[0:1], 16
  s_load_dwordx4 s[24:27], s[0:1], 0
  s_load_dwordx2 s[52:53], s[0:1], 32
  s_getpc_b64 s[40:41]
L_pc:
  v_lshlrev_b32 v72, 7, v0
  v_min_u32 v72, L_done-L_pc, v72
  v_mov_b32 v73, s41
  v_add_co_u32 v72, vcc, s40, v72
  v_lshrrev_b32 v77, 6, v0
  v_and_b32 v74, 63, v0
  v_addc_co_u32 v73, vcc, 0, v73, vcc
  global_load_dword v23, v[72:73], off
  v_readfirstlane_b32 s20, v77
  v_and_b32 v75, 15, v74
  v_lshlrev_b32 v78, 4, v74
  v_lshlrev_b32 v79, 4, v75
  s_lshr_b32 s47, s2, 3
  s_mul_i32 s39, s47, 9216
  s_mul_i32 s38, s20, 2304
  s_add_u32 s39, s39, s38
  s_mul_i32 s38, s20, 192
  v_mul_u32_u24 v81, 0xaaab, v74
  v_lshrrev_b32 v81, 19, v81
  v_mul_u32_u24 v81, 576, v81
  v_add3_u32 v14, v81, v78, s38
  v_add_u32 v80, 64, v74
  v_mul_u32_u24 v81, 0xaaab, v80
  v_lshrrev_b32 v81, 19, v81
  v_mul_u32_u24 v81, 576, v81
  v_add3_u32 v15, v81, v78, s38
  v_add_u32 v80, 128, v74
  v_mul_u32_u24 v81, 0xaaab, v80
  v_lshrrev_b32 v81, 19, v81
  v_mul_u32_u24 v81, 576, v81
  v_add3_u32 v16, v81, v78, s38
  s_lshl_b32 s33, s20, 10
  s_mul_i32 s34, s20, 6144
  s_mov_b32 s36, 0
  s_mov_b32 s14, 294912
  s_mov_b32 s15, 0x00020000
  s_mov_b32 s18, 768
  s_mov_b32 s19, 0x00020000
  s_add_u32 m0, s33, 147456
  s_waitcnt lgkmcnt(0)
  s_mov_b32 s12, s28
  s_and_b32 s13, s29, 0xffff
  buffer_load_dwordx4 a[216:219], v78, s[12:15], s39 offen
  buffer_load_dwordx4 a[220:223], v78, s[12:15], s39 offen offset:1024
  buffer_load_dwordx4 a[224:227], v79, s[12:15], s39 offen offset:2048
  s_mov_b32 s16, s26
  s_and_b32 s17, s27, 0xffff
  buffer_load_dwordx4 v78, s[16:19], 0 offen lds
  s_and_b32 s38, s2, 7
  s_lshl_b32 s38, s38, 5
  s_add_u32 s38, s38, s47
  s_mul_i32 s21, s38, 24576
  s_mov_b32 s4, s24
  s_and_b32 s5, s25, 0xffff
  s_mov_b32 s6, 113246208
  s_mov_b32 s7, 0x00020000
  v_mul_u32_u24 v81, 0xaaab, v0
  v_lshrrev_b32 v81, 21, v81
  v_xor_b32 v80, v0, v81
  v_lshlrev_b32 v1, 4, v80
  v_add_u32 v80, 256, v0
  v_mul_u32_u24 v81, 0xaaab, v80
  v_lshrrev_b32 v81, 21, v81
  v_xor_b32 v80, v80, v81
  v_lshlrev_b32 v2, 4, v80
  v_add_u32 v80, 512, v0
  v_mul_u32_u24 v81, 0xaaab, v80
  v_lshrrev_b32 v81, 21, v81
  v_xor_b32 v80, v80, v81
  v_lshlrev_b32 v3, 4, v80
  s_add_u32 s37, s21, 12288
  s_mov_b32 s22, s21
  s_add_u32 m0, s33, 98304
  s_nop 0
  buffer_load_dwordx4 v1, s[4:7], s21 offen nt lds
  s_add_u32 m0, s33, 102400
  s_nop 0
  buffer_load_dwordx4 v2, s[4:7], s21 offen nt lds
  s_add_u32 m0, s33, 106496
  s_nop 0
  buffer_load_dwordx4 v3, s[4:7], s21 offen nt lds
  s_add_u32 m0, s33, 110592
  s_add_u32 s21, s21, 6291456
  buffer_load_dwordx4 v1, s[4:7], s37 offen nt lds
  s_add_u32 m0, s33, 114688
  s_nop 0
  buffer_load_dwordx4 v2, s[4:7], s37 offen nt lds
  s_add_u32 m0, s33, 118784
  s_nop 0
  buffer_load_dwordx4 v3, s[4:7], s37 offen nt lds
  s_add_u32 s37, s37, 6291456
  v_lshrrev_b32 v76, 4, v74
  v_lshlrev_b32 v18, 4, v76
  v_add_u32 v18, s33, v18
  v_add_u32 v18, 147456, v18
  v_bfe_u32 v81, v74, 2, 2
  v_and_b32 v82, 3, v74
  v_lshl_add_u32 v83, v76, 3, v81
  v_mul_u32_u24 v83, 192, v83
  v_mul_u32_u24 v84, 48, v82
  v_add3_u32 v17, v83, v84, s34
  v_add_u32 v104, 49152, v17
  v_lshlrev_b32 v83, 4, v82
  v_mov_b32 v84, 0xffff
  v_cmp_lt_u32 vcc, 1, v82
  v_lshlrev_b32 v84, v83, v84
  v_mul_u32_u24 v80, 0x300, v75
  v_cndmask_b32 v20, 0, v84, vcc
  v_sub_u32 v19, v84, v20
  s_add_u32 m0, s34, 49152
  s_nop 0
  buffer_load_dwordx4 v14, s[12:15], s36 offen offset:0 lds
  buffer_load_dwordx4 v15, s[12:15], s36 offen offset:1024 lds
  buffer_load_dwordx4 v16, s[12:15], s36 offen offset:2048 lds
  s_add_u32 m0, s34, 52224
  s_add_u32 s36, s36, 12288
  buffer_load_dwordx4 v14, s[12:15], s36 offen offset:0 lds
  buffer_load_dwordx4 v15, s[12:15], s36 offen offset:1024 lds
  buffer_load_dwordx4 v16, s[12:15], s36 offen offset:2048 lds
  s_mov_b32 s8, s30
  s_and_b32 s9, s31, 0xffff
  s_mov_b32 s10, 113246208
  s_mov_b32 s11, 0x00020000
  v_lshlrev_b32 v4, 4, v0
  v_add_u32 v5, 4096, v4
  v_add_u32 v6, 8192, v4
  v_xor_b32 v81, v76, v75
  v_lshl_add_u32 v7, v81, 4, v80
  v_add_u32 v7, 98304, v7
  v_xor_b32 v8, 64, v7
  v_xor_b32 v9, 128, v7
  v_xor_b32 v10, 192, v7
  s_mul_i32 s38, s20, 12
  v_mul_u32_u24 v81, 3, v76
  v_add_u32 v81, s38, v81
  v_add_u32 v82, 0, v81
  v_xor_b32 v82, v82, v75
  v_lshl_add_u32 v11, v82, 4, v80
  v_add_u32 v82, 1, v81
  v_xor_b32 v82, v82, v75
  v_lshl_add_u32 v12, v82, 4, v80
  v_add_u32 v82, 2, v81
  v_xor_b32 v82, v82, v75
  v_lshl_add_u32 v13, v82, 4, v80
  s_mov_b32 s23, 113246208
  s_mov_b32 s44, 6291456
  s_add_u32 s42, s33, 49152
  s_mov_b32 s51, 1
  s_and_b32 s38, s47, 3
  s_mul_i32 s57, s38, 24576
  s_add_u32 s57, s57, 100663296
  s_lshl_b32 s38, s38, 6
  s_add_u32 s52, s52, s38
  s_addc_u32 s53, s53, 0
  s_mov_b32 s55, 112
  s_mov_b32 s68, 0
  s_cmp_eq_u32 s20, 0
  s_cselect_b32 s66, s55, 0
  s_mov_b32 s55, 0
  s_mov_b32 s65, 0
  s_mov_b32 s61, 12
  s_add_u32 s62, s22, 18874368
  s_mov_b32 s54, 0
  s_add_u32 s58, s22, 6291456
  s_add_u32 s59, s22, 12582912
  s_mov_b32 s32, 3
  v_mov_b32 v105, 147456
  v_add_u32 v106, s33, v105
  s_add_u32 m0, s34, 73728
  s_add_u32 s36, s36, 12288
  buffer_load_dwordx4 v14, s[12:15], s36 offen offset:0 lds
  buffer_load_dwordx4 v15, s[12:15], s36 offen offset:1024 lds
  buffer_load_dwordx4 v16, s[12:15], s36 offen offset:2048 lds
  s_add_u32 m0, s34, 76800
  s_add_u32 s36, s36, 12288
  buffer_load_dwordx4 v14, s[12:15], s36 offen offset:0 lds
  buffer_load_dwordx4 v15, s[12:15], s36 offen offset:1024 lds
  buffer_load_dwordx4 v16, s[12:15], s36 offen offset:2048 lds
  s_waitcnt vmcnt(6)
  ds_read_b128 v[96:99], v18 offset:0
  ds_read_b64_tr_b16 a[144:145], v104 offset:0
  ds_read_b64_tr_b16 a[146:147], v104 offset:768
  ds_read_b64_tr_b16 a[148:149], v104 offset:8
  ds_read_b64_tr_b16 a[150:151], v104 offset:776
  ds_read_b64_tr_b16 a[152:153], v104 offset:16
  ds_read_b64_tr_b16 a[154:155], v104 offset:784
  ds_read_b64_tr_b16 a[156:157], v104 offset:24
  ds_read_b64_tr_b16 a[158:159], v104 offset:792
  ds_read_b64_tr_b16 a[160:161], v104 offset:32
  ds_read_b64_tr_b16 a[162:163], v104 offset:800
  ds_read_b64_tr_b16 a[164:165], v104 offset:40
  ds_read_b64_tr_b16 a[166:167], v104 offset:808
  s_add_u32 m0, s34, 0
  s_add_u32 s36, s36, 12288
  buffer_load_dwordx4 v14, s[12:15], s36 offen offset:0 lds
  buffer_load_dwordx4 v15, s[12:15], s36 offen offset:1024 lds
  buffer_load_dwordx4 v16, s[12:15], s36 offen offset:2048 lds
  s_add_u32 m0, s34, 3072
  s_add_u32 s36, s36, 12288
  buffer_load_dwordx4 v14, s[12:15], s36 offen offset:0 lds
  buffer_load_dwordx4 v15, s[12:15], s36 offen offset:1024 lds
  buffer_load_dwordx4 v16, s[12:15], s36 offen offset:2048 lds
  s_waitcnt lgkmcnt(12)
  v_and_b32 v96, v19, v96
  v_and_b32 v97, v20, v97
  v_and_b32 v98, v19, v98
  v_and_b32 v99, v20, v99
  s_waitcnt lgkmcnt(10)
  v_mfma_f32_4x4x4_16b_bf16 v[72:75], v[96:97], a[144:145], 0
  v_mfma_f32_4x4x4_16b_bf16 v[76:79], v[98:99], a[146:147], 0
  s_waitcnt vmcnt(6)
  s_add_u32 m0, s34, 24576
  s_add_u32 s36, s36, 12288
  s_nop 0
  ds_read_b64_tr_b16 a[168:169], v104 offset:24576
  ds_read_b64_tr_b16 a[170:171], v104 offset:25344
  buffer_load_dwordx4 v14, s[12:15], s36 offen offset:0 lds
  s_waitcnt lgkmcnt(10)
  v_mfma_f32_4x4x4_16b_bf16 v[80:83], v[96:97], a[148:149], 0
  v_mfma_f32_4x4x4_16b_bf16 v[84:87], v[98:99], a[150:151], 0
  ds_read_b64_tr_b16 a[172:173], v104 offset:24584
  ds_read_b128 v[100:103], v18 offset:64
  ds_read_b64_tr_b16 a[174:175], v104 offset:25352
  buffer_load_dwordx4 v15, s[12:15], s36 offen offset:1024 lds
  s_waitcnt lgkmcnt(11)
  v_mfma_f32_4x4x4_16b_bf16 v[88:91], v[96:97], a[152:153], 0
  v_mfma_f32_4x4x4_16b_bf16 v[92:95], v[98:99], a[154:155], 0
  v_cvt_pk_bf16_f32 v72, v72, v73
  v_cvt_pk_bf16_f32 v74, v74, v75
  ds_read_b64_tr_b16 a[176:177], v104 offset:24592
  ds_read_b64_tr_b16 a[178:179], v104 offset:25360
  buffer_load_dwordx4 v16, s[12:15], s36 offen offset:2048 lds
  v_cvt_pk_bf16_f32 v76, v76, v77
  v_accvgpr_write_b32 a0, v72
  v_cvt_pk_bf16_f32 v78, v78, v79
  v_accvgpr_write_b32 a1, v74
  v_accvgpr_write_b32 a2, v76
  v_accvgpr_write_b32 a3, v78
  s_waitcnt lgkmcnt(11)
  v_mfma_f32_4x4x4_16b_bf16 v[72:75], v[96:97], a[156:157], 0
  v_mfma_f32_4x4x4_16b_bf16 v[76:79], v[98:99], a[158:159], 0
  v_cvt_pk_bf16_f32 v80, v80, v81
  v_cvt_pk_bf16_f32 v82, v82, v83
  s_add_u32 m0, s34, 27648
  s_add_u32 s36, s36, 12288
  s_nop 0
  ds_read_b64_tr_b16 a[180:181], v104 offset:24600
  ds_read_b64_tr_b16 a[182:183], v104 offset:25368
  buffer_load_dwordx4 v14, s[12:15], s36 offen offset:0 lds
  v_cvt_pk_bf16_f32 v84, v84, v85
  v_accvgpr_write_b32 a4, v80
  v_cvt_pk_bf16_f32 v86, v86, v87
  v_accvgpr_write_b32 a5, v82
  v_accvgpr_write_b32 a6, v84
  v_accvgpr_write_b32 a7, v86
  s_waitcnt lgkmcnt(11)
  v_mfma_f32_4x4x4_16b_bf16 v[80:83], v[96:97], a[160:161], 0
  v_mfma_f32_4x4x4_16b_bf16 v[84:87], v[98:99], a[162:163], 0
  v_cvt_pk_bf16_f32 v88, v88, v89
  v_cvt_pk_bf16_f32 v90, v90, v91
  ds_read_b64_tr_b16 a[184:185], v104 offset:24608
  ds_read_b64_tr_b16 a[186:187], v104 offset:25376
  buffer_load_dwordx4 v15, s[12:15], s36 offen offset:1024 lds
  v_cvt_pk_bf16_f32 v92, v92, v93
  v_accvgpr_write_b32 a8, v88
  v_cvt_pk_bf16_f32 v94, v94, v95
  v_accvgpr_write_b32 a9, v90
  v_accvgpr_write_b32 a10, v92
  v_accvgpr_write_b32 a11, v94
  s_waitcnt lgkmcnt(7)
  v_and_b32 v100, v19, v100
  v_and_b32 v101, v20, v101
  v_mfma_f32_4x4x4_16b_bf16 v[88:91], v[96:97], a[164:165], 0
  v_mfma_f32_4x4x4_16b_bf16 v[92:95], v[98:99], a[166:167], 0
  v_and_b32 v102, v19, v102
  v_and_b32 v103, v20, v103
  ds_read_b64_tr_b16 a[188:189], v104 offset:24616
  ds_read_b64_tr_b16 a[190:191], v104 offset:25384
  buffer_load_dwordx4 v16, s[12:15], s36 offen offset:2048 lds
  v_cvt_pk_bf16_f32 v72, v72, v73
  v_cvt_pk_bf16_f32 v74, v74, v75
  v_cvt_pk_bf16_f32 v76, v76, v77
  v_accvgpr_write_b32 a12, v72
  v_cvt_pk_bf16_f32 v78, v78, v79
  v_accvgpr_write_b32 a13, v74
  v_accvgpr_write_b32 a14, v76
  v_accvgpr_write_b32 a15, v78
  s_waitcnt lgkmcnt(0)
  s_barrier
  ds_read_b128 a[192:195], v7 offset:0
  ds_read_b128 a[196:199], v7 offset:12288
  ds_read_b128 a[200:203], v8 offset:0
  ds_read_b128 a[204:207], v8 offset:12288
  v_mfma_f32_4x4x4_16b_bf16 v[72:75], v[100:101], a[168:169], 0
  v_mfma_f32_4x4x4_16b_bf16 v[76:79], v[102:103], a[170:171], 0
  v_cvt_pk_bf16_f32 v80, v80, v81
  v_cvt_pk_bf16_f32 v82, v82, v83
  s_waitcnt vmcnt(6)
  s_add_u32 m0, s34, 49152
  s_add_u32 s36, s36, 12288
  s_nop 0
  ds_read_b64_tr_b16 a[144:145], v17 offset:0
  ds_read_b64_tr_b16 a[146:147], v17 offset:768
  buffer_load_dwordx4 v14, s[12:15], s36 offen offset:0 lds
  v_cvt_pk_bf16_f32 v84, v84, v85
  v_accvgpr_write_b32 a16, v80
  v_cvt_pk_bf16_f32 v86, v86, v87
  v_accvgpr_write_b32 a17, v82
  v_accvgpr_write_b32 a18, v84
  v_accvgpr_write_b32 a19, v86
  v_mfma_f32_4x4x4_16b_bf16 v[80:83], v[100:101], a[172:173], 0
  v_mfma_f32_4x4x4_16b_bf16 v[84:87], v[102:103], a[174:175], 0
  v_cvt_pk_bf16_f32 v88, v88, v89
  v_cvt_pk_bf16_f32 v90, v90, v91
  s_waitcnt lgkmcnt(4)
  v_mfma_f32_16x16x32_bf16 v[24:27], a[0:3], a[192:195], 0
  ds_read_b64_tr_b16 a[148:149], v17 offset:8
  v_cvt_pk_bf16_f32 v92, v92, v93
  v_mfma_f32_16x16x32_bf16 v[48:51], a[0:3], a[196:199], 0
  ds_read_b128 v[96:99], v18 offset:128
  v_accvgpr_write_b32 a20, v88
  v_mfma_f32_16x16x32_bf16 v[28:31], a[4:7], a[192:195], 0
  ds_read_b64_tr_b16 a[150:151], v17 offset:776
  v_cvt_pk_bf16_f32 v94, v94, v95
  v_mfma_f32_16x16x32_bf16 v[52:55], a[4:7], a[196:199], 0
  buffer_load_dwordx4 v15, s[12:15], s36 offen offset:1024 lds
  v_accvgpr_write_b32 a21, v90
  v_accvgpr_write_b32 a22, v92
  v_accvgpr_write_b32 a23, v94
  v_mfma_f32_4x4x4_16b_bf16 v[88:91], v[100:101], a[176:177], 0
  v_mfma_f32_4x4x4_16b_bf16 v[92:95], v[102:103], a[178:179], 0
  v_cvt_pk_bf16_f32 v72, v72, v73
  v_cvt_pk_bf16_f32 v74, v74, v75
  v_mfma_f32_16x16x32_bf16 v[32:35], a[8:11], a[192:195], 0
  ds_read_b64_tr_b16 a[152:153], v17 offset:16
  ds_read_b128 a[208:211], v9 offset:0
  v_cvt_pk_bf16_f32 v76, v76, v77
  v_mfma_f32_16x16x32_bf16 v[56:59], a[8:11], a[196:199], 0
  ds_read_b64_tr_b16 a[154:155], v17 offset:784
  buffer_load_dwordx4 v16, s[12:15], s36 offen offset:2048 lds
  v_accvgpr_write_b32 a24, v72
  v_cvt_pk_bf16_f32 v78, v78, v79
  v_accvgpr_write_b32 a25, v74
  v_accvgpr_write_b32 a26, v76
  v_accvgpr_write_b32 a27, v78
  v_mfma_f32_4x4x4_16b_bf16 v[72:75], v[100:101], a[180:181], 0
  v_mfma_f32_4x4x4_16b_bf16 v[76:79], v[102:103], a[182:183], 0
  v_cvt_pk_bf16_f32 v80, v80, v81
  v_cvt_pk_bf16_f32 v82, v82, v83
  v_mfma_f32_16x16x32_bf16 v[36:39], a[12:15], a[192:195], 0
  ds_read_b64_tr_b16 a[156:157], v17 offset:24
  ds_read_b128 a[212:215], v9 offset:12288
  v_cvt_pk_bf16_f32 v84, v84, v85
  s_add_u32 m0, s34, 52224
  s_add_u32 s36, s36, 12288
  v_mfma_f32_16x16x32_bf16 v[60:63], a[12:15], a[196:199], 0
  ds_read_b64_tr_b16 a[158:159], v17 offset:792
  buffer_load_dwordx4 v14, s[12:15], s36 offen offset:0 lds
  v_accvgpr_write_b32 a28, v80
  v_cvt_pk_bf16_f32 v86, v86, v87
  v_accvgpr_write_b32 a29, v82
  v_accvgpr_write_b32 a30, v84
  v_accvgpr_write_b32 a31, v86
  v_mfma_f32_4x4x4_16b_bf16 v[80:83], v[100:101], a[184:185], 0
  v_mfma_f32_4x4x4_16b_bf16 v[84:87], v[102:103], a[186:187], 0
  v_cvt_pk_bf16_f32 v88, v88, v89
  v_cvt_pk_bf16_f32 v90, v90, v91
  v_mfma_f32_16x16x32_bf16 v[40:43], a[16:19], a[192:195], 0
  ds_read_b64_tr_b16 a[160:161], v17 offset:32
  v_cvt_pk_bf16_f32 v92, v92, v93
  v_accvgpr_write_b32 a32, v88
  v_mfma_f32_16x16x32_bf16 v[64:67], a[16:19], a[196:199], 0
  ds_read_b64_tr_b16 a[162:163], v17 offset:800
  buffer_load_dwordx4 v15, s[12:15], s36 offen offset:1024 lds
  v_cvt_pk_bf16_f32 v94, v94, v95
  v_accvgpr_write_b32 a33, v90
  v_accvgpr_write_b32 a34, v92
  v_accvgpr_write_b32 a35, v94
  s_waitcnt lgkmcnt(9)
  v_and_b32 v96, v19, v96
  v_and_b32 v97, v20, v97
  v_mfma_f32_4x4x4_16b_bf16 v[88:91], v[100:101], a[188:189], 0
  v_mfma_f32_4x4x4_16b_bf16 v[92:95], v[102:103], a[190:191], 0
  v_and_b32 v98, v19, v98
  v_and_b32 v99, v20, v99
  v_mfma_f32_16x16x32_bf16 v[44:47], a[20:23], a[192:195], 0
  ds_read_b64_tr_b16 a[164:165], v17 offset:40
  v_cvt_pk_bf16_f32 v72, v72, v73
  v_cvt_pk_bf16_f32 v74, v74, v75
  v_mfma_f32_16x16x32_bf16 v[68:71], a[20:23], a[196:199], 0
  ds_read_b64_tr_b16 a[166:167], v17 offset:808
  buffer_load_dwordx4 v16, s[12:15], s36 offen offset:2048 lds
  v_cvt_pk_bf16_f32 v76, v76, v77
  v_accvgpr_write_b32 a36, v72
  v_cvt_pk_bf16_f32 v78, v78, v79
  v_accvgpr_write_b32 a37, v74
  v_accvgpr_write_b32 a38, v76
  v_accvgpr_write_b32 a39, v78
  v_mfma_f32_4x4x4_16b_bf16 v[72:75], v[96:97], a[144:145], 0
  v_mfma_f32_4x4x4_16b_bf16 v[76:79], v[98:99], a[146:147], 0
  v_cvt_pk_bf16_f32 v80, v80, v81
  v_cvt_pk_bf16_f32 v82, v82, v83
  s_waitcnt vmcnt(6)
  v_mfma_f32_16x16x32_bf16 v[24:27], a[24:27], a[200:203], v[24:27]
  ds_read_b64_tr_b16 a[168:169], v17 offset:24576
  v_cvt_pk_bf16_f32 v84, v84, v85
  s_add_u32 m0, s34, 73728
  s_add_u32 s36, s36, 12288
  v_mfma_f32_16x16x32_bf16 v[48:51], a[24:27], a[204:207], v[48:51]
  ds_read_b64_tr_b16 a[170:171], v17 offset:25344
  buffer_load_dwordx4 v14, s[12:15], s36 offen offset:0 lds
  v_accvgpr_write_b32 a40, v80
  v_cvt_pk_bf16_f32 v86, v86, v87
  v_accvgpr_write_b32 a41, v82
  v_accvgpr_write_b32 a42, v84
  v_accvgpr_write_b32 a43, v86
  s_waitcnt lgkmcnt(12)
  v_mfma_f32_4x4x4_16b_bf16 v[80:83], v[96:97], a[148:149], 0
  v_mfma_f32_4x4x4_16b_bf16 v[84:87], v[98:99], a[150:151], 0
  v_cvt_pk_bf16_f32 v88, v88, v89
  v_cvt_pk_bf16_f32 v90, v90, v91
  v_mfma_f32_16x16x32_bf16 v[28:31], a[28:31], a[200:203], v[28:31]
  ds_read_b64_tr_b16 a[172:173], v17 offset:24584
  ds_read_b128 v[100:103], v18 offset:192
  v_cvt_pk_bf16_f32 v92, v92, v93
  v_mfma_f32_16x16x32_bf16 v[52:55], a[28:31], a[204:207], v[52:55]
  ds_read_b64_tr_b16 a[174:175], v17 offset:25352
  buffer_load_dwordx4 v15, s[12:15], s36 offen offset:1024 lds
  v_accvgpr_write_b32 a44, v88
  v_cvt_pk_bf16_f32 v94, v94, v95
  v_accvgpr_write_b32 a45, v90
  v_accvgpr_write_b32 a46, v92
  v_accvgpr_write_b32 a47, v94
  s_waitcnt lgkmcnt(12)
  v_mfma_f32_4x4x4_16b_bf16 v[88:91], v[96:97], a[152:153], 0
  v_mfma_f32_4x4x4_16b_bf16 v[92:95], v[98:99], a[154:155], 0
  v_cvt_pk_bf16_f32 v72, v72, v73
  v_cvt_pk_bf16_f32 v74, v74, v75
  v_mfma_f32_16x16x32_bf16 v[32:35], a[32:35], a[200:203], v[32:35]
  ds_read_b64_tr_b16 a[176:177], v17 offset:24592
  ds_read_b128 a[192:195], v10 offset:0
  v_cvt_pk_bf16_f32 v76, v76, v77
  v_mfma_f32_16x16x32_bf16 v[56:59], a[32:35], a[204:207], v[56:59]
  ds_read_b64_tr_b16 a[178:179], v17 offset:25360
  buffer_load_dwordx4 v16, s[12:15], s36 offen offset:2048 lds
  v_accvgpr_write_b32 a48, v72
  v_cvt_pk_bf16_f32 v78, v78, v79
  v_accvgpr_write_b32 a49, v74
  v_accvgpr_write_b32 a50, v76
  v_accvgpr_write_b32 a51, v78
  s_waitcnt lgkmcnt(12)
  v_mfma_f32_4x4x4_16b_bf16 v[72:75], v[96:97], a[156:157], 0
  v_mfma_f32_4x4x4_16b_bf16 v[76:79], v[98:99], a[158:159], 0
  v_cvt_pk_bf16_f32 v80, v80, v81
  v_cvt_pk_bf16_f32 v82, v82, v83
  v_mfma_f32_16x16x32_bf16 v[36:39], a[36:39], a[200:203], v[36:39]
  ds_read_b64_tr_b16 a[180:181], v17 offset:24600
  ds_read_b128 a[196:199], v10 offset:12288
  v_cvt_pk_bf16_f32 v84, v84, v85
  s_add_u32 m0, s34, 76800
  s_add_u32 s36, s36, 12288
  v_mfma_f32_16x16x32_bf16 v[60:63], a[36:39], a[204:207], v[60:63]
  ds_read_b64_tr_b16 a[182:183], v17 offset:25368
  buffer_load_dwordx4 v14, s[12:15], s36 offen offset:0 lds
  v_accvgpr_write_b32 a52, v80
  v_cvt_pk_bf16_f32 v86, v86, v87
  v_accvgpr_write_b32 a53, v82
  v_accvgpr_write_b32 a54, v84
  v_accvgpr_write_b32 a55, v86
  s_waitcnt lgkmcnt(13)
  v_mfma_f32_4x4x4_16b_bf16 v[80:83], v[96:97], a[160:161], 0
  v_mfma_f32_4x4x4_16b_bf16 v[84:87], v[98:99], a[162:163], 0
  v_cvt_pk_bf16_f32 v88, v88, v89
  v_cvt_pk_bf16_f32 v90, v90, v91
  v_mfma_f32_16x16x32_bf16 v[40:43], a[40:43], a[200:203], v[40:43]
  ds_read_b64_tr_b16 a[184:185], v17 offset:24608
  v_cvt_pk_bf16_f32 v92, v92, v93
  v_accvgpr_write_b32 a56, v88
  v_mfma_f32_16x16x32_bf16 v[64:67], a[40:43], a[204:207], v[64:67]
  ds_read_b64_tr_b16 a[186:187], v17 offset:25376
  buffer_load_dwordx4 v15, s[12:15], s36 offen offset:1024 lds
  v_cvt_pk_bf16_f32 v94, v94, v95
  v_accvgpr_write_b32 a57, v90
  v_accvgpr_write_b32 a58, v92
  v_accvgpr_write_b32 a59, v94
  s_waitcnt lgkmcnt(9)
  v_and_b32 v100, v19, v100
  v_and_b32 v101, v20, v101
  v_mfma_f32_4x4x4_16b_bf16 v[88:91], v[96:97], a[164:165], 0
  v_mfma_f32_4x4x4_16b_bf16 v[92:95], v[98:99], a[166:167], 0
  v_and_b32 v102, v19, v102
  v_and_b32 v103, v20, v103
  v_mfma_f32_16x16x32_bf16 v[44:47], a[44:47], a[200:203], v[44:47]
  ds_read_b64_tr_b16 a[188:189], v17 offset:24616
  v_cvt_pk_bf16_f32 v72, v72, v73
  v_cvt_pk_bf16_f32 v74, v74, v75
  v_mfma_f32_16x16x32_bf16 v[68:71], a[44:47], a[204:207], v[68:71]
  ds_read_b64_tr_b16 a[190:191], v17 offset:25384
  buffer_load_dwordx4 v16, s[12:15], s36 offen offset:2048 lds
  v_cvt_pk_bf16_f32 v76, v76, v77
  v_accvgpr_write_b32 a60, v72
  v_cvt_pk_bf16_f32 v78, v78, v79
  v_accvgpr_write_b32 a61, v74
  v_accvgpr_write_b32 a62, v76
  v_accvgpr_write_b32 a63, v78
  v_mfma_f32_4x4x4_16b_bf16 v[72:75], v[100:101], a[168:169], 0
  v_mfma_f32_4x4x4_16b_bf16 v[76:79], v[102:103], a[170:171], 0
  v_cvt_pk_bf16_f32 v80, v80, v81
  v_cvt_pk_bf16_f32 v82, v82, v83
  s_waitcnt vmcnt(6)
  v_mfma_f32_16x16x32_bf16 v[24:27], a[48:51], a[208:211], v[24:27]
  ds_read_b64_tr_b16 a[144:145], v104 offset:0
  v_cvt_pk_bf16_f32 v84, v84, v85
  s_add_u32 m0, s34, 0
  s_add_u32 s36, s36, 12288
  v_mfma_f32_16x16x32_bf16 v[48:51], a[48:51], a[212:215], v[48:51]
  ds_read_b64_tr_b16 a[146:147], v104 offset:768
  buffer_load_dwordx4 v14, s[12:15], s36 offen offset:0 lds
  v_accvgpr_write_b32 a64, v80
  v_cvt_pk_bf16_f32 v86, v86, v87
  v_accvgpr_write_b32 a65, v82
  v_accvgpr_write_b32 a66, v84
  v_accvgpr_write_b32 a67, v86
  s_waitcnt lgkmcnt(12)
  v_mfma_f32_4x4x4_16b_bf16 v[80:83], v[100:101], a[172:173], 0
  v_mfma_f32_4x4x4_16b_bf16 v[84:87], v[102:103], a[174:175], 0
  v_cvt_pk_bf16_f32 v88, v88, v89
  v_cvt_pk_bf16_f32 v90, v90, v91
  v_mfma_f32_16x16x32_bf16 v[28:31], a[52:55], a[208:211], v[28:31]
  ds_read_b64_tr_b16 a[148:149], v104 offset:8
  ds_read_b128 v[96:99], v18 offset:256
  v_cvt_pk_bf16_f32 v92, v92, v93
  v_mfma_f32_16x16x32_bf16 v[52:55], a[52:55], a[212:215], v[52:55]
  ds_read_b64_tr_b16 a[150:151], v104 offset:776
  buffer_load_dwordx4 v15, s[12:15], s36 offen offset:1024 lds
  v_accvgpr_write_b32 a68, v88
  v_cvt_pk_bf16_f32 v94, v94, v95
  v_accvgpr_write_b32 a69, v90
  v_accvgpr_write_b32 a70, v92
  v_accvgpr_write_b32 a71, v94
  s_waitcnt lgkmcnt(12)
  v_mfma_f32_4x4x4_16b_bf16 v[88:91], v[100:101], a[176:177], 0
  v_mfma_f32_4x4x4_16b_bf16 v[92:95], v[102:103], a[178:179], 0
  v_cvt_pk_bf16_f32 v72, v72, v73
  v_cvt_pk_bf16_f32 v74, v74, v75
  v_mfma_f32_16x16x32_bf16 v[32:35], a[56:59], a[208:211], v[32:35]
  ds_read_b64_tr_b16 a[152:153], v104 offset:16
  ds_read_b128 a[200:203], v7 offset:256
  v_cvt_pk_bf16_f32 v76, v76, v77
  v_mfma_f32_16x16x32_bf16 v[56:59], a[56:59], a[212:215], v[56:59]
  ds_read_b64_tr_b16 a[154:155], v104 offset:784
  buffer_load_dwordx4 v16, s[12:15], s36 offen offset:2048 lds
  v_accvgpr_write_b32 a72, v72
  v_cvt_pk_bf16_f32 v78, v78, v79
  v_accvgpr_write_b32 a73, v74
  v_accvgpr_write_b32 a74, v76
  v_accvgpr_write_b32 a75, v78
  s_waitcnt lgkmcnt(12)
  v_mfma_f32_4x4x4_16b_bf16 v[72:75], v[100:101], a[180:181], 0
  v_mfma_f32_4x4x4_16b_bf16 v[76:79], v[102:103], a[182:183], 0
  v_cvt_pk_bf16_f32 v80, v80, v81
  v_cvt_pk_bf16_f32 v82, v82, v83
  v_mfma_f32_16x16x32_bf16 v[36:39], a[60:63], a[208:211], v[36:39]
  ds_read_b64_tr_b16 a[156:157], v104 offset:24
  ds_read_b128 a[204:207], v7 offset:12544
  v_cvt_pk_bf16_f32 v84, v84, v85
  s_add_u32 m0, s34, 3072
  s_add_u32 s36, s36, 12288
  v_mfma_f32_16x16x32_bf16 v[60:63], a[60:63], a[212:215], v[60:63]
  ds_read_b64_tr_b16 a[158:159], v104 offset:792
  buffer_load_dwordx4 v14, s[12:15], s36 offen offset:0 lds
  v_accvgpr_write_b32 a76, v80
  v_cvt_pk_bf16_f32 v86, v86, v87
  v_accvgpr_write_b32 a77, v82
  v_accvgpr_write_b32 a78, v84
  v_accvgpr_write_b32 a79, v86
  s_waitcnt lgkmcnt(13)
  v_mfma_f32_4x4x4_16b_bf16 v[80:83], v[100:101], a[184:185], 0
  v_mfma_f32_4x4x4_16b_bf16 v[84:87], v[102:103], a[186:187], 0
  v_cvt_pk_bf16_f32 v88, v88, v89
  v_cvt_pk_bf16_f32 v90, v90, v91
  v_mfma_f32_16x16x32_bf16 v[40:43], a[64:67], a[208:211], v[40:43]
  ds_read_b64_tr_b16 a[160:161], v104 offset:32
  v_cvt_pk_bf16_f32 v92, v92, v93
  v_accvgpr_write_b32 a80, v88
  v_mfma_f32_16x16x32_bf16 v[64:67], a[64:67], a[212:215], v[64:67]
  ds_read_b64_tr_b16 a[162:163], v104 offset:800
  buffer_load_dwordx4 v15, s[12:15], s36 offen offset:1024 lds
  v_cvt_pk_bf16_f32 v94, v94, v95
  v_accvgpr_write_b32 a81, v90
  v_accvgpr_write_b32 a82, v92
  v_accvgpr_write_b32 a83, v94
  s_waitcnt lgkmcnt(9)
  v_and_b32 v96, v19, v96
  v_and_b32 v97, v20, v97
  v_mfma_f32_4x4x4_16b_bf16 v[88:91], v[100:101], a[188:189], 0
  v_mfma_f32_4x4x4_16b_bf16 v[92:95], v[102:103], a[190:191], 0
  v_and_b32 v98, v19, v98
  v_and_b32 v99, v20, v99
  v_mfma_f32_16x16x32_bf16 v[44:47], a[68:71], a[208:211], v[44:47]
  ds_read_b64_tr_b16 a[164:165], v104 offset:40
  v_cvt_pk_bf16_f32 v72, v72, v73
  v_cvt_pk_bf16_f32 v74, v74, v75
  v_mfma_f32_16x16x32_bf16 v[68:71], a[68:71], a[212:215], v[68:71]
  ds_read_b64_tr_b16 a[166:167], v104 offset:808
  buffer_load_dwordx4 v16, s[12:15], s36 offen offset:2048 lds
  v_cvt_pk_bf16_f32 v76, v76, v77
  v_accvgpr_write_b32 a84, v72
  v_cvt_pk_bf16_f32 v78, v78, v79
  v_accvgpr_write_b32 a85, v74
  v_accvgpr_write_b32 a86, v76
  v_accvgpr_write_b32 a87, v78
  v_mfma_f32_4x4x4_16b_bf16 v[72:75], v[96:97], a[144:145], 0
  v_mfma_f32_4x4x4_16b_bf16 v[76:79], v[98:99], a[146:147], 0
  v_cvt_pk_bf16_f32 v80, v80, v81
  v_cvt_pk_bf16_f32 v82, v82, v83
  s_waitcnt vmcnt(6)
  v_mfma_f32_16x16x32_bf16 v[24:27], a[72:75], a[192:195], v[24:27]
  ds_read_b64_tr_b16 a[168:169], v104 offset:24576
  v_cvt_pk_bf16_f32 v84, v84, v85
  s_add_u32 m0, s34, 24576
  s_add_u32 s36, s36, 12288
  v_mfma_f32_16x16x32_bf16 v[48:51], a[72:75], a[196:199], v[48:51]
  ds_read_b64_tr_b16 a[170:171], v104 offset:25344
  buffer_load_dwordx4 v14, s[12:15], s36 offen offset:0 lds
  v_accvgpr_write_b32 a88, v80
  v_cvt_pk_bf16_f32 v86, v86, v87
  v_accvgpr_write_b32 a89, v82
  v_accvgpr_write_b32 a90, v84
  v_accvgpr_write_b32 a91, v86
  s_waitcnt lgkmcnt(12)
  v_mfma_f32_4x4x4_16b_bf16 v[80:83], v[96:97], a[148:149], 0
  v_mfma_f32_4x4x4_16b_bf16 v[84:87], v[98:99], a[150:151], 0
  v_cvt_pk_bf16_f32 v88, v88, v89
  v_cvt_pk_bf16_f32 v90, v90, v91
  v_mfma_f32_16x16x32_bf16 v[28:31], a[76:79], a[192:195], v[28:31]
  ds_read_b64_tr_b16 a[172:173], v104 offset:24584
  ds_read_b128 v[100:103], v18 offset:320
  v_cvt_pk_bf16_f32 v92, v92, v93
  v_mfma_f32_16x16x32_bf16 v[52:55], a[76:79], a[196:199], v[52:55]
  ds_read_b64_tr_b16 a[174:175], v104 offset:25352
  buffer_load_dwordx4 v15, s[12:15], s36 offen offset:1024 lds
  v_accvgpr_write_b32 a92, v88
  v_cvt_pk_bf16_f32 v94, v94, v95
  v_accvgpr_write_b32 a93, v90
  v_accvgpr_write_b32 a94, v92
  v_accvgpr_write_b32 a95, v94
  s_waitcnt lgkmcnt(12)
  v_mfma_f32_4x4x4_16b_bf16 v[88:91], v[96:97], a[152:153], 0
  v_mfma_f32_4x4x4_16b_bf16 v[92:95], v[98:99], a[154:155], 0
  v_cvt_pk_bf16_f32 v72, v72, v73
  v_cvt_pk_bf16_f32 v74, v74, v75
  v_mfma_f32_16x16x32_bf16 v[32:35], a[80:83], a[192:195], v[32:35]
  ds_read_b64_tr_b16 a[176:177], v104 offset:24592
  ds_read_b128 a[208:211], v8 offset:256
  v_cvt_pk_bf16_f32 v76, v76, v77
  v_mfma_f32_16x16x32_bf16 v[56:59], a[80:83], a[196:199], v[56:59]
  ds_read_b64_tr_b16 a[178:179], v104 offset:25360
  buffer_load_dwordx4 v16, s[12:15], s36 offen offset:2048 lds
  v_accvgpr_write_b32 a96, v72
  v_cvt_pk_bf16_f32 v78, v78, v79
  v_accvgpr_write_b32 a97, v74
  v_accvgpr_write_b32 a98, v76
  v_accvgpr_write_b32 a99, v78
  s_waitcnt lgkmcnt(12)
  v_mfma_f32_4x4x4_16b_bf16 v[72:75], v[96:97], a[156:157], 0
  v_mfma_f32_4x4x4_16b_bf16 v[76:79], v[98:99], a[158:159], 0
  v_cvt_pk_bf16_f32 v80, v80, v81
  v_cvt_pk_bf16_f32 v82, v82, v83
  v_mfma_f32_16x16x32_bf16 v[36:39], a[84:87], a[192:195], v[36:39]
  ds_read_b64_tr_b16 a[180:181], v104 offset:24600
  ds_read_b128 a[212:215], v8 offset:12544
  v_cvt_pk_bf16_f32 v84, v84, v85
  s_add_u32 m0, s34, 27648
  s_add_u32 s36, s36, 12288
  v_mfma_f32_16x16x32_bf16 v[60:63], a[84:87], a[196:199], v[60:63]
  ds_read_b64_tr_b16 a[182:183], v104 offset:25368
  buffer_load_dwordx4 v14, s[12:15], s36 offen offset:0 lds
  v_accvgpr_write_b32 a100, v80
  v_cvt_pk_bf16_f32 v86, v86, v87
  v_accvgpr_write_b32 a101, v82
  v_accvgpr_write_b32 a102, v84
  v_accvgpr_write_b32 a103, v86
  s_waitcnt lgkmcnt(13)
  v_mfma_f32_4x4x4_16b_bf16 v[80:83], v[96:97], a[160:161], 0
  v_mfma_f32_4x4x4_16b_bf16 v[84:87], v[98:99], a[162:163], 0
  v_cvt_pk_bf16_f32 v88, v88, v89
  v_cvt_pk_bf16_f32 v90, v90, v91
  v_mfma_f32_16x16x32_bf16 v[40:43], a[88:91], a[192:195], v[40:43]
  ds_read_b64_tr_b16 a[184:185], v104 offset:24608
  v_cvt_pk_bf16_f32 v92, v92, v93
  v_accvgpr_write_b32 a104, v88
  v_mfma_f32_16x16x32_bf16 v[64:67], a[88:91], a[196:199], v[64:67]
  ds_read_b64_tr_b16 a[186:187], v104 offset:25376
  buffer_load_dwordx4 v15, s[12:15], s36 offen offset:1024 lds
  v_cvt_pk_bf16_f32 v94, v94, v95
  v_accvgpr_write_b32 a105, v90
  v_accvgpr_write_b32 a106, v92
  v_accvgpr_write_b32 a107, v94
  s_waitcnt lgkmcnt(9)
  v_and_b32 v100, v19, v100
  v_and_b32 v101, v20, v101
  v_mfma_f32_4x4x4_16b_bf16 v[88:91], v[96:97], a[164:165], 0
  v_mfma_f32_4x4x4_16b_bf16 v[92:95], v[98:99], a[166:167], 0
  v_and_b32 v102, v19, v102
  v_and_b32 v103, v20, v103
  v_mfma_f32_16x16x32_bf16 v[44:47], a[92:95], a[192:195], v[44:47]
  ds_read_b64_tr_b16 a[188:189], v104 offset:24616
  v_cvt_pk_bf16_f32 v72, v72, v73
  v_cvt_pk_bf16_f32 v74, v74, v75
  v_mfma_f32_16x16x32_bf16 v[68:71], a[92:95], a[196:199], v[68:71]
  ds_read_b64_tr_b16 a[190:191], v104 offset:25384
  buffer_load_dwordx4 v16, s[12:15], s36 offen offset:2048 lds
  v_cvt_pk_bf16_f32 v76, v76, v77
  v_accvgpr_write_b32 a108, v72
  v_cvt_pk_bf16_f32 v78, v78, v79
  v_accvgpr_write_b32 a109, v74
  v_accvgpr_write_b32 a110, v76
  v_accvgpr_write_b32 a111, v78
  v_mfma_f32_4x4x4_16b_bf16 v[72:75], v[100:101], a[168:169], 0
  v_mfma_f32_4x4x4_16b_bf16 v[76:79], v[102:103], a[170:171], 0
  v_cvt_pk_bf16_f32 v80, v80, v81
  v_cvt_pk_bf16_f32 v82, v82, v83
  s_waitcnt vmcnt(6)
  v_mfma_f32_16x16x32_bf16 v[24:27], a[96:99], a[200:203], v[24:27]
  ds_read_b64_tr_b16 a[144:145], v17 offset:0
  v_cvt_pk_bf16_f32 v84, v84, v85
  s_add_u32 m0, s34, 49152
  s_add_u32 s36, s36, 12288
  v_mfma_f32_16x16x32_bf16 v[48:51], a[96:99], a[204:207], v[48:51]
  ds_read_b64_tr_b16 a[146:147], v17 offset:768
  buffer_load_dwordx4 v14, s[12:15], s36 offen offset:0 lds
  v_accvgpr_write_b32 a112, v80
  v_cvt_pk_bf16_f32 v86, v86, v87
  v_accvgpr_write_b32 a113, v82
  v_accvgpr_write_b32 a114, v84
  v_accvgpr_write_b32 a115, v86
  s_waitcnt lgkmcnt(12)
  v_mfma_f32_4x4x4_16b_bf16 v[80:83], v[100:101], a[172:173], 0
  v_mfma_f32_4x4x4_16b_bf16 v[84:87], v[102:103], a[174:175], 0
  v_cvt_pk_bf16_f32 v88, v88, v89
  v_cvt_pk_bf16_f32 v90, v90, v91
  v_mfma_f32_16x16x32_bf16 v[28:31], a[100:103], a[200:203], v[28:31]
  ds_read_b64_tr_b16 a[148:149], v17 offset:8
  ds_read_b128 v[96:99], v18 offset:384
  v_cvt_pk_bf16_f32 v92, v92, v93
  v_mfma_f32_16x16x32_bf16 v[52:55], a[100:103], a[204:207], v[52:55]
  ds_read_b64_tr_b16 a[150:151], v17 offset:776
  buffer_load_dwordx4 v15, s[12:15], s36 offen offset:1024 lds
  v_accvgpr_write_b32 a116, v88
  v_cvt_pk_bf16_f32 v94, v94, v95
  v_accvgpr_write_b32 a117, v90
  v_accvgpr_write_b32 a118, v92
  v_accvgpr_write_b32 a119, v94
  s_waitcnt lgkmcnt(12)
  v_mfma_f32_4x4x4_16b_bf16 v[88:91], v[100:101], a[176:177], 0
  v_mfma_f32_4x4x4_16b_bf16 v[92:95], v[102:103], a[178:179], 0
  v_cvt_pk_bf16_f32 v72, v72, v73
  v_cvt_pk_bf16_f32 v74, v74, v75
  v_mfma_f32_16x16x32_bf16 v[32:35], a[104:107], a[200:203], v[32:35]
  ds_read_b64_tr_b16 a[152:153], v17 offset:16
  ds_read_b128 a[192:195], v9 offset:256
  v_cvt_pk_bf16_f32 v76, v76, v77
  v_mfma_f32_16x16x32_bf16 v[56:59], a[104:107], a[204:207], v[56:59]
  ds_read_b64_tr_b16 a[154:155], v17 offset:784
  buffer_load_dwordx4 v16, s[12:15], s36 offen offset:2048 lds
  v_accvgpr_write_b32 a120, v72
  v_cvt_pk_bf16_f32 v78, v78, v79
  v_accvgpr_write_b32 a121, v74
  v_accvgpr_write_b32 a122, v76
  v_accvgpr_write_b32 a123, v78
  s_waitcnt lgkmcnt(12)
  v_mfma_f32_4x4x4_16b_bf16 v[72:75], v[100:101], a[180:181], 0
  v_mfma_f32_4x4x4_16b_bf16 v[76:79], v[102:103], a[182:183], 0
  v_cvt_pk_bf16_f32 v80, v80, v81
  v_cvt_pk_bf16_f32 v82, v82, v83
  v_mfma_f32_16x16x32_bf16 v[36:39], a[108:111], a[200:203], v[36:39]
  ds_read_b64_tr_b16 a[156:157], v17 offset:24
  ds_read_b128 a[196:199], v9 offset:12544
  v_cvt_pk_bf16_f32 v84, v84, v85
  s_add_u32 m0, s34, 52224
  s_add_u32 s36, s36, 12288
  v_mfma_f32_16x16x32_bf16 v[60:63], a[108:111], a[204:207], v[60:63]
  ds_read_b64_tr_b16 a[158:159], v17 offset:792
  buffer_load_dwordx4 v14, s[12:15], s36 offen offset:0 lds
  v_accvgpr_write_b32 a124, v80
  v_cvt_pk_bf16_f32 v86, v86, v87
  v_accvgpr_write_b32 a125, v82
  v_accvgpr_write_b32 a126, v84
  v_accvgpr_write_b32 a127, v86
  s_waitcnt lgkmcnt(13)
  v_mfma_f32_4x4x4_16b_bf16 v[80:83], v[100:101], a[184:185], 0
  v_mfma_f32_4x4x4_16b_bf16 v[84:87], v[102:103], a[186:187], 0
  v_cvt_pk_bf16_f32 v88, v88, v89
  v_cvt_pk_bf16_f32 v90, v90, v91
  v_mfma_f32_16x16x32_bf16 v[40:43], a[112:115], a[200:203], v[40:43]
  ds_read_b64_tr_b16 a[160:161], v17 offset:32
  v_cvt_pk_bf16_f32 v92, v92, v93
  v_accvgpr_write_b32 a128, v88
  v_mfma_f32_16x16x32_bf16 v[64:67], a[112:115], a[204:207], v[64:67]
  ds_read_b64_tr_b16 a[162:163], v17 offset:800
  buffer_load_dwordx4 v15, s[12:15], s36 offen offset:1024 lds
  v_cvt_pk_bf16_f32 v94, v94, v95
  v_accvgpr_write_b32 a129, v90
  v_accvgpr_write_b32 a130, v92
  v_accvgpr_write_b32 a131, v94
  s_waitcnt lgkmcnt(9)
  v_and_b32 v96, v19, v96
  v_and_b32 v97, v20, v97
  v_mfma_f32_4x4x4_16b_bf16 v[88:91], v[100:101], a[188:189], 0
  v_mfma_f32_4x4x4_16b_bf16 v[92:95], v[102:103], a[190:191], 0
  v_and_b32 v98, v19, v98
  v_and_b32 v99, v20, v99
  v_mfma_f32_16x16x32_bf16 v[44:47], a[116:119], a[200:203], v[44:47]
  ds_read_b64_tr_b16 a[164:165], v17 offset:40
  v_cvt_pk_bf16_f32 v72, v72, v73
  v_cvt_pk_bf16_f32 v74, v74, v75
  v_mfma_f32_16x16x32_bf16 v[68:71], a[116:119], a[204:207], v[68:71]
  ds_read_b64_tr_b16 a[166:167], v17 offset:808
  buffer_load_dwordx4 v16, s[12:15], s36 offen offset:2048 lds
  v_cvt_pk_bf16_f32 v76, v76, v77
  v_accvgpr_write_b32 a132, v72
  v_cvt_pk_bf16_f32 v78, v78, v79
  v_accvgpr_write_b32 a133, v74
  v_accvgpr_write_b32 a134, v76
  v_accvgpr_write_b32 a135, v78
  v_mfma_f32_4x4x4_16b_bf16 v[72:75], v[96:97], a[144:145], 0
  v_mfma_f32_4x4x4_16b_bf16 v[76:79], v[98:99], a[146:147], 0
  v_cvt_pk_bf16_f32 v80, v80, v81
  v_cvt_pk_bf16_f32 v82, v82, v83
  s_waitcnt vmcnt(6)
  v_mfma_f32_16x16x32_bf16 v[24:27], a[120:123], a[208:211], v[24:27]
  ds_read_b64_tr_b16 a[168:169], v17 offset:24576
  v_cvt_pk_bf16_f32 v84, v84, v85
  s_add_u32 m0, s34, 73728
  s_add_u32 s36, s36, 12288
  v_mfma_f32_16x16x32_bf16 v[48:51], a[120:123], a[212:215], v[48:51]
  ds_read_b64_tr_b16 a[170:171], v17 offset:25344
  buffer_load_dwordx4 v14, s[12:15], s36 offen offset:0 lds
  v_accvgpr_write_b32 a136, v80
  v_cvt_pk_bf16_f32 v86, v86, v87
  v_accvgpr_write_b32 a137, v82
  v_accvgpr_write_b32 a138, v84
  v_accvgpr_write_b32 a139, v86
  s_waitcnt lgkmcnt(12)
  v_mfma_f32_4x4x4_16b_bf16 v[80:83], v[96:97], a[148:149], 0
  v_mfma_f32_4x4x4_16b_bf16 v[84:87], v[98:99], a[150:151], 0
  v_cvt_pk_bf16_f32 v88, v88, v89
  v_cvt_pk_bf16_f32 v90, v90, v91
  v_mfma_f32_16x16x32_bf16 v[28:31], a[124:127], a[208:211], v[28:31]
  ds_read_b64_tr_b16 a[172:173], v17 offset:24584
  ds_read_b128 v[100:103], v18 offset:448
  v_cvt_pk_bf16_f32 v92, v92, v93
  v_mfma_f32_16x16x32_bf16 v[52:55], a[124:127], a[212:215], v[52:55]
  ds_read_b64_tr_b16 a[174:175], v17 offset:25352
  buffer_load_dwordx4 v15, s[12:15], s36 offen offset:1024 lds
  v_accvgpr_write_b32 a140, v88
  v_cvt_pk_bf16_f32 v94, v94, v95
  v_accvgpr_write_b32 a141, v90
  v_accvgpr_write_b32 a142, v92
  v_accvgpr_write_b32 a143, v94
  s_waitcnt lgkmcnt(12)
  v_mfma_f32_4x4x4_16b_bf16 v[88:91], v[96:97], a[152:153], 0
  v_mfma_f32_4x4x4_16b_bf16 v[92:95], v[98:99], a[154:155], 0
  v_cvt_pk_bf16_f32 v112, v72, v73
  v_cvt_pk_bf16_f32 v113, v74, v75
  v_mfma_f32_16x16x32_bf16 v[32:35], a[128:131], a[208:211], v[32:35]
  ds_read_b64_tr_b16 a[176:177], v17 offset:24592
  ds_read_b128 a[200:203], v10 offset:256
  v_cvt_pk_bf16_f32 v114, v76, v77
  v_mfma_f32_16x16x32_bf16 v[56:59], a[128:131], a[212:215], v[56:59]
  ds_read_b64_tr_b16 a[178:179], v17 offset:25360
  buffer_load_dwordx4 v16, s[12:15], s36 offen offset:2048 lds
  v_cvt_pk_bf16_f32 v115, v78, v79
  s_waitcnt lgkmcnt(12)
  v_mfma_f32_4x4x4_16b_bf16 v[72:75], v[96:97], a[156:157], 0
  v_mfma_f32_4x4x4_16b_bf16 v[76:79], v[98:99], a[158:159], 0
  v_cvt_pk_bf16_f32 v116, v80, v81
  v_cvt_pk_bf16_f32 v117, v82, v83
  v_mfma_f32_16x16x32_bf16 v[36:39], a[132:135], a[208:211], v[36:39]
  ds_read_b64_tr_b16 a[180:181], v17 offset:24600
  ds_read_b128 a[204:207], v10 offset:12544
  v_cvt_pk_bf16_f32 v118, v84, v85
  s_add_u32 m0, s34, 76800
  s_add_u32 s36, s36, 12288
  v_mfma_f32_16x16x32_bf16 v[60:63], a[132:135], a[212:215], v[60:63]
  ds_read_b64_tr_b16 a[182:183], v17 offset:25368
  buffer_load_dwordx4 v14, s[12:15], s36 offen offset:0 lds
  v_cvt_pk_bf16_f32 v119, v86, v87
  s_waitcnt lgkmcnt(13)
  v_mfma_f32_4x4x4_16b_bf16 v[80:83], v[96:97], a[160:161], 0
  v_mfma_f32_4x4x4_16b_bf16 v[84:87], v[98:99], a[162:163], 0
  v_cvt_pk_bf16_f32 v120, v88, v89
  v_cvt_pk_bf16_f32 v121, v90, v91
  v_mfma_f32_16x16x32_bf16 v[40:43], a[136:139], a[208:211], v[40:43]
  ds_read_b64_tr_b16 a[184:185], v17 offset:24608
  v_cvt_pk_bf16_f32 v122, v92, v93
  v_mfma_f32_16x16x32_bf16 v[64:67], a[136:139], a[212:215], v[64:67]
  ds_read_b64_tr_b16 a[186:187], v17 offset:25376
  buffer_load_dwordx4 v15, s[12:15], s36 offen offset:1024 lds
  v_cvt_pk_bf16_f32 v123, v94, v95
  s_waitcnt lgkmcnt(9)
  v_and_b32 v100, v19, v100
  v_and_b32 v101, v20, v101
  v_mfma_f32_4x4x4_16b_bf16 v[88:91], v[96:97], a[164:165], 0
  v_mfma_f32_4x4x4_16b_bf16 v[92:95], v[98:99], a[166:167], 0
  v_and_b32 v102, v19, v102
  v_and_b32 v103, v20, v103
  v_mfma_f32_16x16x32_bf16 v[44:47], a[140:143], a[208:211], v[44:47]
  ds_read_b64_tr_b16 a[188:189], v17 offset:24616
  v_cvt_pk_bf16_f32 v124, v72, v73
  v_mfma_f32_16x16x32_bf16 v[68:71], a[140:143], a[212:215], v[68:71]
  ds_read_b64_tr_b16 a[190:191], v17 offset:25384
  buffer_load_dwordx4 v16, s[12:15], s36 offen offset:2048 lds
  v_cvt_pk_bf16_f32 v125, v74, v75
  v_cvt_pk_bf16_f32 v126, v76, v77
  v_cvt_pk_bf16_f32 v127, v78, v79
  v_mfma_f32_4x4x4_16b_bf16 v[72:75], v[100:101], a[168:169], 0
  v_mfma_f32_4x4x4_16b_bf16 v[76:79], v[102:103], a[170:171], 0
  v_cvt_pk_bf16_f32 v128, v80, v81
  v_cvt_pk_bf16_f32 v129, v82, v83
  s_waitcnt vmcnt(6)
  v_mfma_f32_16x16x32_bf16 v[24:27], v[112:115], a[192:195], v[24:27]
  ds_read_b64_tr_b16 a[144:145], v104 offset:0
  v_cvt_pk_bf16_f32 v130, v84, v85
  s_add_u32 m0, s34, 0
  s_add_u32 s36, s36, 12288
  v_mfma_f32_16x16x32_bf16 v[48:51], v[112:115], a[196:199], v[48:51]
  ds_read_b64_tr_b16 a[146:147], v104 offset:768
  buffer_load_dwordx4 v14, s[12:15], s36 offen offset:0 lds
  v_cvt_pk_bf16_f32 v131, v86, v87
  s_waitcnt lgkmcnt(12)
  v_mfma_f32_4x4x4_16b_bf16 v[80:83], v[100:101], a[172:173], 0
  v_mfma_f32_4x4x4_16b_bf16 v[84:87], v[102:103], a[174:175], 0
  v_cvt_pk_bf16_f32 v132, v88, v89
  v_cvt_pk_bf16_f32 v133, v90, v91
  v_mfma_f32_16x16x32_bf16 v[28:31], v[116:119], a[192:195], v[28:31]
  ds_read_b64_tr_b16 a[148:149], v104 offset:8
  ds_read_b128 v[96:99], v18 offset:512
  v_cvt_pk_bf16_f32 v134, v92, v93
  v_mfma_f32_16x16x32_bf16 v[52:55], v[116:119], a[196:199], v[52:55]
  ds_read_b64_tr_b16 a[150:151], v104 offset:776
  buffer_load_dwordx4 v15, s[12:15], s36 offen offset:1024 lds
  v_cvt_pk_bf16_f32 v135, v94, v95
  s_waitcnt lgkmcnt(12)
  v_mfma_f32_4x4x4_16b_bf16 v[88:91], v[100:101], a[176:177], 0
  v_mfma_f32_4x4x4_16b_bf16 v[92:95], v[102:103], a[178:179], 0
  v_cvt_pk_bf16_f32 v136, v72, v73
  v_cvt_pk_bf16_f32 v137, v74, v75
  v_mfma_f32_16x16x32_bf16 v[32:35], v[120:123], a[192:195], v[32:35]
  ds_read_b64_tr_b16 a[152:153], v104 offset:16
  ds_read_b128 a[208:211], v7 offset:512
  v_cvt_pk_bf16_f32 v138, v76, v77
  v_mfma_f32_16x16x32_bf16 v[56:59], v[120:123], a[196:199], v[56:59]
  ds_read_b64_tr_b16 a[154:155], v104 offset:784
  buffer_load_dwordx4 v16, s[12:15], s36 offen offset:2048 lds
  v_cvt_pk_bf16_f32 v139, v78, v79
  s_waitcnt lgkmcnt(12)
  v_mfma_f32_4x4x4_16b_bf16 v[72:75], v[100:101], a[180:181], 0
  v_mfma_f32_4x4x4_16b_bf16 v[76:79], v[102:103], a[182:183], 0
  v_cvt_pk_bf16_f32 v140, v80, v81
  v_cvt_pk_bf16_f32 v141, v82, v83
  v_mfma_f32_16x16x32_bf16 v[36:39], v[124:127], a[192:195], v[36:39]
  ds_read_b64_tr_b16 a[156:157], v104 offset:24
  ds_read_b128 a[212:215], v7 offset:12800
  v_cvt_pk_bf16_f32 v142, v84, v85
  s_add_u32 m0, s34, 3072
  s_add_u32 s36, s36, 12288
  v_mfma_f32_16x16x32_bf16 v[60:63], v[124:127], a[196:199], v[60:63]
  ds_read_b64_tr_b16 a[158:159], v104 offset:792
  buffer_load_dwordx4 v14, s[12:15], s36 offen offset:0 lds
  v_cvt_pk_bf16_f32 v143, v86, v87
  s_waitcnt lgkmcnt(13)
  v_mfma_f32_4x4x4_16b_bf16 v[80:83], v[100:101], a[184:185], 0
  v_mfma_f32_4x4x4_16b_bf16 v[84:87], v[102:103], a[186:187], 0
  v_cvt_pk_bf16_f32 v144, v88, v89
  v_cvt_pk_bf16_f32 v145, v90, v91
  v_mfma_f32_16x16x32_bf16 v[40:43], v[128:131], a[192:195], v[40:43]
  ds_read_b64_tr_b16 a[160:161], v104 offset:32
  v_cvt_pk_bf16_f32 v146, v92, v93
  v_mfma_f32_16x16x32_bf16 v[64:67], v[128:131], a[196:199], v[64:67]
  ds_read_b64_tr_b16 a[162:163], v104 offset:800
  buffer_load_dwordx4 v15, s[12:15], s36 offen offset:1024 lds
  v_cvt_pk_bf16_f32 v147, v94, v95
  s_waitcnt lgkmcnt(9)
  v_and_b32 v96, v19, v96
  v_and_b32 v97, v20, v97
  v_mfma_f32_4x4x4_16b_bf16 v[88:91], v[100:101], a[188:189], 0
  v_mfma_f32_4x4x4_16b_bf16 v[92:95], v[102:103], a[190:191], 0
  v_and_b32 v98, v19, v98
  v_and_b32 v99, v20, v99
  v_mfma_f32_16x16x32_bf16 v[44:47], v[132:135], a[192:195], v[44:47]
  ds_read_b64_tr_b16 a[164:165], v104 offset:40
  v_cvt_pk_bf16_f32 v148, v72, v73
  v_mfma_f32_16x16x32_bf16 v[68:71], v[132:135], a[196:199], v[68:71]
  ds_read_b64_tr_b16 a[166:167], v104 offset:808
  buffer_load_dwordx4 v16, s[12:15], s36 offen offset:2048 lds
  v_cvt_pk_bf16_f32 v149, v74, v75
  v_cvt_pk_bf16_f32 v150, v76, v77
  v_cvt_pk_bf16_f32 v151, v78, v79
  v_mfma_f32_4x4x4_16b_bf16 v[72:75], v[96:97], a[144:145], 0
  v_mfma_f32_4x4x4_16b_bf16 v[76:79], v[98:99], a[146:147], 0
  v_cvt_pk_bf16_f32 v152, v80, v81
  v_cvt_pk_bf16_f32 v153, v82, v83
  s_waitcnt vmcnt(6)
  v_mfma_f32_16x16x32_bf16 v[24:27], v[136:139], a[200:203], v[24:27]
  ds_read_b64_tr_b16 a[168:169], v104 offset:24576
  v_cvt_pk_bf16_f32 v154, v84, v85
  s_add_u32 m0, s34, 24576
  s_add_u32 s36, s36, 12288
  v_mfma_f32_16x16x32_bf16 v[48:51], v[136:139], a[204:207], v[48:51]
  ds_read_b64_tr_b16 a[170:171], v104 offset:25344
  buffer_load_dwordx4 v14, s[12:15], s36 offen offset:0 lds
  v_cvt_pk_bf16_f32 v155, v86, v87
  s_waitcnt lgkmcnt(12)
  v_mfma_f32_4x4x4_16b_bf16 v[80:83], v[96:97], a[148:149], 0
  v_mfma_f32_4x4x4_16b_bf16 v[84:87], v[98:99], a[150:151], 0
  v_cvt_pk_bf16_f32 v156, v88, v89
  v_cvt_pk_bf16_f32 v157, v90, v91
  v_mfma_f32_16x16x32_bf16 v[28:31], v[140:143], a[200:203], v[28:31]
  ds_read_b64_tr_b16 a[172:173], v104 offset:24584
  ds_read_b128 v[100:103], v18 offset:576
  v_cvt_pk_bf16_f32 v158, v92, v93
  v_mfma_f32_16x16x32_bf16 v[52:55], v[140:143], a[204:207], v[52:55]
  ds_read_b64_tr_b16 a[174:175], v104 offset:25352
  buffer_load_dwordx4 v15, s[12:15], s36 offen offset:1024 lds
  v_cvt_pk_bf16_f32 v159, v94, v95
  s_waitcnt lgkmcnt(12)
  v_mfma_f32_4x4x4_16b_bf16 v[88:91], v[96:97], a[152:153], 0
  v_mfma_f32_4x4x4_16b_bf16 v[92:95], v[98:99], a[154:155], 0
  v_cvt_pk_bf16_f32 v160, v72, v73
  v_cvt_pk_bf16_f32 v161, v74, v75
  v_mfma_f32_16x16x32_bf16 v[32:35], v[144:147], a[200:203], v[32:35]
  ds_read_b64_tr_b16 a[176:177], v104 offset:24592
  ds_read_b128 a[192:195], v8 offset:512
  v_cvt_pk_bf16_f32 v162, v76, v77
  v_mfma_f32_16x16x32_bf16 v[56:59], v[144:147], a[204:207], v[56:59]
  ds_read_b64_tr_b16 a[178:179], v104 offset:25360
  buffer_load_dwordx4 v16, s[12:15], s36 offen offset:2048 lds
  v_cvt_pk_bf16_f32 v163, v78, v79
  s_waitcnt lgkmcnt(12)
  v_mfma_f32_4x4x4_16b_bf16 v[72:75], v[96:97], a[156:157], 0
  v_mfma_f32_4x4x4_16b_bf16 v[76:79], v[98:99], a[158:159], 0
  v_cvt_pk_bf16_f32 v164, v80, v81
  v_cvt_pk_bf16_f32 v165, v82, v83
  v_mfma_f32_16x16x32_bf16 v[36:39], v[148:151], a[200:203], v[36:39]
  ds_read_b64_tr_b16 a[180:181], v104 offset:24600
  ds_read_b128 a[196:199], v8 offset:12800
  v_cvt_pk_bf16_f32 v166, v84, v85
  s_add_u32 m0, s34, 27648
  s_add_u32 s36, s36, 12288
  v_mfma_f32_16x16x32_bf16 v[60:63], v[148:151], a[204:207], v[60:63]
  ds_read_b64_tr_b16 a[182:183], v104 offset:25368
  buffer_load_dwordx4 v14, s[12:15], s36 offen offset:0 lds
  v_cvt_pk_bf16_f32 v167, v86, v87
  s_waitcnt lgkmcnt(13)
  v_mfma_f32_4x4x4_16b_bf16 v[80:83], v[96:97], a[160:161], 0
  v_mfma_f32_4x4x4_16b_bf16 v[84:87], v[98:99], a[162:163], 0
  v_cvt_pk_bf16_f32 v168, v88, v89
  v_cvt_pk_bf16_f32 v169, v90, v91
  v_mfma_f32_16x16x32_bf16 v[40:43], v[152:155], a[200:203], v[40:43]
  ds_read_b64_tr_b16 a[184:185], v104 offset:24608
  v_cvt_pk_bf16_f32 v170, v92, v93
  v_mfma_f32_16x16x32_bf16 v[64:67], v[152:155], a[204:207], v[64:67]
  ds_read_b64_tr_b16 a[186:187], v104 offset:25376
  buffer_load_dwordx4 v15, s[12:15], s36 offen offset:1024 lds
  v_cvt_pk_bf16_f32 v171, v94, v95
  s_waitcnt lgkmcnt(9)
  v_and_b32 v100, v19, v100
  v_and_b32 v101, v20, v101
  v_mfma_f32_4x4x4_16b_bf16 v[88:91], v[96:97], a[164:165], 0
  v_mfma_f32_4x4x4_16b_bf16 v[92:95], v[98:99], a[166:167], 0
  v_and_b32 v102, v19, v102
  v_and_b32 v103, v20, v103
  v_mfma_f32_16x16x32_bf16 v[44:47], v[156:159], a[200:203], v[44:47]
  ds_read_b64_tr_b16 a[188:189], v104 offset:24616
  v_cvt_pk_bf16_f32 v172, v72, v73
  v_mfma_f32_16x16x32_bf16 v[68:71], v[156:159], a[204:207], v[68:71]
  ds_read_b64_tr_b16 a[190:191], v104 offset:25384
  buffer_load_dwordx4 v16, s[12:15], s36 offen offset:2048 lds
  v_cvt_pk_bf16_f32 v173, v74, v75
  v_cvt_pk_bf16_f32 v174, v76, v77
  v_cvt_pk_bf16_f32 v175, v78, v79
  v_mfma_f32_4x4x4_16b_bf16 v[72:75], v[100:101], a[168:169], 0
  v_mfma_f32_4x4x4_16b_bf16 v[76:79], v[102:103], a[170:171], 0
  v_cvt_pk_bf16_f32 v176, v80, v81
  v_cvt_pk_bf16_f32 v177, v82, v83
  s_waitcnt vmcnt(6)
  v_mfma_f32_16x16x32_bf16 v[24:27], v[160:163], a[208:211], v[24:27]
  ds_read_b64_tr_b16 a[144:145], v17 offset:0
  v_cvt_pk_bf16_f32 v178, v84, v85
  s_add_u32 m0, s33, 122880
  v_mfma_f32_16x16x32_bf16 v[48:51], v[160:163], a[212:215], v[48:51]
  ds_read_b64_tr_b16 a[146:147], v17 offset:768
  buffer_load_dwordx4 v1, s[4:7], s21 offen nt lds
  v_cvt_pk_bf16_f32 v179, v86, v87
  s_waitcnt lgkmcnt(12)
  v_mfma_f32_4x4x4_16b_bf16 v[80:83], v[100:101], a[172:173], 0
  v_mfma_f32_4x4x4_16b_bf16 v[84:87], v[102:103], a[174:175], 0
  v_cvt_pk_bf16_f32 v180, v88, v89
  v_cvt_pk_bf16_f32 v181, v90, v91
  v_mfma_f32_16x16x32_bf16 v[28:31], v[164:167], a[208:211], v[28:31]
  ds_read_b64_tr_b16 a[148:149], v17 offset:8
  ds_read_b128 v[96:99], v18 offset:640
  v_cvt_pk_bf16_f32 v182, v92, v93
  s_add_u32 m0, s33, 126976
  v_mfma_f32_16x16x32_bf16 v[52:55], v[164:167], a[212:215], v[52:55]
  ds_read_b64_tr_b16 a[150:151], v17 offset:776
  buffer_load_dwordx4 v2, s[4:7], s21 offen nt lds
  v_cvt_pk_bf16_f32 v183, v94, v95
  s_waitcnt lgkmcnt(12)
  v_mfma_f32_4x4x4_16b_bf16 v[88:91], v[100:101], a[176:177], 0
  v_mfma_f32_4x4x4_16b_bf16 v[92:95], v[102:103], a[178:179], 0
  v_cvt_pk_bf16_f32 v184, v72, v73
  v_cvt_pk_bf16_f32 v185, v74, v75
  v_mfma_f32_16x16x32_bf16 v[32:35], v[168:171], a[208:211], v[32:35]
  ds_read_b64_tr_b16 a[152:153], v17 offset:16
  ds_read_b128 a[200:203], v9 offset:512
  v_cvt_pk_bf16_f32 v186, v76, v77
  s_add_u32 m0, s33, 131072
  v_mfma_f32_16x16x32_bf16 v[56:59], v[168:171], a[212:215], v[56:59]
  ds_read_b64_tr_b16 a[154:155], v17 offset:784
  buffer_load_dwordx4 v3, s[4:7], s21 offen nt lds
  v_cvt_pk_bf16_f32 v187, v78, v79
  s_waitcnt lgkmcnt(12)
  v_mfma_f32_4x4x4_16b_bf16 v[72:75], v[100:101], a[180:181], 0
  v_mfma_f32_4x4x4_16b_bf16 v[76:79], v[102:103], a[182:183], 0
  v_cvt_pk_bf16_f32 v188, v80, v81
  v_cvt_pk_bf16_f32 v189, v82, v83
  v_mfma_f32_16x16x32_bf16 v[36:39], v[172:175], a[208:211], v[36:39]
  ds_read_b64_tr_b16 a[156:157], v17 offset:24
  ds_read_b128 a[204:207], v9 offset:12800
  v_cvt_pk_bf16_f32 v190, v84, v85
  s_add_u32 m0, s33, 135168
  s_add_u32 s21, s21, 6291456
  v_mfma_f32_16x16x32_bf16 v[60:63], v[172:175], a[212:215], v[60:63]
  ds_read_b64_tr_b16 a[158:159], v17 offset:792
  buffer_load_dwordx4 v1, s[4:7], s37 offen nt lds
  v_cvt_pk_bf16_f32 v191, v86, v87
  s_waitcnt lgkmcnt(13)
  v_mfma_f32_4x4x4_16b_bf16 v[80:83], v[100:101], a[184:185], 0
  v_mfma_f32_4x4x4_16b_bf16 v[84:87], v[102:103], a[186:187], 0
  v_cvt_pk_bf16_f32 v192, v88, v89
  v_cvt_pk_bf16_f32 v193, v90, v91
  v_mfma_f32_16x16x32_bf16 v[40:43], v[176:179], a[208:211], v[40:43]
  ds_read_b64_tr_b16 a[160:161], v17 offset:32
  v_cvt_pk_bf16_f32 v194, v92, v93
  s_add_u32 m0, s33, 139264
  v_mfma_f32_16x16x32_bf16 v[64:67], v[176:179], a[212:215], v[64:67]
  ds_read_b64_tr_b16 a[162:163], v17 offset:800
  buffer_load_dwordx4 v2, s[4:7], s37 offen nt lds
  v_cvt_pk_bf16_f32 v195, v94, v95
  s_waitcnt lgkmcnt(9)
  v_and_b32 v96, v19, v96
  v_and_b32 v97, v20, v97
  v_mfma_f32_4x4x4_16b_bf16 v[88:91], v[100:101], a[188:189], 0
  v_mfma_f32_4x4x4_16b_bf16 v[92:95], v[102:103], a[190:191], 0
  v_and_b32 v98, v19, v98
  v_and_b32 v99, v20, v99
  v_mfma_f32_16x16x32_bf16 v[44:47], v[180:183], a[208:211], v[44:47]
  ds_read_b64_tr_b16 a[164:165], v17 offset:40
  v_cvt_pk_bf16_f32 v196, v72, v73
  s_add_u32 m0, s33, 143360
  v_mfma_f32_16x16x32_bf16 v[68:71], v[180:183], a[212:215], v[68:71]
  ds_read_b64_tr_b16 a[166:167], v17 offset:808
  buffer_load_dwordx4 v3, s[4:7], s37 offen nt lds
  s_add_u32 s37, s37, 6291456
  v_cvt_pk_bf16_f32 v197, v74, v75
  v_cvt_pk_bf16_f32 v198, v76, v77
  v_cvt_pk_bf16_f32 v199, v78, v79
  s_waitcnt lgkmcnt(0)
  s_barrier
  v_mfma_f32_4x4x4_16b_bf16 v[72:75], v[96:97], a[144:145], 0
  v_mfma_f32_4x4x4_16b_bf16 v[76:79], v[98:99], a[146:147], 0
  v_cvt_pk_bf16_f32 v200, v80, v81
  v_cvt_pk_bf16_f32 v201, v82, v83
  s_waitcnt vmcnt(6)
  v_mfma_f32_16x16x32_bf16 v[24:27], v[184:187], a[192:195], v[24:27]
  ds_read_b64_tr_b16 a[168:169], v17 offset:24576
  v_cvt_pk_bf16_f32 v202, v84, v85
  s_add_u32 m0, s33, 49152
  v_mfma_f32_16x16x32_bf16 v[48:51], v[184:187], a[196:199], v[48:51]
  ds_read_b64_tr_b16 a[170:171], v17 offset:25344
  buffer_load_dwordx4 v1, s[4:7], s21 offen nt lds
  v_cvt_pk_bf16_f32 v203, v86, v87
  v_mfma_f32_4x4x4_16b_bf16 v[80:83], v[96:97], a[148:149], 0
  v_mfma_f32_4x4x4_16b_bf16 v[84:87], v[98:99], a[150:151], 0
  v_cvt_pk_bf16_f32 v204, v88, v89
  v_cvt_pk_bf16_f32 v205, v90, v91
  v_mfma_f32_16x16x32_bf16 v[28:31], v[188:191], a[192:195], v[28:31]
  ds_read_b64_tr_b16 a[172:173], v17 offset:24584
  ds_read_b128 v[100:103], v18 offset:704
  v_cvt_pk_bf16_f32 v206, v92, v93
  s_add_u32 m0, s33, 53248
  v_mfma_f32_16x16x32_bf16 v[52:55], v[188:191], a[196:199], v[52:55]
  ds_read_b64_tr_b16 a[174:175], v17 offset:25352
  buffer_load_dwordx4 v2, s[4:7], s21 offen nt lds
  v_cvt_pk_bf16_f32 v207, v94, v95
  v_mfma_f32_4x4x4_16b_bf16 v[88:91], v[96:97], a[152:153], 0
  v_mfma_f32_4x4x4_16b_bf16 v[92:95], v[98:99], a[154:155], 0
  v_cvt_pk_bf16_f32 v208, v72, v73
  v_cvt_pk_bf16_f32 v209, v74, v75
  v_mfma_f32_16x16x32_bf16 v[32:35], v[192:195], a[192:195], v[32:35]
  ds_read_b64_tr_b16 a[176:177], v17 offset:24592
  ds_read_b128 a[208:211], v10 offset:512
  v_cvt_pk_bf16_f32 v210, v76, v77
  s_add_u32 m0, s33, 57344
  v_mfma_f32_16x16x32_bf16 v[56:59], v[192:195], a[196:199], v[56:59]
  ds_read_b64_tr_b16 a[178:179], v17 offset:25360
  buffer_load_dwordx4 v3, s[4:7], s21 offen nt lds
  v_cvt_pk_bf16_f32 v211, v78, v79
  v_mfma_f32_4x4x4_16b_bf16 v[72:75], v[96:97], a[156:157], 0
  v_mfma_f32_4x4x4_16b_bf16 v[76:79], v[98:99], a[158:159], 0
  v_cvt_pk_bf16_f32 v212, v80, v81
  v_cvt_pk_bf16_f32 v213, v82, v83
  v_mfma_f32_16x16x32_bf16 v[36:39], v[196:199], a[192:195], v[36:39]
  ds_read_b64_tr_b16 a[180:181], v17 offset:24600
  ds_read_b128 a[212:215], v10 offset:12800
  v_cvt_pk_bf16_f32 v214, v84, v85
  s_add_u32 m0, s33, 61440
  s_add_u32 s21, s21, 6291456
  v_mfma_f32_16x16x32_bf16 v[60:63], v[196:199], a[196:199], v[60:63]
  ds_read_b64_tr_b16 a[182:183], v17 offset:25368
  buffer_load_dwordx4 v1, s[4:7], s37 offen nt lds
  v_cvt_pk_bf16_f32 v215, v86, v87
  v_mfma_f32_4x4x4_16b_bf16 v[80:83], v[96:97], a[160:161], 0
  v_mfma_f32_4x4x4_16b_bf16 v[84:87], v[98:99], a[162:163], 0
  v_cvt_pk_bf16_f32 v216, v88, v89
  v_cvt_pk_bf16_f32 v217, v90, v91
  v_mfma_f32_16x16x32_bf16 v[40:43], v[200:203], a[192:195], v[40:43]
  ds_read_b64_tr_b16 a[184:185], v17 offset:24608
  v_cvt_pk_bf16_f32 v218, v92, v93
  s_add_u32 m0, s33, 65536
  v_mfma_f32_16x16x32_bf16 v[64:67], v[200:203], a[196:199], v[64:67]
  ds_read_b64_tr_b16 a[186:187], v17 offset:25376
  buffer_load_dwordx4 v2, s[4:7], s37 offen nt lds
  v_cvt_pk_bf16_f32 v219, v94, v95
  s_waitcnt lgkmcnt(9)
  v_and_b32 v100, v19, v100
  v_and_b32 v101, v20, v101
  v_mfma_f32_4x4x4_16b_bf16 v[88:91], v[96:97], a[164:165], 0
  v_mfma_f32_4x4x4_16b_bf16 v[92:95], v[98:99], a[166:167], 0
  v_and_b32 v102, v19, v102
  v_and_b32 v103, v20, v103
  v_mfma_f32_16x16x32_bf16 v[44:47], v[204:207], a[192:195], v[44:47]
  ds_read_b64_tr_b16 a[188:189], v17 offset:24616
  v_cvt_pk_bf16_f32 v220, v72, v73
  s_add_u32 m0, s33, 69632
  v_mfma_f32_16x16x32_bf16 v[68:71], v[204:207], a[196:199], v[68:71]
  ds_read_b64_tr_b16 a[190:191], v17 offset:25384
  buffer_load_dwordx4 v3, s[4:7], s37 offen nt lds
  s_add_u32 s37, s37, 6291456
  v_cvt_pk_bf16_f32 v221, v74, v75
  v_cvt_pk_bf16_f32 v222, v76, v77
  v_cvt_pk_bf16_f32 v223, v78, v79
  v_mfma_f32_4x4x4_16b_bf16 v[72:75], v[100:101], a[168:169], 0
  v_mfma_f32_4x4x4_16b_bf16 v[76:79], v[102:103], a[170:171], 0
  v_cvt_pk_bf16_f32 v224, v80, v81
  v_cvt_pk_bf16_f32 v225, v82, v83
  v_mfma_f32_16x16x32_bf16 v[24:27], v[208:211], a[200:203], v[24:27]
  v_cvt_pk_bf16_f32 v226, v84, v85
  v_mfma_f32_16x16x32_bf16 v[48:51], v[208:211], a[204:207], v[48:51]
  v_cvt_pk_bf16_f32 v227, v86, v87
  s_waitcnt lgkmcnt(10)
  v_mfma_f32_4x4x4_16b_bf16 v[80:83], v[100:101], a[172:173], 0
  v_mfma_f32_4x4x4_16b_bf16 v[84:87], v[102:103], a[174:175], 0
  v_cvt_pk_bf16_f32 v228, v88, v89
  v_cvt_pk_bf16_f32 v229, v90, v91
  v_mfma_f32_16x16x32_bf16 v[28:31], v[212:215], a[200:203], v[28:31]
  v_cvt_pk_bf16_f32 v230, v92, v93
  v_mfma_f32_16x16x32_bf16 v[52:55], v[212:215], a[204:207], v[52:55]
  v_cvt_pk_bf16_f32 v231, v94, v95
  s_waitcnt lgkmcnt(7)
  v_mfma_f32_4x4x4_16b_bf16 v[88:91], v[100:101], a[176:177], 0
  v_mfma_f32_4x4x4_16b_bf16 v[92:95], v[102:103], a[178:179], 0
  v_cvt_pk_bf16_f32 v232, v72, v73
  v_cvt_pk_bf16_f32 v233, v74, v75
  v_mfma_f32_16x16x32_bf16 v[32:35], v[216:219], a[200:203], v[32:35]
  v_cvt_pk_bf16_f32 v234, v76, v77
  v_mfma_f32_16x16x32_bf16 v[56:59], v[216:219], a[204:207], v[56:59]
  v_cvt_pk_bf16_f32 v235, v78, v79
  s_waitcnt lgkmcnt(4)
  v_mfma_f32_4x4x4_16b_bf16 v[72:75], v[100:101], a[180:181], 0
  v_mfma_f32_4x4x4_16b_bf16 v[76:79], v[102:103], a[182:183], 0
  v_cvt_pk_bf16_f32 v236, v80, v81
  v_cvt_pk_bf16_f32 v237, v82, v83
  v_mfma_f32_16x16x32_bf16 v[36:39], v[220:223], a[200:203], v[36:39]
  v_cvt_pk_bf16_f32 v238, v84, v85
  v_mfma_f32_16x16x32_bf16 v[60:63], v[220:223], a[204:207], v[60:63]
  v_cvt_pk_bf16_f32 v239, v86, v87
  s_waitcnt lgkmcnt(2)
  v_mfma_f32_4x4x4_16b_bf16 v[80:83], v[100:101], a[184:185], 0
  v_mfma_f32_4x4x4_16b_bf16 v[84:87], v[102:103], a[186:187], 0
  v_cvt_pk_bf16_f32 v240, v88, v89
  v_cvt_pk_bf16_f32 v241, v90, v91
  v_mfma_f32_16x16x32_bf16 v[40:43], v[224:227], a[200:203], v[40:43]
  v_cvt_pk_bf16_f32 v242, v92, v93
  v_mfma_f32_16x16x32_bf16 v[64:67], v[224:227], a[204:207], v[64:67]
  v_cvt_pk_bf16_f32 v243, v94, v95
  s_waitcnt lgkmcnt(0)
  v_mfma_f32_4x4x4_16b_bf16 v[88:91], v[100:101], a[188:189], 0
  v_mfma_f32_4x4x4_16b_bf16 v[92:95], v[102:103], a[190:191], 0
  v_cvt_pk_bf16_f32 v244, v72, v73
  v_cvt_pk_bf16_f32 v245, v74, v75
  v_mfma_f32_16x16x32_bf16 v[44:47], v[228:231], a[200:203], v[44:47]
  v_cvt_pk_bf16_f32 v246, v76, v77
  v_mfma_f32_16x16x32_bf16 v[68:71], v[228:231], a[204:207], v[68:71]
  v_cvt_pk_bf16_f32 v247, v78, v79
  v_mfma_f32_16x16x32_bf16 v[24:27], v[232:235], a[208:211], v[24:27]
  v_cvt_pk_bf16_f32 v248, v80, v81
  v_mfma_f32_16x16x32_bf16 v[48:51], v[232:235], a[212:215], v[48:51]
  v_cvt_pk_bf16_f32 v249, v82, v83
  v_cvt_pk_bf16_f32 v250, v84, v85
  v_cvt_pk_bf16_f32 v251, v86, v87
  v_mfma_f32_16x16x32_bf16 v[28:31], v[236:239], a[208:211], v[28:31]
  v_cvt_pk_bf16_f32 v252, v88, v89
  v_mfma_f32_16x16x32_bf16 v[52:55], v[236:239], a[212:215], v[52:55]
  v_cvt_pk_bf16_f32 v253, v90, v91
  v_cvt_pk_bf16_f32 v254, v92, v93
  v_cvt_pk_bf16_f32 v255, v94, v95
  v_mfma_f32_16x16x32_bf16 v[32:35], v[240:243], a[208:211], v[32:35]
  v_mfma_f32_16x16x32_bf16 v[56:59], v[240:243], a[212:215], v[56:59]
  v_mfma_f32_16x16x32_bf16 v[36:39], v[244:247], a[208:211], v[36:39]
  v_mfma_f32_16x16x32_bf16 v[60:63], v[244:247], a[212:215], v[60:63]
  v_mfma_f32_16x16x32_bf16 v[40:43], v[248:251], a[208:211], v[40:43]
  v_mfma_f32_16x16x32_bf16 v[64:67], v[248:251], a[212:215], v[64:67]
  v_mfma_f32_16x16x32_bf16 v[44:47], v[252:255], a[208:211], v[44:47]
  v_mfma_f32_16x16x32_bf16 v[68:71], v[252:255], a[212:215], v[68:71]
  s_mov_b64 vcc, -1
  s_nop 4
  v_cvt_pk_bf16_f32 v24, v24, v25
  v_cvt_pk_bf16_f32 v25, v26, v27
  v_cvt_pk_bf16_f32 v26, v28, v29
  v_cvt_pk_bf16_f32 v27, v30, v31
  ds_write_b128 v11, v[24:27] offset:0
  v_cvt_pk_bf16_f32 v28, v32, v33
  v_cvt_pk_bf16_f32 v29, v34, v35
  v_cvt_pk_bf16_f32 v30, v36, v37
  v_cvt_pk_bf16_f32 v31, v38, v39
  ds_write_b128 v12, v[28:31] offset:0
  v_cvt_pk_bf16_f32 v32, v40, v41
  v_cvt_pk_bf16_f32 v33, v42, v43
  v_cvt_pk_bf16_f32 v34, v44, v45
  v_cvt_pk_bf16_f32 v35, v46, v47
  ds_write_b128 v13, v[32:35] offset:0
  s_waitcnt vmcnt(6) lgkmcnt(0)
  s_barrier
  ds_read_b128 a[192:195], v7 offset:24576
  ds_read_b128 a[196:199], v8 offset:24576
  ds_read_b128 a[216:219], v1 offset:0
  ds_read_b128 a[220:223], v2 offset:0
  ds_read_b128 a[224:227], v3 offset:0
  ds_read_b128 a[200:203], v9 offset:24576
  ds_read_b128 a[204:207], v10 offset:24576
  ds_read_b128 a[228:231], v1 offset:12288
  ds_read_b128 a[232:235], v2 offset:12288
  ds_read_b128 a[236:239], v3 offset:12288
  s_add_u32 m0, s42, 24576
  s_nop 0
  buffer_load_dwordx4 v1, s[4:7], s21 offen nt lds
  s_add_u32 m0, s42, 28672
  s_nop 0
  s_nop 0
  buffer_load_dwordx4 v2, s[4:7], s21 offen nt lds
  s_add_u32 m0, s42, 32768
  s_nop 0
  s_nop 0
  buffer_load_dwordx4 v3, s[4:7], s21 offen nt lds
  s_waitcnt lgkmcnt(8)
.p2align 6
L_loop0:
  v_mfma_f32_16x16x32_bf16 v[24:27], a[0:3], a[192:195], 0
  ds_read_b128 a[208:211], v7 offset:24832
  v_mfma_f32_16x16x32_bf16 v[24:27], a[24:27], a[196:199], v[24:27]
  ds_read_b128 a[212:215], v8 offset:24832
  v_mfma_f32_16x16x32_bf16 v[28:31], a[4:7], a[192:195], 0
  v_mfma_f32_16x16x32_bf16 v[28:31], a[28:31], a[196:199], v[28:31]
  v_mfma_f32_16x16x32_bf16 v[32:35], a[8:11], a[192:195], 0
  v_mfma_f32_16x16x32_bf16 v[32:35], a[32:35], a[196:199], v[32:35]
  v_mfma_f32_16x16x32_bf16 v[36:39], a[12:15], a[192:195], 0
  v_mfma_f32_16x16x32_bf16 v[36:39], a[36:39], a[196:199], v[36:39]
  v_mfma_f32_16x16x32_bf16 v[40:43], a[16:19], a[192:195], 0
  v_mfma_f32_16x16x32_bf16 v[40:43], a[40:43], a[196:199], v[40:43]
  v_mfma_f32_16x16x32_bf16 v[44:47], a[20:23], a[192:195], 0
  v_mfma_f32_16x16x32_bf16 v[44:47], a[44:47], a[196:199], v[44:47]
  s_waitcnt lgkmcnt(5)
  v_mfma_f32_16x16x32_bf16 v[24:27], a[48:51], a[200:203], v[24:27]
  ds_read_b128 a[192:195], v9 offset:24832
  v_mfma_f32_16x16x32_bf16 v[24:27], a[72:75], a[204:207], v[24:27]
  ds_read_b128 a[196:199], v10 offset:24832
  v_mfma_f32_16x16x32_bf16 v[28:31], a[52:55], a[200:203], v[28:31]
  v_cvt_pk_bf16_f32 v48, v48, v49
  v_mfma_f32_16x16x32_bf16 v[28:31], a[76:79], a[204:207], v[28:31]
  v_cvt_pk_bf16_f32 v49, v50, v51
  v_mfma_f32_16x16x32_bf16 v[32:35], a[56:59], a[200:203], v[32:35]
  v_cvt_pk_bf16_f32 v50, v52, v53
  v_mfma_f32_16x16x32_bf16 v[32:35], a[80:83], a[204:207], v[32:35]
  v_cvt_pk_bf16_f32 v51, v54, v55
  v_mfma_f32_16x16x32_bf16 v[36:39], a[60:63], a[200:203], v[36:39]
  v_mfma_f32_16x16x32_bf16 v[36:39], a[84:87], a[204:207], v[36:39]
  v_mfma_f32_16x16x32_bf16 v[40:43], a[64:67], a[200:203], v[40:43]
  v_mfma_f32_16x16x32_bf16 v[40:43], a[88:91], a[204:207], v[40:43]
  v_mfma_f32_16x16x32_bf16 v[44:47], a[68:71], a[200:203], v[44:47]
  ds_write_b128 v11, v[48:51] offset:36864
  v_mfma_f32_16x16x32_bf16 v[44:47], a[92:95], a[204:207], v[44:47]
  s_waitcnt lgkmcnt(3)
  v_mfma_f32_16x16x32_bf16 v[24:27], a[96:99], a[208:211], v[24:27]
  ds_read_b128 a[200:203], v7 offset:25088
  v_mfma_f32_16x16x32_bf16 v[24:27], a[120:123], a[212:215], v[24:27]
  ds_read_b128 a[204:207], v8 offset:25088
  v_mfma_f32_16x16x32_bf16 v[28:31], a[100:103], a[208:211], v[28:31]
  v_cvt_pk_bf16_f32 v52, v56, v57
  v_mfma_f32_16x16x32_bf16 v[28:31], a[124:127], a[212:215], v[28:31]
  v_cvt_pk_bf16_f32 v53, v58, v59
  v_mfma_f32_16x16x32_bf16 v[32:35], a[104:107], a[208:211], v[32:35]
  v_cvt_pk_bf16_f32 v54, v60, v61
  v_mfma_f32_16x16x32_bf16 v[32:35], a[128:131], a[212:215], v[32:35]
  v_cvt_pk_bf16_f32 v55, v62, v63
  v_mfma_f32_16x16x32_bf16 v[36:39], a[108:111], a[208:211], v[36:39]
  ds_write_b128 v12, v[52:55] offset:36864
  v_mfma_f32_16x16x32_bf16 v[36:39], a[132:135], a[212:215], v[36:39]
  v_mfma_f32_16x16x32_bf16 v[40:43], a[112:115], a[208:211], v[40:43]
  buffer_store_dwordx4 a[216:219], v4, s[8:11], s22 offen sc1
  v_mfma_f32_16x16x32_bf16 v[40:43], a[136:139], a[212:215], v[40:43]
  buffer_store_dwordx4 a[220:223], v5, s[8:11], s22 offen sc1
  v_mfma_f32_16x16x32_bf16 v[44:47], a[116:119], a[208:211], v[44:47]
  v_mfma_f32_16x16x32_bf16 v[44:47], a[140:143], a[212:215], v[44:47]
  s_waitcnt lgkmcnt(4)
  v_mfma_f32_16x16x32_bf16 v[24:27], v[112:115], a[192:195], v[24:27]
  ds_read_b128 a[208:211], v9 offset:25088
  v_mfma_f32_16x16x32_bf16 v[24:27], v[136:139], a[196:199], v[24:27]
  ds_read_b128 a[212:215], v10 offset:25088
  v_mfma_f32_16x16x32_bf16 v[28:31], v[116:119], a[192:195], v[28:31]
  v_cvt_pk_bf16_f32 v56, v64, v65
  v_mfma_f32_16x16x32_bf16 v[28:31], v[140:143], a[196:199], v[28:31]
  v_cvt_pk_bf16_f32 v57, v66, v67
  v_mfma_f32_16x16x32_bf16 v[32:35], v[120:123], a[192:195], v[32:35]
  v_cvt_pk_bf16_f32 v58, v68, v69
  v_mfma_f32_16x16x32_bf16 v[32:35], v[144:147], a[196:199], v[32:35]
  v_cvt_pk_bf16_f32 v59, v70, v71
  v_mfma_f32_16x16x32_bf16 v[36:39], v[124:127], a[192:195], v[36:39]
  v_mfma_f32_16x16x32_bf16 v[36:39], v[148:151], a[196:199], v[36:39]
  v_mfma_f32_16x16x32_bf16 v[40:43], v[128:131], a[192:195], v[40:43]
  buffer_store_dwordx4 a[224:227], v6, s[8:11], s22 offen sc1
  v_mfma_f32_16x16x32_bf16 v[40:43], v[152:155], a[196:199], v[40:43]
  v_mfma_f32_16x16x32_bf16 v[44:47], v[132:135], a[192:195], v[44:47]
  ds_write_b128 v13, v[56:59] offset:36864
  v_mfma_f32_16x16x32_bf16 v[44:47], v[156:159], a[196:199], v[44:47]
  s_waitcnt lgkmcnt(4)
  v_mfma_f32_16x16x32_bf16 v[24:27], v[160:163], a[200:203], v[24:27]
  ds_read_b128 a[192:195], v7 offset:36864
  v_mfma_f32_16x16x32_bf16 v[24:27], v[184:187], a[204:207], v[24:27]
  ds_read_b128 a[196:199], v8 offset:36864
  v_mfma_f32_16x16x32_bf16 v[28:31], v[164:167], a[200:203], v[28:31]
  v_mfma_f32_16x16x32_bf16 v[28:31], v[188:191], a[204:207], v[28:31]
  s_add_u32 s62, s62, s44
  s_sub_u32 s61, s61, 1
  v_mfma_f32_16x16x32_bf16 v[32:35], v[168:171], a[200:203], v[32:35]
  s_cmp_eq_u32 s61, 0
  s_cselect_b32 s55, s66, s55
  s_cselect_b32 s65, 144, s65
  v_mfma_f32_16x16x32_bf16 v[32:35], v[192:195], a[204:207], v[32:35]
  v_mfma_f32_16x16x32_bf16 v[36:39], v[172:175], a[200:203], v[36:39]
  v_mfma_f32_16x16x32_bf16 v[36:39], v[196:199], a[204:207], v[36:39]
  v_mfma_f32_16x16x32_bf16 v[40:43], v[176:179], a[200:203], v[40:43]
  v_mfma_f32_16x16x32_bf16 v[40:43], v[200:203], a[204:207], v[40:43]
  v_mfma_f32_16x16x32_bf16 v[44:47], v[180:183], a[200:203], v[44:47]
  v_mfma_f32_16x16x32_bf16 v[44:47], v[204:207], a[204:207], v[44:47]
  s_waitcnt lgkmcnt(3)
  v_mfma_f32_16x16x32_bf16 v[24:27], v[208:211], a[208:211], v[24:27]
  ds_read_b128 a[200:203], v9 offset:36864
  v_mfma_f32_16x16x32_bf16 v[24:27], v[232:235], a[212:215], v[24:27]
  ds_read_b128 a[204:207], v10 offset:36864
  v_mfma_f32_16x16x32_bf16 v[28:31], v[212:215], a[208:211], v[28:31]
  v_mfma_f32_16x16x32_bf16 v[28:31], v[236:239], a[212:215], v[28:31]
  v_mfma_f32_16x16x32_bf16 v[32:35], v[216:219], a[208:211], v[32:35]
  v_mfma_f32_16x16x32_bf16 v[32:35], v[240:243], a[212:215], v[32:35]
  v_mfma_f32_16x16x32_bf16 v[36:39], v[220:223], a[208:211], v[36:39]
  v_mfma_f32_16x16x32_bf16 v[36:39], v[244:247], a[212:215], v[36:39]
  s_add_u32 m0, s42, 36864
  v_mfma_f32_16x16x32_bf16 v[40:43], v[224:227], a[208:211], v[40:43]
  s_cbranch_vccz L_sk1
  buffer_load_dwordx4 v1, s[4:7], s37 offen nt lds
  s_add_u32 m0, s42, 40960
  s_nop 0
  buffer_load_dwordx4 v2, s[4:7], s37 offen nt lds
  s_add_u32 m0, s42, 45056
  s_nop 0
  buffer_load_dwordx4 v3, s[4:7], s37 offen nt lds
L_sk1:
  v_mfma_f32_16x16x32_bf16 v[40:43], v[248:251], a[212:215], v[40:43]
  v_mfma_f32_16x16x32_bf16 v[44:47], v[228:231], a[208:211], v[44:47]
  s_cmp_eq_u32 s32, s68
  v_mfma_f32_16x16x32_bf16 v[44:47], v[252:255], a[212:215], v[44:47]
  s_waitcnt lgkmcnt(2)
  s_cbranch_scc1 L_half1
  v_mfma_f32_16x16x32_bf16 v[48:51], a[0:3], a[192:195], 0
  ds_read_b128 a[208:211], v7 offset:37120
  v_mfma_f32_16x16x32_bf16 v[48:51], a[24:27], a[196:199], v[48:51]
  ds_read_b128 a[212:215], v8 offset:37120
  v_mfma_f32_16x16x32_bf16 v[52:55], a[4:7], a[192:195], 0
  v_cvt_pk_bf16_f32 v24, v24, v25
  v_mfma_f32_16x16x32_bf16 v[52:55], a[28:31], a[196:199], v[52:55]
  v_cvt_pk_bf16_f32 v25, v26, v27
  v_mfma_f32_16x16x32_bf16 v[56:59], a[8:11], a[192:195], 0
  v_cvt_pk_bf16_f32 v26, v28, v29
  v_mfma_f32_16x16x32_bf16 v[56:59], a[32:35], a[196:199], v[56:59]
  v_cvt_pk_bf16_f32 v27, v30, v31
  v_mfma_f32_16x16x32_bf16 v[60:63], a[12:15], a[192:195], 0
  ds_write_b128 v11, v[24:27] offset:24576
  v_mfma_f32_16x16x32_bf16 v[60:63], a[36:39], a[196:199], v[60:63]
  v_mfma_f32_16x16x32_bf16 v[64:67], a[16:19], a[192:195], 0
  v_mfma_f32_16x16x32_bf16 v[64:67], a[40:43], a[196:199], v[64:67]
  v_mfma_f32_16x16x32_bf16 v[68:71], a[20:23], a[192:195], 0
  v_mfma_f32_16x16x32_bf16 v[68:71], a[44:47], a[196:199], v[68:71]
  s_waitcnt lgkmcnt(3)
  v_mfma_f32_16x16x32_bf16 v[48:51], a[48:51], a[200:203], v[48:51]
  ds_read_b128 a[192:195], v9 offset:37120
  v_mfma_f32_16x16x32_bf16 v[48:51], a[72:75], a[204:207], v[48:51]
  ds_read_b128 a[196:199], v10 offset:37120
  v_mfma_f32_16x16x32_bf16 v[52:55], a[52:55], a[200:203], v[52:55]
  v_cvt_pk_bf16_f32 v28, v32, v33
  v_mfma_f32_16x16x32_bf16 v[52:55], a[76:79], a[204:207], v[52:55]
  v_cvt_pk_bf16_f32 v29, v34, v35
  v_mfma_f32_16x16x32_bf16 v[56:59], a[56:59], a[200:203], v[56:59]
  v_cvt_pk_bf16_f32 v30, v36, v37
  v_mfma_f32_16x16x32_bf16 v[56:59], a[80:83], a[204:207], v[56:59]
  v_cvt_pk_bf16_f32 v31, v38, v39
  v_mfma_f32_16x16x32_bf16 v[60:63], a[60:63], a[200:203], v[60:63]
  v_mfma_f32_16x16x32_bf16 v[60:63], a[84:87], a[204:207], v[60:63]
  v_mfma_f32_16x16x32_bf16 v[64:67], a[64:67], a[200:203], v[64:67]
  v_mfma_f32_16x16x32_bf16 v[64:67], a[88:91], a[204:207], v[64:67]
  v_mfma_f32_16x16x32_bf16 v[68:71], a[68:71], a[200:203], v[68:71]
  ds_write_b128 v12, v[28:31] offset:24576
  v_mfma_f32_16x16x32_bf16 v[68:71], a[92:95], a[204:207], v[68:71]
  s_waitcnt lgkmcnt(4)
  v_mfma_f32_16x16x32_bf16 v[48:51], a[96:99], a[208:211], v[48:51]
  ds_read_b128 a[200:203], v7 offset:37376
  v_mfma_f32_16x16x32_bf16 v[48:51], a[120:123], a[212:215], v[48:51]
  ds_read_b128 a[204:207], v8 offset:37376
  v_mfma_f32_16x16x32_bf16 v[52:55], a[100:103], a[208:211], v[52:55]
  v_cvt_pk_bf16_f32 v32, v40, v41
  v_mfma_f32_16x16x32_bf16 v[52:55], a[124:127], a[212:215], v[52:55]
  v_cvt_pk_bf16_f32 v33, v42, v43
  v_mfma_f32_16x16x32_bf16 v[56:59], a[104:107], a[208:211], v[56:59]
  v_cvt_pk_bf16_f32 v34, v44, v45
  v_mfma_f32_16x16x32_bf16 v[56:59], a[128:131], a[212:215], v[56:59]
  v_cvt_pk_bf16_f32 v35, v46, v47
  v_mfma_f32_16x16x32_bf16 v[60:63], a[108:111], a[208:211], v[60:63]
  ds_write_b128 v13, v[32:35] offset:24576
  v_mfma_f32_16x16x32_bf16 v[60:63], a[132:135], a[212:215], v[60:63]
  v_mfma_f32_16x16x32_bf16 v[64:67], a[112:115], a[208:211], v[64:67]
  buffer_store_dwordx4 a[228:231], v4, s[8:11], s23 offen sc1
  v_mfma_f32_16x16x32_bf16 v[64:67], a[136:139], a[212:215], v[64:67]
  buffer_store_dwordx4 a[232:235], v5, s[8:11], s23 offen sc1
  v_mfma_f32_16x16x32_bf16 v[68:71], a[116:119], a[208:211], v[68:71]
  v_mfma_f32_16x16x32_bf16 v[68:71], a[140:143], a[212:215], v[68:71]
  s_waitcnt lgkmcnt(0)
  v_mfma_f32_16x16x32_bf16 v[48:51], v[112:115], a[192:195], v[48:51]
  ds_read_b128 a[208:211], v9 offset:37376
  s_add_u32 s69, s54, 112
  s_lshr_b32 s56, s69, 1
  v_mfma_f32_16x16x32_bf16 v[48:51], v[136:139], a[196:199], v[48:51]
  ds_read_b128 a[212:215], v10 offset:37376
  s_bitcmp1_b32 s69, 0
  s_cselect_b32 s69, 12289, 1
  v_mfma_f32_16x16x32_bf16 v[52:55], v[116:119], a[192:195], v[52:55]
  s_cmp_lt_u32 s54, 112
  s_cselect_b32 s56, s54, s56
  s_cselect_b32 s69, 0, s69
  v_mfma_f32_16x16x32_bf16 v[52:55], v[140:143], a[196:199], v[52:55]
  v_xor_b32 v7, 0x14000, v7
  s_mul_i32 s56, s56, 98304
  s_add_u32 s69, s69, s57
  v_mfma_f32_16x16x32_bf16 v[56:59], v[120:123], a[192:195], v[56:59]
  v_xor_b32 v8, 0x14000, v8
  s_add_u32 s56, s56, s69
  s_cmp_lt_u32 s54, 144
  s_cselect_b32 s56, s56, s6
  v_mfma_f32_16x16x32_bf16 v[56:59], v[144:147], a[196:199], v[56:59]
  v_xor_b32 v9, 0x14000, v9
  s_cmp_ge_i32 s61, 0
  s_cselect_b32 s56, s62, s56
  v_mfma_f32_16x16x32_bf16 v[60:63], v[124:127], a[192:195], v[60:63]
  v_xor_b32 v10, 0x14000, v10
  v_mov_b32 v23, s56
  v_mfma_f32_16x16x32_bf16 v[60:63], v[148:151], a[196:199], v[60:63]
  ds_write_b32 v106, v23 offset:4
  v_mfma_f32_16x16x32_bf16 v[64:67], v[128:131], a[192:195], v[64:67]
  buffer_store_dwordx4 a[236:239], v6, s[8:11], s23 offen sc1
  v_mfma_f32_16x16x32_bf16 v[64:67], v[152:155], a[196:199], v[64:67]
  s_add_u32 s23, s22, 12288
  s_mov_b32 s22, s58
  v_mfma_f32_16x16x32_bf16 v[68:71], v[132:135], a[192:195], v[68:71]
  s_mov_b32 s58, s59
  v_mfma_f32_16x16x32_bf16 v[68:71], v[156:159], a[196:199], v[68:71]
  s_waitcnt vmcnt(12) lgkmcnt(0)
  s_cbranch_vccz L_ow2
L_ob2:
  s_barrier
  s_cmp_eq_u32 s32, 1
  s_cbranch_scc1 L_tail1
  v_mfma_f32_16x16x32_bf16 v[48:51], v[160:163], a[200:203], v[48:51]
  ds_read_b128 a[192:195], v7 offset:0
  v_mfma_f32_16x16x32_bf16 v[48:51], v[184:187], a[204:207], v[48:51]
  ds_read_b128 a[196:199], v8 offset:0
  v_mfma_f32_16x16x32_bf16 v[52:55], v[164:167], a[200:203], v[52:55]
  ds_read_b128 a[216:219], v1 offset:24576
  v_mfma_f32_16x16x32_bf16 v[52:55], v[188:191], a[204:207], v[52:55]
  ds_read_b32 v107, v105 offset:4
  v_mfma_f32_16x16x32_bf16 v[56:59], v[168:171], a[200:203], v[56:59]
  ds_read_b128 a[220:223], v2 offset:24576
  v_mfma_f32_16x16x32_bf16 v[56:59], v[192:195], a[204:207], v[56:59]
  ds_read_b128 a[224:227], v3 offset:24576
  v_mfma_f32_16x16x32_bf16 v[60:63], v[172:175], a[200:203], v[60:63]
  s_mov_b32 s59, s21
  v_mfma_f32_16x16x32_bf16 v[60:63], v[196:199], a[204:207], v[60:63]
  s_cmp_lt_u32 s54, s55
  s_cselect_b32 s54, 1, s65
  s_cbranch_scc0 L_cl3
  s_atomic_add s54, s[52:53], 0 glc
L_cl3:
  v_mfma_f32_16x16x32_bf16 v[64:67], v[176:179], a[200:203], v[64:67]
  v_mfma_f32_16x16x32_bf16 v[64:67], v[200:203], a[204:207], v[64:67]
  s_waitcnt lgkmcnt(2)
  v_readfirstlane_b32 s21, v107
  v_mfma_f32_16x16x32_bf16 v[68:71], v[180:183], a[200:203], v[68:71]
  v_mfma_f32_16x16x32_bf16 v[68:71], v[204:207], a[204:207], v[68:71]
  s_cmp_lt_u32 s21, s6
  s_cselect_b32 s32, 4, s32
  s_cselect_b64 vcc, -1, 0
  v_mfma_f32_16x16x32_bf16 v[48:51], v[208:211], a[208:211], v[48:51]
  ds_read_b128 a[200:203], v9 offset:0
  s_add_u32 s37, s21, 12288
  s_bitcmp1_b32 s21, 0
  v_mfma_f32_16x16x32_bf16 v[48:51], v[232:235], a[212:215], v[48:51]
  ds_read_b128 a[204:207], v10 offset:0
  s_cselect_b32 s37, s6, s37
  s_cselect_b32 s68, 1, s68
  s_andn2_b32 s21, s21, 1
  v_mfma_f32_16x16x32_bf16 v[52:55], v[212:215], a[208:211], v[52:55]
  ds_read_b128 a[228:231], v1 offset:36864
  v_mfma_f32_16x16x32_bf16 v[52:55], v[236:239], a[212:215], v[52:55]
  ds_read_b128 a[232:235], v2 offset:36864
  v_mfma_f32_16x16x32_bf16 v[56:59], v[216:219], a[208:211], v[56:59]
  ds_read_b128 a[236:239], v3 offset:36864
  v_mfma_f32_16x16x32_bf16 v[56:59], v[240:243], a[212:215], v[56:59]
  s_sub_u32 s32, s32, 1
  v_mfma_f32_16x16x32_bf16 v[60:63], v[220:223], a[208:211], v[60:63]
  s_xor_b32 s42, s42, 0x14000
  v_mfma_f32_16x16x32_bf16 v[60:63], v[244:247], a[212:215], v[60:63]
  s_add_u32 m0, s42, 0
  v_mfma_f32_16x16x32_bf16 v[64:67], v[224:227], a[208:211], v[64:67]
  s_cbranch_vccz L_sk4
  buffer_load_dwordx4 v1, s[4:7], s21 offen nt lds
  s_add_u32 m0, s42, 4096
  s_nop 0
  buffer_load_dwordx4 v2, s[4:7], s21 offen nt lds
  s_add_u32 m0, s42, 8192
  s_nop 0
  buffer_load_dwordx4 v3, s[4:7], s21 offen nt lds
L_sk4:
  v_mfma_f32_16x16x32_bf16 v[64:67], v[248:251], a[212:215], v[64:67]
  v_mfma_f32_16x16x32_bf16 v[68:71], v[228:231], a[208:211], v[68:71]
  v_mfma_f32_16x16x32_bf16 v[68:71], v[252:255], a[212:215], v[68:71]
L_mid0:
  v_mfma_f32_16x16x32_bf16 v[24:27], a[0:3], a[192:195], 0
  ds_read_b128 a[208:211], v7 offset:256
  v_mfma_f32_16x16x32_bf16 v[24:27], a[24:27], a[196:199], v[24:27]
  ds_read_b128 a[212:215], v8 offset:256
  v_mfma_f32_16x16x32_bf16 v[28:31], a[4:7], a[192:195], 0
  v_mfma_f32_16x16x32_bf16 v[28:31], a[28:31], a[196:199], v[28:31]
  v_mfma_f32_16x16x32_bf16 v[32:35], a[8:11], a[192:195], 0
  v_mfma_f32_16x16x32_bf16 v[32:35], a[32:35], a[196:199], v[32:35]
  v_mfma_f32_16x16x32_bf16 v[36:39], a[12:15], a[192:195], 0
  v_mfma_f32_16x16x32_bf16 v[36:39], a[36:39], a[196:199], v[36:39]
  v_mfma_f32_16x16x32_bf16 v[40:43], a[16:19], a[192:195], 0
  v_mfma_f32_16x16x32_bf16 v[40:43], a[40:43], a[196:199], v[40:43]
  v_mfma_f32_16x16x32_bf16 v[44:47], a[20:23], a[192:195], 0
  v_mfma_f32_16x16x32_bf16 v[44:47], a[44:47], a[196:199], v[44:47]
  s_waitcnt lgkmcnt(5)
  v_mfma_f32_16x16x32_bf16 v[24:27], a[48:51], a[200:203], v[24:27]
  ds_read_b128 a[192:195], v9 offset:256
  v_mfma_f32_16x16x32_bf16 v[24:27], a[72:75], a[204:207], v[24:27]
  ds_read_b128 a[196:199], v10 offset:256
  v_mfma_f32_16x16x32_bf16 v[28:31], a[52:55], a[200:203], v[28:31]
  v_cvt_pk_bf16_f32 v48, v48, v49
  v_mfma_f32_16x16x32_bf16 v[28:31], a[76:79], a[204:207], v[28:31]
  v_cvt_pk_bf16_f32 v49, v50, v51
  v_mfma_f32_16x16x32_bf16 v[32:35], a[56:59], a[200:203], v[32:35]
  v_cvt_pk_bf16_f32 v50, v52, v53
  v_mfma_f32_16x16x32_bf16 v[32:35], a[80:83], a[204:207], v[32:35]
  v_cvt_pk_bf16_f32 v51, v54, v55
  v_mfma_f32_16x16x32_bf16 v[36:39], a[60:63], a[200:203], v[36:39]
  v_mfma_f32_16x16x32_bf16 v[36:39], a[84:87], a[204:207], v[36:39]
  v_mfma_f32_16x16x32_bf16 v[40:43], a[64:67], a[200:203], v[40:43]
  v_mfma_f32_16x16x32_bf16 v[40:43], a[88:91], a[204:207], v[40:43]
  v_mfma_f32_16x16x32_bf16 v[44:47], a[68:71], a[200:203], v[44:47]
  ds_write_b128 v11, v[48:51] offset:12288
  v_mfma_f32_16x16x32_bf16 v[44:47], a[92:95], a[204:207], v[44:47]
  s_waitcnt lgkmcnt(3)
  v_mfma_f32_16x16x32_bf16 v[24:27], a[96:99], a[208:211], v[24:27]
  ds_read_b128 a[200:203], v7 offset:512
  v_mfma_f32_16x16x32_bf16 v[24:27], a[120:123], a[212:215], v[24:27]
  ds_read_b128 a[204:207], v8 offset:512
  v_mfma_f32_16x16x32_bf16 v[28:31], a[100:103], a[208:211], v[28:31]
  v_cvt_pk_bf16_f32 v52, v56, v57
  v_mfma_f32_16x16x32_bf16 v[28:31], a[124:127], a[212:215], v[28:31]
  v_cvt_pk_bf16_f32 v53, v58, v59
  v_mfma_f32_16x16x32_bf16 v[32:35], a[104:107], a[208:211], v[32:35]
  v_cvt_pk_bf16_f32 v54, v60, v61
  v_mfma_f32_16x16x32_bf16 v[32:35], a[128:131], a[212:215], v[32:35]
  v_cvt_pk_bf16_f32 v55, v62, v63
  v_mfma_f32_16x16x32_bf16 v[36:39], a[108:111], a[208:211], v[36:39]
  ds_write_b128 v12, v[52:55] offset:12288
  v_mfma_f32_16x16x32_bf16 v[36:39], a[132:135], a[212:215], v[36:39]
  v_mfma_f32_16x16x32_bf16 v[40:43], a[112:115], a[208:211], v[40:43]
  buffer_store_dwordx4 a[216:219], v4, s[8:11], s22 offen sc1
  v_mfma_f32_16x16x32_bf16 v[40:43], a[136:139], a[212:215], v[40:43]
  buffer_store_dwordx4 a[220:223], v5, s[8:11], s22 offen sc1
  v_mfma_f32_16x16x32_bf16 v[44:47], a[116:119], a[208:211], v[44:47]
  v_mfma_f32_16x16x32_bf16 v[44:47], a[140:143], a[212:215], v[44:47]
  s_waitcnt lgkmcnt(4)
  v_mfma_f32_16x16x32_bf16 v[24:27], v[112:115], a[192:195], v[24:27]
  ds_read_b128 a[208:211], v9 offset:512
  v_mfma_f32_16x16x32_bf16 v[24:27], v[136:139], a[196:199], v[24:27]
  ds_read_b128 a[212:215], v10 offset:512
  v_mfma_f32_16x16x32_bf16 v[28:31], v[116:119], a[192:195], v[28:31]
  v_cvt_pk_bf16_f32 v56, v64, v65
  v_mfma_f32_16x16x32_bf16 v[28:31], v[140:143], a[196:199], v[28:31]
  v_cvt_pk_bf16_f32 v57, v66, v67
  v_mfma_f32_16x16x32_bf16 v[32:35], v[120:123], a[192:195], v[32:35]
  v_cvt_pk_bf16_f32 v58, v68, v69
  v_mfma_f32_16x16x32_bf16 v[32:35], v[144:147], a[196:199], v[32:35]
  v_cvt_pk_bf16_f32 v59, v70, v71
  v_mfma_f32_16x16x32_bf16 v[36:39], v[124:127], a[192:195], v[36:39]
  v_mfma_f32_16x16x32_bf16 v[36:39], v[148:151], a[196:199], v[36:39]
  v_mfma_f32_16x16x32_bf16 v[40:43], v[128:131], a[192:195], v[40:43]
  buffer_store_dwordx4 a[224:227], v6, s[8:11], s22 offen sc1
  v_mfma_f32_16x16x32_bf16 v[40:43], v[152:155], a[196:199], v[40:43]
  v_mfma_f32_16x16x32_bf16 v[44:47], v[132:135], a[192:195], v[44:47]
  ds_write_b128 v13, v[56:59] offset:12288
  v_mfma_f32_16x16x32_bf16 v[44:47], v[156:159], a[196:199], v[44:47]
  s_waitcnt lgkmcnt(4)
  v_mfma_f32_16x16x32_bf16 v[24:27], v[160:163], a[200:203], v[24:27]
  ds_read_b128 a[192:195], v7 offset:12288
  v_mfma_f32_16x16x32_bf16 v[24:27], v[184:187], a[204:207], v[24:27]
  ds_read_b128 a[196:199], v8 offset:12288
  v_mfma_f32_16x16x32_bf16 v[28:31], v[164:167], a[200:203], v[28:31]
  v_mfma_f32_16x16x32_bf16 v[28:31], v[188:191], a[204:207], v[28:31]
  s_add_u32 s62, s62, s44
  s_sub_u32 s61, s61, 1
  v_mfma_f32_16x16x32_bf16 v[32:35], v[168:171], a[200:203], v[32:35]
  s_cmp_eq_u32 s61, 0
  s_cselect_b32 s55, s66, s55
  s_cselect_b32 s65, 144, s65
  v_mfma_f32_16x16x32_bf16 v[32:35], v[192:195], a[204:207], v[32:35]
  v_mfma_f32_16x16x32_bf16 v[36:39], v[172:175], a[200:203], v[36:39]
  v_mfma_f32_16x16x32_bf16 v[36:39], v[196:199], a[204:207], v[36:39]
  v_mfma_f32_16x16x32_bf16 v[40:43], v[176:179], a[200:203], v[40:43]
  v_mfma_f32_16x16x32_bf16 v[40:43], v[200:203], a[204:207], v[40:43]
  v_mfma_f32_16x16x32_bf16 v[44:47], v[180:183], a[200:203], v[44:47]
  v_mfma_f32_16x16x32_bf16 v[44:47], v[204:207], a[204:207], v[44:47]
  s_waitcnt lgkmcnt(3)
  v_mfma_f32_16x16x32_bf16 v[24:27], v[208:211], a[208:211], v[24:27]
  ds_read_b128 a[200:203], v9 offset:12288
  v_mfma_f32_16x16x32_bf16 v[24:27], v[232:235], a[212:215], v[24:27]
  ds_read_b128 a[204:207], v10 offset:12288
  v_mfma_f32_16x16x32_bf16 v[28:31], v[212:215], a[208:211], v[28:31]
  v_mfma_f32_16x16x32_bf16 v[28:31], v[236:239], a[212:215], v[28:31]
  v_mfma_f32_16x16x32_bf16 v[32:35], v[216:219], a[208:211], v[32:35]
  v_mfma_f32_16x16x32_bf16 v[32:35], v[240:243], a[212:215], v[32:35]
  v_mfma_f32_16x16x32_bf16 v[36:39], v[220:223], a[208:211], v[36:39]
  v_mfma_f32_16x16x32_bf16 v[36:39], v[244:247], a[212:215], v[36:39]
  s_add_u32 m0, s42, 12288
  v_mfma_f32_16x16x32_bf16 v[40:43], v[224:227], a[208:211], v[40:43]
  s_cbranch_vccz L_sk5
  buffer_load_dwordx4 v1, s[4:7], s37 offen nt lds
  s_add_u32 m0, s42, 16384
  s_nop 0
  buffer_load_dwordx4 v2, s[4:7], s37 offen nt lds
  s_add_u32 m0, s42, 20480
  s_nop 0
  buffer_load_dwordx4 v3, s[4:7], s37 offen nt lds
L_sk5:
  v_mfma_f32_16x16x32_bf16 v[40:43], v[248:251], a[212:215], v[40:43]
  v_mfma_f32_16x16x32_bf16 v[44:47], v[228:231], a[208:211], v[44:47]
  s_cmp_eq_u32 s32, s68
  v_mfma_f32_16x16x32_bf16 v[44:47], v[252:255], a[212:215], v[44:47]
  s_waitcnt lgkmcnt(2)
  s_cbranch_scc1 L_half0
  v_mfma_f32_16x16x32_bf16 v[48:51], a[0:3], a[192:195], 0
  ds_read_b128 a[208:211], v7 offset:12544
  v_mfma_f32_16x16x32_bf16 v[48:51], a[24:27], a[196:199], v[48:51]
  ds_read_b128 a[212:215], v8 offset:12544
  v_mfma_f32_16x16x32_bf16 v[52:55], a[4:7], a[192:195], 0
  v_cvt_pk_bf16_f32 v24, v24, v25
  v_mfma_f32_16x16x32_bf16 v[52:55], a[28:31], a[196:199], v[52:55]
  v_cvt_pk_bf16_f32 v25, v26, v27
  v_mfma_f32_16x16x32_bf16 v[56:59], a[8:11], a[192:195], 0
  v_cvt_pk_bf16_f32 v26, v28, v29
  v_mfma_f32_16x16x32_bf16 v[56:59], a[32:35], a[196:199], v[56:59]
  v_cvt_pk_bf16_f32 v27, v30, v31
  v_mfma_f32_16x16x32_bf16 v[60:63], a[12:15], a[192:195], 0
  ds_write_b128 v11, v[24:27] offset:0
  v_mfma_f32_16x16x32_bf16 v[60:63], a[36:39], a[196:199], v[60:63]
  v_mfma_f32_16x16x32_bf16 v[64:67], a[16:19], a[192:195], 0
  v_mfma_f32_16x16x32_bf16 v[64:67], a[40:43], a[196:199], v[64:67]
  v_mfma_f32_16x16x32_bf16 v[68:71], a[20:23], a[192:195], 0
  v_mfma_f32_16x16x32_bf16 v[68:71], a[44:47], a[196:199], v[68:71]
  s_waitcnt lgkmcnt(3)
  v_mfma_f32_16x16x32_bf16 v[48:51], a[48:51], a[200:203], v[48:51]
  ds_read_b128 a[192:195], v9 offset:12544
  v_mfma_f32_16x16x32_bf16 v[48:51], a[72:75], a[204:207], v[48:51]
  ds_read_b128 a[196:199], v10 offset:12544
  v_mfma_f32_16x16x32_bf16 v[52:55], a[52:55], a[200:203], v[52:55]
  v_cvt_pk_bf16_f32 v28, v32, v33
  v_mfma_f32_16x16x32_bf16 v[52:55], a[76:79], a[204:207], v[52:55]
  v_cvt_pk_bf16_f32 v29, v34, v35
  v_mfma_f32_16x16x32_bf16 v[56:59], a[56:59], a[200:203], v[56:59]
  v_cvt_pk_bf16_f32 v30, v36, v37
  v_mfma_f32_16x16x32_bf16 v[56:59], a[80:83], a[204:207], v[56:59]
  v_cvt_pk_bf16_f32 v31, v38, v39
  v_mfma_f32_16x16x32_bf16 v[60:63], a[60:63], a[200:203], v[60:63]
  v_mfma_f32_16x16x32_bf16 v[60:63], a[84:87], a[204:207], v[60:63]
  v_mfma_f32_16x16x32_bf16 v[64:67], a[64:67], a[200:203], v[64:67]
  v_mfma_f32_16x16x32_bf16 v[64:67], a[88:91], a[204:207], v[64:67]
  v_mfma_f32_16x16x32_bf16 v[68:71], a[68:71], a[200:203], v[68:71]
  ds_write_b128 v12, v[28:31] offset:0
  v_mfma_f32_16x16x32_bf16 v[68:71], a[92:95], a[204:207], v[68:71]
  s_waitcnt lgkmcnt(4)
  v_mfma_f32_16x16x32_bf16 v[48:51], a[96:99], a[208:211], v[48:51]
  ds_read_b128 a[200:203], v7 offset:12800
  v_mfma_f32_16x16x32_bf16 v[48:51], a[120:123], a[212:215], v[48:51]
  ds_read_b128 a[204:207], v8 offset:12800
  v_mfma_f32_16x16x32_bf16 v[52:55], a[100:103], a[208:211], v[52:55]
  v_cvt_pk_bf16_f32 v32, v40, v41
  v_mfma_f32_16x16x32_bf16 v[52:55], a[124:127], a[212:215], v[52:55]
  v_cvt_pk_bf16_f32 v33, v42, v43
  v_mfma_f32_16x16x32_bf16 v[56:59], a[104:107], a[208:211], v[56:59]
  v_cvt_pk_bf16_f32 v34, v44, v45
  v_mfma_f32_16x16x32_bf16 v[56:59], a[128:131], a[212:215], v[56:59]
  v_cvt_pk_bf16_f32 v35, v46, v47
  v_mfma_f32_16x16x32_bf16 v[60:63], a[108:111], a[208:211], v[60:63]
  ds_write_b128 v13, v[32:35] offset:0
  v_mfma_f32_16x16x32_bf16 v[60:63], a[132:135], a[212:215], v[60:63]
  v_mfma_f32_16x16x32_bf16 v[64:67], a[112:115], a[208:211], v[64:67]
  buffer_store_dwordx4 a[228:231], v4, s[8:11], s23 offen sc1
  v_mfma_f32_16x16x32_bf16 v[64:67], a[136:139], a[212:215], v[64:67]
  buffer_store_dwordx4 a[232:235], v5, s[8:11], s23 offen sc1
  v_mfma_f32_16x16x32_bf16 v[68:71], a[116:119], a[208:211], v[68:71]
  v_mfma_f32_16x16x32_bf16 v[68:71], a[140:143], a[212:215], v[68:71]
  s_waitcnt lgkmcnt(0)
  v_mfma_f32_16x16x32_bf16 v[48:51], v[112:115], a[192:195], v[48:51]
  ds_read_b128 a[208:211], v9 offset:12800
  s_add_u32 s69, s54, 112
  s_lshr_b32 s56, s69, 1
  v_mfma_f32_16x16x32_bf16 v[48:51], v[136:139], a[196:199], v[48:51]
  ds_read_b128 a[212:215], v10 offset:12800
  s_bitcmp1_b32 s69, 0
  s_cselect_b32 s69, 12289, 1
  v_mfma_f32_16x16x32_bf16 v[52:55], v[116:119], a[192:195], v[52:55]
  s_cmp_lt_u32 s54, 112
  s_cselect_b32 s56, s54, s56
  s_cselect_b32 s69, 0, s69
  v_mfma_f32_16x16x32_bf16 v[52:55], v[140:143], a[196:199], v[52:55]
  s_mul_i32 s56, s56, 98304
  s_add_u32 s69, s69, s57
  v_mfma_f32_16x16x32_bf16 v[56:59], v[120:123], a[192:195], v[56:59]
  s_add_u32 s56, s56, s69
  s_cmp_lt_u32 s54, 144
  s_cselect_b32 s56, s56, s6
  v_mfma_f32_16x16x32_bf16 v[56:59], v[144:147], a[196:199], v[56:59]
  s_cmp_ge_i32 s61, 0
  s_cselect_b32 s56, s62, s56
  v_mfma_f32_16x16x32_bf16 v[60:63], v[124:127], a[192:195], v[60:63]
  v_mov_b32 v23, s56
  v_mfma_f32_16x16x32_bf16 v[60:63], v[148:151], a[196:199], v[60:63]
  ds_write_b32 v106, v23 offset:0
  v_mfma_f32_16x16x32_bf16 v[64:67], v[128:131], a[192:195], v[64:67]
  buffer_store_dwordx4 a[236:239], v6, s[8:11], s23 offen sc1
  v_mfma_f32_16x16x32_bf16 v[64:67], v[152:155], a[196:199], v[64:67]
  s_add_u32 s23, s22, 12288
  s_mov_b32 s22, s58
  v_mfma_f32_16x16x32_bf16 v[68:71], v[132:135], a[192:195], v[68:71]
  s_mov_b32 s58, s59
  v_mfma_f32_16x16x32_bf16 v[68:71], v[156:159], a[196:199], v[68:71]
  s_waitcnt vmcnt(15) lgkmcnt(0)
  s_cbranch_vccz L_ow6
L_ob6:
  s_barrier
  s_cmp_eq_u32 s32, 1
  s_cbranch_scc1 L_tail0
  v_mfma_f32_16x16x32_bf16 v[48:51], v[160:163], a[200:203], v[48:51]
  ds_read_b128 a[192:195], v7 offset:24576
  v_mfma_f32_16x16x32_bf16 v[48:51], v[184:187], a[204:207], v[48:51]
  ds_read_b128 a[196:199], v8 offset:24576
  v_mfma_f32_16x16x32_bf16 v[52:55], v[164:167], a[200:203], v[52:55]
  ds_read_b128 a[216:219], v1 offset:0
  v_mfma_f32_16x16x32_bf16 v[52:55], v[188:191], a[204:207], v[52:55]
  ds_read_b32 v107, v105 offset:0
  v_mfma_f32_16x16x32_bf16 v[56:59], v[168:171], a[200:203], v[56:59]
  ds_read_b128 a[220:223], v2 offset:0
  v_mfma_f32_16x16x32_bf16 v[56:59], v[192:195], a[204:207], v[56:59]
  ds_read_b128 a[224:227], v3 offset:0
  v_mfma_f32_16x16x32_bf16 v[60:63], v[172:175], a[200:203], v[60:63]
  s_mov_b32 s59, s21
  v_mfma_f32_16x16x32_bf16 v[60:63], v[196:199], a[204:207], v[60:63]
  s_cmp_lt_u32 s54, s55
  s_cselect_b32 s54, 1, s65
  s_cbranch_scc0 L_cl7
  s_atomic_add s54, s[52:53], 0 glc
L_cl7:
  v_mfma_f32_16x16x32_bf16 v[64:67], v[176:179], a[200:203], v[64:67]
  v_mfma_f32_16x16x32_bf16 v[64:67], v[200:203], a[204:207], v[64:67]
  s_waitcnt lgkmcnt(2)
  v_readfirstlane_b32 s21, v107
  v_mfma_f32_16x16x32_bf16 v[68:71], v[180:183], a[200:203], v[68:71]
  v_mfma_f32_16x16x32_bf16 v[68:71], v[204:207], a[204:207], v[68:71]
  s_cmp_lt_u32 s21, s6
  s_cselect_b32 s32, 4, s32
  s_cselect_b64 vcc, -1, 0
  v_mfma_f32_16x16x32_bf16 v[48:51], v[208:211], a[208:211], v[48:51]
  ds_read_b128 a[200:203], v9 offset:24576
  s_add_u32 s37, s21, 12288
  s_bitcmp1_b32 s21, 0
  v_mfma_f32_16x16x32_bf16 v[48:51], v[232:235], a[212:215], v[48:51]
  ds_read_b128 a[204:207], v10 offset:24576
  s_cselect_b32 s37, s6, s37
  s_cselect_b32 s68, 1, s68
  s_andn2_b32 s21, s21, 1
  v_mfma_f32_16x16x32_bf16 v[52:55], v[212:215], a[208:211], v[52:55]
  ds_read_b128 a[228:231], v1 offset:12288
  v_mfma_f32_16x16x32_bf16 v[52:55], v[236:239], a[212:215], v[52:55]
  ds_read_b128 a[232:235], v2 offset:12288
  v_mfma_f32_16x16x32_bf16 v[56:59], v[216:219], a[208:211], v[56:59]
  ds_read_b128 a[236:239], v3 offset:12288
  v_mfma_f32_16x16x32_bf16 v[56:59], v[240:243], a[212:215], v[56:59]
  s_sub_u32 s32, s32, 1
  v_mfma_f32_16x16x32_bf16 v[60:63], v[220:223], a[208:211], v[60:63]
  v_mfma_f32_16x16x32_bf16 v[60:63], v[244:247], a[212:215], v[60:63]
  s_add_u32 m0, s42, 24576
  v_mfma_f32_16x16x32_bf16 v[64:67], v[224:227], a[208:211], v[64:67]
  s_cbranch_vccz L_sk8
  buffer_load_dwordx4 v1, s[4:7], s21 offen nt lds
  s_add_u32 m0, s42, 28672
  s_nop 0
  buffer_load_dwordx4 v2, s[4:7], s21 offen nt lds
  s_add_u32 m0, s42, 32768
  s_nop 0
  buffer_load_dwordx4 v3, s[4:7], s21 offen nt lds
L_sk8:
  v_mfma_f32_16x16x32_bf16 v[64:67], v[248:251], a[212:215], v[64:67]
  v_mfma_f32_16x16x32_bf16 v[68:71], v[228:231], a[208:211], v[68:71]
  v_mfma_f32_16x16x32_bf16 v[68:71], v[252:255], a[212:215], v[68:71]
  s_branch L_loop0
L_tail1:
  v_mfma_f32_16x16x32_bf16 v[48:51], v[160:163], a[200:203], v[48:51]
  ds_read_b128 a[216:219], v1 offset:24576
  v_mfma_f32_16x16x32_bf16 v[48:51], v[184:187], a[204:207], v[48:51]
  ds_read_b128 a[220:223], v2 offset:24576
  v_mfma_f32_16x16x32_bf16 v[48:51], v[208:211], a[208:211], v[48:51]
  ds_read_b128 a[224:227], v3 offset:24576
  v_mfma_f32_16x16x32_bf16 v[48:51], v[232:235], a[212:215], v[48:51]
  ds_read_b128 a[228:231], v1 offset:36864
  v_mfma_f32_16x16x32_bf16 v[52:55], v[164:167], a[200:203], v[52:55]
  ds_read_b128 a[232:235], v2 offset:36864
  v_mfma_f32_16x16x32_bf16 v[52:55], v[188:191], a[204:207], v[52:55]
  ds_read_b128 a[236:239], v3 offset:36864
  v_mfma_f32_16x16x32_bf16 v[52:55], v[212:215], a[208:211], v[52:55]
  s_waitcnt lgkmcnt(5)
  buffer_store_dwordx4 a[216:219], v4, s[8:11], s22 offen sc1
  v_mfma_f32_16x16x32_bf16 v[52:55], v[236:239], a[212:215], v[52:55]
  v_mfma_f32_16x16x32_bf16 v[56:59], v[168:171], a[200:203], v[56:59]
  s_waitcnt lgkmcnt(4)
  buffer_store_dwordx4 a[220:223], v5, s[8:11], s22 offen sc1
  v_mfma_f32_16x16x32_bf16 v[56:59], v[192:195], a[204:207], v[56:59]
  v_mfma_f32_16x16x32_bf16 v[56:59], v[216:219], a[208:211], v[56:59]
  s_waitcnt lgkmcnt(3)
  buffer_store_dwordx4 a[224:227], v6, s[8:11], s22 offen sc1
  v_mfma_f32_16x16x32_bf16 v[56:59], v[240:243], a[212:215], v[56:59]
  v_mfma_f32_16x16x32_bf16 v[60:63], v[172:175], a[200:203], v[60:63]
  s_waitcnt lgkmcnt(2)
  buffer_store_dwordx4 a[228:231], v4, s[8:11], s23 offen sc1
  v_mfma_f32_16x16x32_bf16 v[60:63], v[196:199], a[204:207], v[60:63]
  v_mfma_f32_16x16x32_bf16 v[60:63], v[220:223], a[208:211], v[60:63]
  s_waitcnt lgkmcnt(1)
  buffer_store_dwordx4 a[232:235], v5, s[8:11], s23 offen sc1
  v_mfma_f32_16x16x32_bf16 v[60:63], v[244:247], a[212:215], v[60:63]
  v_mfma_f32_16x16x32_bf16 v[64:67], v[176:179], a[200:203], v[64:67]
  s_waitcnt lgkmcnt(0)
  buffer_store_dwordx4 a[236:239], v6, s[8:11], s23 offen sc1
  v_mfma_f32_16x16x32_bf16 v[64:67], v[200:203], a[204:207], v[64:67]
  v_cvt_pk_bf16_f32 v48, v48, v49
  v_cvt_pk_bf16_f32 v49, v50, v51
  v_mfma_f32_16x16x32_bf16 v[64:67], v[224:227], a[208:211], v[64:67]
  v_mfma_f32_16x16x32_bf16 v[64:67], v[248:251], a[212:215], v[64:67]
  v_cvt_pk_bf16_f32 v50, v52, v53
  v_cvt_pk_bf16_f32 v51, v54, v55
  v_mfma_f32_16x16x32_bf16 v[68:71], v[180:183], a[200:203], v[68:71]
  ds_write_b128 v11, v[48:51] offset:12288
  v_mfma_f32_16x16x32_bf16 v[68:71], v[204:207], a[204:207], v[68:71]
  v_mfma_f32_16x16x32_bf16 v[68:71], v[228:231], a[208:211], v[68:71]
  v_mfma_f32_16x16x32_bf16 v[68:71], v[252:255], a[212:215], v[68:71]
  s_add_u32 s23, s22, 12288
  v_cvt_pk_bf16_f32 v52, v56, v57
  v_cvt_pk_bf16_f32 v53, v58, v59
  v_cvt_pk_bf16_f32 v54, v60, v61
  v_cvt_pk_bf16_f32 v55, v62, v63
  ds_write_b128 v12, v[52:55] offset:12288
  v_cvt_pk_bf16_f32 v56, v64, v65
  v_cvt_pk_bf16_f32 v57, v66, v67
  v_cvt_pk_bf16_f32 v58, v68, v69
  v_cvt_pk_bf16_f32 v59, v70, v71
  ds_write_b128 v13, v[56:59] offset:12288
  s_waitcnt lgkmcnt(0)
  s_barrier
  ds_read_b128 a[192:195], v1 offset:12288
  ds_read_b128 a[196:199], v2 offset:12288
  ds_read_b128 a[200:203], v3 offset:12288
  s_waitcnt lgkmcnt(2)
  buffer_store_dwordx4 a[192:195], v4, s[8:11], s23 offen sc1
  s_waitcnt lgkmcnt(1)
  buffer_store_dwordx4 a[196:199], v5, s[8:11], s23 offen sc1
  s_waitcnt lgkmcnt(0)
  buffer_store_dwordx4 a[200:203], v6, s[8:11], s23 offen sc1
  s_endpgm
L_tail0:
  v_mfma_f32_16x16x32_bf16 v[48:51], v[160:163], a[200:203], v[48:51]
  ds_read_b128 a[216:219], v1 offset:0
  v_mfma_f32_16x16x32_bf16 v[48:51], v[184:187], a[204:207], v[48:51]
  ds_read_b128 a[220:223], v2 offset:0
  v_mfma_f32_16x16x32_bf16 v[48:51], v[208:211], a[208:211], v[48:51]
  ds_read_b128 a[224:227], v3 offset:0
  v_mfma_f32_16x16x32_bf16 v[48:51], v[232:235], a[212:215], v[48:51]
  ds_read_b128 a[228:231], v1 offset:12288
  v_mfma_f32_16x16x32_bf16 v[52:55], v[164:167], a[200:203], v[52:55]
  ds_read_b128 a[232:235], v2 offset:12288
  v_mfma_f32_16x16x32_bf16 v[52:55], v[188:191], a[204:207], v[52:55]
  ds_read_b128 a[236:239], v3 offset:12288
  v_mfma_f32_16x16x32_bf16 v[52:55], v[212:215], a[208:211], v[52:55]
  s_waitcnt lgkmcnt(5)
  buffer_store_dwordx4 a[216:219], v4, s[8:11], s22 offen sc1
  v_mfma_f32_16x16x32_bf16 v[52:55], v[236:239], a[212:215], v[52:55]
  v_mfma_f32_16x16x32_bf16 v[56:59], v[168:171], a[200:203], v[56:59]
  s_waitcnt lgkmcnt(4)
  buffer_store_dwordx4 a[220:223], v5, s[8:11], s22 offen sc1
  v_mfma_f32_16x16x32_bf16 v[56:59], v[192:195], a[204:207], v[56:59]
  v_mfma_f32_16x16x32_bf16 v[56:59], v[216:219], a[208:211], v[56:59]
  s_waitcnt lgkmcnt(3)
  buffer_store_dwordx4 a[224:227], v6, s[8:11], s22 offen sc1
  v_mfma_f32_16x16x32_bf16 v[56:59], v[240:243], a[212:215], v[56:59]
  v_mfma_f32_16x16x32_bf16 v[60:63], v[172:175], a[200:203], v[60:63]
  s_waitcnt lgkmcnt(2)
  buffer_store_dwordx4 a[228:231], v4, s[8:11], s23 offen sc1
  v_mfma_f32_16x16x32_bf16 v[60:63], v[196:199], a[204:207], v[60:63]
  v_mfma_f32_16x16x32_bf16 v[60:63], v[220:223], a[208:211], v[60:63]
  s_waitcnt lgkmcnt(1)
  buffer_store_dwordx4 a[232:235], v5, s[8:11], s23 offen sc1
  v_mfma_f32_16x16x32_bf16 v[60:63], v[244:247], a[212:215], v[60:63]
  v_mfma_f32_16x16x32_bf16 v[64:67], v[176:179], a[200:203], v[64:67]
  s_waitcnt lgkmcnt(0)
  buffer_store_dwordx4 a[236:239], v6, s[8:11], s23 offen sc1
  v_mfma_f32_16x16x32_bf16 v[64:67], v[200:203], a[204:207], v[64:67]
  v_cvt_pk_bf16_f32 v48, v48, v49
  v_cvt_pk_bf16_f32 v49, v50, v51
  v_mfma_f32_16x16x32_bf16 v[64:67], v[224:227], a[208:211], v[64:67]
  v_mfma_f32_16x16x32_bf16 v[64:67], v[248:251], a[212:215], v[64:67]
  v_cvt_pk_bf16_f32 v50, v52, v53
  v_cvt_pk_bf16_f32 v51, v54, v55
  v_mfma_f32_16x16x32_bf16 v[68:71], v[180:183], a[200:203], v[68:71]
  ds_write_b128 v11, v[48:51] offset:36864
  v_mfma_f32_16x16x32_bf16 v[68:71], v[204:207], a[204:207], v[68:71]
  v_mfma_f32_16x16x32_bf16 v[68:71], v[228:231], a[208:211], v[68:71]
  v_mfma_f32_16x16x32_bf16 v[68:71], v[252:255], a[212:215], v[68:71]
  s_add_u32 s23, s22, 12288
  v_cvt_pk_bf16_f32 v52, v56, v57
  v_cvt_pk_bf16_f32 v53, v58, v59
  v_cvt_pk_bf16_f32 v54, v60, v61
  v_cvt_pk_bf16_f32 v55, v62, v63
  ds_write_b128 v12, v[52:55] offset:36864
  v_cvt_pk_bf16_f32 v56, v64, v65
  v_cvt_pk_bf16_f32 v57, v66, v67
  v_cvt_pk_bf16_f32 v58, v68, v69
  v_cvt_pk_bf16_f32 v59, v70, v71
  ds_write_b128 v13, v[56:59] offset:36864
  s_waitcnt lgkmcnt(0)
  s_barrier
  ds_read_b128 a[192:195], v1 offset:36864
  ds_read_b128 a[196:199], v2 offset:36864
  ds_read_b128 a[200:203], v3 offset:36864
  s_waitcnt lgkmcnt(2)
  buffer_store_dwordx4 a[192:195], v4, s[8:11], s23 offen sc1
  s_waitcnt lgkmcnt(1)
  buffer_store_dwordx4 a[196:199], v5, s[8:11], s23 offen sc1
  s_waitcnt lgkmcnt(0)
  buffer_store_dwordx4 a[200:203], v6, s[8:11], s23 offen sc1
  s_endpgm
L_half0:
  s_nop 1
  v_cvt_pk_bf16_f32 v24, v24, v25
  v_cvt_pk_bf16_f32 v25, v26, v27
  v_cvt_pk_bf16_f32 v26, v28, v29
  v_cvt_pk_bf16_f32 v27, v30, v31
  ds_write_b128 v11, v[24:27] offset:0
  v_cvt_pk_bf16_f32 v28, v32, v33
  v_cvt_pk_bf16_f32 v29, v34, v35
  v_cvt_pk_bf16_f32 v30, v36, v37
  v_cvt_pk_bf16_f32 v31, v38, v39
  ds_write_b128 v12, v[28:31] offset:0
  v_cvt_pk_bf16_f32 v32, v40, v41
  v_cvt_pk_bf16_f32 v33, v42, v43
  v_cvt_pk_bf16_f32 v34, v44, v45
  v_cvt_pk_bf16_f32 v35, v46, v47
  ds_write_b128 v13, v[32:35] offset:0
  buffer_store_dwordx4 a[228:231], v4, s[8:11], s23 offen sc1
  buffer_store_dwordx4 a[232:235], v5, s[8:11], s23 offen sc1
  buffer_store_dwordx4 a[236:239], v6, s[8:11], s23 offen sc1
  s_add_u32 s23, s22, 12288
  s_mov_b32 s22, s58
  s_waitcnt lgkmcnt(0)
  s_barrier
  ds_read_b128 a[216:219], v1 offset:0
  ds_read_b128 a[220:223], v2 offset:0
  ds_read_b128 a[224:227], v3 offset:0
  ds_read_b128 a[228:231], v1 offset:12288
  ds_read_b128 a[232:235], v2 offset:12288
  ds_read_b128 a[236:239], v3 offset:12288
  s_waitcnt lgkmcnt(5)
  buffer_store_dwordx4 a[216:219], v4, s[8:11], s22 offen sc1
  s_waitcnt lgkmcnt(4)
  buffer_store_dwordx4 a[220:223], v5, s[8:11], s22 offen sc1
  s_waitcnt lgkmcnt(3)
  buffer_store_dwordx4 a[224:227], v6, s[8:11], s22 offen sc1
  s_waitcnt lgkmcnt(2)
  buffer_store_dwordx4 a[228:231], v4, s[8:11], s23 offen sc1
  s_waitcnt lgkmcnt(1)
  buffer_store_dwordx4 a[232:235], v5, s[8:11], s23 offen sc1
  s_waitcnt lgkmcnt(0)
  buffer_store_dwordx4 a[236:239], v6, s[8:11], s23 offen sc1
  s_endpgm
L_half1:
  s_nop 1
  v_cvt_pk_bf16_f32 v24, v24, v25
  v_cvt_pk_bf16_f32 v25, v26, v27
  v_cvt_pk_bf16_f32 v26, v28, v29
  v_cvt_pk_bf16_f32 v27, v30, v31
  ds_write_b128 v11, v[24:27] offset:24576
  v_cvt_pk_bf16_f32 v28, v32, v33
  v_cvt_pk_bf16_f32 v29, v34, v35
  v_cvt_pk_bf16_f32 v30, v36, v37
  v_cvt_pk_bf16_f32 v31, v38, v39
  ds_write_b128 v12, v[28:31] offset:24576
  v_cvt_pk_bf16_f32 v32, v40, v41
  v_cvt_pk_bf16_f32 v33, v42, v43
  v_cvt_pk_bf16_f32 v34, v44, v45
  v_cvt_pk_bf16_f32 v35, v46, v47
  ds_write_b128 v13, v[32:35] offset:24576
  buffer_store_dwordx4 a[228:231], v4, s[8:11], s23 offen sc1
  buffer_store_dwordx4 a[232:235], v5, s[8:11], s23 offen sc1
  buffer_store_dwordx4 a[236:239], v6, s[8:11], s23 offen sc1
  s_add_u32 s23, s22, 12288
  s_mov_b32 s22, s58
  s_waitcnt lgkmcnt(0)
  s_barrier
  ds_read_b128 a[216:219], v1 offset:24576
  ds_read_b128 a[220:223], v2 offset:24576
  ds_read_b128 a[224:227], v3 offset:24576
  ds_read_b128 a[228:231], v1 offset:36864
  ds_read_b128 a[232:235], v2 offset:36864
  ds_read_b128 a[236:239], v3 offset:36864
  s_waitcnt lgkmcnt(5)
  buffer_store_dwordx4 a[216:219], v4, s[8:11], s22 offen sc1
  s_waitcnt lgkmcnt(4)
  buffer_store_dwordx4 a[220:223], v5, s[8:11], s22 offen sc1
  s_waitcnt lgkmcnt(3)
  buffer_store_dwordx4 a[224:227], v6, s[8:11], s22 offen sc1
  s_waitcnt lgkmcnt(2)
  buffer_store_dwordx4 a[228:231], v4, s[8:11], s23 offen sc1
  s_waitcnt lgkmcnt(1)
  buffer_store_dwordx4 a[232:235], v5, s[8:11], s23 offen sc1
  s_waitcnt lgkmcnt(0)
  buffer_store_dwordx4 a[236:239], v6, s[8:11], s23 offen sc1
  s_endpgm
L_ow2:
  s_cmp_eq_u32 s32, 1
  s_cbranch_scc1 L_ob2
  s_waitcnt vmcnt(9)
  s_branch L_ob2
L_ow6:
  s_cmp_eq_u32 s32, 1
  s_cbranch_scc1 L_ob6
  s_waitcnt vmcnt(9)
  s_branch L_ob6
L_done:
  s_endpgm
.section .rodata,"a"
.p2align 6
.amdhsa_kernel standalone__depthwise_separable__vision_kernel
  .amdhsa_next_free_vgpr 512
  .amdhsa_next_free_sgpr 100
  .amdhsa_accum_offset 256
  .amdhsa_group_segment_fixed_size 0
  .amdhsa_kernarg_size 48
  .amdhsa_user_sgpr_count 2
  .amdhsa_user_sgpr_kernarg_segment_ptr 1
  .amdhsa_system_sgpr_workgroup_id_x 1
  .amdhsa_float_denorm_mode_32 3
.end_amdhsa_kernel
```

```asm
; @launch grid=(256,1,1) block=(256,1,1) lds=151552
.amdgcn_target "amdgcn-amd-amdhsa--gfx950"
.text
.globl standalone__depthwise_separable__vision_kernel
.p2align 8
.type standalone__depthwise_separable__vision_kernel,@function
standalone__depthwise_separable__vision_kernel:
  s_cmp_ge_u32 s2, 256
  s_cbranch_scc1 L_done
  s_load_dwordx4 s[28:31], s[0:1], 16
  s_load_dwordx4 s[24:27], s[0:1], 0
  s_load_dwordx2 s[52:53], s[0:1], 32
  s_getpc_b64 s[40:41]
L_pc:
  v_lshlrev_b32 v72, 7, v0
  v_min_u32 v72, L_done-L_pc, v72
  v_mov_b32 v73, s41
  v_add_co_u32 v72, vcc, s40, v72
  v_lshrrev_b32 v77, 6, v0
  v_and_b32 v74, 63, v0
  v_addc_co_u32 v73, vcc, 0, v73, vcc
  global_load_dword v23, v[72:73], off
  v_readfirstlane_b32 s20, v77
  v_and_b32 v75, 15, v74
  v_lshlrev_b32 v78, 4, v74
  v_lshlrev_b32 v79, 4, v75
  s_lshr_b32 s47, s2, 3
  s_mul_i32 s39, s47, 9216
  s_mul_i32 s38, s20, 2304
  s_add_u32 s39, s39, s38
  s_and_b32 s38, s2, 7
  s_lshl_b32 s38, s38, 5
  s_add_u32 s38, s38, s47
  s_mul_i32 s21, s38, 24576
  v_mul_u32_u24 v81, 0xaaab, v0
  v_lshrrev_b32 v81, 21, v81
  v_xor_b32 v80, v0, v81
  v_lshlrev_b32 v1, 4, v80
  v_add_u32 v80, 256, v0
  v_mul_u32_u24 v81, 0xaaab, v80
  v_lshrrev_b32 v81, 21, v81
  v_xor_b32 v80, v80, v81
  v_lshlrev_b32 v2, 4, v80
  v_add_u32 v80, 512, v0
  v_mul_u32_u24 v81, 0xaaab, v80
  v_lshrrev_b32 v81, 21, v81
  v_xor_b32 v80, v80, v81
  v_lshlrev_b32 v3, 4, v80
  s_add_u32 s37, s21, 12288
  s_mov_b32 s22, s21
  s_mov_b32 s6, 113246208
  s_mov_b32 s7, 0x00020000
  s_lshl_b32 s33, s20, 10
  s_mul_i32 s34, s20, 6144
  s_mov_b32 s36, 0
  s_mov_b32 s14, 294912
  s_mov_b32 s15, 0x00020000
  s_mov_b32 s18, 768
  s_mov_b32 s19, 0x00020000
  s_add_u32 m0, s33, 147456
  s_waitcnt lgkmcnt(0)
  s_mov_b32 s12, s28
  s_and_b32 s13, s29, 0xffff
  buffer_load_dwordx4 a[216:219], v78, s[12:15], s39 offen
  buffer_load_dwordx4 a[220:223], v78, s[12:15], s39 offen offset:1024
  buffer_load_dwordx4 a[224:227], v79, s[12:15], s39 offen offset:2048
  s_mov_b32 s16, s26
  s_and_b32 s17, s27, 0xffff
  buffer_load_dwordx4 v78, s[16:19], 0 offen lds
  s_mov_b32 s4, s24
  s_and_b32 s5, s25, 0xffff
  s_add_u32 m0, s33, 98304
  s_nop 0
  buffer_load_dwordx4 v1, s[4:7], s21 offen nt lds
  s_add_u32 m0, s33, 102400
  s_nop 0
  buffer_load_dwordx4 v2, s[4:7], s21 offen nt lds
  s_add_u32 m0, s33, 106496
  s_nop 0
  buffer_load_dwordx4 v3, s[4:7], s21 offen nt lds
  s_add_u32 m0, s33, 110592
  s_add_u32 s21, s21, 6291456
  buffer_load_dwordx4 v1, s[4:7], s37 offen nt lds
  s_add_u32 m0, s33, 114688
  s_nop 0
  buffer_load_dwordx4 v2, s[4:7], s37 offen nt lds
  s_add_u32 m0, s33, 118784
  s_nop 0
  buffer_load_dwordx4 v3, s[4:7], s37 offen nt lds
  s_add_u32 s37, s37, 6291456
  s_mul_i32 s38, s20, 192
  v_mul_u32_u24 v81, 0xaaab, v74
  v_lshrrev_b32 v81, 19, v81
  v_mul_u32_u24 v81, 576, v81
  v_add3_u32 v14, v81, v78, s38
  v_add_u32 v80, 64, v74
  v_mul_u32_u24 v81, 0xaaab, v80
  v_lshrrev_b32 v81, 19, v81
  v_mul_u32_u24 v81, 576, v81
  v_add3_u32 v15, v81, v78, s38
  v_add_u32 v80, 128, v74
  v_mul_u32_u24 v81, 0xaaab, v80
  v_lshrrev_b32 v81, 19, v81
  v_mul_u32_u24 v81, 576, v81
  v_add3_u32 v16, v81, v78, s38
  v_lshrrev_b32 v76, 4, v74
  v_lshlrev_b32 v18, 4, v76
  v_add_u32 v18, s33, v18
  v_add_u32 v18, 147456, v18
  v_bfe_u32 v81, v74, 2, 2
  v_and_b32 v82, 3, v74
  v_lshl_add_u32 v83, v76, 3, v81
  v_mul_u32_u24 v83, 192, v83
  v_mul_u32_u24 v84, 48, v82
  v_add3_u32 v17, v83, v84, s34
  v_add_u32 v104, 49152, v17
  v_lshlrev_b32 v83, 4, v82
  v_mov_b32 v84, 0xffff
  v_cmp_lt_u32 vcc, 1, v82
  v_lshlrev_b32 v84, v83, v84
  v_mul_u32_u24 v80, 0x300, v75
  v_cndmask_b32 v20, 0, v84, vcc
  v_sub_u32 v19, v84, v20
  s_add_u32 m0, s34, 49152
  s_nop 0
  buffer_load_dwordx4 v14, s[12:15], s36 offen offset:0 lds
  buffer_load_dwordx4 v15, s[12:15], s36 offen offset:1024 lds
  buffer_load_dwordx4 v16, s[12:15], s36 offen offset:2048 lds
  s_mov_b32 s8, s30
  s_and_b32 s9, s31, 0xffff
  s_mov_b32 s10, 113246208
  s_mov_b32 s11, 0x00020000
  v_lshlrev_b32 v4, 4, v0
  v_add_u32 v5, 4096, v4
  v_add_u32 v6, 8192, v4
  v_xor_b32 v81, v76, v75
  v_lshl_add_u32 v7, v81, 4, v80
  v_add_u32 v7, 98304, v7
  v_xor_b32 v8, 64, v7
  v_xor_b32 v9, 128, v7
  v_xor_b32 v10, 192, v7
  s_mul_i32 s38, s20, 12
  v_mul_u32_u24 v81, 3, v76
  v_add_u32 v81, s38, v81
  v_add_u32 v82, 0, v81
  v_xor_b32 v82, v82, v75
  v_lshl_add_u32 v11, v82, 4, v80
  v_add_u32 v82, 1, v81
  v_xor_b32 v82, v82, v75
  v_lshl_add_u32 v12, v82, 4, v80
  v_add_u32 v82, 2, v81
  v_xor_b32 v82, v82, v75
  v_lshl_add_u32 v13, v82, 4, v80
  s_mov_b32 s23, 113246208
  s_mov_b32 s44, 6291456
  s_add_u32 s42, s33, 49152
  s_mov_b32 s51, 1
  s_and_b32 s38, s47, 3
  s_mul_i32 s57, s38, 24576
  s_add_u32 s57, s57, 100663296
  s_lshl_b32 s38, s38, 6
  s_add_u32 s52, s52, s38
  s_addc_u32 s53, s53, 0
  s_mov_b32 s55, 112
  s_mov_b32 s68, 0
  s_cmp_eq_u32 s20, 0
  s_cselect_b32 s66, s55, 0
  s_mov_b32 s55, 0
  s_mov_b32 s65, 0
  s_mov_b32 s61, 12
  s_add_u32 s62, s22, 18874368
  s_mov_b32 s54, 0
  s_add_u32 s58, s22, 6291456
  s_add_u32 s59, s22, 12582912
  s_mov_b32 s32, 3
  v_mov_b32 v105, 147456
  v_add_u32 v106, s33, v105
  s_waitcnt vmcnt(9)
  ds_read_b128 v[24:27], v18 offset:0
  ds_read_b128 v[28:31], v18 offset:64
  ds_read_b128 v[32:35], v18 offset:128
  ds_read_b128 v[36:39], v18 offset:192
  ds_read_b128 v[40:43], v18 offset:256
  ds_read_b128 v[44:47], v18 offset:320
  ds_read_b128 v[48:51], v18 offset:384
  ds_read_b128 v[52:55], v18 offset:448
  ds_read_b128 v[56:59], v18 offset:512
  ds_read_b128 v[60:63], v18 offset:576
  ds_read_b128 v[64:67], v18 offset:640
  ds_read_b128 v[68:71], v18 offset:704
  s_waitcnt lgkmcnt(9)
  v_and_b32 v24, v19, v24
  v_and_b32 v25, v20, v25
  v_and_b32 v26, v19, v26
  v_and_b32 v27, v20, v27
  v_accvgpr_write_b32 a208, v24
  v_accvgpr_write_b32 a209, v25
  v_accvgpr_write_b32 a210, v26
  v_accvgpr_write_b32 a211, v27
  v_and_b32 v28, v19, v28
  v_and_b32 v29, v20, v29
  v_and_b32 v30, v19, v30
  v_and_b32 v31, v20, v31
  v_accvgpr_write_b32 a212, v28
  v_accvgpr_write_b32 a213, v29
  v_accvgpr_write_b32 a214, v30
  v_accvgpr_write_b32 a215, v31
  v_and_b32 v32, v19, v32
  v_and_b32 v33, v20, v33
  v_and_b32 v34, v19, v34
  v_and_b32 v35, v20, v35
  v_accvgpr_write_b32 a216, v32
  v_accvgpr_write_b32 a217, v33
  v_accvgpr_write_b32 a218, v34
  v_accvgpr_write_b32 a219, v35
  s_waitcnt lgkmcnt(6)
  v_and_b32 v36, v19, v36
  v_and_b32 v37, v20, v37
  v_and_b32 v38, v19, v38
  v_and_b32 v39, v20, v39
  v_accvgpr_write_b32 a220, v36
  v_accvgpr_write_b32 a221, v37
  v_accvgpr_write_b32 a222, v38
  v_accvgpr_write_b32 a223, v39
  v_and_b32 v40, v19, v40
  v_and_b32 v41, v20, v41
  v_and_b32 v42, v19, v42
  v_and_b32 v43, v20, v43
  v_accvgpr_write_b32 a224, v40
  v_accvgpr_write_b32 a225, v41
  v_accvgpr_write_b32 a226, v42
  v_accvgpr_write_b32 a227, v43
  v_and_b32 v44, v19, v44
  v_and_b32 v45, v20, v45
  v_and_b32 v46, v19, v46
  v_and_b32 v47, v20, v47
  v_accvgpr_write_b32 a228, v44
  v_accvgpr_write_b32 a229, v45
  v_accvgpr_write_b32 a230, v46
  v_accvgpr_write_b32 a231, v47
  s_waitcnt lgkmcnt(3)
  v_and_b32 v48, v19, v48
  v_and_b32 v49, v20, v49
  v_and_b32 v50, v19, v50
  v_and_b32 v51, v20, v51
  v_accvgpr_write_b32 a232, v48
  v_accvgpr_write_b32 a233, v49
  v_accvgpr_write_b32 a234, v50
  v_accvgpr_write_b32 a235, v51
  v_and_b32 v52, v19, v52
  v_and_b32 v53, v20, v53
  v_and_b32 v54, v19, v54
  v_and_b32 v55, v20, v55
  v_accvgpr_write_b32 a236, v52
  v_accvgpr_write_b32 a237, v53
  v_accvgpr_write_b32 a238, v54
  v_accvgpr_write_b32 a239, v55
  v_and_b32 v56, v19, v56
  v_and_b32 v57, v20, v57
  v_and_b32 v58, v19, v58
  v_and_b32 v59, v20, v59
  v_accvgpr_write_b32 a240, v56
  v_accvgpr_write_b32 a241, v57
  v_accvgpr_write_b32 a242, v58
  v_accvgpr_write_b32 a243, v59
  s_waitcnt lgkmcnt(0)
  v_and_b32 v60, v19, v60
  v_and_b32 v61, v20, v61
  v_and_b32 v62, v19, v62
  v_and_b32 v63, v20, v63
  v_accvgpr_write_b32 a244, v60
  v_accvgpr_write_b32 a245, v61
  v_accvgpr_write_b32 a246, v62
  v_accvgpr_write_b32 a247, v63
  v_and_b32 v64, v19, v64
  v_and_b32 v65, v20, v65
  v_and_b32 v66, v19, v66
  v_and_b32 v67, v20, v67
  v_accvgpr_write_b32 a248, v64
  v_accvgpr_write_b32 a249, v65
  v_accvgpr_write_b32 a250, v66
  v_accvgpr_write_b32 a251, v67
  v_and_b32 v68, v19, v68
  v_and_b32 v69, v20, v69
  v_and_b32 v70, v19, v70
  v_and_b32 v71, v20, v71
  v_accvgpr_write_b32 a252, v68
  v_accvgpr_write_b32 a253, v69
  v_accvgpr_write_b32 a254, v70
  v_accvgpr_write_b32 a255, v71
  s_add_u32 m0, s34, 52224
  s_add_u32 s36, s36, 12288
  buffer_load_dwordx4 v14, s[12:15], s36 offen offset:0 lds
  buffer_load_dwordx4 v15, s[12:15], s36 offen offset:1024 lds
  buffer_load_dwordx4 v16, s[12:15], s36 offen offset:2048 lds
  s_add_u32 m0, s34, 73728
  s_add_u32 s36, s36, 12288
  buffer_load_dwordx4 v14, s[12:15], s36 offen offset:0 lds
  buffer_load_dwordx4 v15, s[12:15], s36 offen offset:1024 lds
  buffer_load_dwordx4 v16, s[12:15], s36 offen offset:2048 lds
  s_add_u32 m0, s34, 76800
  s_add_u32 s36, s36, 12288
  buffer_load_dwordx4 v14, s[12:15], s36 offen offset:0 lds
  buffer_load_dwordx4 v15, s[12:15], s36 offen offset:1024 lds
  buffer_load_dwordx4 v16, s[12:15], s36 offen offset:2048 lds
  s_waitcnt vmcnt(6)
  ds_read_b64_tr_b16 a[144:145], v104 offset:0
  ds_read_b64_tr_b16 a[146:147], v104 offset:768
  ds_read_b64_tr_b16 a[148:149], v104 offset:8
  ds_read_b64_tr_b16 a[150:151], v104 offset:776
  ds_read_b64_tr_b16 a[152:153], v104 offset:16
  ds_read_b64_tr_b16 a[154:155], v104 offset:784
  ds_read_b64_tr_b16 a[156:157], v104 offset:24
  ds_read_b64_tr_b16 a[158:159], v104 offset:792
  ds_read_b64_tr_b16 a[160:161], v104 offset:32
  ds_read_b64_tr_b16 a[162:163], v104 offset:800
  ds_read_b64_tr_b16 a[164:165], v104 offset:40
  ds_read_b64_tr_b16 a[166:167], v104 offset:808
  s_barrier
  ds_read_b128 a[192:195], v7 offset:0
  ds_read_b128 a[196:199], v7 offset:12288
  s_add_u32 m0, s34, 0
  s_add_u32 s36, s36, 12288
  buffer_load_dwordx4 v14, s[12:15], s36 offen offset:0 lds
  buffer_load_dwordx4 v15, s[12:15], s36 offen offset:1024 lds
  buffer_load_dwordx4 v16, s[12:15], s36 offen offset:2048 lds
  s_add_u32 m0, s34, 3072
  s_add_u32 s36, s36, 12288
  buffer_load_dwordx4 v14, s[12:15], s36 offen offset:0 lds
  buffer_load_dwordx4 v15, s[12:15], s36 offen offset:1024 lds
  buffer_load_dwordx4 v16, s[12:15], s36 offen offset:2048 lds
  s_waitcnt vmcnt(6) lgkmcnt(12)
  v_mfma_f32_4x4x4_16b_bf16 v[72:75], a[208:209], a[144:145], 0
  v_mfma_f32_4x4x4_16b_bf16 v[76:79], a[210:211], a[146:147], 0
  s_add_u32 m0, s34, 24576
  s_add_u32 s36, s36, 12288
  s_nop 0
  ds_read_b64_tr_b16 a[168:169], v104 offset:24576
  ds_read_b64_tr_b16 a[170:171], v104 offset:25344
  buffer_load_dwordx4 v14, s[12:15], s36 offen offset:0 lds
  s_waitcnt lgkmcnt(12)
  v_mfma_f32_4x4x4_16b_bf16 v[80:83], a[208:209], a[148:149], 0
  v_mfma_f32_4x4x4_16b_bf16 v[84:87], a[210:211], a[150:151], 0
  ds_read_b64_tr_b16 a[172:173], v104 offset:24584
  ds_read_b64_tr_b16 a[174:175], v104 offset:25352
  buffer_load_dwordx4 v15, s[12:15], s36 offen offset:1024 lds
  s_waitcnt lgkmcnt(12)
  v_mfma_f32_4x4x4_16b_bf16 v[88:91], a[208:209], a[152:153], 0
  v_mfma_f32_4x4x4_16b_bf16 v[92:95], a[210:211], a[154:155], 0
  v_cvt_pk_bf16_f32 v72, v72, v73
  v_cvt_pk_bf16_f32 v74, v74, v75
  ds_read_b64_tr_b16 a[176:177], v104 offset:24592
  ds_read_b64_tr_b16 a[178:179], v104 offset:25360
  buffer_load_dwordx4 v16, s[12:15], s36 offen offset:2048 lds
  v_cvt_pk_bf16_f32 v76, v76, v77
  v_accvgpr_write_b32 a0, v72
  v_cvt_pk_bf16_f32 v78, v78, v79
  v_accvgpr_write_b32 a1, v74
  v_accvgpr_write_b32 a2, v76
  v_accvgpr_write_b32 a3, v78
  s_waitcnt lgkmcnt(12)
  v_mfma_f32_4x4x4_16b_bf16 v[72:75], a[208:209], a[156:157], 0
  v_mfma_f32_4x4x4_16b_bf16 v[76:79], a[210:211], a[158:159], 0
  v_cvt_pk_bf16_f32 v80, v80, v81
  v_cvt_pk_bf16_f32 v82, v82, v83
  s_add_u32 m0, s34, 27648
  s_add_u32 s36, s36, 12288
  s_nop 0
  ds_read_b64_tr_b16 a[180:181], v104 offset:24600
  ds_read_b64_tr_b16 a[182:183], v104 offset:25368
  buffer_load_dwordx4 v14, s[12:15], s36 offen offset:0 lds
  v_cvt_pk_bf16_f32 v84, v84, v85
  v_accvgpr_write_b32 a4, v80
  v_cvt_pk_bf16_f32 v86, v86, v87
  v_accvgpr_write_b32 a5, v82
  v_accvgpr_write_b32 a6, v84
  v_accvgpr_write_b32 a7, v86
  s_waitcnt lgkmcnt(12)
  v_mfma_f32_4x4x4_16b_bf16 v[80:83], a[208:209], a[160:161], 0
  v_mfma_f32_4x4x4_16b_bf16 v[84:87], a[210:211], a[162:163], 0
  v_cvt_pk_bf16_f32 v88, v88, v89
  v_cvt_pk_bf16_f32 v90, v90, v91
  ds_read_b64_tr_b16 a[184:185], v104 offset:24608
  ds_read_b64_tr_b16 a[186:187], v104 offset:25376
  buffer_load_dwordx4 v15, s[12:15], s36 offen offset:1024 lds
  v_cvt_pk_bf16_f32 v92, v92, v93
  v_accvgpr_write_b32 a8, v88
  v_cvt_pk_bf16_f32 v94, v94, v95
  v_accvgpr_write_b32 a9, v90
  v_accvgpr_write_b32 a10, v92
  v_accvgpr_write_b32 a11, v94
  s_waitcnt lgkmcnt(12)
  v_mfma_f32_4x4x4_16b_bf16 v[88:91], a[208:209], a[164:165], 0
  v_mfma_f32_4x4x4_16b_bf16 v[92:95], a[210:211], a[166:167], 0
  v_cvt_pk_bf16_f32 v72, v72, v73
  v_cvt_pk_bf16_f32 v74, v74, v75
  ds_read_b64_tr_b16 a[188:189], v104 offset:24616
  ds_read_b64_tr_b16 a[190:191], v104 offset:25384
  buffer_load_dwordx4 v16, s[12:15], s36 offen offset:2048 lds
  v_cvt_pk_bf16_f32 v76, v76, v77
  v_accvgpr_write_b32 a12, v72
  v_cvt_pk_bf16_f32 v78, v78, v79
  v_accvgpr_write_b32 a13, v74
  v_accvgpr_write_b32 a14, v76
  v_accvgpr_write_b32 a15, v78
  s_waitcnt vmcnt(6) lgkmcnt(6)
  v_mfma_f32_4x4x4_16b_bf16 v[72:75], a[212:213], a[168:169], 0
  v_mfma_f32_4x4x4_16b_bf16 v[76:79], a[214:215], a[170:171], 0
  v_cvt_pk_bf16_f32 v80, v80, v81
  v_cvt_pk_bf16_f32 v82, v82, v83
  v_mfma_f32_16x16x32_bf16 v[24:27], a[0:3], a[192:195], 0
  ds_read_b64_tr_b16 a[144:145], v17 offset:0
  v_cvt_pk_bf16_f32 v84, v84, v85
  s_add_u32 m0, s34, 49152
  s_add_u32 s36, s36, 12288
  v_mfma_f32_16x16x32_bf16 v[48:51], a[0:3], a[196:199], 0
  ds_read_b64_tr_b16 a[146:147], v17 offset:768
  buffer_load_dwordx4 v14, s[12:15], s36 offen offset:0 lds
  v_accvgpr_write_b32 a16, v80
  v_cvt_pk_bf16_f32 v86, v86, v87
  v_accvgpr_write_b32 a17, v82
  v_accvgpr_write_b32 a18, v84
  v_accvgpr_write_b32 a19, v86
  v_mfma_f32_4x4x4_16b_bf16 v[80:83], a[212:213], a[172:173], 0
  v_mfma_f32_4x4x4_16b_bf16 v[84:87], a[214:215], a[174:175], 0
  v_cvt_pk_bf16_f32 v88, v88, v89
  v_cvt_pk_bf16_f32 v90, v90, v91
  v_mfma_f32_16x16x32_bf16 v[28:31], a[4:7], a[192:195], 0
  ds_read_b64_tr_b16 a[148:149], v17 offset:8
  ds_read_b128 a[200:203], v8 offset:0
  v_cvt_pk_bf16_f32 v92, v92, v93
  v_mfma_f32_16x16x32_bf16 v[52:55], a[4:7], a[196:199], 0
  ds_read_b64_tr_b16 a[150:151], v17 offset:776
  buffer_load_dwordx4 v15, s[12:15], s36 offen offset:1024 lds
  buffer_load_dwordx4 v16, s[12:15], s36 offen offset:2048 lds
  v_accvgpr_write_b32 a20, v88
  v_cvt_pk_bf16_f32 v94, v94, v95
  v_accvgpr_write_b32 a21, v90
  v_accvgpr_write_b32 a22, v92
  v_accvgpr_write_b32 a23, v94
  v_mfma_f32_4x4x4_16b_bf16 v[88:91], a[212:213], a[176:177], 0
  v_mfma_f32_4x4x4_16b_bf16 v[92:95], a[214:215], a[178:179], 0
  v_cvt_pk_bf16_f32 v72, v72, v73
  v_cvt_pk_bf16_f32 v74, v74, v75
  v_mfma_f32_16x16x32_bf16 v[32:35], a[8:11], a[192:195], 0
  ds_read_b64_tr_b16 a[152:153], v17 offset:16
  ds_read_b128 a[204:207], v8 offset:12288
  v_cvt_pk_bf16_f32 v76, v76, v77
  s_add_u32 m0, s34, 52224
  s_add_u32 s36, s36, 12288
  v_mfma_f32_16x16x32_bf16 v[56:59], a[8:11], a[196:199], 0
  ds_read_b64_tr_b16 a[154:155], v17 offset:784
  buffer_load_dwordx4 v14, s[12:15], s36 offen offset:0 lds
  v_accvgpr_write_b32 a24, v72
  v_cvt_pk_bf16_f32 v78, v78, v79
  v_accvgpr_write_b32 a25, v74
  v_accvgpr_write_b32 a26, v76
  v_accvgpr_write_b32 a27, v78
  s_waitcnt lgkmcnt(8)
  v_mfma_f32_4x4x4_16b_bf16 v[72:75], a[212:213], a[180:181], 0
  v_mfma_f32_4x4x4_16b_bf16 v[76:79], a[214:215], a[182:183], 0
  v_cvt_pk_bf16_f32 v80, v80, v81
  v_cvt_pk_bf16_f32 v82, v82, v83
  v_mfma_f32_16x16x32_bf16 v[36:39], a[12:15], a[192:195], 0
  ds_read_b64_tr_b16 a[156:157], v17 offset:24
  ds_read_b64_tr_b16 a[158:159], v17 offset:792
  v_cvt_pk_bf16_f32 v84, v84, v85
  v_mfma_f32_16x16x32_bf16 v[60:63], a[12:15], a[196:199], 0
  buffer_load_dwordx4 v15, s[12:15], s36 offen offset:1024 lds
  buffer_load_dwordx4 v16, s[12:15], s36 offen offset:2048 lds
  v_accvgpr_write_b32 a28, v80
  v_cvt_pk_bf16_f32 v86, v86, v87
  v_accvgpr_write_b32 a29, v82
  v_accvgpr_write_b32 a30, v84
  v_accvgpr_write_b32 a31, v86
  v_mfma_f32_4x4x4_16b_bf16 v[80:83], a[212:213], a[184:185], 0
  v_mfma_f32_4x4x4_16b_bf16 v[84:87], a[214:215], a[186:187], 0
  v_cvt_pk_bf16_f32 v88, v88, v89
  v_cvt_pk_bf16_f32 v90, v90, v91
  v_mfma_f32_16x16x32_bf16 v[40:43], a[16:19], a[192:195], 0
  ds_read_b64_tr_b16 a[160:161], v17 offset:32
  v_cvt_pk_bf16_f32 v92, v92, v93
  s_add_u32 m0, s34, 73728
  s_add_u32 s36, s36, 12288
  v_mfma_f32_16x16x32_bf16 v[64:67], a[16:19], a[196:199], 0
  ds_read_b64_tr_b16 a[162:163], v17 offset:800
  buffer_load_dwordx4 v14, s[12:15], s36 offen offset:0 lds
  v_accvgpr_write_b32 a32, v88
  v_cvt_pk_bf16_f32 v94, v94, v95
  v_accvgpr_write_b32 a33, v90
  v_accvgpr_write_b32 a34, v92
  v_accvgpr_write_b32 a35, v94
  v_mfma_f32_4x4x4_16b_bf16 v[88:91], a[212:213], a[188:189], 0
  v_mfma_f32_4x4x4_16b_bf16 v[92:95], a[214:215], a[190:191], 0
  v_cvt_pk_bf16_f32 v72, v72, v73
  v_cvt_pk_bf16_f32 v74, v74, v75
  v_mfma_f32_16x16x32_bf16 v[44:47], a[20:23], a[192:195], 0
  ds_read_b64_tr_b16 a[164:165], v17 offset:40
  ds_read_b64_tr_b16 a[166:167], v17 offset:808
  v_cvt_pk_bf16_f32 v76, v76, v77
  v_mfma_f32_16x16x32_bf16 v[68:71], a[20:23], a[196:199], 0
  buffer_load_dwordx4 v15, s[12:15], s36 offen offset:1024 lds
  buffer_load_dwordx4 v16, s[12:15], s36 offen offset:2048 lds
  v_accvgpr_write_b32 a36, v72
  v_cvt_pk_bf16_f32 v78, v78, v79
  v_accvgpr_write_b32 a37, v74
  v_accvgpr_write_b32 a38, v76
  v_accvgpr_write_b32 a39, v78
  s_waitcnt vmcnt(9) lgkmcnt(6)
  v_mfma_f32_4x4x4_16b_bf16 v[72:75], a[216:217], a[144:145], 0
  v_mfma_f32_4x4x4_16b_bf16 v[76:79], a[218:219], a[146:147], 0
  v_cvt_pk_bf16_f32 v80, v80, v81
  v_cvt_pk_bf16_f32 v82, v82, v83
  v_mfma_f32_16x16x32_bf16 v[24:27], a[24:27], a[200:203], v[24:27]
  ds_read_b64_tr_b16 a[168:169], v17 offset:24576
  v_cvt_pk_bf16_f32 v84, v84, v85
  s_add_u32 m0, s34, 76800
  s_add_u32 s36, s36, 12288
  v_mfma_f32_16x16x32_bf16 v[48:51], a[24:27], a[204:207], v[48:51]
  ds_read_b64_tr_b16 a[170:171], v17 offset:25344
  buffer_load_dwordx4 v14, s[12:15], s36 offen offset:0 lds
  v_accvgpr_write_b32 a40, v80
  v_cvt_pk_bf16_f32 v86, v86, v87
  v_accvgpr_write_b32 a41, v82
  v_accvgpr_write_b32 a42, v84
  v_accvgpr_write_b32 a43, v86
  v_mfma_f32_4x4x4_16b_bf16 v[80:83], a[216:217], a[148:149], 0
  v_mfma_f32_4x4x4_16b_bf16 v[84:87], a[218:219], a[150:151], 0
  v_cvt_pk_bf16_f32 v88, v88, v89
  v_cvt_pk_bf16_f32 v90, v90, v91
  v_mfma_f32_16x16x32_bf16 v[28:31], a[28:31], a[200:203], v[28:31]
  ds_read_b64_tr_b16 a[172:173], v17 offset:24584
  ds_read_b128 a[192:195], v9 offset:0
  v_cvt_pk_bf16_f32 v92, v92, v93
  v_mfma_f32_16x16x32_bf16 v[52:55], a[28:31], a[204:207], v[52:55]
  ds_read_b64_tr_b16 a[174:175], v17 offset:25352
  buffer_load_dwordx4 v15, s[12:15], s36 offen offset:1024 lds
  v_accvgpr_write_b32 a44, v88
  v_cvt_pk_bf16_f32 v94, v94, v95
  v_accvgpr_write_b32 a45, v90
  v_accvgpr_write_b32 a46, v92
  v_accvgpr_write_b32 a47, v94
  v_mfma_f32_4x4x4_16b_bf16 v[88:91], a[216:217], a[152:153], 0
  v_mfma_f32_4x4x4_16b_bf16 v[92:95], a[218:219], a[154:155], 0
  v_cvt_pk_bf16_f32 v72, v72, v73
  v_cvt_pk_bf16_f32 v74, v74, v75
  v_mfma_f32_16x16x32_bf16 v[32:35], a[32:35], a[200:203], v[32:35]
  ds_read_b64_tr_b16 a[176:177], v17 offset:24592
  ds_read_b128 a[196:199], v9 offset:12288
  v_cvt_pk_bf16_f32 v76, v76, v77
  v_mfma_f32_16x16x32_bf16 v[56:59], a[32:35], a[204:207], v[56:59]
  ds_read_b64_tr_b16 a[178:179], v17 offset:25360
  buffer_load_dwordx4 v16, s[12:15], s36 offen offset:2048 lds
  v_accvgpr_write_b32 a48, v72
  v_cvt_pk_bf16_f32 v78, v78, v79
  v_accvgpr_write_b32 a49, v74
  v_accvgpr_write_b32 a50, v76
  v_accvgpr_write_b32 a51, v78
  s_waitcnt lgkmcnt(8)
  v_mfma_f32_4x4x4_16b_bf16 v[72:75], a[216:217], a[156:157], 0
  v_mfma_f32_4x4x4_16b_bf16 v[76:79], a[218:219], a[158:159], 0
  v_cvt_pk_bf16_f32 v80, v80, v81
  v_cvt_pk_bf16_f32 v82, v82, v83
  v_mfma_f32_16x16x32_bf16 v[36:39], a[36:39], a[200:203], v[36:39]
  ds_read_b64_tr_b16 a[180:181], v17 offset:24600
  v_cvt_pk_bf16_f32 v84, v84, v85
  s_add_u32 m0, s34, 0
  s_add_u32 s36, s36, 12288
  v_mfma_f32_16x16x32_bf16 v[60:63], a[36:39], a[204:207], v[60:63]
  ds_read_b64_tr_b16 a[182:183], v17 offset:25368
  buffer_load_dwordx4 v14, s[12:15], s36 offen offset:0 lds
  v_accvgpr_write_b32 a52, v80
  v_cvt_pk_bf16_f32 v86, v86, v87
  v_accvgpr_write_b32 a53, v82
  v_accvgpr_write_b32 a54, v84
  v_accvgpr_write_b32 a55, v86
  v_mfma_f32_4x4x4_16b_bf16 v[80:83], a[216:217], a[160:161], 0
  v_mfma_f32_4x4x4_16b_bf16 v[84:87], a[218:219], a[162:163], 0
  v_cvt_pk_bf16_f32 v88, v88, v89
  v_cvt_pk_bf16_f32 v90, v90, v91
  v_mfma_f32_16x16x32_bf16 v[40:43], a[40:43], a[200:203], v[40:43]
  ds_read_b64_tr_b16 a[184:185], v17 offset:24608
  v_cvt_pk_bf16_f32 v92, v92, v93
  v_mfma_f32_16x16x32_bf16 v[64:67], a[40:43], a[204:207], v[64:67]
  ds_read_b64_tr_b16 a[186:187], v17 offset:25376
  buffer_load_dwordx4 v15, s[12:15], s36 offen offset:1024 lds
  v_accvgpr_write_b32 a56, v88
  v_cvt_pk_bf16_f32 v94, v94, v95
  v_accvgpr_write_b32 a57, v90
  v_accvgpr_write_b32 a58, v92
  v_accvgpr_write_b32 a59, v94
  v_mfma_f32_4x4x4_16b_bf16 v[88:91], a[216:217], a[164:165], 0
  v_mfma_f32_4x4x4_16b_bf16 v[92:95], a[218:219], a[166:167], 0
  v_cvt_pk_bf16_f32 v72, v72, v73
  v_cvt_pk_bf16_f32 v74, v74, v75
  v_mfma_f32_16x16x32_bf16 v[44:47], a[44:47], a[200:203], v[44:47]
  ds_read_b64_tr_b16 a[188:189], v17 offset:24616
  v_cvt_pk_bf16_f32 v76, v76, v77
  v_mfma_f32_16x16x32_bf16 v[68:71], a[44:47], a[204:207], v[68:71]
  ds_read_b64_tr_b16 a[190:191], v17 offset:25384
  buffer_load_dwordx4 v16, s[12:15], s36 offen offset:2048 lds
  v_accvgpr_write_b32 a60, v72
  v_cvt_pk_bf16_f32 v78, v78, v79
  v_accvgpr_write_b32 a61, v74
  v_accvgpr_write_b32 a62, v76
  v_accvgpr_write_b32 a63, v78
  s_waitcnt vmcnt(9) lgkmcnt(6)
  v_mfma_f32_4x4x4_16b_bf16 v[72:75], a[220:221], a[168:169], 0
  v_mfma_f32_4x4x4_16b_bf16 v[76:79], a[222:223], a[170:171], 0
  v_cvt_pk_bf16_f32 v80, v80, v81
  v_cvt_pk_bf16_f32 v82, v82, v83
  v_mfma_f32_16x16x32_bf16 v[24:27], a[48:51], a[192:195], v[24:27]
  ds_read_b64_tr_b16 a[144:145], v104 offset:0
  v_cvt_pk_bf16_f32 v84, v84, v85
  s_add_u32 m0, s34, 3072
  s_add_u32 s36, s36, 12288
  v_mfma_f32_16x16x32_bf16 v[48:51], a[48:51], a[196:199], v[48:51]
  ds_read_b64_tr_b16 a[146:147], v104 offset:768
  buffer_load_dwordx4 v14, s[12:15], s36 offen offset:0 lds
  v_accvgpr_write_b32 a64, v80
  v_cvt_pk_bf16_f32 v86, v86, v87
  v_accvgpr_write_b32 a65, v82
  v_accvgpr_write_b32 a66, v84
  v_accvgpr_write_b32 a67, v86
  v_mfma_f32_4x4x4_16b_bf16 v[80:83], a[220:221], a[172:173], 0
  v_mfma_f32_4x4x4_16b_bf16 v[84:87], a[222:223], a[174:175], 0
  v_cvt_pk_bf16_f32 v88, v88, v89
  v_cvt_pk_bf16_f32 v90, v90, v91
  v_mfma_f32_16x16x32_bf16 v[28:31], a[52:55], a[192:195], v[28:31]
  ds_read_b64_tr_b16 a[148:149], v104 offset:8
  ds_read_b128 a[200:203], v10 offset:0
  v_cvt_pk_bf16_f32 v92, v92, v93
  v_mfma_f32_16x16x32_bf16 v[52:55], a[52:55], a[196:199], v[52:55]
  ds_read_b64_tr_b16 a[150:151], v104 offset:776
  buffer_load_dwordx4 v15, s[12:15], s36 offen offset:1024 lds
  buffer_load_dwordx4 v16, s[12:15], s36 offen offset:2048 lds
  v_accvgpr_write_b32 a68, v88
  v_cvt_pk_bf16_f32 v94, v94, v95
  v_accvgpr_write_b32 a69, v90
  v_accvgpr_write_b32 a70, v92
  v_accvgpr_write_b32 a71, v94
  v_mfma_f32_4x4x4_16b_bf16 v[88:91], a[220:221], a[176:177], 0
  v_mfma_f32_4x4x4_16b_bf16 v[92:95], a[222:223], a[178:179], 0
  v_cvt_pk_bf16_f32 v72, v72, v73
  v_cvt_pk_bf16_f32 v74, v74, v75
  v_mfma_f32_16x16x32_bf16 v[32:35], a[56:59], a[192:195], v[32:35]
  ds_read_b64_tr_b16 a[152:153], v104 offset:16
  ds_read_b128 a[204:207], v10 offset:12288
  v_cvt_pk_bf16_f32 v76, v76, v77
  s_add_u32 m0, s34, 24576
  s_add_u32 s36, s36, 12288
  s_waitcnt lgkmcnt(7)
  v_mfma_f32_16x16x32_bf16 v[56:59], a[56:59], a[196:199], v[56:59]
  ds_read_b64_tr_b16 a[154:155], v104 offset:784
  buffer_load_dwordx4 v14, s[12:15], s36 offen offset:0 lds
  v_accvgpr_write_b32 a72, v72
  v_cvt_pk_bf16_f32 v78, v78, v79
  v_accvgpr_write_b32 a73, v74
  v_accvgpr_write_b32 a74, v76
  v_accvgpr_write_b32 a75, v78
  v_mfma_f32_4x4x4_16b_bf16 v[72:75], a[220:221], a[180:181], 0
  v_mfma_f32_4x4x4_16b_bf16 v[76:79], a[222:223], a[182:183], 0
  v_cvt_pk_bf16_f32 v80, v80, v81
  v_cvt_pk_bf16_f32 v82, v82, v83
  v_mfma_f32_16x16x32_bf16 v[36:39], a[60:63], a[192:195], v[36:39]
  ds_read_b64_tr_b16 a[156:157], v104 offset:24
  ds_read_b64_tr_b16 a[158:159], v104 offset:792
  v_cvt_pk_bf16_f32 v84, v84, v85
  v_mfma_f32_16x16x32_bf16 v[60:63], a[60:63], a[196:199], v[60:63]
  buffer_load_dwordx4 v15, s[12:15], s36 offen offset:1024 lds
  buffer_load_dwordx4 v16, s[12:15], s36 offen offset:2048 lds
  v_accvgpr_write_b32 a76, v80
  v_cvt_pk_bf16_f32 v86, v86, v87
  v_accvgpr_write_b32 a77, v82
  v_accvgpr_write_b32 a78, v84
  v_accvgpr_write_b32 a79, v86
  v_mfma_f32_4x4x4_16b_bf16 v[80:83], a[220:221], a[184:185], 0
  v_mfma_f32_4x4x4_16b_bf16 v[84:87], a[222:223], a[186:187], 0
  v_cvt_pk_bf16_f32 v88, v88, v89
  v_cvt_pk_bf16_f32 v90, v90, v91
  v_mfma_f32_16x16x32_bf16 v[40:43], a[64:67], a[192:195], v[40:43]
  ds_read_b64_tr_b16 a[160:161], v104 offset:32
  v_cvt_pk_bf16_f32 v92, v92, v93
  s_add_u32 m0, s34, 27648
  s_add_u32 s36, s36, 12288
  v_mfma_f32_16x16x32_bf16 v[64:67], a[64:67], a[196:199], v[64:67]
  ds_read_b64_tr_b16 a[162:163], v104 offset:800
  buffer_load_dwordx4 v14, s[12:15], s36 offen offset:0 lds
  v_accvgpr_write_b32 a80, v88
  v_cvt_pk_bf16_f32 v94, v94, v95
  v_accvgpr_write_b32 a81, v90
  v_accvgpr_write_b32 a82, v92
  v_accvgpr_write_b32 a83, v94
  v_mfma_f32_4x4x4_16b_bf16 v[88:91], a[220:221], a[188:189], 0
  v_mfma_f32_4x4x4_16b_bf16 v[92:95], a[222:223], a[190:191], 0
  v_cvt_pk_bf16_f32 v72, v72, v73
  v_cvt_pk_bf16_f32 v74, v74, v75
  v_mfma_f32_16x16x32_bf16 v[44:47], a[68:71], a[192:195], v[44:47]
  ds_read_b64_tr_b16 a[164:165], v104 offset:40
  ds_read_b64_tr_b16 a[166:167], v104 offset:808
  v_cvt_pk_bf16_f32 v76, v76, v77
  v_mfma_f32_16x16x32_bf16 v[68:71], a[68:71], a[196:199], v[68:71]
  buffer_load_dwordx4 v15, s[12:15], s36 offen offset:1024 lds
  buffer_load_dwordx4 v16, s[12:15], s36 offen offset:2048 lds
  v_accvgpr_write_b32 a84, v72
  v_cvt_pk_bf16_f32 v78, v78, v79
  v_accvgpr_write_b32 a85, v74
  v_accvgpr_write_b32 a86, v76
  v_accvgpr_write_b32 a87, v78
  s_waitcnt vmcnt(12) lgkmcnt(6)
  v_mfma_f32_4x4x4_16b_bf16 v[72:75], a[224:225], a[144:145], 0
  v_mfma_f32_4x4x4_16b_bf16 v[76:79], a[226:227], a[146:147], 0
  v_cvt_pk_bf16_f32 v80, v80, v81
  v_cvt_pk_bf16_f32 v82, v82, v83
  v_mfma_f32_16x16x32_bf16 v[24:27], a[72:75], a[200:203], v[24:27]
  ds_read_b64_tr_b16 a[168:169], v104 offset:24576
  v_cvt_pk_bf16_f32 v84, v84, v85
  s_add_u32 m0, s34, 49152
  s_add_u32 s36, s36, 12288
  s_waitcnt lgkmcnt(1)
  v_mfma_f32_16x16x32_bf16 v[48:51], a[72:75], a[204:207], v[48:51]
  ds_read_b64_tr_b16 a[170:171], v104 offset:25344
  buffer_load_dwordx4 v14, s[12:15], s36 offen offset:0 lds
  v_accvgpr_write_b32 a88, v80
  v_cvt_pk_bf16_f32 v86, v86, v87
  v_accvgpr_write_b32 a89, v82
  v_accvgpr_write_b32 a90, v84
  v_accvgpr_write_b32 a91, v86
  v_mfma_f32_4x4x4_16b_bf16 v[80:83], a[224:225], a[148:149], 0
  v_mfma_f32_4x4x4_16b_bf16 v[84:87], a[226:227], a[150:151], 0
  v_cvt_pk_bf16_f32 v88, v88, v89
  v_cvt_pk_bf16_f32 v90, v90, v91
  v_mfma_f32_16x16x32_bf16 v[28:31], a[76:79], a[200:203], v[28:31]
  ds_read_b64_tr_b16 a[172:173], v104 offset:24584
  ds_read_b128 a[192:195], v7 offset:256
  v_cvt_pk_bf16_f32 v92, v92, v93
  v_mfma_f32_16x16x32_bf16 v[52:55], a[76:79], a[204:207], v[52:55]
  ds_read_b64_tr_b16 a[174:175], v104 offset:25352
  buffer_load_dwordx4 v15, s[12:15], s36 offen offset:1024 lds
  v_accvgpr_write_b32 a92, v88
  v_cvt_pk_bf16_f32 v94, v94, v95
  v_accvgpr_write_b32 a93, v90
  v_accvgpr_write_b32 a94, v92
  v_accvgpr_write_b32 a95, v94
  v_mfma_f32_4x4x4_16b_bf16 v[88:91], a[224:225], a[152:153], 0
  v_mfma_f32_4x4x4_16b_bf16 v[92:95], a[226:227], a[154:155], 0
  v_cvt_pk_bf16_f32 v72, v72, v73
  v_cvt_pk_bf16_f32 v74, v74, v75
  v_mfma_f32_16x16x32_bf16 v[32:35], a[80:83], a[200:203], v[32:35]
  ds_read_b64_tr_b16 a[176:177], v104 offset:24592
  ds_read_b128 a[196:199], v7 offset:12544
  v_cvt_pk_bf16_f32 v76, v76, v77
  v_mfma_f32_16x16x32_bf16 v[56:59], a[80:83], a[204:207], v[56:59]
  ds_read_b64_tr_b16 a[178:179], v104 offset:25360
  buffer_load_dwordx4 v16, s[12:15], s36 offen offset:2048 lds
  v_accvgpr_write_b32 a96, v72
  v_cvt_pk_bf16_f32 v78, v78, v79
  v_accvgpr_write_b32 a97, v74
  v_accvgpr_write_b32 a98, v76
  v_accvgpr_write_b32 a99, v78
  v_mfma_f32_4x4x4_16b_bf16 v[72:75], a[224:225], a[156:157], 0
  v_mfma_f32_4x4x4_16b_bf16 v[76:79], a[226:227], a[158:159], 0
  v_cvt_pk_bf16_f32 v80, v80, v81
  v_cvt_pk_bf16_f32 v82, v82, v83
  v_mfma_f32_16x16x32_bf16 v[36:39], a[84:87], a[200:203], v[36:39]
  ds_read_b64_tr_b16 a[180:181], v104 offset:24600
  v_cvt_pk_bf16_f32 v84, v84, v85
  s_add_u32 m0, s34, 52224
  s_add_u32 s36, s36, 12288
  v_mfma_f32_16x16x32_bf16 v[60:63], a[84:87], a[204:207], v[60:63]
  ds_read_b64_tr_b16 a[182:183], v104 offset:25368
  buffer_load_dwordx4 v14, s[12:15], s36 offen offset:0 lds
  v_accvgpr_write_b32 a100, v80
  v_cvt_pk_bf16_f32 v86, v86, v87
  v_accvgpr_write_b32 a101, v82
  v_accvgpr_write_b32 a102, v84
  v_accvgpr_write_b32 a103, v86
  v_mfma_f32_4x4x4_16b_bf16 v[80:83], a[224:225], a[160:161], 0
  v_mfma_f32_4x4x4_16b_bf16 v[84:87], a[226:227], a[162:163], 0
  v_cvt_pk_bf16_f32 v88, v88, v89
  v_cvt_pk_bf16_f32 v90, v90, v91
  v_mfma_f32_16x16x32_bf16 v[40:43], a[88:91], a[200:203], v[40:43]
  ds_read_b64_tr_b16 a[184:185], v104 offset:24608
  v_cvt_pk_bf16_f32 v92, v92, v93
  v_mfma_f32_16x16x32_bf16 v[64:67], a[88:91], a[204:207], v[64:67]
  ds_read_b64_tr_b16 a[186:187], v104 offset:25376
  buffer_load_dwordx4 v15, s[12:15], s36 offen offset:1024 lds
  v_accvgpr_write_b32 a104, v88
  v_cvt_pk_bf16_f32 v94, v94, v95
  v_accvgpr_write_b32 a105, v90
  v_accvgpr_write_b32 a106, v92
  v_accvgpr_write_b32 a107, v94
  v_mfma_f32_4x4x4_16b_bf16 v[88:91], a[224:225], a[164:165], 0
  v_mfma_f32_4x4x4_16b_bf16 v[92:95], a[226:227], a[166:167], 0
  v_cvt_pk_bf16_f32 v72, v72, v73
  v_cvt_pk_bf16_f32 v74, v74, v75
  v_mfma_f32_16x16x32_bf16 v[44:47], a[92:95], a[200:203], v[44:47]
  ds_read_b64_tr_b16 a[188:189], v104 offset:24616
  v_cvt_pk_bf16_f32 v76, v76, v77
  v_mfma_f32_16x16x32_bf16 v[68:71], a[92:95], a[204:207], v[68:71]
  ds_read_b64_tr_b16 a[190:191], v104 offset:25384
  buffer_load_dwordx4 v16, s[12:15], s36 offen offset:2048 lds
  v_accvgpr_write_b32 a108, v72
  v_cvt_pk_bf16_f32 v78, v78, v79
  v_accvgpr_write_b32 a109, v74
  v_accvgpr_write_b32 a110, v76
  v_accvgpr_write_b32 a111, v78
  s_waitcnt vmcnt(12) lgkmcnt(6)
  v_mfma_f32_4x4x4_16b_bf16 v[72:75], a[228:229], a[168:169], 0
  v_mfma_f32_4x4x4_16b_bf16 v[76:79], a[230:231], a[170:171], 0
  v_cvt_pk_bf16_f32 v80, v80, v81
  v_cvt_pk_bf16_f32 v82, v82, v83
  v_mfma_f32_16x16x32_bf16 v[24:27], a[96:99], a[192:195], v[24:27]
  ds_read_b64_tr_b16 a[144:145], v17 offset:0
  v_cvt_pk_bf16_f32 v84, v84, v85
  s_add_u32 m0, s34, 73728
  s_add_u32 s36, s36, 12288
  s_waitcnt lgkmcnt(1)
  v_mfma_f32_16x16x32_bf16 v[48:51], a[96:99], a[196:199], v[48:51]
  ds_read_b64_tr_b16 a[146:147], v17 offset:768
  buffer_load_dwordx4 v14, s[12:15], s36 offen offset:0 lds
  v_accvgpr_write_b32 a112, v80
  v_cvt_pk_bf16_f32 v86, v86, v87
  v_accvgpr_write_b32 a113, v82
  v_accvgpr_write_b32 a114, v84
  v_accvgpr_write_b32 a115, v86
  v_mfma_f32_4x4x4_16b_bf16 v[80:83], a[228:229], a[172:173], 0
  v_mfma_f32_4x4x4_16b_bf16 v[84:87], a[230:231], a[174:175], 0
  v_cvt_pk_bf16_f32 v88, v88, v89
  v_cvt_pk_bf16_f32 v90, v90, v91
  v_mfma_f32_16x16x32_bf16 v[28:31], a[100:103], a[192:195], v[28:31]
  ds_read_b64_tr_b16 a[148:149], v17 offset:8
  ds_read_b128 a[200:203], v8 offset:256
  v_cvt_pk_bf16_f32 v92, v92, v93
  v_mfma_f32_16x16x32_bf16 v[52:55], a[100:103], a[196:199], v[52:55]
  ds_read_b64_tr_b16 a[150:151], v17 offset:776
  buffer_load_dwordx4 v15, s[12:15], s36 offen offset:1024 lds
  v_accvgpr_write_b32 a116, v88
  v_cvt_pk_bf16_f32 v94, v94, v95
  v_accvgpr_write_b32 a117, v90
  v_accvgpr_write_b32 a118, v92
  v_accvgpr_write_b32 a119, v94
  v_mfma_f32_4x4x4_16b_bf16 v[88:91], a[228:229], a[176:177], 0
  v_mfma_f32_4x4x4_16b_bf16 v[92:95], a[230:231], a[178:179], 0
  v_cvt_pk_bf16_f32 v72, v72, v73
  v_cvt_pk_bf16_f32 v74, v74, v75
  v_mfma_f32_16x16x32_bf16 v[32:35], a[104:107], a[192:195], v[32:35]
  ds_read_b64_tr_b16 a[152:153], v17 offset:16
  ds_read_b128 a[204:207], v8 offset:12544
  v_cvt_pk_bf16_f32 v76, v76, v77
  v_mfma_f32_16x16x32_bf16 v[56:59], a[104:107], a[196:199], v[56:59]
  ds_read_b64_tr_b16 a[154:155], v17 offset:784
  buffer_load_dwordx4 v16, s[12:15], s36 offen offset:2048 lds
  v_accvgpr_write_b32 a120, v72
  v_cvt_pk_bf16_f32 v78, v78, v79
  v_accvgpr_write_b32 a121, v74
  v_accvgpr_write_b32 a122, v76
  v_accvgpr_write_b32 a123, v78
  v_mfma_f32_4x4x4_16b_bf16 v[72:75], a[228:229], a[180:181], 0
  v_mfma_f32_4x4x4_16b_bf16 v[76:79], a[230:231], a[182:183], 0
  v_cvt_pk_bf16_f32 v80, v80, v81
  v_cvt_pk_bf16_f32 v82, v82, v83
  v_mfma_f32_16x16x32_bf16 v[36:39], a[108:111], a[192:195], v[36:39]
  ds_read_b64_tr_b16 a[156:157], v17 offset:24
  v_cvt_pk_bf16_f32 v84, v84, v85
  s_add_u32 m0, s34, 76800
  s_add_u32 s36, s36, 12288
  v_mfma_f32_16x16x32_bf16 v[60:63], a[108:111], a[196:199], v[60:63]
  ds_read_b64_tr_b16 a[158:159], v17 offset:792
  buffer_load_dwordx4 v14, s[12:15], s36 offen offset:0 lds
  v_accvgpr_write_b32 a124, v80
  v_cvt_pk_bf16_f32 v86, v86, v87
  v_accvgpr_write_b32 a125, v82
  v_accvgpr_write_b32 a126, v84
  v_accvgpr_write_b32 a127, v86
  v_mfma_f32_4x4x4_16b_bf16 v[80:83], a[228:229], a[184:185], 0
  v_mfma_f32_4x4x4_16b_bf16 v[84:87], a[230:231], a[186:187], 0
  v_cvt_pk_bf16_f32 v88, v88, v89
  v_cvt_pk_bf16_f32 v90, v90, v91
  v_mfma_f32_16x16x32_bf16 v[40:43], a[112:115], a[192:195], v[40:43]
  ds_read_b64_tr_b16 a[160:161], v17 offset:32
  v_cvt_pk_bf16_f32 v92, v92, v93
  v_mfma_f32_16x16x32_bf16 v[64:67], a[112:115], a[196:199], v[64:67]
  ds_read_b64_tr_b16 a[162:163], v17 offset:800
  buffer_load_dwordx4 v15, s[12:15], s36 offen offset:1024 lds
  v_accvgpr_write_b32 a128, v88
  v_cvt_pk_bf16_f32 v94, v94, v95
  v_accvgpr_write_b32 a129, v90
  v_accvgpr_write_b32 a130, v92
  v_accvgpr_write_b32 a131, v94
  v_mfma_f32_4x4x4_16b_bf16 v[88:91], a[228:229], a[188:189], 0
  v_mfma_f32_4x4x4_16b_bf16 v[92:95], a[230:231], a[190:191], 0
  v_cvt_pk_bf16_f32 v72, v72, v73
  v_cvt_pk_bf16_f32 v74, v74, v75
  v_mfma_f32_16x16x32_bf16 v[44:47], a[116:119], a[192:195], v[44:47]
  ds_read_b64_tr_b16 a[164:165], v17 offset:40
  v_cvt_pk_bf16_f32 v76, v76, v77
  v_mfma_f32_16x16x32_bf16 v[68:71], a[116:119], a[196:199], v[68:71]
  ds_read_b64_tr_b16 a[166:167], v17 offset:808
  buffer_load_dwordx4 v16, s[12:15], s36 offen offset:2048 lds
  v_accvgpr_write_b32 a132, v72
  v_cvt_pk_bf16_f32 v78, v78, v79
  v_accvgpr_write_b32 a133, v74
  v_accvgpr_write_b32 a134, v76
  v_accvgpr_write_b32 a135, v78
  s_waitcnt vmcnt(12) lgkmcnt(6)
  v_mfma_f32_4x4x4_16b_bf16 v[72:75], a[232:233], a[144:145], 0
  v_mfma_f32_4x4x4_16b_bf16 v[76:79], a[234:235], a[146:147], 0
  v_cvt_pk_bf16_f32 v80, v80, v81
  v_cvt_pk_bf16_f32 v82, v82, v83
  v_mfma_f32_16x16x32_bf16 v[24:27], a[120:123], a[200:203], v[24:27]
  ds_read_b64_tr_b16 a[168:169], v17 offset:24576
  v_cvt_pk_bf16_f32 v84, v84, v85
  s_add_u32 m0, s34, 0
  s_add_u32 s36, s36, 12288
  s_waitcnt lgkmcnt(1)
  v_mfma_f32_16x16x32_bf16 v[48:51], a[120:123], a[204:207], v[48:51]
  ds_read_b64_tr_b16 a[170:171], v17 offset:25344
  buffer_load_dwordx4 v14, s[12:15], s36 offen offset:0 lds
  v_accvgpr_write_b32 a136, v80
  v_cvt_pk_bf16_f32 v86, v86, v87
  v_accvgpr_write_b32 a137, v82
  v_accvgpr_write_b32 a138, v84
  v_accvgpr_write_b32 a139, v86
  v_mfma_f32_4x4x4_16b_bf16 v[80:83], a[232:233], a[148:149], 0
  v_mfma_f32_4x4x4_16b_bf16 v[84:87], a[234:235], a[150:151], 0
  v_cvt_pk_bf16_f32 v88, v88, v89
  v_cvt_pk_bf16_f32 v90, v90, v91
  v_mfma_f32_16x16x32_bf16 v[28:31], a[124:127], a[200:203], v[28:31]
  ds_read_b64_tr_b16 a[172:173], v17 offset:24584
  ds_read_b128 a[192:195], v9 offset:256
  v_cvt_pk_bf16_f32 v92, v92, v93
  v_mfma_f32_16x16x32_bf16 v[52:55], a[124:127], a[204:207], v[52:55]
  ds_read_b64_tr_b16 a[174:175], v17 offset:25352
  buffer_load_dwordx4 v15, s[12:15], s36 offen offset:1024 lds
  v_accvgpr_write_b32 a140, v88
  v_cvt_pk_bf16_f32 v94, v94, v95
  v_accvgpr_write_b32 a141, v90
  v_accvgpr_write_b32 a142, v92
  v_accvgpr_write_b32 a143, v94
  v_mfma_f32_4x4x4_16b_bf16 v[88:91], a[232:233], a[152:153], 0
  v_mfma_f32_4x4x4_16b_bf16 v[92:95], a[234:235], a[154:155], 0
  v_cvt_pk_bf16_f32 v112, v72, v73
  v_cvt_pk_bf16_f32 v113, v74, v75
  v_mfma_f32_16x16x32_bf16 v[32:35], a[128:131], a[200:203], v[32:35]
  ds_read_b64_tr_b16 a[176:177], v17 offset:24592
  ds_read_b128 a[196:199], v9 offset:12544
  v_cvt_pk_bf16_f32 v114, v76, v77
  v_mfma_f32_16x16x32_bf16 v[56:59], a[128:131], a[204:207], v[56:59]
  ds_read_b64_tr_b16 a[178:179], v17 offset:25360
  buffer_load_dwordx4 v16, s[12:15], s36 offen offset:2048 lds
  v_cvt_pk_bf16_f32 v115, v78, v79
  v_mfma_f32_4x4x4_16b_bf16 v[72:75], a[232:233], a[156:157], 0
  v_mfma_f32_4x4x4_16b_bf16 v[76:79], a[234:235], a[158:159], 0
  v_cvt_pk_bf16_f32 v116, v80, v81
  v_cvt_pk_bf16_f32 v117, v82, v83
  v_mfma_f32_16x16x32_bf16 v[36:39], a[132:135], a[200:203], v[36:39]
  ds_read_b64_tr_b16 a[180:181], v17 offset:24600
  v_cvt_pk_bf16_f32 v118, v84, v85
  s_add_u32 m0, s34, 3072
  s_add_u32 s36, s36, 12288
  v_mfma_f32_16x16x32_bf16 v[60:63], a[132:135], a[204:207], v[60:63]
  ds_read_b64_tr_b16 a[182:183], v17 offset:25368
  buffer_load_dwordx4 v14, s[12:15], s36 offen offset:0 lds
  v_cvt_pk_bf16_f32 v119, v86, v87
  v_mfma_f32_4x4x4_16b_bf16 v[80:83], a[232:233], a[160:161], 0
  v_mfma_f32_4x4x4_16b_bf16 v[84:87], a[234:235], a[162:163], 0
  v_cvt_pk_bf16_f32 v120, v88, v89
  v_cvt_pk_bf16_f32 v121, v90, v91
  v_mfma_f32_16x16x32_bf16 v[40:43], a[136:139], a[200:203], v[40:43]
  ds_read_b64_tr_b16 a[184:185], v17 offset:24608
  v_cvt_pk_bf16_f32 v122, v92, v93
  v_mfma_f32_16x16x32_bf16 v[64:67], a[136:139], a[204:207], v[64:67]
  ds_read_b64_tr_b16 a[186:187], v17 offset:25376
  buffer_load_dwordx4 v15, s[12:15], s36 offen offset:1024 lds
  v_cvt_pk_bf16_f32 v123, v94, v95
  v_mfma_f32_4x4x4_16b_bf16 v[88:91], a[232:233], a[164:165], 0
  v_mfma_f32_4x4x4_16b_bf16 v[92:95], a[234:235], a[166:167], 0
  v_cvt_pk_bf16_f32 v124, v72, v73
  v_cvt_pk_bf16_f32 v125, v74, v75
  v_mfma_f32_16x16x32_bf16 v[44:47], a[140:143], a[200:203], v[44:47]
  ds_read_b64_tr_b16 a[188:189], v17 offset:24616
  v_cvt_pk_bf16_f32 v126, v76, v77
  v_mfma_f32_16x16x32_bf16 v[68:71], a[140:143], a[204:207], v[68:71]
  ds_read_b64_tr_b16 a[190:191], v17 offset:25384
  buffer_load_dwordx4 v16, s[12:15], s36 offen offset:2048 lds
  v_cvt_pk_bf16_f32 v127, v78, v79
  s_waitcnt vmcnt(12) lgkmcnt(6)
  v_mfma_f32_4x4x4_16b_bf16 v[72:75], a[236:237], a[168:169], 0
  v_mfma_f32_4x4x4_16b_bf16 v[76:79], a[238:239], a[170:171], 0
  v_cvt_pk_bf16_f32 v128, v80, v81
  v_cvt_pk_bf16_f32 v129, v82, v83
  v_mfma_f32_16x16x32_bf16 v[24:27], v[112:115], a[192:195], v[24:27]
  ds_read_b64_tr_b16 a[144:145], v104 offset:0
  v_cvt_pk_bf16_f32 v130, v84, v85
  s_add_u32 m0, s34, 24576
  s_add_u32 s36, s36, 12288
  s_waitcnt lgkmcnt(1)
  v_mfma_f32_16x16x32_bf16 v[48:51], v[112:115], a[196:199], v[48:51]
  ds_read_b64_tr_b16 a[146:147], v104 offset:768
  buffer_load_dwordx4 v14, s[12:15], s36 offen offset:0 lds
  v_cvt_pk_bf16_f32 v131, v86, v87
  v_mfma_f32_4x4x4_16b_bf16 v[80:83], a[236:237], a[172:173], 0
  v_mfma_f32_4x4x4_16b_bf16 v[84:87], a[238:239], a[174:175], 0
  v_cvt_pk_bf16_f32 v132, v88, v89
  v_cvt_pk_bf16_f32 v133, v90, v91
  v_mfma_f32_16x16x32_bf16 v[28:31], v[116:119], a[192:195], v[28:31]
  ds_read_b64_tr_b16 a[148:149], v104 offset:8
  ds_read_b128 a[200:203], v10 offset:256
  v_cvt_pk_bf16_f32 v134, v92, v93
  v_mfma_f32_16x16x32_bf16 v[52:55], v[116:119], a[196:199], v[52:55]
  ds_read_b64_tr_b16 a[150:151], v104 offset:776
  buffer_load_dwordx4 v15, s[12:15], s36 offen offset:1024 lds
  v_cvt_pk_bf16_f32 v135, v94, v95
  v_mfma_f32_4x4x4_16b_bf16 v[88:91], a[236:237], a[176:177], 0
  v_mfma_f32_4x4x4_16b_bf16 v[92:95], a[238:239], a[178:179], 0
  v_cvt_pk_bf16_f32 v136, v72, v73
  v_cvt_pk_bf16_f32 v137, v74, v75
  v_mfma_f32_16x16x32_bf16 v[32:35], v[120:123], a[192:195], v[32:35]
  ds_read_b64_tr_b16 a[152:153], v104 offset:16
  ds_read_b128 a[204:207], v10 offset:12544
  v_cvt_pk_bf16_f32 v138, v76, v77
  v_mfma_f32_16x16x32_bf16 v[56:59], v[120:123], a[196:199], v[56:59]
  ds_read_b64_tr_b16 a[154:155], v104 offset:784
  buffer_load_dwordx4 v16, s[12:15], s36 offen offset:2048 lds
  v_cvt_pk_bf16_f32 v139, v78, v79
  v_mfma_f32_4x4x4_16b_bf16 v[72:75], a[236:237], a[180:181], 0
  v_mfma_f32_4x4x4_16b_bf16 v[76:79], a[238:239], a[182:183], 0
  v_cvt_pk_bf16_f32 v140, v80, v81
  v_cvt_pk_bf16_f32 v141, v82, v83
  v_mfma_f32_16x16x32_bf16 v[36:39], v[124:127], a[192:195], v[36:39]
  ds_read_b64_tr_b16 a[156:157], v104 offset:24
  v_cvt_pk_bf16_f32 v142, v84, v85
  s_add_u32 m0, s34, 27648
  s_add_u32 s36, s36, 12288
  v_mfma_f32_16x16x32_bf16 v[60:63], v[124:127], a[196:199], v[60:63]
  ds_read_b64_tr_b16 a[158:159], v104 offset:792
  buffer_load_dwordx4 v14, s[12:15], s36 offen offset:0 lds
  v_cvt_pk_bf16_f32 v143, v86, v87
  v_mfma_f32_4x4x4_16b_bf16 v[80:83], a[236:237], a[184:185], 0
  v_mfma_f32_4x4x4_16b_bf16 v[84:87], a[238:239], a[186:187], 0
  v_cvt_pk_bf16_f32 v144, v88, v89
  v_cvt_pk_bf16_f32 v145, v90, v91
  v_mfma_f32_16x16x32_bf16 v[40:43], v[128:131], a[192:195], v[40:43]
  ds_read_b64_tr_b16 a[160:161], v104 offset:32
  v_cvt_pk_bf16_f32 v146, v92, v93
  v_mfma_f32_16x16x32_bf16 v[64:67], v[128:131], a[196:199], v[64:67]
  ds_read_b64_tr_b16 a[162:163], v104 offset:800
  buffer_load_dwordx4 v15, s[12:15], s36 offen offset:1024 lds
  v_cvt_pk_bf16_f32 v147, v94, v95
  v_mfma_f32_4x4x4_16b_bf16 v[88:91], a[236:237], a[188:189], 0
  v_mfma_f32_4x4x4_16b_bf16 v[92:95], a[238:239], a[190:191], 0
  v_cvt_pk_bf16_f32 v148, v72, v73
  v_cvt_pk_bf16_f32 v149, v74, v75
  v_mfma_f32_16x16x32_bf16 v[44:47], v[132:135], a[192:195], v[44:47]
  ds_read_b64_tr_b16 a[164:165], v104 offset:40
  v_cvt_pk_bf16_f32 v150, v76, v77
  v_mfma_f32_16x16x32_bf16 v[68:71], v[132:135], a[196:199], v[68:71]
  ds_read_b64_tr_b16 a[166:167], v104 offset:808
  buffer_load_dwordx4 v16, s[12:15], s36 offen offset:2048 lds
  v_cvt_pk_bf16_f32 v151, v78, v79
  s_waitcnt vmcnt(12) lgkmcnt(6)
  v_mfma_f32_4x4x4_16b_bf16 v[72:75], a[240:241], a[144:145], 0
  v_mfma_f32_4x4x4_16b_bf16 v[76:79], a[242:243], a[146:147], 0
  v_cvt_pk_bf16_f32 v152, v80, v81
  v_cvt_pk_bf16_f32 v153, v82, v83
  v_mfma_f32_16x16x32_bf16 v[24:27], v[136:139], a[200:203], v[24:27]
  ds_read_b64_tr_b16 a[168:169], v104 offset:24576
  v_cvt_pk_bf16_f32 v154, v84, v85
  s_add_u32 m0, s33, 122880
  v_mfma_f32_16x16x32_bf16 v[48:51], v[136:139], a[204:207], v[48:51]
  ds_read_b64_tr_b16 a[170:171], v104 offset:25344
  buffer_load_dwordx4 v1, s[4:7], s21 offen nt lds
  v_cvt_pk_bf16_f32 v155, v86, v87
  v_mfma_f32_4x4x4_16b_bf16 v[80:83], a[240:241], a[148:149], 0
  v_mfma_f32_4x4x4_16b_bf16 v[84:87], a[242:243], a[150:151], 0
  v_cvt_pk_bf16_f32 v156, v88, v89
  v_cvt_pk_bf16_f32 v157, v90, v91
  v_mfma_f32_16x16x32_bf16 v[28:31], v[140:143], a[200:203], v[28:31]
  ds_read_b64_tr_b16 a[172:173], v104 offset:24584
  ds_read_b128 a[192:195], v7 offset:512
  v_cvt_pk_bf16_f32 v158, v92, v93
  s_add_u32 m0, s33, 126976
  v_mfma_f32_16x16x32_bf16 v[52:55], v[140:143], a[204:207], v[52:55]
  ds_read_b64_tr_b16 a[174:175], v104 offset:25352
  buffer_load_dwordx4 v2, s[4:7], s21 offen nt lds
  v_cvt_pk_bf16_f32 v159, v94, v95
  v_mfma_f32_4x4x4_16b_bf16 v[88:91], a[240:241], a[152:153], 0
  v_mfma_f32_4x4x4_16b_bf16 v[92:95], a[242:243], a[154:155], 0
  v_cvt_pk_bf16_f32 v160, v72, v73
  v_cvt_pk_bf16_f32 v161, v74, v75
  v_mfma_f32_16x16x32_bf16 v[32:35], v[144:147], a[200:203], v[32:35]
  ds_read_b64_tr_b16 a[176:177], v104 offset:24592
  ds_read_b128 a[196:199], v7 offset:12800
  v_cvt_pk_bf16_f32 v162, v76, v77
  s_add_u32 m0, s33, 131072
  v_mfma_f32_16x16x32_bf16 v[56:59], v[144:147], a[204:207], v[56:59]
  ds_read_b64_tr_b16 a[178:179], v104 offset:25360
  buffer_load_dwordx4 v3, s[4:7], s21 offen nt lds
  v_cvt_pk_bf16_f32 v163, v78, v79
  s_waitcnt lgkmcnt(8)
  v_mfma_f32_4x4x4_16b_bf16 v[72:75], a[240:241], a[156:157], 0
  v_mfma_f32_4x4x4_16b_bf16 v[76:79], a[242:243], a[158:159], 0
  v_cvt_pk_bf16_f32 v164, v80, v81
  v_cvt_pk_bf16_f32 v165, v82, v83
  v_mfma_f32_16x16x32_bf16 v[36:39], v[148:151], a[200:203], v[36:39]
  ds_read_b64_tr_b16 a[180:181], v104 offset:24600
  v_cvt_pk_bf16_f32 v166, v84, v85
  s_add_u32 m0, s33, 135168
  s_add_u32 s21, s21, 6291456
  v_mfma_f32_16x16x32_bf16 v[60:63], v[148:151], a[204:207], v[60:63]
  ds_read_b64_tr_b16 a[182:183], v104 offset:25368
  buffer_load_dwordx4 v1, s[4:7], s37 offen nt lds
  v_cvt_pk_bf16_f32 v167, v86, v87
  v_mfma_f32_4x4x4_16b_bf16 v[80:83], a[240:241], a[160:161], 0
  v_mfma_f32_4x4x4_16b_bf16 v[84:87], a[242:243], a[162:163], 0
  v_cvt_pk_bf16_f32 v168, v88, v89
  v_cvt_pk_bf16_f32 v169, v90, v91
  v_mfma_f32_16x16x32_bf16 v[40:43], v[152:155], a[200:203], v[40:43]
  ds_read_b64_tr_b16 a[184:185], v104 offset:24608
  v_cvt_pk_bf16_f32 v170, v92, v93
  s_add_u32 m0, s33, 139264
  v_mfma_f32_16x16x32_bf16 v[64:67], v[152:155], a[204:207], v[64:67]
  ds_read_b64_tr_b16 a[186:187], v104 offset:25376
  buffer_load_dwordx4 v2, s[4:7], s37 offen nt lds
  v_cvt_pk_bf16_f32 v171, v94, v95
  v_mfma_f32_4x4x4_16b_bf16 v[88:91], a[240:241], a[164:165], 0
  v_mfma_f32_4x4x4_16b_bf16 v[92:95], a[242:243], a[166:167], 0
  v_cvt_pk_bf16_f32 v172, v72, v73
  v_cvt_pk_bf16_f32 v173, v74, v75
  v_mfma_f32_16x16x32_bf16 v[44:47], v[156:159], a[200:203], v[44:47]
  ds_read_b64_tr_b16 a[188:189], v104 offset:24616
  v_cvt_pk_bf16_f32 v174, v76, v77
  s_add_u32 m0, s33, 143360
  v_mfma_f32_16x16x32_bf16 v[68:71], v[156:159], a[204:207], v[68:71]
  ds_read_b64_tr_b16 a[190:191], v104 offset:25384
  buffer_load_dwordx4 v3, s[4:7], s37 offen nt lds
  s_add_u32 s37, s37, 6291456
  v_cvt_pk_bf16_f32 v175, v78, v79
  s_waitcnt vmcnt(12) lgkmcnt(6)
  v_mfma_f32_4x4x4_16b_bf16 v[72:75], a[244:245], a[168:169], 0
  v_mfma_f32_4x4x4_16b_bf16 v[76:79], a[246:247], a[170:171], 0
  v_cvt_pk_bf16_f32 v176, v80, v81
  v_cvt_pk_bf16_f32 v177, v82, v83
  v_mfma_f32_16x16x32_bf16 v[24:27], v[160:163], a[192:195], v[24:27]
  ds_read_b64_tr_b16 a[144:145], v17 offset:0
  v_cvt_pk_bf16_f32 v178, v84, v85
  v_mfma_f32_16x16x32_bf16 v[48:51], v[160:163], a[196:199], v[48:51]
  ds_read_b64_tr_b16 a[146:147], v17 offset:768
  v_cvt_pk_bf16_f32 v179, v86, v87
  v_mfma_f32_4x4x4_16b_bf16 v[80:83], a[244:245], a[172:173], 0
  v_mfma_f32_4x4x4_16b_bf16 v[84:87], a[246:247], a[174:175], 0
  v_cvt_pk_bf16_f32 v180, v88, v89
  v_cvt_pk_bf16_f32 v181, v90, v91
  v_mfma_f32_16x16x32_bf16 v[28:31], v[164:167], a[192:195], v[28:31]
  ds_read_b64_tr_b16 a[148:149], v17 offset:8
  v_cvt_pk_bf16_f32 v182, v92, v93
  v_mfma_f32_16x16x32_bf16 v[52:55], v[164:167], a[196:199], v[52:55]
  ds_read_b128 a[200:203], v8 offset:512
  ds_read_b64_tr_b16 a[150:151], v17 offset:776
  v_cvt_pk_bf16_f32 v183, v94, v95
  v_mfma_f32_4x4x4_16b_bf16 v[88:91], a[244:245], a[176:177], 0
  v_mfma_f32_4x4x4_16b_bf16 v[92:95], a[246:247], a[178:179], 0
  v_cvt_pk_bf16_f32 v184, v72, v73
  v_cvt_pk_bf16_f32 v185, v74, v75
  v_mfma_f32_16x16x32_bf16 v[32:35], v[168:171], a[192:195], v[32:35]
  ds_read_b64_tr_b16 a[152:153], v17 offset:16
  v_cvt_pk_bf16_f32 v186, v76, v77
  v_mfma_f32_16x16x32_bf16 v[56:59], v[168:171], a[196:199], v[56:59]
  ds_read_b128 a[204:207], v8 offset:12800
  ds_read_b64_tr_b16 a[154:155], v17 offset:784
  v_cvt_pk_bf16_f32 v187, v78, v79
  s_waitcnt lgkmcnt(8)
  v_mfma_f32_4x4x4_16b_bf16 v[72:75], a[244:245], a[180:181], 0
  v_mfma_f32_4x4x4_16b_bf16 v[76:79], a[246:247], a[182:183], 0
  v_cvt_pk_bf16_f32 v188, v80, v81
  v_cvt_pk_bf16_f32 v189, v82, v83
  v_mfma_f32_16x16x32_bf16 v[36:39], v[172:175], a[192:195], v[36:39]
  ds_read_b64_tr_b16 a[156:157], v17 offset:24
  v_cvt_pk_bf16_f32 v190, v84, v85
  v_mfma_f32_16x16x32_bf16 v[60:63], v[172:175], a[196:199], v[60:63]
  ds_read_b64_tr_b16 a[158:159], v17 offset:792
  v_cvt_pk_bf16_f32 v191, v86, v87
  v_mfma_f32_4x4x4_16b_bf16 v[80:83], a[244:245], a[184:185], 0
  v_mfma_f32_4x4x4_16b_bf16 v[84:87], a[246:247], a[186:187], 0
  v_cvt_pk_bf16_f32 v192, v88, v89
  v_cvt_pk_bf16_f32 v193, v90, v91
  v_mfma_f32_16x16x32_bf16 v[40:43], v[176:179], a[192:195], v[40:43]
  ds_read_b64_tr_b16 a[160:161], v17 offset:32
  v_cvt_pk_bf16_f32 v194, v92, v93
  v_mfma_f32_16x16x32_bf16 v[64:67], v[176:179], a[196:199], v[64:67]
  ds_read_b64_tr_b16 a[162:163], v17 offset:800
  v_cvt_pk_bf16_f32 v195, v94, v95
  v_mfma_f32_4x4x4_16b_bf16 v[88:91], a[244:245], a[188:189], 0
  v_mfma_f32_4x4x4_16b_bf16 v[92:95], a[246:247], a[190:191], 0
  v_cvt_pk_bf16_f32 v196, v72, v73
  v_cvt_pk_bf16_f32 v197, v74, v75
  v_mfma_f32_16x16x32_bf16 v[44:47], v[180:183], a[192:195], v[44:47]
  ds_read_b64_tr_b16 a[164:165], v17 offset:40
  v_cvt_pk_bf16_f32 v198, v76, v77
  v_mfma_f32_16x16x32_bf16 v[68:71], v[180:183], a[196:199], v[68:71]
  ds_read_b64_tr_b16 a[166:167], v17 offset:808
  v_cvt_pk_bf16_f32 v199, v78, v79
  s_waitcnt lgkmcnt(0)
  s_barrier
  s_waitcnt vmcnt(6)
  v_mfma_f32_4x4x4_16b_bf16 v[72:75], a[248:249], a[144:145], 0
  v_mfma_f32_4x4x4_16b_bf16 v[76:79], a[250:251], a[146:147], 0
  v_cvt_pk_bf16_f32 v200, v80, v81
  v_cvt_pk_bf16_f32 v201, v82, v83
  v_mfma_f32_16x16x32_bf16 v[24:27], v[184:187], a[200:203], v[24:27]
  ds_read_b64_tr_b16 a[168:169], v17 offset:24576
  v_cvt_pk_bf16_f32 v202, v84, v85
  s_add_u32 m0, s33, 49152
  v_mfma_f32_16x16x32_bf16 v[48:51], v[184:187], a[204:207], v[48:51]
  ds_read_b64_tr_b16 a[170:171], v17 offset:25344
  buffer_load_dwordx4 v1, s[4:7], s21 offen nt lds
  v_cvt_pk_bf16_f32 v203, v86, v87
  v_mfma_f32_4x4x4_16b_bf16 v[80:83], a[248:249], a[148:149], 0
  v_mfma_f32_4x4x4_16b_bf16 v[84:87], a[250:251], a[150:151], 0
  v_cvt_pk_bf16_f32 v204, v88, v89
  v_cvt_pk_bf16_f32 v205, v90, v91
  v_mfma_f32_16x16x32_bf16 v[28:31], v[188:191], a[200:203], v[28:31]
  ds_read_b64_tr_b16 a[172:173], v17 offset:24584
  ds_read_b128 a[192:195], v9 offset:512
  v_cvt_pk_bf16_f32 v206, v92, v93
  s_add_u32 m0, s33, 53248
  v_mfma_f32_16x16x32_bf16 v[52:55], v[188:191], a[204:207], v[52:55]
  ds_read_b64_tr_b16 a[174:175], v17 offset:25352
  buffer_load_dwordx4 v2, s[4:7], s21 offen nt lds
  v_cvt_pk_bf16_f32 v207, v94, v95
  v_mfma_f32_4x4x4_16b_bf16 v[88:91], a[248:249], a[152:153], 0
  v_mfma_f32_4x4x4_16b_bf16 v[92:95], a[250:251], a[154:155], 0
  v_cvt_pk_bf16_f32 v208, v72, v73
  v_cvt_pk_bf16_f32 v209, v74, v75
  v_mfma_f32_16x16x32_bf16 v[32:35], v[192:195], a[200:203], v[32:35]
  ds_read_b64_tr_b16 a[176:177], v17 offset:24592
  ds_read_b128 a[196:199], v9 offset:12800
  v_cvt_pk_bf16_f32 v210, v76, v77
  s_add_u32 m0, s33, 57344
  v_mfma_f32_16x16x32_bf16 v[56:59], v[192:195], a[204:207], v[56:59]
  ds_read_b64_tr_b16 a[178:179], v17 offset:25360
  buffer_load_dwordx4 v3, s[4:7], s21 offen nt lds
  v_cvt_pk_bf16_f32 v211, v78, v79
  v_mfma_f32_4x4x4_16b_bf16 v[72:75], a[248:249], a[156:157], 0
  v_mfma_f32_4x4x4_16b_bf16 v[76:79], a[250:251], a[158:159], 0
  v_cvt_pk_bf16_f32 v212, v80, v81
  v_cvt_pk_bf16_f32 v213, v82, v83
  v_mfma_f32_16x16x32_bf16 v[36:39], v[196:199], a[200:203], v[36:39]
  ds_read_b64_tr_b16 a[180:181], v17 offset:24600
  v_cvt_pk_bf16_f32 v214, v84, v85
  s_add_u32 m0, s33, 61440
  s_add_u32 s21, s21, 6291456
  v_mfma_f32_16x16x32_bf16 v[60:63], v[196:199], a[204:207], v[60:63]
  ds_read_b64_tr_b16 a[182:183], v17 offset:25368
  buffer_load_dwordx4 v1, s[4:7], s37 offen nt lds
  v_cvt_pk_bf16_f32 v215, v86, v87
  v_mfma_f32_4x4x4_16b_bf16 v[80:83], a[248:249], a[160:161], 0
  v_mfma_f32_4x4x4_16b_bf16 v[84:87], a[250:251], a[162:163], 0
  v_cvt_pk_bf16_f32 v216, v88, v89
  v_cvt_pk_bf16_f32 v217, v90, v91
  v_mfma_f32_16x16x32_bf16 v[40:43], v[200:203], a[200:203], v[40:43]
  ds_read_b64_tr_b16 a[184:185], v17 offset:24608
  v_cvt_pk_bf16_f32 v218, v92, v93
  s_add_u32 m0, s33, 65536
  v_mfma_f32_16x16x32_bf16 v[64:67], v[200:203], a[204:207], v[64:67]
  ds_read_b64_tr_b16 a[186:187], v17 offset:25376
  buffer_load_dwordx4 v2, s[4:7], s37 offen nt lds
  v_cvt_pk_bf16_f32 v219, v94, v95
  v_mfma_f32_4x4x4_16b_bf16 v[88:91], a[248:249], a[164:165], 0
  v_mfma_f32_4x4x4_16b_bf16 v[92:95], a[250:251], a[166:167], 0
  v_cvt_pk_bf16_f32 v220, v72, v73
  v_cvt_pk_bf16_f32 v221, v74, v75
  v_mfma_f32_16x16x32_bf16 v[44:47], v[204:207], a[200:203], v[44:47]
  ds_read_b64_tr_b16 a[188:189], v17 offset:24616
  v_cvt_pk_bf16_f32 v222, v76, v77
  s_add_u32 m0, s33, 69632
  v_mfma_f32_16x16x32_bf16 v[68:71], v[204:207], a[204:207], v[68:71]
  ds_read_b64_tr_b16 a[190:191], v17 offset:25384
  buffer_load_dwordx4 v3, s[4:7], s37 offen nt lds
  s_add_u32 s37, s37, 6291456
  v_cvt_pk_bf16_f32 v223, v78, v79
  s_waitcnt lgkmcnt(6)
  v_mfma_f32_4x4x4_16b_bf16 v[72:75], a[252:253], a[168:169], 0
  v_mfma_f32_4x4x4_16b_bf16 v[76:79], a[254:255], a[170:171], 0
  v_cvt_pk_bf16_f32 v224, v80, v81
  v_cvt_pk_bf16_f32 v225, v82, v83
  v_mfma_f32_16x16x32_bf16 v[24:27], v[208:211], a[192:195], v[24:27]
  v_cvt_pk_bf16_f32 v226, v84, v85
  v_mfma_f32_16x16x32_bf16 v[48:51], v[208:211], a[196:199], v[48:51]
  v_cvt_pk_bf16_f32 v227, v86, v87
  v_mfma_f32_4x4x4_16b_bf16 v[80:83], a[252:253], a[172:173], 0
  v_mfma_f32_4x4x4_16b_bf16 v[84:87], a[254:255], a[174:175], 0
  v_cvt_pk_bf16_f32 v228, v88, v89
  v_cvt_pk_bf16_f32 v229, v90, v91
  v_mfma_f32_16x16x32_bf16 v[28:31], v[212:215], a[192:195], v[28:31]
  v_cvt_pk_bf16_f32 v230, v92, v93
  v_mfma_f32_16x16x32_bf16 v[52:55], v[212:215], a[196:199], v[52:55]
  ds_read_b128 a[200:203], v10 offset:512
  v_cvt_pk_bf16_f32 v231, v94, v95
  v_mfma_f32_4x4x4_16b_bf16 v[88:91], a[252:253], a[176:177], 0
  v_mfma_f32_4x4x4_16b_bf16 v[92:95], a[254:255], a[178:179], 0
  v_cvt_pk_bf16_f32 v232, v72, v73
  v_cvt_pk_bf16_f32 v233, v74, v75
  v_mfma_f32_16x16x32_bf16 v[32:35], v[216:219], a[192:195], v[32:35]
  v_cvt_pk_bf16_f32 v234, v76, v77
  v_mfma_f32_16x16x32_bf16 v[56:59], v[216:219], a[196:199], v[56:59]
  ds_read_b128 a[204:207], v10 offset:12800
  v_cvt_pk_bf16_f32 v235, v78, v79
  s_waitcnt lgkmcnt(2)
  v_mfma_f32_4x4x4_16b_bf16 v[72:75], a[252:253], a[180:181], 0
  v_mfma_f32_4x4x4_16b_bf16 v[76:79], a[254:255], a[182:183], 0
  v_cvt_pk_bf16_f32 v236, v80, v81
  v_cvt_pk_bf16_f32 v237, v82, v83
  v_mfma_f32_16x16x32_bf16 v[36:39], v[220:223], a[192:195], v[36:39]
  v_cvt_pk_bf16_f32 v238, v84, v85
  v_mfma_f32_16x16x32_bf16 v[60:63], v[220:223], a[196:199], v[60:63]
  v_cvt_pk_bf16_f32 v239, v86, v87
  v_mfma_f32_4x4x4_16b_bf16 v[80:83], a[252:253], a[184:185], 0
  v_mfma_f32_4x4x4_16b_bf16 v[84:87], a[254:255], a[186:187], 0
  v_cvt_pk_bf16_f32 v240, v88, v89
  v_cvt_pk_bf16_f32 v241, v90, v91
  v_mfma_f32_16x16x32_bf16 v[40:43], v[224:227], a[192:195], v[40:43]
  v_cvt_pk_bf16_f32 v242, v92, v93
  v_mfma_f32_16x16x32_bf16 v[64:67], v[224:227], a[196:199], v[64:67]
  v_cvt_pk_bf16_f32 v243, v94, v95
  v_mfma_f32_4x4x4_16b_bf16 v[88:91], a[252:253], a[188:189], 0
  v_mfma_f32_4x4x4_16b_bf16 v[92:95], a[254:255], a[190:191], 0
  v_cvt_pk_bf16_f32 v244, v72, v73
  v_cvt_pk_bf16_f32 v245, v74, v75
  v_mfma_f32_16x16x32_bf16 v[44:47], v[228:231], a[192:195], v[44:47]
  v_cvt_pk_bf16_f32 v246, v76, v77
  v_mfma_f32_16x16x32_bf16 v[68:71], v[228:231], a[196:199], v[68:71]
  v_cvt_pk_bf16_f32 v247, v78, v79
  s_waitcnt lgkmcnt(0)
  v_mfma_f32_16x16x32_bf16 v[24:27], v[232:235], a[200:203], v[24:27]
  v_cvt_pk_bf16_f32 v248, v80, v81
  v_mfma_f32_16x16x32_bf16 v[28:31], v[236:239], a[200:203], v[28:31]
  v_cvt_pk_bf16_f32 v249, v82, v83
  v_cvt_pk_bf16_f32 v250, v84, v85
  v_cvt_pk_bf16_f32 v251, v86, v87
  v_mfma_f32_16x16x32_bf16 v[32:35], v[240:243], a[200:203], v[32:35]
  v_cvt_pk_bf16_f32 v252, v88, v89
  v_mfma_f32_16x16x32_bf16 v[36:39], v[244:247], a[200:203], v[36:39]
  v_cvt_pk_bf16_f32 v253, v90, v91
  v_cvt_pk_bf16_f32 v254, v92, v93
  v_cvt_pk_bf16_f32 v255, v94, v95
  v_mfma_f32_16x16x32_bf16 v[48:51], v[232:235], a[204:207], v[48:51]
  v_mfma_f32_16x16x32_bf16 v[40:43], v[248:251], a[200:203], v[40:43]
  v_mfma_f32_16x16x32_bf16 v[44:47], v[252:255], a[200:203], v[44:47]
  v_mfma_f32_16x16x32_bf16 v[52:55], v[236:239], a[204:207], v[52:55]
  v_mfma_f32_16x16x32_bf16 v[56:59], v[240:243], a[204:207], v[56:59]
  v_cvt_pk_bf16_f32 v24, v24, v25
  v_cvt_pk_bf16_f32 v25, v26, v27
  v_mfma_f32_16x16x32_bf16 v[60:63], v[244:247], a[204:207], v[60:63]
  v_cvt_pk_bf16_f32 v26, v28, v29
  v_cvt_pk_bf16_f32 v27, v30, v31
  v_mfma_f32_16x16x32_bf16 v[64:67], v[248:251], a[204:207], v[64:67]
  v_cvt_pk_bf16_f32 v28, v32, v33
  v_cvt_pk_bf16_f32 v29, v34, v35
  v_mfma_f32_16x16x32_bf16 v[68:71], v[252:255], a[204:207], v[68:71]
  v_cvt_pk_bf16_f32 v30, v36, v37
  v_cvt_pk_bf16_f32 v31, v38, v39
  s_mov_b64 vcc, -1
  ds_write_b128 v11, v[24:27] offset:0
  ds_write_b128 v12, v[28:31] offset:0
  v_cvt_pk_bf16_f32 v32, v40, v41
  v_cvt_pk_bf16_f32 v33, v42, v43
  v_cvt_pk_bf16_f32 v34, v44, v45
  v_cvt_pk_bf16_f32 v35, v46, v47
  ds_write_b128 v13, v[32:35] offset:0
  s_waitcnt vmcnt(6) lgkmcnt(0)
  s_barrier
  ds_read_b128 a[192:195], v7 offset:24576
  ds_read_b128 a[196:199], v8 offset:24576
  ds_read_b128 a[216:219], v1 offset:0
  ds_read_b128 a[220:223], v2 offset:0
  ds_read_b128 a[224:227], v3 offset:0
  ds_read_b128 a[200:203], v9 offset:24576
  ds_read_b128 a[204:207], v10 offset:24576
  ds_read_b128 a[228:231], v1 offset:12288
  ds_read_b128 a[232:235], v2 offset:12288
  ds_read_b128 a[236:239], v3 offset:12288
  s_add_u32 m0, s42, 24576
  s_nop 0
  buffer_load_dwordx4 v1, s[4:7], s21 offen nt lds
  s_add_u32 m0, s42, 28672
  s_nop 0
  s_nop 0
  buffer_load_dwordx4 v2, s[4:7], s21 offen nt lds
  s_add_u32 m0, s42, 32768
  s_nop 0
  s_nop 0
  buffer_load_dwordx4 v3, s[4:7], s21 offen nt lds
  s_waitcnt lgkmcnt(8)
.p2align 6
L_loop0:
  v_mfma_f32_16x16x32_bf16 v[24:27], a[0:3], a[192:195], 0
  ds_read_b128 a[208:211], v7 offset:24832
  v_mfma_f32_16x16x32_bf16 v[24:27], a[24:27], a[196:199], v[24:27]
  ds_read_b128 a[212:215], v8 offset:24832
  v_mfma_f32_16x16x32_bf16 v[28:31], a[4:7], a[192:195], 0
  v_mfma_f32_16x16x32_bf16 v[28:31], a[28:31], a[196:199], v[28:31]
  v_mfma_f32_16x16x32_bf16 v[32:35], a[8:11], a[192:195], 0
  v_mfma_f32_16x16x32_bf16 v[32:35], a[32:35], a[196:199], v[32:35]
  v_mfma_f32_16x16x32_bf16 v[36:39], a[12:15], a[192:195], 0
  v_mfma_f32_16x16x32_bf16 v[36:39], a[36:39], a[196:199], v[36:39]
  v_mfma_f32_16x16x32_bf16 v[40:43], a[16:19], a[192:195], 0
  v_mfma_f32_16x16x32_bf16 v[40:43], a[40:43], a[196:199], v[40:43]
  v_mfma_f32_16x16x32_bf16 v[44:47], a[20:23], a[192:195], 0
  v_mfma_f32_16x16x32_bf16 v[44:47], a[44:47], a[196:199], v[44:47]
  s_waitcnt lgkmcnt(5)
  v_mfma_f32_16x16x32_bf16 v[24:27], a[48:51], a[200:203], v[24:27]
  ds_read_b128 a[192:195], v9 offset:24832
  v_mfma_f32_16x16x32_bf16 v[24:27], a[72:75], a[204:207], v[24:27]
  ds_read_b128 a[196:199], v10 offset:24832
  v_mfma_f32_16x16x32_bf16 v[28:31], a[52:55], a[200:203], v[28:31]
  v_cvt_pk_bf16_f32 v48, v48, v49
  v_mfma_f32_16x16x32_bf16 v[28:31], a[76:79], a[204:207], v[28:31]
  v_cvt_pk_bf16_f32 v49, v50, v51
  v_mfma_f32_16x16x32_bf16 v[32:35], a[56:59], a[200:203], v[32:35]
  v_cvt_pk_bf16_f32 v50, v52, v53
  v_mfma_f32_16x16x32_bf16 v[32:35], a[80:83], a[204:207], v[32:35]
  v_cvt_pk_bf16_f32 v51, v54, v55
  v_mfma_f32_16x16x32_bf16 v[36:39], a[60:63], a[200:203], v[36:39]
  v_mfma_f32_16x16x32_bf16 v[36:39], a[84:87], a[204:207], v[36:39]
  v_mfma_f32_16x16x32_bf16 v[40:43], a[64:67], a[200:203], v[40:43]
  v_mfma_f32_16x16x32_bf16 v[40:43], a[88:91], a[204:207], v[40:43]
  v_mfma_f32_16x16x32_bf16 v[44:47], a[68:71], a[200:203], v[44:47]
  ds_write_b128 v11, v[48:51] offset:36864
  v_mfma_f32_16x16x32_bf16 v[44:47], a[92:95], a[204:207], v[44:47]
  s_waitcnt lgkmcnt(3)
  v_mfma_f32_16x16x32_bf16 v[24:27], a[96:99], a[208:211], v[24:27]
  ds_read_b128 a[200:203], v7 offset:25088
  v_mfma_f32_16x16x32_bf16 v[24:27], a[120:123], a[212:215], v[24:27]
  ds_read_b128 a[204:207], v8 offset:25088
  v_mfma_f32_16x16x32_bf16 v[28:31], a[100:103], a[208:211], v[28:31]
  v_cvt_pk_bf16_f32 v52, v56, v57
  v_mfma_f32_16x16x32_bf16 v[28:31], a[124:127], a[212:215], v[28:31]
  v_cvt_pk_bf16_f32 v53, v58, v59
  v_mfma_f32_16x16x32_bf16 v[32:35], a[104:107], a[208:211], v[32:35]
  v_cvt_pk_bf16_f32 v54, v60, v61
  v_mfma_f32_16x16x32_bf16 v[32:35], a[128:131], a[212:215], v[32:35]
  v_cvt_pk_bf16_f32 v55, v62, v63
  v_mfma_f32_16x16x32_bf16 v[36:39], a[108:111], a[208:211], v[36:39]
  ds_write_b128 v12, v[52:55] offset:36864
  v_mfma_f32_16x16x32_bf16 v[36:39], a[132:135], a[212:215], v[36:39]
  v_mfma_f32_16x16x32_bf16 v[40:43], a[112:115], a[208:211], v[40:43]
  buffer_store_dwordx4 a[216:219], v4, s[8:11], s22 offen sc1
  v_mfma_f32_16x16x32_bf16 v[40:43], a[136:139], a[212:215], v[40:43]
  buffer_store_dwordx4 a[220:223], v5, s[8:11], s22 offen sc1
  v_mfma_f32_16x16x32_bf16 v[44:47], a[116:119], a[208:211], v[44:47]
  v_mfma_f32_16x16x32_bf16 v[44:47], a[140:143], a[212:215], v[44:47]
  s_waitcnt lgkmcnt(4)
  v_mfma_f32_16x16x32_bf16 v[24:27], v[112:115], a[192:195], v[24:27]
  ds_read_b128 a[208:211], v9 offset:25088
  v_mfma_f32_16x16x32_bf16 v[24:27], v[136:139], a[196:199], v[24:27]
  ds_read_b128 a[212:215], v10 offset:25088
  v_mfma_f32_16x16x32_bf16 v[28:31], v[116:119], a[192:195], v[28:31]
  v_cvt_pk_bf16_f32 v56, v64, v65
  v_mfma_f32_16x16x32_bf16 v[28:31], v[140:143], a[196:199], v[28:31]
  v_cvt_pk_bf16_f32 v57, v66, v67
  v_mfma_f32_16x16x32_bf16 v[32:35], v[120:123], a[192:195], v[32:35]
  v_cvt_pk_bf16_f32 v58, v68, v69
  v_mfma_f32_16x16x32_bf16 v[32:35], v[144:147], a[196:199], v[32:35]
  v_cvt_pk_bf16_f32 v59, v70, v71
  v_mfma_f32_16x16x32_bf16 v[36:39], v[124:127], a[192:195], v[36:39]
  v_mfma_f32_16x16x32_bf16 v[36:39], v[148:151], a[196:199], v[36:39]
  v_mfma_f32_16x16x32_bf16 v[40:43], v[128:131], a[192:195], v[40:43]
  buffer_store_dwordx4 a[224:227], v6, s[8:11], s22 offen sc1
  v_mfma_f32_16x16x32_bf16 v[40:43], v[152:155], a[196:199], v[40:43]
  v_mfma_f32_16x16x32_bf16 v[44:47], v[132:135], a[192:195], v[44:47]
  ds_write_b128 v13, v[56:59] offset:36864
  v_mfma_f32_16x16x32_bf16 v[44:47], v[156:159], a[196:199], v[44:47]
  s_waitcnt lgkmcnt(4)
  v_mfma_f32_16x16x32_bf16 v[24:27], v[160:163], a[200:203], v[24:27]
  ds_read_b128 a[192:195], v7 offset:36864
  v_mfma_f32_16x16x32_bf16 v[24:27], v[184:187], a[204:207], v[24:27]
  ds_read_b128 a[196:199], v8 offset:36864
  v_mfma_f32_16x16x32_bf16 v[28:31], v[164:167], a[200:203], v[28:31]
  v_mfma_f32_16x16x32_bf16 v[28:31], v[188:191], a[204:207], v[28:31]
  s_add_u32 s62, s62, s44
  s_sub_u32 s61, s61, 1
  v_mfma_f32_16x16x32_bf16 v[32:35], v[168:171], a[200:203], v[32:35]
  s_cmp_eq_u32 s61, 0
  s_cselect_b32 s55, s66, s55
  s_cselect_b32 s65, 144, s65
  v_mfma_f32_16x16x32_bf16 v[32:35], v[192:195], a[204:207], v[32:35]
  v_mfma_f32_16x16x32_bf16 v[36:39], v[172:175], a[200:203], v[36:39]
  v_mfma_f32_16x16x32_bf16 v[36:39], v[196:199], a[204:207], v[36:39]
  v_mfma_f32_16x16x32_bf16 v[40:43], v[176:179], a[200:203], v[40:43]
  v_mfma_f32_16x16x32_bf16 v[40:43], v[200:203], a[204:207], v[40:43]
  v_mfma_f32_16x16x32_bf16 v[44:47], v[180:183], a[200:203], v[44:47]
  v_mfma_f32_16x16x32_bf16 v[44:47], v[204:207], a[204:207], v[44:47]
  s_waitcnt lgkmcnt(3)
  v_mfma_f32_16x16x32_bf16 v[24:27], v[208:211], a[208:211], v[24:27]
  ds_read_b128 a[200:203], v9 offset:36864
  v_mfma_f32_16x16x32_bf16 v[24:27], v[232:235], a[212:215], v[24:27]
  ds_read_b128 a[204:207], v10 offset:36864
  v_mfma_f32_16x16x32_bf16 v[28:31], v[212:215], a[208:211], v[28:31]
  v_mfma_f32_16x16x32_bf16 v[28:31], v[236:239], a[212:215], v[28:31]
  v_mfma_f32_16x16x32_bf16 v[32:35], v[216:219], a[208:211], v[32:35]
  v_mfma_f32_16x16x32_bf16 v[32:35], v[240:243], a[212:215], v[32:35]
  v_mfma_f32_16x16x32_bf16 v[36:39], v[220:223], a[208:211], v[36:39]
  v_mfma_f32_16x16x32_bf16 v[36:39], v[244:247], a[212:215], v[36:39]
  s_add_u32 m0, s42, 36864
  v_mfma_f32_16x16x32_bf16 v[40:43], v[224:227], a[208:211], v[40:43]
  s_cbranch_vccz L_sk1
  buffer_load_dwordx4 v1, s[4:7], s37 offen nt lds
  s_add_u32 m0, s42, 40960
  s_nop 0
  buffer_load_dwordx4 v2, s[4:7], s37 offen nt lds
  s_add_u32 m0, s42, 45056
  s_nop 0
  buffer_load_dwordx4 v3, s[4:7], s37 offen nt lds
L_sk1:
  v_mfma_f32_16x16x32_bf16 v[40:43], v[248:251], a[212:215], v[40:43]
  v_mfma_f32_16x16x32_bf16 v[44:47], v[228:231], a[208:211], v[44:47]
  s_cmp_eq_u32 s32, s68
  v_mfma_f32_16x16x32_bf16 v[44:47], v[252:255], a[212:215], v[44:47]
  s_waitcnt lgkmcnt(2)
  s_cbranch_scc1 L_half1
  v_mfma_f32_16x16x32_bf16 v[48:51], a[0:3], a[192:195], 0
  ds_read_b128 a[208:211], v7 offset:37120
  v_mfma_f32_16x16x32_bf16 v[48:51], a[24:27], a[196:199], v[48:51]
  ds_read_b128 a[212:215], v8 offset:37120
  v_mfma_f32_16x16x32_bf16 v[52:55], a[4:7], a[192:195], 0
  v_cvt_pk_bf16_f32 v24, v24, v25
  v_mfma_f32_16x16x32_bf16 v[52:55], a[28:31], a[196:199], v[52:55]
  v_cvt_pk_bf16_f32 v25, v26, v27
  v_mfma_f32_16x16x32_bf16 v[56:59], a[8:11], a[192:195], 0
  v_cvt_pk_bf16_f32 v26, v28, v29
  v_mfma_f32_16x16x32_bf16 v[56:59], a[32:35], a[196:199], v[56:59]
  v_cvt_pk_bf16_f32 v27, v30, v31
  v_mfma_f32_16x16x32_bf16 v[60:63], a[12:15], a[192:195], 0
  ds_write_b128 v11, v[24:27] offset:24576
  v_mfma_f32_16x16x32_bf16 v[60:63], a[36:39], a[196:199], v[60:63]
  v_mfma_f32_16x16x32_bf16 v[64:67], a[16:19], a[192:195], 0
  v_mfma_f32_16x16x32_bf16 v[64:67], a[40:43], a[196:199], v[64:67]
  v_mfma_f32_16x16x32_bf16 v[68:71], a[20:23], a[192:195], 0
  v_mfma_f32_16x16x32_bf16 v[68:71], a[44:47], a[196:199], v[68:71]
  s_waitcnt lgkmcnt(3)
  v_mfma_f32_16x16x32_bf16 v[48:51], a[48:51], a[200:203], v[48:51]
  ds_read_b128 a[192:195], v9 offset:37120
  v_mfma_f32_16x16x32_bf16 v[48:51], a[72:75], a[204:207], v[48:51]
  ds_read_b128 a[196:199], v10 offset:37120
  v_mfma_f32_16x16x32_bf16 v[52:55], a[52:55], a[200:203], v[52:55]
  v_cvt_pk_bf16_f32 v28, v32, v33
  v_mfma_f32_16x16x32_bf16 v[52:55], a[76:79], a[204:207], v[52:55]
  v_cvt_pk_bf16_f32 v29, v34, v35
  v_mfma_f32_16x16x32_bf16 v[56:59], a[56:59], a[200:203], v[56:59]
  v_cvt_pk_bf16_f32 v30, v36, v37
  v_mfma_f32_16x16x32_bf16 v[56:59], a[80:83], a[204:207], v[56:59]
  v_cvt_pk_bf16_f32 v31, v38, v39
  v_mfma_f32_16x16x32_bf16 v[60:63], a[60:63], a[200:203], v[60:63]
  v_mfma_f32_16x16x32_bf16 v[60:63], a[84:87], a[204:207], v[60:63]
  v_mfma_f32_16x16x32_bf16 v[64:67], a[64:67], a[200:203], v[64:67]
  v_mfma_f32_16x16x32_bf16 v[64:67], a[88:91], a[204:207], v[64:67]
  v_mfma_f32_16x16x32_bf16 v[68:71], a[68:71], a[200:203], v[68:71]
  ds_write_b128 v12, v[28:31] offset:24576
  v_mfma_f32_16x16x32_bf16 v[68:71], a[92:95], a[204:207], v[68:71]
  s_waitcnt lgkmcnt(4)
  v_mfma_f32_16x16x32_bf16 v[48:51], a[96:99], a[208:211], v[48:51]
  ds_read_b128 a[200:203], v7 offset:37376
  v_mfma_f32_16x16x32_bf16 v[48:51], a[120:123], a[212:215], v[48:51]
  ds_read_b128 a[204:207], v8 offset:37376
  v_mfma_f32_16x16x32_bf16 v[52:55], a[100:103], a[208:211], v[52:55]
  v_cvt_pk_bf16_f32 v32, v40, v41
  v_mfma_f32_16x16x32_bf16 v[52:55], a[124:127], a[212:215], v[52:55]
  v_cvt_pk_bf16_f32 v33, v42, v43
  v_mfma_f32_16x16x32_bf16 v[56:59], a[104:107], a[208:211], v[56:59]
  v_cvt_pk_bf16_f32 v34, v44, v45
  v_mfma_f32_16x16x32_bf16 v[56:59], a[128:131], a[212:215], v[56:59]
  v_cvt_pk_bf16_f32 v35, v46, v47
  v_mfma_f32_16x16x32_bf16 v[60:63], a[108:111], a[208:211], v[60:63]
  ds_write_b128 v13, v[32:35] offset:24576
  v_mfma_f32_16x16x32_bf16 v[60:63], a[132:135], a[212:215], v[60:63]
  v_mfma_f32_16x16x32_bf16 v[64:67], a[112:115], a[208:211], v[64:67]
  buffer_store_dwordx4 a[228:231], v4, s[8:11], s23 offen sc1
  v_mfma_f32_16x16x32_bf16 v[64:67], a[136:139], a[212:215], v[64:67]
  buffer_store_dwordx4 a[232:235], v5, s[8:11], s23 offen sc1
  v_mfma_f32_16x16x32_bf16 v[68:71], a[116:119], a[208:211], v[68:71]
  v_mfma_f32_16x16x32_bf16 v[68:71], a[140:143], a[212:215], v[68:71]
  s_waitcnt lgkmcnt(0)
  v_mfma_f32_16x16x32_bf16 v[48:51], v[112:115], a[192:195], v[48:51]
  ds_read_b128 a[208:211], v9 offset:37376
  s_add_u32 s69, s54, 112
  s_lshr_b32 s56, s69, 1
  v_mfma_f32_16x16x32_bf16 v[48:51], v[136:139], a[196:199], v[48:51]
  ds_read_b128 a[212:215], v10 offset:37376
  s_bitcmp1_b32 s69, 0
  s_cselect_b32 s69, 12289, 1
  v_mfma_f32_16x16x32_bf16 v[52:55], v[116:119], a[192:195], v[52:55]
  s_cmp_lt_u32 s54, 112
  s_cselect_b32 s56, s54, s56
  s_cselect_b32 s69, 0, s69
  v_mfma_f32_16x16x32_bf16 v[52:55], v[140:143], a[196:199], v[52:55]
  v_xor_b32 v7, 0x14000, v7
  s_mul_i32 s56, s56, 98304
  s_add_u32 s69, s69, s57
  v_mfma_f32_16x16x32_bf16 v[56:59], v[120:123], a[192:195], v[56:59]
  v_xor_b32 v8, 0x14000, v8
  s_add_u32 s56, s56, s69
  s_cmp_lt_u32 s54, 144
  s_cselect_b32 s56, s56, s6
  v_mfma_f32_16x16x32_bf16 v[56:59], v[144:147], a[196:199], v[56:59]
  v_xor_b32 v9, 0x14000, v9
  s_cmp_ge_i32 s61, 0
  s_cselect_b32 s56, s62, s56
  v_mfma_f32_16x16x32_bf16 v[60:63], v[124:127], a[192:195], v[60:63]
  v_xor_b32 v10, 0x14000, v10
  v_mov_b32 v23, s56
  v_mfma_f32_16x16x32_bf16 v[60:63], v[148:151], a[196:199], v[60:63]
  ds_write_b32 v106, v23 offset:4
  v_mfma_f32_16x16x32_bf16 v[64:67], v[128:131], a[192:195], v[64:67]
  buffer_store_dwordx4 a[236:239], v6, s[8:11], s23 offen sc1
  v_mfma_f32_16x16x32_bf16 v[64:67], v[152:155], a[196:199], v[64:67]
  s_add_u32 s23, s22, 12288
  s_mov_b32 s22, s58
  v_mfma_f32_16x16x32_bf16 v[68:71], v[132:135], a[192:195], v[68:71]
  s_mov_b32 s58, s59
  v_mfma_f32_16x16x32_bf16 v[68:71], v[156:159], a[196:199], v[68:71]
  s_waitcnt vmcnt(12) lgkmcnt(0)
  s_cbranch_vccz L_ow2
L_ob2:
  s_barrier
  s_cmp_eq_u32 s32, 1
  s_cbranch_scc1 L_tail1
  v_mfma_f32_16x16x32_bf16 v[48:51], v[160:163], a[200:203], v[48:51]
  ds_read_b128 a[192:195], v7 offset:0
  v_mfma_f32_16x16x32_bf16 v[48:51], v[184:187], a[204:207], v[48:51]
  ds_read_b128 a[196:199], v8 offset:0
  v_mfma_f32_16x16x32_bf16 v[52:55], v[164:167], a[200:203], v[52:55]
  ds_read_b128 a[216:219], v1 offset:24576
  v_mfma_f32_16x16x32_bf16 v[52:55], v[188:191], a[204:207], v[52:55]
  ds_read_b32 v107, v105 offset:4
  v_mfma_f32_16x16x32_bf16 v[56:59], v[168:171], a[200:203], v[56:59]
  ds_read_b128 a[220:223], v2 offset:24576
  v_mfma_f32_16x16x32_bf16 v[56:59], v[192:195], a[204:207], v[56:59]
  ds_read_b128 a[224:227], v3 offset:24576
  v_mfma_f32_16x16x32_bf16 v[60:63], v[172:175], a[200:203], v[60:63]
  s_mov_b32 s59, s21
  v_mfma_f32_16x16x32_bf16 v[60:63], v[196:199], a[204:207], v[60:63]
  s_cmp_lt_u32 s54, s55
  s_cselect_b32 s54, 1, s65
  s_cbranch_scc0 L_cl3
  s_atomic_add s54, s[52:53], 0 glc
L_cl3:
  v_mfma_f32_16x16x32_bf16 v[64:67], v[176:179], a[200:203], v[64:67]
  v_mfma_f32_16x16x32_bf16 v[64:67], v[200:203], a[204:207], v[64:67]
  s_waitcnt lgkmcnt(2)
  v_readfirstlane_b32 s21, v107
  v_mfma_f32_16x16x32_bf16 v[68:71], v[180:183], a[200:203], v[68:71]
  v_mfma_f32_16x16x32_bf16 v[68:71], v[204:207], a[204:207], v[68:71]
  s_cmp_lt_u32 s21, s6
  s_cselect_b32 s32, 4, s32
  s_cselect_b64 vcc, -1, 0
  v_mfma_f32_16x16x32_bf16 v[48:51], v[208:211], a[208:211], v[48:51]
  ds_read_b128 a[200:203], v9 offset:0
  s_add_u32 s37, s21, 12288
  s_bitcmp1_b32 s21, 0
  v_mfma_f32_16x16x32_bf16 v[48:51], v[232:235], a[212:215], v[48:51]
  ds_read_b128 a[204:207], v10 offset:0
  s_cselect_b32 s37, s6, s37
  s_cselect_b32 s68, 1, s68
  s_andn2_b32 s21, s21, 1
  v_mfma_f32_16x16x32_bf16 v[52:55], v[212:215], a[208:211], v[52:55]
  ds_read_b128 a[228:231], v1 offset:36864
  v_mfma_f32_16x16x32_bf16 v[52:55], v[236:239], a[212:215], v[52:55]
  ds_read_b128 a[232:235], v2 offset:36864
  v_mfma_f32_16x16x32_bf16 v[56:59], v[216:219], a[208:211], v[56:59]
  ds_read_b128 a[236:239], v3 offset:36864
  v_mfma_f32_16x16x32_bf16 v[56:59], v[240:243], a[212:215], v[56:59]
  s_sub_u32 s32, s32, 1
  v_mfma_f32_16x16x32_bf16 v[60:63], v[220:223], a[208:211], v[60:63]
  s_xor_b32 s42, s42, 0x14000
  v_mfma_f32_16x16x32_bf16 v[60:63], v[244:247], a[212:215], v[60:63]
  s_add_u32 m0, s42, 0
  v_mfma_f32_16x16x32_bf16 v[64:67], v[224:227], a[208:211], v[64:67]
  s_cbranch_vccz L_sk4
  buffer_load_dwordx4 v1, s[4:7], s21 offen nt lds
  s_add_u32 m0, s42, 4096
  s_nop 0
  buffer_load_dwordx4 v2, s[4:7], s21 offen nt lds
  s_add_u32 m0, s42, 8192
  s_nop 0
  buffer_load_dwordx4 v3, s[4:7], s21 offen nt lds
L_sk4:
  v_mfma_f32_16x16x32_bf16 v[64:67], v[248:251], a[212:215], v[64:67]
  v_mfma_f32_16x16x32_bf16 v[68:71], v[228:231], a[208:211], v[68:71]
  v_mfma_f32_16x16x32_bf16 v[68:71], v[252:255], a[212:215], v[68:71]
L_mid0:
  v_mfma_f32_16x16x32_bf16 v[24:27], a[0:3], a[192:195], 0
  ds_read_b128 a[208:211], v7 offset:256
  v_mfma_f32_16x16x32_bf16 v[24:27], a[24:27], a[196:199], v[24:27]
  ds_read_b128 a[212:215], v8 offset:256
  v_mfma_f32_16x16x32_bf16 v[28:31], a[4:7], a[192:195], 0
  v_mfma_f32_16x16x32_bf16 v[28:31], a[28:31], a[196:199], v[28:31]
  v_mfma_f32_16x16x32_bf16 v[32:35], a[8:11], a[192:195], 0
  v_mfma_f32_16x16x32_bf16 v[32:35], a[32:35], a[196:199], v[32:35]
  v_mfma_f32_16x16x32_bf16 v[36:39], a[12:15], a[192:195], 0
  v_mfma_f32_16x16x32_bf16 v[36:39], a[36:39], a[196:199], v[36:39]
  v_mfma_f32_16x16x32_bf16 v[40:43], a[16:19], a[192:195], 0
  v_mfma_f32_16x16x32_bf16 v[40:43], a[40:43], a[196:199], v[40:43]
  v_mfma_f32_16x16x32_bf16 v[44:47], a[20:23], a[192:195], 0
  v_mfma_f32_16x16x32_bf16 v[44:47], a[44:47], a[196:199], v[44:47]
  s_waitcnt lgkmcnt(5)
  v_mfma_f32_16x16x32_bf16 v[24:27], a[48:51], a[200:203], v[24:27]
  ds_read_b128 a[192:195], v9 offset:256
  v_mfma_f32_16x16x32_bf16 v[24:27], a[72:75], a[204:207], v[24:27]
  ds_read_b128 a[196:199], v10 offset:256
  v_mfma_f32_16x16x32_bf16 v[28:31], a[52:55], a[200:203], v[28:31]
  v_cvt_pk_bf16_f32 v48, v48, v49
  v_mfma_f32_16x16x32_bf16 v[28:31], a[76:79], a[204:207], v[28:31]
  v_cvt_pk_bf16_f32 v49, v50, v51
  v_mfma_f32_16x16x32_bf16 v[32:35], a[56:59], a[200:203], v[32:35]
  v_cvt_pk_bf16_f32 v50, v52, v53
  v_mfma_f32_16x16x32_bf16 v[32:35], a[80:83], a[204:207], v[32:35]
  v_cvt_pk_bf16_f32 v51, v54, v55
  v_mfma_f32_16x16x32_bf16 v[36:39], a[60:63], a[200:203], v[36:39]
  v_mfma_f32_16x16x32_bf16 v[36:39], a[84:87], a[204:207], v[36:39]
  v_mfma_f32_16x16x32_bf16 v[40:43], a[64:67], a[200:203], v[40:43]
  v_mfma_f32_16x16x32_bf16 v[40:43], a[88:91], a[204:207], v[40:43]
  v_mfma_f32_16x16x32_bf16 v[44:47], a[68:71], a[200:203], v[44:47]
  ds_write_b128 v11, v[48:51] offset:12288
  v_mfma_f32_16x16x32_bf16 v[44:47], a[92:95], a[204:207], v[44:47]
  s_waitcnt lgkmcnt(3)
  v_mfma_f32_16x16x32_bf16 v[24:27], a[96:99], a[208:211], v[24:27]
  ds_read_b128 a[200:203], v7 offset:512
  v_mfma_f32_16x16x32_bf16 v[24:27], a[120:123], a[212:215], v[24:27]
  ds_read_b128 a[204:207], v8 offset:512
  v_mfma_f32_16x16x32_bf16 v[28:31], a[100:103], a[208:211], v[28:31]
  v_cvt_pk_bf16_f32 v52, v56, v57
  v_mfma_f32_16x16x32_bf16 v[28:31], a[124:127], a[212:215], v[28:31]
  v_cvt_pk_bf16_f32 v53, v58, v59
  v_mfma_f32_16x16x32_bf16 v[32:35], a[104:107], a[208:211], v[32:35]
  v_cvt_pk_bf16_f32 v54, v60, v61
  v_mfma_f32_16x16x32_bf16 v[32:35], a[128:131], a[212:215], v[32:35]
  v_cvt_pk_bf16_f32 v55, v62, v63
  v_mfma_f32_16x16x32_bf16 v[36:39], a[108:111], a[208:211], v[36:39]
  ds_write_b128 v12, v[52:55] offset:12288
  v_mfma_f32_16x16x32_bf16 v[36:39], a[132:135], a[212:215], v[36:39]
  v_mfma_f32_16x16x32_bf16 v[40:43], a[112:115], a[208:211], v[40:43]
  buffer_store_dwordx4 a[216:219], v4, s[8:11], s22 offen sc1
  v_mfma_f32_16x16x32_bf16 v[40:43], a[136:139], a[212:215], v[40:43]
  buffer_store_dwordx4 a[220:223], v5, s[8:11], s22 offen sc1
  v_mfma_f32_16x16x32_bf16 v[44:47], a[116:119], a[208:211], v[44:47]
  v_mfma_f32_16x16x32_bf16 v[44:47], a[140:143], a[212:215], v[44:47]
  s_waitcnt lgkmcnt(4)
  v_mfma_f32_16x16x32_bf16 v[24:27], v[112:115], a[192:195], v[24:27]
  ds_read_b128 a[208:211], v9 offset:512
  v_mfma_f32_16x16x32_bf16 v[24:27], v[136:139], a[196:199], v[24:27]
  ds_read_b128 a[212:215], v10 offset:512
  v_mfma_f32_16x16x32_bf16 v[28:31], v[116:119], a[192:195], v[28:31]
  v_cvt_pk_bf16_f32 v56, v64, v65
  v_mfma_f32_16x16x32_bf16 v[28:31], v[140:143], a[196:199], v[28:31]
  v_cvt_pk_bf16_f32 v57, v66, v67
  v_mfma_f32_16x16x32_bf16 v[32:35], v[120:123], a[192:195], v[32:35]
  v_cvt_pk_bf16_f32 v58, v68, v69
  v_mfma_f32_16x16x32_bf16 v[32:35], v[144:147], a[196:199], v[32:35]
  v_cvt_pk_bf16_f32 v59, v70, v71
  v_mfma_f32_16x16x32_bf16 v[36:39], v[124:127], a[192:195], v[36:39]
  v_mfma_f32_16x16x32_bf16 v[36:39], v[148:151], a[196:199], v[36:39]
  v_mfma_f32_16x16x32_bf16 v[40:43], v[128:131], a[192:195], v[40:43]
  buffer_store_dwordx4 a[224:227], v6, s[8:11], s22 offen sc1
  v_mfma_f32_16x16x32_bf16 v[40:43], v[152:155], a[196:199], v[40:43]
  v_mfma_f32_16x16x32_bf16 v[44:47], v[132:135], a[192:195], v[44:47]
  ds_write_b128 v13, v[56:59] offset:12288
  v_mfma_f32_16x16x32_bf16 v[44:47], v[156:159], a[196:199], v[44:47]
  s_waitcnt lgkmcnt(4)
  v_mfma_f32_16x16x32_bf16 v[24:27], v[160:163], a[200:203], v[24:27]
  ds_read_b128 a[192:195], v7 offset:12288
  v_mfma_f32_16x16x32_bf16 v[24:27], v[184:187], a[204:207], v[24:27]
  ds_read_b128 a[196:199], v8 offset:12288
  v_mfma_f32_16x16x32_bf16 v[28:31], v[164:167], a[200:203], v[28:31]
  v_mfma_f32_16x16x32_bf16 v[28:31], v[188:191], a[204:207], v[28:31]
  s_add_u32 s62, s62, s44
  s_sub_u32 s61, s61, 1
  v_mfma_f32_16x16x32_bf16 v[32:35], v[168:171], a[200:203], v[32:35]
  s_cmp_eq_u32 s61, 0
  s_cselect_b32 s55, s66, s55
  s_cselect_b32 s65, 144, s65
  v_mfma_f32_16x16x32_bf16 v[32:35], v[192:195], a[204:207], v[32:35]
  v_mfma_f32_16x16x32_bf16 v[36:39], v[172:175], a[200:203], v[36:39]
  v_mfma_f32_16x16x32_bf16 v[36:39], v[196:199], a[204:207], v[36:39]
  v_mfma_f32_16x16x32_bf16 v[40:43], v[176:179], a[200:203], v[40:43]
  v_mfma_f32_16x16x32_bf16 v[40:43], v[200:203], a[204:207], v[40:43]
  v_mfma_f32_16x16x32_bf16 v[44:47], v[180:183], a[200:203], v[44:47]
  v_mfma_f32_16x16x32_bf16 v[44:47], v[204:207], a[204:207], v[44:47]
  s_waitcnt lgkmcnt(3)
  v_mfma_f32_16x16x32_bf16 v[24:27], v[208:211], a[208:211], v[24:27]
  ds_read_b128 a[200:203], v9 offset:12288
  v_mfma_f32_16x16x32_bf16 v[24:27], v[232:235], a[212:215], v[24:27]
  ds_read_b128 a[204:207], v10 offset:12288
  v_mfma_f32_16x16x32_bf16 v[28:31], v[212:215], a[208:211], v[28:31]
  v_mfma_f32_16x16x32_bf16 v[28:31], v[236:239], a[212:215], v[28:31]
  v_mfma_f32_16x16x32_bf16 v[32:35], v[216:219], a[208:211], v[32:35]
  v_mfma_f32_16x16x32_bf16 v[32:35], v[240:243], a[212:215], v[32:35]
  v_mfma_f32_16x16x32_bf16 v[36:39], v[220:223], a[208:211], v[36:39]
  v_mfma_f32_16x16x32_bf16 v[36:39], v[244:247], a[212:215], v[36:39]
  s_add_u32 m0, s42, 12288
  v_mfma_f32_16x16x32_bf16 v[40:43], v[224:227], a[208:211], v[40:43]
  s_cbranch_vccz L_sk5
  buffer_load_dwordx4 v1, s[4:7], s37 offen nt lds
  s_add_u32 m0, s42, 16384
  s_nop 0
  buffer_load_dwordx4 v2, s[4:7], s37 offen nt lds
  s_add_u32 m0, s42, 20480
  s_nop 0
  buffer_load_dwordx4 v3, s[4:7], s37 offen nt lds
L_sk5:
  v_mfma_f32_16x16x32_bf16 v[40:43], v[248:251], a[212:215], v[40:43]
  v_mfma_f32_16x16x32_bf16 v[44:47], v[228:231], a[208:211], v[44:47]
  s_cmp_eq_u32 s32, s68
  v_mfma_f32_16x16x32_bf16 v[44:47], v[252:255], a[212:215], v[44:47]
  s_waitcnt lgkmcnt(2)
  s_cbranch_scc1 L_half0
  v_mfma_f32_16x16x32_bf16 v[48:51], a[0:3], a[192:195], 0
  ds_read_b128 a[208:211], v7 offset:12544
  v_mfma_f32_16x16x32_bf16 v[48:51], a[24:27], a[196:199], v[48:51]
  ds_read_b128 a[212:215], v8 offset:12544
  v_mfma_f32_16x16x32_bf16 v[52:55], a[4:7], a[192:195], 0
  v_cvt_pk_bf16_f32 v24, v24, v25
  v_mfma_f32_16x16x32_bf16 v[52:55], a[28:31], a[196:199], v[52:55]
  v_cvt_pk_bf16_f32 v25, v26, v27
  v_mfma_f32_16x16x32_bf16 v[56:59], a[8:11], a[192:195], 0
  v_cvt_pk_bf16_f32 v26, v28, v29
  v_mfma_f32_16x16x32_bf16 v[56:59], a[32:35], a[196:199], v[56:59]
  v_cvt_pk_bf16_f32 v27, v30, v31
  v_mfma_f32_16x16x32_bf16 v[60:63], a[12:15], a[192:195], 0
  ds_write_b128 v11, v[24:27] offset:0
  v_mfma_f32_16x16x32_bf16 v[60:63], a[36:39], a[196:199], v[60:63]
  v_mfma_f32_16x16x32_bf16 v[64:67], a[16:19], a[192:195], 0
  v_mfma_f32_16x16x32_bf16 v[64:67], a[40:43], a[196:199], v[64:67]
  v_mfma_f32_16x16x32_bf16 v[68:71], a[20:23], a[192:195], 0
  v_mfma_f32_16x16x32_bf16 v[68:71], a[44:47], a[196:199], v[68:71]
  s_waitcnt lgkmcnt(3)
  v_mfma_f32_16x16x32_bf16 v[48:51], a[48:51], a[200:203], v[48:51]
  ds_read_b128 a[192:195], v9 offset:12544
  v_mfma_f32_16x16x32_bf16 v[48:51], a[72:75], a[204:207], v[48:51]
  ds_read_b128 a[196:199], v10 offset:12544
  v_mfma_f32_16x16x32_bf16 v[52:55], a[52:55], a[200:203], v[52:55]
  v_cvt_pk_bf16_f32 v28, v32, v33
  v_mfma_f32_16x16x32_bf16 v[52:55], a[76:79], a[204:207], v[52:55]
  v_cvt_pk_bf16_f32 v29, v34, v35
  v_mfma_f32_16x16x32_bf16 v[56:59], a[56:59], a[200:203], v[56:59]
  v_cvt_pk_bf16_f32 v30, v36, v37
  v_mfma_f32_16x16x32_bf16 v[56:59], a[80:83], a[204:207], v[56:59]
  v_cvt_pk_bf16_f32 v31, v38, v39
  v_mfma_f32_16x16x32_bf16 v[60:63], a[60:63], a[200:203], v[60:63]
  v_mfma_f32_16x16x32_bf16 v[60:63], a[84:87], a[204:207], v[60:63]
  v_mfma_f32_16x16x32_bf16 v[64:67], a[64:67], a[200:203], v[64:67]
  v_mfma_f32_16x16x32_bf16 v[64:67], a[88:91], a[204:207], v[64:67]
  v_mfma_f32_16x16x32_bf16 v[68:71], a[68:71], a[200:203], v[68:71]
  ds_write_b128 v12, v[28:31] offset:0
  v_mfma_f32_16x16x32_bf16 v[68:71], a[92:95], a[204:207], v[68:71]
  s_waitcnt lgkmcnt(4)
  v_mfma_f32_16x16x32_bf16 v[48:51], a[96:99], a[208:211], v[48:51]
  ds_read_b128 a[200:203], v7 offset:12800
  v_mfma_f32_16x16x32_bf16 v[48:51], a[120:123], a[212:215], v[48:51]
  ds_read_b128 a[204:207], v8 offset:12800
  v_mfma_f32_16x16x32_bf16 v[52:55], a[100:103], a[208:211], v[52:55]
  v_cvt_pk_bf16_f32 v32, v40, v41
  v_mfma_f32_16x16x32_bf16 v[52:55], a[124:127], a[212:215], v[52:55]
  v_cvt_pk_bf16_f32 v33, v42, v43
  v_mfma_f32_16x16x32_bf16 v[56:59], a[104:107], a[208:211], v[56:59]
  v_cvt_pk_bf16_f32 v34, v44, v45
  v_mfma_f32_16x16x32_bf16 v[56:59], a[128:131], a[212:215], v[56:59]
  v_cvt_pk_bf16_f32 v35, v46, v47
  v_mfma_f32_16x16x32_bf16 v[60:63], a[108:111], a[208:211], v[60:63]
  ds_write_b128 v13, v[32:35] offset:0
  v_mfma_f32_16x16x32_bf16 v[60:63], a[132:135], a[212:215], v[60:63]
  v_mfma_f32_16x16x32_bf16 v[64:67], a[112:115], a[208:211], v[64:67]
  buffer_store_dwordx4 a[228:231], v4, s[8:11], s23 offen sc1
  v_mfma_f32_16x16x32_bf16 v[64:67], a[136:139], a[212:215], v[64:67]
  buffer_store_dwordx4 a[232:235], v5, s[8:11], s23 offen sc1
  v_mfma_f32_16x16x32_bf16 v[68:71], a[116:119], a[208:211], v[68:71]
  v_mfma_f32_16x16x32_bf16 v[68:71], a[140:143], a[212:215], v[68:71]
  s_waitcnt lgkmcnt(0)
  v_mfma_f32_16x16x32_bf16 v[48:51], v[112:115], a[192:195], v[48:51]
  ds_read_b128 a[208:211], v9 offset:12800
  s_add_u32 s69, s54, 112
  s_lshr_b32 s56, s69, 1
  v_mfma_f32_16x16x32_bf16 v[48:51], v[136:139], a[196:199], v[48:51]
  ds_read_b128 a[212:215], v10 offset:12800
  s_bitcmp1_b32 s69, 0
  s_cselect_b32 s69, 12289, 1
  v_mfma_f32_16x16x32_bf16 v[52:55], v[116:119], a[192:195], v[52:55]
  s_cmp_lt_u32 s54, 112
  s_cselect_b32 s56, s54, s56
  s_cselect_b32 s69, 0, s69
  v_mfma_f32_16x16x32_bf16 v[52:55], v[140:143], a[196:199], v[52:55]
  s_mul_i32 s56, s56, 98304
  s_add_u32 s69, s69, s57
  v_mfma_f32_16x16x32_bf16 v[56:59], v[120:123], a[192:195], v[56:59]
  s_add_u32 s56, s56, s69
  s_cmp_lt_u32 s54, 144
  s_cselect_b32 s56, s56, s6
  v_mfma_f32_16x16x32_bf16 v[56:59], v[144:147], a[196:199], v[56:59]
  s_cmp_ge_i32 s61, 0
  s_cselect_b32 s56, s62, s56
  v_mfma_f32_16x16x32_bf16 v[60:63], v[124:127], a[192:195], v[60:63]
  v_mov_b32 v23, s56
  v_mfma_f32_16x16x32_bf16 v[60:63], v[148:151], a[196:199], v[60:63]
  ds_write_b32 v106, v23 offset:0
  v_mfma_f32_16x16x32_bf16 v[64:67], v[128:131], a[192:195], v[64:67]
  buffer_store_dwordx4 a[236:239], v6, s[8:11], s23 offen sc1
  v_mfma_f32_16x16x32_bf16 v[64:67], v[152:155], a[196:199], v[64:67]
  s_add_u32 s23, s22, 12288
  s_mov_b32 s22, s58
  v_mfma_f32_16x16x32_bf16 v[68:71], v[132:135], a[192:195], v[68:71]
  s_mov_b32 s58, s59
  v_mfma_f32_16x16x32_bf16 v[68:71], v[156:159], a[196:199], v[68:71]
  s_waitcnt vmcnt(15) lgkmcnt(0)
  s_cbranch_vccz L_ow6
L_ob6:
  s_barrier
  s_cmp_eq_u32 s32, 1
  s_cbranch_scc1 L_tail0
  v_mfma_f32_16x16x32_bf16 v[48:51], v[160:163], a[200:203], v[48:51]
  ds_read_b128 a[192:195], v7 offset:24576
  v_mfma_f32_16x16x32_bf16 v[48:51], v[184:187], a[204:207], v[48:51]
  ds_read_b128 a[196:199], v8 offset:24576
  v_mfma_f32_16x16x32_bf16 v[52:55], v[164:167], a[200:203], v[52:55]
  ds_read_b128 a[216:219], v1 offset:0
  v_mfma_f32_16x16x32_bf16 v[52:55], v[188:191], a[204:207], v[52:55]
  ds_read_b32 v107, v105 offset:0
  v_mfma_f32_16x16x32_bf16 v[56:59], v[168:171], a[200:203], v[56:59]
  ds_read_b128 a[220:223], v2 offset:0
  v_mfma_f32_16x16x32_bf16 v[56:59], v[192:195], a[204:207], v[56:59]
  ds_read_b128 a[224:227], v3 offset:0
  v_mfma_f32_16x16x32_bf16 v[60:63], v[172:175], a[200:203], v[60:63]
  s_mov_b32 s59, s21
  v_mfma_f32_16x16x32_bf16 v[60:63], v[196:199], a[204:207], v[60:63]
  s_cmp_lt_u32 s54, s55
  s_cselect_b32 s54, 1, s65
  s_cbranch_scc0 L_cl7
  s_atomic_add s54, s[52:53], 0 glc
L_cl7:
  v_mfma_f32_16x16x32_bf16 v[64:67], v[176:179], a[200:203], v[64:67]
  v_mfma_f32_16x16x32_bf16 v[64:67], v[200:203], a[204:207], v[64:67]
  s_waitcnt lgkmcnt(2)
  v_readfirstlane_b32 s21, v107
  v_mfma_f32_16x16x32_bf16 v[68:71], v[180:183], a[200:203], v[68:71]
  v_mfma_f32_16x16x32_bf16 v[68:71], v[204:207], a[204:207], v[68:71]
  s_cmp_lt_u32 s21, s6
  s_cselect_b32 s32, 4, s32
  s_cselect_b64 vcc, -1, 0
  v_mfma_f32_16x16x32_bf16 v[48:51], v[208:211], a[208:211], v[48:51]
  ds_read_b128 a[200:203], v9 offset:24576
  s_add_u32 s37, s21, 12288
  s_bitcmp1_b32 s21, 0
  v_mfma_f32_16x16x32_bf16 v[48:51], v[232:235], a[212:215], v[48:51]
  ds_read_b128 a[204:207], v10 offset:24576
  s_cselect_b32 s37, s6, s37
  s_cselect_b32 s68, 1, s68
  s_andn2_b32 s21, s21, 1
  v_mfma_f32_16x16x32_bf16 v[52:55], v[212:215], a[208:211], v[52:55]
  ds_read_b128 a[228:231], v1 offset:12288
  v_mfma_f32_16x16x32_bf16 v[52:55], v[236:239], a[212:215], v[52:55]
  ds_read_b128 a[232:235], v2 offset:12288
  v_mfma_f32_16x16x32_bf16 v[56:59], v[216:219], a[208:211], v[56:59]
  ds_read_b128 a[236:239], v3 offset:12288
  v_mfma_f32_16x16x32_bf16 v[56:59], v[240:243], a[212:215], v[56:59]
  s_sub_u32 s32, s32, 1
  v_mfma_f32_16x16x32_bf16 v[60:63], v[220:223], a[208:211], v[60:63]
  v_mfma_f32_16x16x32_bf16 v[60:63], v[244:247], a[212:215], v[60:63]
  s_add_u32 m0, s42, 24576
  v_mfma_f32_16x16x32_bf16 v[64:67], v[224:227], a[208:211], v[64:67]
  s_cbranch_vccz L_sk8
  buffer_load_dwordx4 v1, s[4:7], s21 offen nt lds
  s_add_u32 m0, s42, 28672
  s_nop 0
  buffer_load_dwordx4 v2, s[4:7], s21 offen nt lds
  s_add_u32 m0, s42, 32768
  s_nop 0
  buffer_load_dwordx4 v3, s[4:7], s21 offen nt lds
L_sk8:
  v_mfma_f32_16x16x32_bf16 v[64:67], v[248:251], a[212:215], v[64:67]
  v_mfma_f32_16x16x32_bf16 v[68:71], v[228:231], a[208:211], v[68:71]
  v_mfma_f32_16x16x32_bf16 v[68:71], v[252:255], a[212:215], v[68:71]
  s_branch L_loop0
L_tail1:
  v_mfma_f32_16x16x32_bf16 v[48:51], v[160:163], a[200:203], v[48:51]
  ds_read_b128 a[216:219], v1 offset:24576
  v_mfma_f32_16x16x32_bf16 v[48:51], v[184:187], a[204:207], v[48:51]
  ds_read_b128 a[220:223], v2 offset:24576
  v_mfma_f32_16x16x32_bf16 v[48:51], v[208:211], a[208:211], v[48:51]
  ds_read_b128 a[224:227], v3 offset:24576
  v_mfma_f32_16x16x32_bf16 v[48:51], v[232:235], a[212:215], v[48:51]
  ds_read_b128 a[228:231], v1 offset:36864
  v_mfma_f32_16x16x32_bf16 v[52:55], v[164:167], a[200:203], v[52:55]
  ds_read_b128 a[232:235], v2 offset:36864
  v_mfma_f32_16x16x32_bf16 v[52:55], v[188:191], a[204:207], v[52:55]
  ds_read_b128 a[236:239], v3 offset:36864
  v_mfma_f32_16x16x32_bf16 v[52:55], v[212:215], a[208:211], v[52:55]
  s_waitcnt lgkmcnt(5)
  buffer_store_dwordx4 a[216:219], v4, s[8:11], s22 offen sc1
  v_mfma_f32_16x16x32_bf16 v[52:55], v[236:239], a[212:215], v[52:55]
  v_mfma_f32_16x16x32_bf16 v[56:59], v[168:171], a[200:203], v[56:59]
  s_waitcnt lgkmcnt(4)
  buffer_store_dwordx4 a[220:223], v5, s[8:11], s22 offen sc1
  v_mfma_f32_16x16x32_bf16 v[56:59], v[192:195], a[204:207], v[56:59]
  v_mfma_f32_16x16x32_bf16 v[56:59], v[216:219], a[208:211], v[56:59]
  s_waitcnt lgkmcnt(3)
  buffer_store_dwordx4 a[224:227], v6, s[8:11], s22 offen sc1
  v_mfma_f32_16x16x32_bf16 v[56:59], v[240:243], a[212:215], v[56:59]
  v_mfma_f32_16x16x32_bf16 v[60:63], v[172:175], a[200:203], v[60:63]
  s_waitcnt lgkmcnt(2)
  buffer_store_dwordx4 a[228:231], v4, s[8:11], s23 offen sc1
  v_mfma_f32_16x16x32_bf16 v[60:63], v[196:199], a[204:207], v[60:63]
  v_mfma_f32_16x16x32_bf16 v[60:63], v[220:223], a[208:211], v[60:63]
  s_waitcnt lgkmcnt(1)
  buffer_store_dwordx4 a[232:235], v5, s[8:11], s23 offen sc1
  v_mfma_f32_16x16x32_bf16 v[60:63], v[244:247], a[212:215], v[60:63]
  v_mfma_f32_16x16x32_bf16 v[64:67], v[176:179], a[200:203], v[64:67]
  s_waitcnt lgkmcnt(0)
  buffer_store_dwordx4 a[236:239], v6, s[8:11], s23 offen sc1
  v_mfma_f32_16x16x32_bf16 v[64:67], v[200:203], a[204:207], v[64:67]
  v_cvt_pk_bf16_f32 v48, v48, v49
  v_cvt_pk_bf16_f32 v49, v50, v51
  v_mfma_f32_16x16x32_bf16 v[64:67], v[224:227], a[208:211], v[64:67]
  v_mfma_f32_16x16x32_bf16 v[64:67], v[248:251], a[212:215], v[64:67]
  v_cvt_pk_bf16_f32 v50, v52, v53
  v_cvt_pk_bf16_f32 v51, v54, v55
  v_mfma_f32_16x16x32_bf16 v[68:71], v[180:183], a[200:203], v[68:71]
  ds_write_b128 v11, v[48:51] offset:12288
  v_mfma_f32_16x16x32_bf16 v[68:71], v[204:207], a[204:207], v[68:71]
  v_mfma_f32_16x16x32_bf16 v[68:71], v[228:231], a[208:211], v[68:71]
  v_mfma_f32_16x16x32_bf16 v[68:71], v[252:255], a[212:215], v[68:71]
  s_add_u32 s23, s22, 12288
  v_cvt_pk_bf16_f32 v52, v56, v57
  v_cvt_pk_bf16_f32 v53, v58, v59
  v_cvt_pk_bf16_f32 v54, v60, v61
  v_cvt_pk_bf16_f32 v55, v62, v63
  ds_write_b128 v12, v[52:55] offset:12288
  v_cvt_pk_bf16_f32 v56, v64, v65
  v_cvt_pk_bf16_f32 v57, v66, v67
  v_cvt_pk_bf16_f32 v58, v68, v69
  v_cvt_pk_bf16_f32 v59, v70, v71
  ds_write_b128 v13, v[56:59] offset:12288
  s_waitcnt lgkmcnt(0)
  s_barrier
  ds_read_b128 a[192:195], v1 offset:12288
  ds_read_b128 a[196:199], v2 offset:12288
  ds_read_b128 a[200:203], v3 offset:12288
  s_waitcnt lgkmcnt(2)
  buffer_store_dwordx4 a[192:195], v4, s[8:11], s23 offen sc1
  s_waitcnt lgkmcnt(1)
  buffer_store_dwordx4 a[196:199], v5, s[8:11], s23 offen sc1
  s_waitcnt lgkmcnt(0)
  buffer_store_dwordx4 a[200:203], v6, s[8:11], s23 offen sc1
  s_endpgm
L_tail0:
  v_mfma_f32_16x16x32_bf16 v[48:51], v[160:163], a[200:203], v[48:51]
  ds_read_b128 a[216:219], v1 offset:0
  v_mfma_f32_16x16x32_bf16 v[48:51], v[184:187], a[204:207], v[48:51]
  ds_read_b128 a[220:223], v2 offset:0
  v_mfma_f32_16x16x32_bf16 v[48:51], v[208:211], a[208:211], v[48:51]
  ds_read_b128 a[224:227], v3 offset:0
  v_mfma_f32_16x16x32_bf16 v[48:51], v[232:235], a[212:215], v[48:51]
  ds_read_b128 a[228:231], v1 offset:12288
  v_mfma_f32_16x16x32_bf16 v[52:55], v[164:167], a[200:203], v[52:55]
  ds_read_b128 a[232:235], v2 offset:12288
  v_mfma_f32_16x16x32_bf16 v[52:55], v[188:191], a[204:207], v[52:55]
  ds_read_b128 a[236:239], v3 offset:12288
  v_mfma_f32_16x16x32_bf16 v[52:55], v[212:215], a[208:211], v[52:55]
  s_waitcnt lgkmcnt(5)
  buffer_store_dwordx4 a[216:219], v4, s[8:11], s22 offen sc1
  v_mfma_f32_16x16x32_bf16 v[52:55], v[236:239], a[212:215], v[52:55]
  v_mfma_f32_16x16x32_bf16 v[56:59], v[168:171], a[200:203], v[56:59]
  s_waitcnt lgkmcnt(4)
  buffer_store_dwordx4 a[220:223], v5, s[8:11], s22 offen sc1
  v_mfma_f32_16x16x32_bf16 v[56:59], v[192:195], a[204:207], v[56:59]
  v_mfma_f32_16x16x32_bf16 v[56:59], v[216:219], a[208:211], v[56:59]
  s_waitcnt lgkmcnt(3)
  buffer_store_dwordx4 a[224:227], v6, s[8:11], s22 offen sc1
  v_mfma_f32_16x16x32_bf16 v[56:59], v[240:243], a[212:215], v[56:59]
  v_mfma_f32_16x16x32_bf16 v[60:63], v[172:175], a[200:203], v[60:63]
  s_waitcnt lgkmcnt(2)
  buffer_store_dwordx4 a[228:231], v4, s[8:11], s23 offen sc1
  v_mfma_f32_16x16x32_bf16 v[60:63], v[196:199], a[204:207], v[60:63]
  v_mfma_f32_16x16x32_bf16 v[60:63], v[220:223], a[208:211], v[60:63]
  s_waitcnt lgkmcnt(1)
  buffer_store_dwordx4 a[232:235], v5, s[8:11], s23 offen sc1
  v_mfma_f32_16x16x32_bf16 v[60:63], v[244:247], a[212:215], v[60:63]
  v_mfma_f32_16x16x32_bf16 v[64:67], v[176:179], a[200:203], v[64:67]
  s_waitcnt lgkmcnt(0)
  buffer_store_dwordx4 a[236:239], v6, s[8:11], s23 offen sc1
  v_mfma_f32_16x16x32_bf16 v[64:67], v[200:203], a[204:207], v[64:67]
  v_cvt_pk_bf16_f32 v48, v48, v49
  v_cvt_pk_bf16_f32 v49, v50, v51
  v_mfma_f32_16x16x32_bf16 v[64:67], v[224:227], a[208:211], v[64:67]
  v_mfma_f32_16x16x32_bf16 v[64:67], v[248:251], a[212:215], v[64:67]
  v_cvt_pk_bf16_f32 v50, v52, v53
  v_cvt_pk_bf16_f32 v51, v54, v55
  v_mfma_f32_16x16x32_bf16 v[68:71], v[180:183], a[200:203], v[68:71]
  ds_write_b128 v11, v[48:51] offset:36864
  v_mfma_f32_16x16x32_bf16 v[68:71], v[204:207], a[204:207], v[68:71]
  v_mfma_f32_16x16x32_bf16 v[68:71], v[228:231], a[208:211], v[68:71]
  v_mfma_f32_16x16x32_bf16 v[68:71], v[252:255], a[212:215], v[68:71]
  s_add_u32 s23, s22, 12288
  v_cvt_pk_bf16_f32 v52, v56, v57
  v_cvt_pk_bf16_f32 v53, v58, v59
  v_cvt_pk_bf16_f32 v54, v60, v61
  v_cvt_pk_bf16_f32 v55, v62, v63
  ds_write_b128 v12, v[52:55] offset:36864
  v_cvt_pk_bf16_f32 v56, v64, v65
  v_cvt_pk_bf16_f32 v57, v66, v67
  v_cvt_pk_bf16_f32 v58, v68, v69
  v_cvt_pk_bf16_f32 v59, v70, v71
  ds_write_b128 v13, v[56:59] offset:36864
  s_waitcnt lgkmcnt(0)
  s_barrier
  ds_read_b128 a[192:195], v1 offset:36864
  ds_read_b128 a[196:199], v2 offset:36864
  ds_read_b128 a[200:203], v3 offset:36864
  s_waitcnt lgkmcnt(2)
  buffer_store_dwordx4 a[192:195], v4, s[8:11], s23 offen sc1
  s_waitcnt lgkmcnt(1)
  buffer_store_dwordx4 a[196:199], v5, s[8:11], s23 offen sc1
  s_waitcnt lgkmcnt(0)
  buffer_store_dwordx4 a[200:203], v6, s[8:11], s23 offen sc1
  s_endpgm
L_half0:
  s_nop 1
  v_cvt_pk_bf16_f32 v24, v24, v25
  v_cvt_pk_bf16_f32 v25, v26, v27
  v_cvt_pk_bf16_f32 v26, v28, v29
  v_cvt_pk_bf16_f32 v27, v30, v31
  ds_write_b128 v11, v[24:27] offset:0
  v_cvt_pk_bf16_f32 v28, v32, v33
  v_cvt_pk_bf16_f32 v29, v34, v35
  v_cvt_pk_bf16_f32 v30, v36, v37
  v_cvt_pk_bf16_f32 v31, v38, v39
  ds_write_b128 v12, v[28:31] offset:0
  v_cvt_pk_bf16_f32 v32, v40, v41
  v_cvt_pk_bf16_f32 v33, v42, v43
  v_cvt_pk_bf16_f32 v34, v44, v45
  v_cvt_pk_bf16_f32 v35, v46, v47
  ds_write_b128 v13, v[32:35] offset:0
  buffer_store_dwordx4 a[228:231], v4, s[8:11], s23 offen sc1
  buffer_store_dwordx4 a[232:235], v5, s[8:11], s23 offen sc1
  buffer_store_dwordx4 a[236:239], v6, s[8:11], s23 offen sc1
  s_add_u32 s23, s22, 12288
  s_mov_b32 s22, s58
  s_waitcnt lgkmcnt(0)
  s_barrier
  ds_read_b128 a[216:219], v1 offset:0
  ds_read_b128 a[220:223], v2 offset:0
  ds_read_b128 a[224:227], v3 offset:0
  ds_read_b128 a[228:231], v1 offset:12288
  ds_read_b128 a[232:235], v2 offset:12288
  ds_read_b128 a[236:239], v3 offset:12288
  s_waitcnt lgkmcnt(5)
  buffer_store_dwordx4 a[216:219], v4, s[8:11], s22 offen sc1
  s_waitcnt lgkmcnt(4)
  buffer_store_dwordx4 a[220:223], v5, s[8:11], s22 offen sc1
  s_waitcnt lgkmcnt(3)
  buffer_store_dwordx4 a[224:227], v6, s[8:11], s22 offen sc1
  s_waitcnt lgkmcnt(2)
  buffer_store_dwordx4 a[228:231], v4, s[8:11], s23 offen sc1
  s_waitcnt lgkmcnt(1)
  buffer_store_dwordx4 a[232:235], v5, s[8:11], s23 offen sc1
  s_waitcnt lgkmcnt(0)
  buffer_store_dwordx4 a[236:239], v6, s[8:11], s23 offen sc1
  s_endpgm
L_half1:
  s_nop 1
  v_cvt_pk_bf16_f32 v24, v24, v25
  v_cvt_pk_bf16_f32 v25, v26, v27
  v_cvt_pk_bf16_f32 v26, v28, v29
  v_cvt_pk_bf16_f32 v27, v30, v31
  ds_write_b128 v11, v[24:27] offset:24576
  v_cvt_pk_bf16_f32 v28, v32, v33
  v_cvt_pk_bf16_f32 v29, v34, v35
  v_cvt_pk_bf16_f32 v30, v36, v37
  v_cvt_pk_bf16_f32 v31, v38, v39
  ds_write_b128 v12, v[28:31] offset:24576
  v_cvt_pk_bf16_f32 v32, v40, v41
  v_cvt_pk_bf16_f32 v33, v42, v43
  v_cvt_pk_bf16_f32 v34, v44, v45
  v_cvt_pk_bf16_f32 v35, v46, v47
  ds_write_b128 v13, v[32:35] offset:24576
  buffer_store_dwordx4 a[228:231], v4, s[8:11], s23 offen sc1
  buffer_store_dwordx4 a[232:235], v5, s[8:11], s23 offen sc1
  buffer_store_dwordx4 a[236:239], v6, s[8:11], s23 offen sc1
  s_add_u32 s23, s22, 12288
  s_mov_b32 s22, s58
  s_waitcnt lgkmcnt(0)
  s_barrier
  ds_read_b128 a[216:219], v1 offset:24576
  ds_read_b128 a[220:223], v2 offset:24576
  ds_read_b128 a[224:227], v3 offset:24576
  ds_read_b128 a[228:231], v1 offset:36864
  ds_read_b128 a[232:235], v2 offset:36864
  ds_read_b128 a[236:239], v3 offset:36864
  s_waitcnt lgkmcnt(5)
  buffer_store_dwordx4 a[216:219], v4, s[8:11], s22 offen sc1
  s_waitcnt lgkmcnt(4)
  buffer_store_dwordx4 a[220:223], v5, s[8:11], s22 offen sc1
  s_waitcnt lgkmcnt(3)
  buffer_store_dwordx4 a[224:227], v6, s[8:11], s22 offen sc1
  s_waitcnt lgkmcnt(2)
  buffer_store_dwordx4 a[228:231], v4, s[8:11], s23 offen sc1
  s_waitcnt lgkmcnt(1)
  buffer_store_dwordx4 a[232:235], v5, s[8:11], s23 offen sc1
  s_waitcnt lgkmcnt(0)
  buffer_store_dwordx4 a[236:239], v6, s[8:11], s23 offen sc1
  s_endpgm
L_ow2:
  s_cmp_eq_u32 s32, 1
  s_cbranch_scc1 L_ob2
  s_waitcnt vmcnt(9)
  s_branch L_ob2
L_ow6:
  s_cmp_eq_u32 s32, 1
  s_cbranch_scc1 L_ob6
  s_waitcnt vmcnt(9)
  s_branch L_ob6
L_done:
  s_endpgm
.section .rodata,"a"
.p2align 6
.amdhsa_kernel standalone__depthwise_separable__vision_kernel
  .amdhsa_next_free_vgpr 512
  .amdhsa_next_free_sgpr 100
  .amdhsa_accum_offset 256
  .amdhsa_group_segment_fixed_size 0
  .amdhsa_kernarg_size 48
  .amdhsa_user_sgpr_count 2
  .amdhsa_user_sgpr_kernarg_segment_ptr 1
  .amdhsa_system_sgpr_workgroup_id_x 1
  .amdhsa_float_denorm_mode_32 3
.end_amdhsa_kernel
```
